```python
import torch

def _softmax(x, axis=-1):
    return torch.softmax(x, dim=axis)
def _gelu(x):
    return torch.nn.functional.gelu(x, approximate="tanh")
def _silu(x):
    return torch.nn.functional.silu(x)
def _sigmoid(x):
    return torch.sigmoid(x)
def _layernorm(x, axis=-1, eps=1e-5):
    m = x.mean(dim=axis, keepdim=True)
    v = x.var(dim=axis, keepdim=True, unbiased=False)
    return (x - m) / torch.sqrt(v + eps)
def _scatter_add(tgt, idx, src, axis=0):
    return tgt.clone().index_add_(axis, idx, src)
def _segment_sum(src, seg, n):
    out = torch.zeros((n,) + src.shape[1:], dtype=src.dtype)
    return out.index_add_(0, seg, src)
def _pad(x, pw):
    flat = tuple(v for pair in reversed(pw) for v in pair)
    return torch.nn.functional.pad(x, flat)

kernel_name = 'standalone__mha_block_cached__near_ridge'

def setup_inputs():

    _w = (lambda a: (lambda t: t.to(torch.bfloat16) if t.is_floating_point() else t)(torch.as_tensor(a)))
    B, Sq, D = 8, 304, 512
    H, Sk, Dh = 32, 1024, 128
    return {
        "x": _w((lambda *s: torch.randn(*s, dtype=torch.bfloat16) * 0.8)(B, Sq, D)),
        "k_cache": _w((lambda *s: torch.randn(*s, dtype=torch.bfloat16) * 0.8)(B, H, Sk, Dh)),
        "v_cache": _w((lambda *s: torch.randn(*s, dtype=torch.bfloat16) * 0.05)(B, H, Sk, Dh)),
        "wq": _w((lambda *s: torch.randn(*s, dtype=torch.bfloat16) * 0.8)(D, H * Dh) * (D ** -0.5)),
        "wo": _w((lambda *s: torch.randn(*s, dtype=torch.bfloat16) * 0.05)(H * Dh, D) * ((H * Dh) ** -0.5)),
    }

def reference(x, k_cache, v_cache, wq, wo):
    B, Sq, D = x.shape
    H, Dh = 32, 128
    q = (lambda x, *d: x.permute(*d))((x @ wq).reshape(B, Sq, H, Dh), 0, 2, 1, 3)
    scores = torch.einsum("bhqd,bhkd->bhqk", q, k_cache) * (Dh ** -0.5)
    p = _softmax(scores, axis=-1)
    o = torch.einsum("bhqk,bhkd->bhqd", p, v_cache)
    return (lambda x, *d: x.permute(*d))(o, 0, 2, 1, 3).reshape(B, Sq, H * Dh) @ wo
```

```asm
; @launch grid=(256,1,1) block=(256,1,1) lds=163840
.amdgcn_target "amdgcn-amd-amdhsa--gfx950"
.text
.globl standalone__mha_block_cached__near_ridge_kernel
.p2align 8
.type standalone__mha_block_cached__near_ridge_kernel,@function
standalone__mha_block_cached__near_ridge_kernel:
    s_cmp_ge_u32 s2, 256
    s_cbranch_scc1 L_end
    s_load_dwordx16 s[36:51], s[0:1], 0
    v_lshrrev_b32 v243, 6, v0
    v_and_b32 v237, 63, v0
    v_readfirstlane_b32 s24, v243
    s_mov_b32 s85, 0
L_restart:
    v_lshrrev_b32 v239, 4, v237
    s_and_b32 s31, s2, 7
    s_lshr_b32 s32, s2, 3
    s_and_b32 s25, s31, 3
    s_lshl_b32 s25, s25, 1
    s_and_b32 s27, s32, 1
    s_add_u32 s25, s25, s27
    s_lshr_b32 s26, s31, 2
    s_lshl_b32 s26, s26, 4
    s_lshr_b32 s28, s32, 1
    s_add_u32 s26, s26, s28
    s_lshl_b32 s33, s27, 2
    s_add_u32 s33, s33, s28
    s_mov_b32 s33, s28
    v_and_b32 v240, 15, v237
    v_lshlrev_b32 v243, 1, v239
    v_xor_b32 v243, v243, v240
    v_lshlrev_b32 v244, 13, v239
    v_lshl_add_u32 v225, v243, 4, v244
    v_xor_b32 v226, 0x80, v225
    s_lshr_b32 s27, s24, 1
    s_lshl_b32 s27, s27, 7
    v_xor_b32 v250, s27, v225
    v_and_b32 v243, 7, v237
    v_xor_b32 v243, v243, v239
    v_lshrrev_b32 v244, 3, v237
    v_lshlrev_b32 v244, 10, v244
    v_lshl_add_u32 v223, v243, 4, v244
    v_xor_b32 v224, 64, v223
    s_mul_i32 s28, s24, 81920
    s_lshl_b32 s34, s24, 12
    s_lshl_b32 s52, s24, 10
    s_mul_i32 s35, s24, 10240
    s_add_u32 s35, s35, 32768
    s_add_u32 s27, s33, 0
    s_and_b32 s27, s27, 7
    s_lshl_b32 s94, s27, 19
    s_lshl_b32 s27, s27, 7
    s_add_u32 s86, s28, s27
    s_lshl_b32 s53, s24, 15
    s_add_u32 s29, s53, s94
    s_waitcnt lgkmcnt(0)
    s_mov_b32 s0, s31
    s_mov_b32 s1, s32
    s_lshl_b32 s27, s26, 8
    s_add_u32 s8, s42, s27
    s_addc_u32 s9, s43, 0
    s_mov_b32 s10, 0x3fe100
    s_mov_b32 s11, 0x20000
    s_add_u32 m0, s52, 114688
    s_add_u32 s27, s29, 0
    buffer_load_dwordx4 v250, s[8:11], s27 offen lds
    s_add_u32 m0, s52, 118784
    s_add_u32 s27, s29, 131072
    buffer_load_dwordx4 v250, s[8:11], s27 offen lds
    s_add_u32 m0, s52, 122880
    s_add_u32 s27, s29, 262144
    buffer_load_dwordx4 v250, s[8:11], s27 offen lds
    s_add_u32 m0, s52, 126976
    s_add_u32 s27, s29, 393216
    buffer_load_dwordx4 v250, s[8:11], s27 offen lds
    s_mul_i32 s27, s25, 311296
    s_add_u32 s4, s36, s27
    s_addc_u32 s5, s37, 0
    s_mov_b32 s6, 311296
    s_mov_b32 s7, 0x20000
    v_mov_b32 v247, 0x7ffffff0
    v_lshlrev_b32 v246, 7, v237
    s_add_u32 m0, s35, 0
    s_add_u32 s27, s86, 0
    buffer_load_dwordx4 v223, s[4:7], s27 offen lds
    s_add_u32 s27, s86, 7168
    buffer_load_dwordx4 v224, s[4:7], s27 offen offset:1024 lds
    s_add_u32 s27, s86, 14336
    buffer_load_dwordx4 v223, s[4:7], s27 offen offset:2048 lds
    s_add_u32 s27, s86, 21504
    buffer_load_dwordx4 v224, s[4:7], s27 offen offset:3072 lds
    s_getpc_b64 s[20:21]
    s_and_b32 s20, s20, 0xffffff00
    s_mov_b32 s22, 0x14a20
    s_mov_b32 s23, 0x20000
    v_cmp_gt_u32 vcc, 6, v237
    s_lshl_b32 s31, s1, 2
    s_add_u32 s31, s31, s24
    s_mul_i32 s31, s31, 768
    v_cndmask_b32 v249, v247, v246, vcc
    buffer_load_dword v252, v249, s[20:23], s31 offen
    s_add_u32 s27, s33, 1
    s_and_b32 s27, s27, 7
    s_lshl_b32 s95, s27, 19
    s_lshl_b32 s27, s27, 7
    s_add_u32 s87, s28, s27
    s_add_u32 s27, s33, 2
    s_and_b32 s27, s27, 7
    s_lshl_b32 s96, s27, 19
    s_lshl_b32 s27, s27, 7
    s_add_u32 s88, s28, s27
    s_add_u32 s27, s33, 3
    s_and_b32 s27, s27, 7
    s_lshl_b32 s97, s27, 19
    s_lshl_b32 s27, s27, 7
    s_add_u32 s89, s28, s27
    s_add_u32 s27, s33, 4
    s_and_b32 s27, s27, 7
    s_lshl_b32 s98, s27, 19
    s_lshl_b32 s27, s27, 7
    s_add_u32 s90, s28, s27
    s_add_u32 s27, s33, 5
    s_and_b32 s27, s27, 7
    s_lshl_b32 s99, s27, 19
    s_lshl_b32 s27, s27, 7
    s_add_u32 s91, s28, s27
    s_add_u32 s27, s33, 6
    s_and_b32 s27, s27, 7
    s_lshl_b32 s100, s27, 19
    s_lshl_b32 s27, s27, 7
    s_add_u32 s92, s28, s27
    s_add_u32 s27, s33, 7
    s_and_b32 s27, s27, 7
    s_lshl_b32 s101, s27, 19
    s_lshl_b32 s27, s27, 7
    s_add_u32 s93, s28, s27
    v_cmp_eq_u32 vcc, 0, v237
    v_lshlrev_b32 v238, 4, v237
    v_lshrrev_b32 v241, 2, v240
    v_and_b32 v242, 3, v237
    v_cndmask_b32 v253, v247, v237, vcc
    s_lshl_b32 s27, s25, 5
    s_add_u32 s27, s27, s26
    s_lshl_b32 s27, s27, 18
    s_add_u32 s12, s38, s27
    s_addc_u32 s13, s39, 0
    s_mov_b32 s14, 262144
    s_mov_b32 s15, 0x20000
    s_add_u32 s16, s40, s27
    s_addc_u32 s17, s41, 0
    s_mov_b32 s18, 262144
    s_mov_b32 s19, 0x20000
    s_mul_i32 s30, s25, 5
    s_add_u32 s30, s30, s26
    s_lshl_b32 s30, s30, 14
    s_mov_b32 s3, s30
    s_mov_b32 s33, 0x3e0293ee
    s_bfe_u32 s55, s1, 0x10003
    s_lshl_b32 s55, s55, 1
    s_lshr_b32 s27, s0, 2
    s_add_u32 s55, s55, s27
    s_add_u32 s54, s1, 0
    s_and_b32 s54, s54, 7
    s_lshl_b32 s27, s0, 7
    s_add_u32 s56, s44, s27
    s_addc_u32 s57, s45, 0
    s_mov_b32 s58, 4193408
    s_mov_b32 s59, 0x20000
    v_lshlrev_b32 v244, 8, v239
    v_xor_b32 v243, v240, v239
    v_lshl_add_u32 v217, v243, 4, v244
    v_xor_b32 v218, 0x40, v217
    v_xor_b32 v219, 0x80, v217
    v_xor_b32 v220, 0xc0, v217
    v_lshlrev_b32 v243, 1, v239
    v_xor_b32 v246, v243, v240
    v_lshl_add_u32 v221, v246, 4, v244
    v_xor_b32 v222, 0x80, v221
    v_and_b32 v244, 7, v237
    v_xor_b32 v243, v243, v244
    v_lshrrev_b32 v244, 3, v237
    v_lshlrev_b32 v244, 10, v244
    v_lshl_add_u32 v251, v243, 4, v244
    v_lshrrev_b32 v243, 1, v240
    v_xor_b32 v243, v243, v239
    v_lshlrev_b32 v244, 7, v240
    v_add_u32 v244, s35, v244
    v_lshl_add_u32 v227, v243, 4, v244
    v_xor_b32 v228, 64, v227
    v_and_b32 v245, 1, v239
    v_lshl_add_u32 v245, v245, 2, v241
    v_lshlrev_b32 v246, 3, v242
    v_lshl_add_u32 v246, v245, 5, v246
    v_lshl_add_u32 v244, v239, 3, v241
    v_lshl_add_u32 v244, v244, 8, v246
    v_add_u32 v229, 0x1c000, v244
    v_xor_b32 v230, 0x20, v229
    v_xor_b32 v231, 0x40, v229
    v_xor_b32 v232, 0x60, v229
    v_xor_b32 v233, 0x80, v229
    v_xor_b32 v234, 0xa0, v229
    v_xor_b32 v235, 0xc0, v229
    v_xor_b32 v236, 0xe0, v229
    v_lshl_add_u32 v244, v239, 2, v241
    v_lshl_add_u32 v244, v244, 8, v246
    v_add_u32 v209, 0x10000, v244
    v_xor_b32 v210, 0x20, v209
    v_xor_b32 v211, 0x40, v209
    v_xor_b32 v212, 0x60, v209
    v_xor_b32 v213, 0x80, v209
    v_xor_b32 v214, 0xa0, v209
    v_xor_b32 v215, 0xc0, v209
    v_xor_b32 v216, 0xe0, v209
    v_lshrrev_b32 v246, 1, v239
    v_and_b32 v243, 1, v239
    v_lshl_add_u32 v246, v243, 1, v246
    v_xor_b32 v246, v246, v240
    v_lshlrev_b32 v244, 8, v240
    v_lshl_add_u32 v205, v246, 4, v244
    v_xor_b32 v206, 0x40, v205
    v_xor_b32 v207, 0x80, v205
    v_xor_b32 v208, 0xc0, v205
    s_add_u32 m0, s35, 4096
    s_add_u32 s27, s86, 32768
    buffer_load_dwordx4 v223, s[4:7], s27 offen lds
    s_add_u32 s27, s86, 39936
    buffer_load_dwordx4 v224, s[4:7], s27 offen offset:1024 lds
    s_add_u32 s27, s86, 47104
    buffer_load_dwordx4 v223, s[4:7], s27 offen offset:2048 lds
    s_add_u32 s27, s86, 54272
    buffer_load_dwordx4 v224, s[4:7], s27 offen offset:3072 lds
    s_add_u32 m0, s35, 8192
    s_add_u32 s27, s86, 65536
    buffer_load_dwordx4 v223, s[4:7], s27 offen lds
    s_add_u32 s27, s86, 72704
    buffer_load_dwordx4 v224, s[4:7], s27 offen offset:1024 lds
    s_add_u32 s29, s53, s95
    s_add_u32 m0, s52, 131072
    s_add_u32 s27, s29, 0
    buffer_load_dwordx4 v250, s[8:11], s27 offen lds
    s_add_u32 m0, s52, 135168
    s_add_u32 s27, s29, 131072
    buffer_load_dwordx4 v250, s[8:11], s27 offen lds
    s_add_u32 m0, s52, 139264
    s_add_u32 s27, s29, 262144
    buffer_load_dwordx4 v250, s[8:11], s27 offen lds
    s_add_u32 m0, s52, 143360
    s_add_u32 s27, s29, 393216
    buffer_load_dwordx4 v250, s[8:11], s27 offen lds
    s_add_u32 s60, s50, 0x2000000
    s_addc_u32 s61, s51, 0
    s_mov_b32 s62, 81920
    s_mov_b32 s63, 0x20000
    s_lshr_b32 s27, s24, 1
    s_lshl_b32 s53, s25, 1
    s_add_u32 s53, s53, s27
    s_lshl_b32 s53, s53, 3
    s_lshr_b32 s27, s26, 2
    s_add_u32 s53, s53, s27
    s_lshl_b32 s53, s53, 3
    s_and_b32 s27, s24, 1
    s_add_u32 s53, s53, s27
    s_lshl_b32 s53, s53, 2
    s_and_b32 s27, s26, 3
    s_add_u32 s53, s53, s27
    s_lshl_b32 s53, s53, 2
    v_mov_b32 v254, 0
    buffer_store_dword v254, v253, s[60:63], s53 offen sc0 sc1
    s_lshl_b32 s27, s2, 2
    s_add_u32 s27, s27, s24
    s_lshl_b32 s27, s27, 6
    s_add_u32 s27, s27, 16384
    buffer_store_dword v254, v253, s[60:63], s27 offen sc0 sc1
    s_cmp_eq_u32 s24, 3
    s_cbranch_scc1 L_varB
    v_and_b32 v255, 7, v237
    v_lshlrev_b32 v255, 5, v255
    v_mov_b32 v254, 1
    s_and_b32 s28, s1, 16
    s_lshl_b32 s32, s24, 2
    s_add_u32 s28, s28, s32
    s_bfe_u32 s32, s1, 0x20001
    s_add_u32 s28, s28, s32
    s_lshl_b32 s28, s28, 1
    s_bfe_u32 s32, s1, 0x10003
    s_add_u32 s28, s28, s32
    s_lshl_b32 s28, s28, 1
    s_and_b32 s32, s1, 1
    s_add_u32 s28, s28, s32
    s_lshl_b32 s28, s28, 15
    s_add_u32 m0, s35, 40960
    s_add_u32 s27, s87, 0
    buffer_load_dwordx4 v223, s[4:7], s27 offen lds
    s_add_u32 s27, s87, 7168
    buffer_load_dwordx4 v224, s[4:7], s27 offen offset:1024 lds
    s_add_u32 s27, s87, 14336
    buffer_load_dwordx4 v223, s[4:7], s27 offen offset:2048 lds
    s_add_u32 s27, s87, 21504
    buffer_load_dwordx4 v224, s[4:7], s27 offen offset:3072 lds
    s_add_u32 m0, s35, 45056
    s_add_u32 s27, s87, 32768
    buffer_load_dwordx4 v223, s[4:7], s27 offen lds
    s_add_u32 s27, s87, 39936
    buffer_load_dwordx4 v224, s[4:7], s27 offen offset:1024 lds
    s_add_u32 s27, s87, 47104
    buffer_load_dwordx4 v223, s[4:7], s27 offen offset:2048 lds
    s_add_u32 s27, s87, 54272
    buffer_load_dwordx4 v224, s[4:7], s27 offen offset:3072 lds
    s_add_u32 m0, s35, 49152
    s_add_u32 s27, s87, 65536
    buffer_load_dwordx4 v223, s[4:7], s27 offen lds
    s_add_u32 s27, s87, 72704
    buffer_load_dwordx4 v224, s[4:7], s27 offen offset:1024 lds
    s_waitcnt vmcnt(16)
    s_barrier
    ds_read_b64_tr_b16 a[240:241], v229 offset:0
    ds_read_b64_tr_b16 a[242:243], v229 offset:1024
    ds_read_b64_tr_b16 a[244:245], v229 offset:8192
    ds_read_b64_tr_b16 a[246:247], v229 offset:9216
    ds_read_b128 a[160:163], v227 offset:0
    ds_read_b128 a[164:167], v228 offset:0
    ds_read_b128 a[168:171], v227 offset:2048
    ds_read_b128 a[172:175], v228 offset:2048
    ds_read_b128 a[176:179], v227 offset:4096
    ds_read_b128 a[180:183], v228 offset:4096
    ds_read_b128 a[184:187], v227 offset:6144
    ds_read_b128 a[188:191], v228 offset:6144
    ds_read_b128 a[192:195], v227 offset:8192
    ds_read_b128 a[196:199], v228 offset:8192
    s_waitcnt lgkmcnt(9)
    v_mfma_f32_16x16x32_bf16 v[0:3], a[240:243], a[160:163], 0
    s_waitcnt lgkmcnt(8)
    ds_read_b64_tr_b16 a[248:249], v230 offset:0
    v_mfma_f32_16x16x32_bf16 v[0:3], a[244:247], a[164:167], v[0:3]
    s_waitcnt lgkmcnt(7)
    ds_read_b64_tr_b16 a[250:251], v230 offset:1024
    v_mfma_f32_16x16x32_bf16 v[32:35], a[244:247], a[172:175], 0
    ds_read_b64_tr_b16 a[252:253], v230 offset:8192
    v_mfma_f32_16x16x32_bf16 v[32:35], a[240:243], a[168:171], v[32:35]
    s_waitcnt lgkmcnt(8)
    ds_read_b64_tr_b16 a[254:255], v230 offset:9216
    v_mfma_f32_16x16x32_bf16 v[64:67], a[240:243], a[176:179], 0
    s_waitcnt lgkmcnt(8)
    v_mfma_f32_16x16x32_bf16 v[64:67], a[244:247], a[180:183], v[64:67]
    s_waitcnt lgkmcnt(6)
    v_mfma_f32_16x16x32_bf16 v[96:99], a[244:247], a[188:191], 0
    v_mfma_f32_16x16x32_bf16 v[96:99], a[240:243], a[184:187], v[96:99]
    s_waitcnt lgkmcnt(5)
    v_mfma_f32_16x16x32_bf16 v[128:131], a[240:243], a[192:195], 0
    s_waitcnt lgkmcnt(4)
    v_mfma_f32_16x16x32_bf16 v[128:131], a[244:247], a[196:199], v[128:131]
    s_waitcnt lgkmcnt(2)
    v_mfma_f32_16x16x32_bf16 v[4:7], a[248:251], a[160:163], 0
    s_waitcnt lgkmcnt(0)
    ds_read_b64_tr_b16 a[240:241], v231 offset:0
    v_mfma_f32_16x16x32_bf16 v[4:7], a[252:255], a[164:167], v[4:7]
    s_add_u32 m0, s35, 0
    ds_read_b64_tr_b16 a[242:243], v231 offset:1024
    v_mfma_f32_16x16x32_bf16 v[36:39], a[252:255], a[172:175], 0
    s_add_u32 s27, s88, 0
    ds_read_b64_tr_b16 a[244:245], v231 offset:8192
    buffer_load_dwordx4 v223, s[4:7], s27 offen lds
    v_mfma_f32_16x16x32_bf16 v[36:39], a[248:251], a[168:171], v[36:39]
    ds_read_b64_tr_b16 a[246:247], v231 offset:9216
    v_mfma_f32_16x16x32_bf16 v[68:71], a[248:251], a[176:179], 0
    v_mfma_f32_16x16x32_bf16 v[68:71], a[252:255], a[180:183], v[68:71]
    v_mfma_f32_16x16x32_bf16 v[100:103], a[252:255], a[188:191], 0
    v_mfma_f32_16x16x32_bf16 v[100:103], a[248:251], a[184:187], v[100:103]
    v_mfma_f32_16x16x32_bf16 v[132:135], a[248:251], a[192:195], 0
    v_mfma_f32_16x16x32_bf16 v[132:135], a[252:255], a[196:199], v[132:135]
    s_waitcnt lgkmcnt(2)
    s_add_u32 s27, s88, 7168
    buffer_load_dwordx4 v224, s[4:7], s27 offen offset:1024 lds
    v_mfma_f32_16x16x32_bf16 v[8:11], a[240:243], a[160:163], 0
    s_waitcnt lgkmcnt(0)
    ds_read_b64_tr_b16 a[248:249], v232 offset:0
    v_mfma_f32_16x16x32_bf16 v[8:11], a[244:247], a[164:167], v[8:11]
    ds_read_b64_tr_b16 a[250:251], v232 offset:1024
    v_mfma_f32_16x16x32_bf16 v[40:43], a[244:247], a[172:175], 0
    ds_read_b64_tr_b16 a[252:253], v232 offset:8192
    v_mfma_f32_16x16x32_bf16 v[40:43], a[240:243], a[168:171], v[40:43]
    ds_read_b64_tr_b16 a[254:255], v232 offset:9216
    v_mfma_f32_16x16x32_bf16 v[72:75], a[240:243], a[176:179], 0
    v_mfma_f32_16x16x32_bf16 v[72:75], a[244:247], a[180:183], v[72:75]
    v_mfma_f32_16x16x32_bf16 v[104:107], a[244:247], a[188:191], 0
    s_add_u32 s27, s88, 14336
    buffer_load_dwordx4 v223, s[4:7], s27 offen offset:2048 lds
    v_mfma_f32_16x16x32_bf16 v[104:107], a[240:243], a[184:187], v[104:107]
    v_mfma_f32_16x16x32_bf16 v[136:139], a[240:243], a[192:195], 0
    v_mfma_f32_16x16x32_bf16 v[136:139], a[244:247], a[196:199], v[136:139]
    s_waitcnt lgkmcnt(2)
    v_mfma_f32_16x16x32_bf16 v[12:15], a[248:251], a[160:163], 0
    s_waitcnt lgkmcnt(0)
    ds_read_b64_tr_b16 a[240:241], v233 offset:0
    v_mfma_f32_16x16x32_bf16 v[12:15], a[252:255], a[164:167], v[12:15]
    ds_read_b64_tr_b16 a[242:243], v233 offset:1024
    v_mfma_f32_16x16x32_bf16 v[44:47], a[252:255], a[172:175], 0
    ds_read_b64_tr_b16 a[244:245], v233 offset:8192
    v_mfma_f32_16x16x32_bf16 v[44:47], a[248:251], a[168:171], v[44:47]
    ds_read_b64_tr_b16 a[246:247], v233 offset:9216
    v_mfma_f32_16x16x32_bf16 v[76:79], a[248:251], a[176:179], 0
    s_add_u32 s27, s88, 21504
    buffer_load_dwordx4 v224, s[4:7], s27 offen offset:3072 lds
    v_mfma_f32_16x16x32_bf16 v[76:79], a[252:255], a[180:183], v[76:79]
    v_mfma_f32_16x16x32_bf16 v[108:111], a[252:255], a[188:191], 0
    v_mfma_f32_16x16x32_bf16 v[108:111], a[248:251], a[184:187], v[108:111]
    v_mfma_f32_16x16x32_bf16 v[140:143], a[248:251], a[192:195], 0
    v_mfma_f32_16x16x32_bf16 v[140:143], a[252:255], a[196:199], v[140:143]
    s_waitcnt lgkmcnt(2)
    v_mfma_f32_16x16x32_bf16 v[16:19], a[240:243], a[160:163], 0
    s_waitcnt lgkmcnt(0)
    s_add_u32 m0, s35, 4096
    ds_read_b64_tr_b16 a[248:249], v234 offset:0
    v_mfma_f32_16x16x32_bf16 v[16:19], a[244:247], a[164:167], v[16:19]
    s_add_u32 s27, s88, 32768
    ds_read_b64_tr_b16 a[250:251], v234 offset:1024
    buffer_load_dwordx4 v223, s[4:7], s27 offen lds
    v_mfma_f32_16x16x32_bf16 v[48:51], a[244:247], a[172:175], 0
    ds_read_b64_tr_b16 a[252:253], v234 offset:8192
    v_mfma_f32_16x16x32_bf16 v[48:51], a[240:243], a[168:171], v[48:51]
    s_waitcnt vmcnt(5)
    ds_read_b64_tr_b16 a[254:255], v234 offset:9216
    v_mfma_f32_16x16x32_bf16 v[80:83], a[240:243], a[176:179], 0
    ds_read_b128 a[200:203], v227 offset:40960
    v_mfma_f32_16x16x32_bf16 v[80:83], a[244:247], a[180:183], v[80:83]
    ds_read_b128 a[204:207], v228 offset:40960
    v_mfma_f32_16x16x32_bf16 v[112:115], a[244:247], a[188:191], 0
    ds_read_b128 a[208:211], v227 offset:43008
    v_mfma_f32_16x16x32_bf16 v[112:115], a[240:243], a[184:187], v[112:115]
    ds_read_b128 a[212:215], v228 offset:43008
    v_mfma_f32_16x16x32_bf16 v[144:147], a[240:243], a[192:195], 0
    s_add_u32 s27, s88, 39936
    buffer_load_dwordx4 v224, s[4:7], s27 offen offset:1024 lds
    ds_read_b128 a[216:219], v227 offset:45056
    v_mfma_f32_16x16x32_bf16 v[144:147], a[244:247], a[196:199], v[144:147]
    s_waitcnt lgkmcnt(7)
    ds_read_b128 a[220:223], v228 offset:45056
    v_mfma_f32_16x16x32_bf16 v[20:23], a[248:251], a[160:163], 0
    s_waitcnt lgkmcnt(6)
    ds_read_b64_tr_b16 a[240:241], v235 offset:0
    v_mfma_f32_16x16x32_bf16 v[20:23], a[252:255], a[164:167], v[20:23]
    ds_read_b64_tr_b16 a[242:243], v235 offset:1024
    v_mfma_f32_16x16x32_bf16 v[52:55], a[252:255], a[172:175], 0
    ds_read_b64_tr_b16 a[244:245], v235 offset:8192
    v_mfma_f32_16x16x32_bf16 v[52:55], a[248:251], a[168:171], v[52:55]
    ds_read_b64_tr_b16 a[246:247], v235 offset:9216
    v_mfma_f32_16x16x32_bf16 v[84:87], a[248:251], a[176:179], 0
    ds_read_b128 a[224:227], v227 offset:47104
    v_mfma_f32_16x16x32_bf16 v[84:87], a[252:255], a[180:183], v[84:87]
    ds_read_b128 a[228:231], v228 offset:47104
    v_mfma_f32_16x16x32_bf16 v[116:119], a[252:255], a[188:191], 0
    s_add_u32 s27, s88, 47104
    buffer_load_dwordx4 v223, s[4:7], s27 offen offset:2048 lds
    ds_read_b128 a[232:235], v227 offset:49152
    v_mfma_f32_16x16x32_bf16 v[116:119], a[248:251], a[184:187], v[116:119]
    ds_read_b128 a[236:239], v228 offset:49152
    v_mfma_f32_16x16x32_bf16 v[148:151], a[248:251], a[192:195], 0
    v_mfma_f32_16x16x32_bf16 v[148:151], a[252:255], a[196:199], v[148:151]
    s_waitcnt lgkmcnt(6)
    v_mfma_f32_16x16x32_bf16 v[24:27], a[240:243], a[160:163], 0
    s_waitcnt lgkmcnt(4)
    ds_read_b64_tr_b16 a[248:249], v236 offset:0
    v_mfma_f32_16x16x32_bf16 v[24:27], a[244:247], a[164:167], v[24:27]
    ds_read_b64_tr_b16 a[250:251], v236 offset:1024
    v_mfma_f32_16x16x32_bf16 v[56:59], a[244:247], a[172:175], 0
    ds_read_b64_tr_b16 a[252:253], v236 offset:8192
    v_mfma_f32_16x16x32_bf16 v[56:59], a[240:243], a[168:171], v[56:59]
    s_add_u32 s27, s88, 54272
    ds_read_b64_tr_b16 a[254:255], v236 offset:9216
    buffer_load_dwordx4 v224, s[4:7], s27 offen offset:3072 lds
    v_mfma_f32_16x16x32_bf16 v[88:91], a[240:243], a[176:179], 0
    v_mfma_f32_16x16x32_bf16 v[88:91], a[244:247], a[180:183], v[88:91]
    v_mfma_f32_16x16x32_bf16 v[120:123], a[244:247], a[188:191], 0
    v_mfma_f32_16x16x32_bf16 v[120:123], a[240:243], a[184:187], v[120:123]
    v_mfma_f32_16x16x32_bf16 v[152:155], a[240:243], a[192:195], 0
    v_mfma_f32_16x16x32_bf16 v[152:155], a[244:247], a[196:199], v[152:155]
    s_add_u32 m0, s35, 8192
    s_waitcnt vmcnt(8) lgkmcnt(0)
    s_barrier
    v_mfma_f32_16x16x32_bf16 v[28:31], a[248:251], a[160:163], 0
    s_add_u32 s27, s88, 65536
    buffer_load_dwordx4 v223, s[4:7], s27 offen lds
    ds_read_b64_tr_b16 a[240:241], v229 offset:16384
    v_mfma_f32_16x16x32_bf16 v[28:31], a[252:255], a[164:167], v[28:31]
    ds_read_b64_tr_b16 a[242:243], v229 offset:17408
    v_mfma_f32_16x16x32_bf16 v[60:63], a[252:255], a[172:175], 0
    ds_read_b64_tr_b16 a[244:245], v229 offset:24576
    v_mfma_f32_16x16x32_bf16 v[60:63], a[248:251], a[168:171], v[60:63]
    ds_read_b64_tr_b16 a[246:247], v229 offset:25600
    v_mfma_f32_16x16x32_bf16 v[92:95], a[248:251], a[176:179], 0
    v_mfma_f32_16x16x32_bf16 v[92:95], a[252:255], a[180:183], v[92:95]
    v_mfma_f32_16x16x32_bf16 v[124:127], a[252:255], a[188:191], 0
    v_mfma_f32_16x16x32_bf16 v[124:127], a[248:251], a[184:187], v[124:127]
    v_mfma_f32_16x16x32_bf16 v[156:159], a[248:251], a[192:195], 0
    s_add_u32 s27, s88, 72704
    buffer_load_dwordx4 v224, s[4:7], s27 offen offset:1024 lds
    v_mfma_f32_16x16x32_bf16 v[156:159], a[252:255], a[196:199], v[156:159]
    s_waitcnt lgkmcnt(2)
    v_mfma_f32_16x16x32_bf16 v[0:3], a[240:243], a[200:203], v[0:3]
    s_waitcnt lgkmcnt(0)
    ds_read_b64_tr_b16 a[248:249], v230 offset:16384
    v_mfma_f32_16x16x32_bf16 v[0:3], a[244:247], a[204:207], v[0:3]
    ds_read_b64_tr_b16 a[250:251], v230 offset:17408
    v_mfma_f32_16x16x32_bf16 v[32:35], a[244:247], a[212:215], v[32:35]
    ds_read_b64_tr_b16 a[252:253], v230 offset:24576
    v_mfma_f32_16x16x32_bf16 v[32:35], a[240:243], a[208:211], v[32:35]
    ds_read_b64_tr_b16 a[254:255], v230 offset:25600
    v_mfma_f32_16x16x32_bf16 v[64:67], a[240:243], a[216:219], v[64:67]
    v_mfma_f32_16x16x32_bf16 v[64:67], a[244:247], a[220:223], v[64:67]
    v_mfma_f32_16x16x32_bf16 v[96:99], a[244:247], a[228:231], v[96:99]
    v_mfma_f32_16x16x32_bf16 v[96:99], a[240:243], a[224:227], v[96:99]
    v_mfma_f32_16x16x32_bf16 v[128:131], a[240:243], a[232:235], v[128:131]
    v_mfma_f32_16x16x32_bf16 v[128:131], a[244:247], a[236:239], v[128:131]
    s_waitcnt lgkmcnt(2)
    v_mfma_f32_16x16x32_bf16 v[4:7], a[248:251], a[200:203], v[4:7]
    s_waitcnt lgkmcnt(0)
    ds_read_b64_tr_b16 a[240:241], v231 offset:16384
    v_mfma_f32_16x16x32_bf16 v[4:7], a[252:255], a[204:207], v[4:7]
    s_add_u32 m0, s35, 40960
    ds_read_b64_tr_b16 a[242:243], v231 offset:17408
    v_mfma_f32_16x16x32_bf16 v[36:39], a[252:255], a[212:215], v[36:39]
    s_add_u32 s27, s89, 0
    ds_read_b64_tr_b16 a[244:245], v231 offset:24576
    buffer_load_dwordx4 v223, s[4:7], s27 offen lds
    v_mfma_f32_16x16x32_bf16 v[36:39], a[248:251], a[208:211], v[36:39]
    ds_read_b64_tr_b16 a[246:247], v231 offset:25600
    v_mfma_f32_16x16x32_bf16 v[68:71], a[248:251], a[216:219], v[68:71]
    v_mfma_f32_16x16x32_bf16 v[68:71], a[252:255], a[220:223], v[68:71]
    v_mfma_f32_16x16x32_bf16 v[100:103], a[252:255], a[228:231], v[100:103]
    v_mfma_f32_16x16x32_bf16 v[100:103], a[248:251], a[224:227], v[100:103]
    v_mfma_f32_16x16x32_bf16 v[132:135], a[248:251], a[232:235], v[132:135]
    s_add_u32 s27, s89, 7168
    buffer_load_dwordx4 v224, s[4:7], s27 offen offset:1024 lds
    v_mfma_f32_16x16x32_bf16 v[132:135], a[252:255], a[236:239], v[132:135]
    s_waitcnt lgkmcnt(2)
    v_mfma_f32_16x16x32_bf16 v[8:11], a[240:243], a[200:203], v[8:11]
    s_waitcnt lgkmcnt(0)
    ds_read_b64_tr_b16 a[248:249], v232 offset:16384
    v_mfma_f32_16x16x32_bf16 v[8:11], a[244:247], a[204:207], v[8:11]
    ds_read_b64_tr_b16 a[250:251], v232 offset:17408
    v_mfma_f32_16x16x32_bf16 v[40:43], a[244:247], a[212:215], v[40:43]
    ds_read_b64_tr_b16 a[252:253], v232 offset:24576
    v_mfma_f32_16x16x32_bf16 v[40:43], a[240:243], a[208:211], v[40:43]
    ds_read_b64_tr_b16 a[254:255], v232 offset:25600
    v_mfma_f32_16x16x32_bf16 v[72:75], a[240:243], a[216:219], v[72:75]
    v_mfma_f32_16x16x32_bf16 v[72:75], a[244:247], a[220:223], v[72:75]
    s_add_u32 s27, s89, 14336
    buffer_load_dwordx4 v223, s[4:7], s27 offen offset:2048 lds
    v_mfma_f32_16x16x32_bf16 v[104:107], a[244:247], a[228:231], v[104:107]
    v_mfma_f32_16x16x32_bf16 v[104:107], a[240:243], a[224:227], v[104:107]
    v_mfma_f32_16x16x32_bf16 v[136:139], a[240:243], a[232:235], v[136:139]
    v_mfma_f32_16x16x32_bf16 v[136:139], a[244:247], a[236:239], v[136:139]
    s_waitcnt lgkmcnt(2)
    v_mfma_f32_16x16x32_bf16 v[12:15], a[248:251], a[200:203], v[12:15]
    s_waitcnt lgkmcnt(0)
    ds_read_b64_tr_b16 a[240:241], v233 offset:16384
    v_mfma_f32_16x16x32_bf16 v[12:15], a[252:255], a[204:207], v[12:15]
    ds_read_b64_tr_b16 a[242:243], v233 offset:17408
    v_mfma_f32_16x16x32_bf16 v[44:47], a[252:255], a[212:215], v[44:47]
    s_add_u32 s27, s89, 21504
    ds_read_b64_tr_b16 a[244:245], v233 offset:24576
    buffer_load_dwordx4 v224, s[4:7], s27 offen offset:3072 lds
    v_mfma_f32_16x16x32_bf16 v[44:47], a[248:251], a[208:211], v[44:47]
    ds_read_b64_tr_b16 a[246:247], v233 offset:25600
    v_mfma_f32_16x16x32_bf16 v[76:79], a[248:251], a[216:219], v[76:79]
    v_mfma_f32_16x16x32_bf16 v[76:79], a[252:255], a[220:223], v[76:79]
    v_mfma_f32_16x16x32_bf16 v[108:111], a[252:255], a[228:231], v[108:111]
    v_mfma_f32_16x16x32_bf16 v[108:111], a[248:251], a[224:227], v[108:111]
    v_mfma_f32_16x16x32_bf16 v[140:143], a[248:251], a[232:235], v[140:143]
    s_add_u32 m0, s35, 45056
    v_mfma_f32_16x16x32_bf16 v[140:143], a[252:255], a[236:239], v[140:143]
    s_waitcnt lgkmcnt(2)
    s_add_u32 s27, s89, 32768
    buffer_load_dwordx4 v223, s[4:7], s27 offen lds
    v_mfma_f32_16x16x32_bf16 v[16:19], a[240:243], a[200:203], v[16:19]
    s_waitcnt lgkmcnt(0)
    ds_read_b64_tr_b16 a[248:249], v234 offset:16384
    v_mfma_f32_16x16x32_bf16 v[16:19], a[244:247], a[204:207], v[16:19]
    ds_read_b64_tr_b16 a[250:251], v234 offset:17408
    v_mfma_f32_16x16x32_bf16 v[48:51], a[244:247], a[212:215], v[48:51]
    ds_read_b64_tr_b16 a[252:253], v234 offset:24576
    v_mfma_f32_16x16x32_bf16 v[48:51], a[240:243], a[208:211], v[48:51]
    s_waitcnt vmcnt(5)
    ds_read_b64_tr_b16 a[254:255], v234 offset:25600
    v_mfma_f32_16x16x32_bf16 v[80:83], a[240:243], a[216:219], v[80:83]
    ds_read_b128 a[160:163], v227 offset:0
    v_mfma_f32_16x16x32_bf16 v[80:83], a[244:247], a[220:223], v[80:83]
    ds_read_b128 a[164:167], v228 offset:0
    v_mfma_f32_16x16x32_bf16 v[112:115], a[244:247], a[228:231], v[112:115]
    s_add_u32 s27, s89, 39936
    buffer_load_dwordx4 v224, s[4:7], s27 offen offset:1024 lds
    ds_read_b128 a[168:171], v227 offset:2048
    v_mfma_f32_16x16x32_bf16 v[112:115], a[240:243], a[224:227], v[112:115]
    ds_read_b128 a[172:175], v228 offset:2048
    v_mfma_f32_16x16x32_bf16 v[144:147], a[240:243], a[232:235], v[144:147]
    ds_read_b128 a[176:179], v227 offset:4096
    v_mfma_f32_16x16x32_bf16 v[144:147], a[244:247], a[236:239], v[144:147]
    s_waitcnt lgkmcnt(7)
    ds_read_b128 a[180:183], v228 offset:4096
    v_mfma_f32_16x16x32_bf16 v[20:23], a[248:251], a[200:203], v[20:23]
    s_waitcnt lgkmcnt(6)
    ds_read_b64_tr_b16 a[240:241], v235 offset:16384
    v_mfma_f32_16x16x32_bf16 v[20:23], a[252:255], a[204:207], v[20:23]
    ds_read_b64_tr_b16 a[242:243], v235 offset:17408
    v_mfma_f32_16x16x32_bf16 v[52:55], a[252:255], a[212:215], v[52:55]
    ds_read_b64_tr_b16 a[244:245], v235 offset:24576
    v_mfma_f32_16x16x32_bf16 v[52:55], a[248:251], a[208:211], v[52:55]
    s_add_u32 s27, s89, 47104
    ds_read_b64_tr_b16 a[246:247], v235 offset:25600
    buffer_load_dwordx4 v223, s[4:7], s27 offen offset:2048 lds
    v_mfma_f32_16x16x32_bf16 v[84:87], a[248:251], a[216:219], v[84:87]
    ds_read_b128 a[184:187], v227 offset:6144
    v_mfma_f32_16x16x32_bf16 v[84:87], a[252:255], a[220:223], v[84:87]
    ds_read_b128 a[188:191], v228 offset:6144
    v_mfma_f32_16x16x32_bf16 v[116:119], a[252:255], a[228:231], v[116:119]
    ds_read_b128 a[192:195], v227 offset:8192
    v_mfma_f32_16x16x32_bf16 v[116:119], a[248:251], a[224:227], v[116:119]
    ds_read_b128 a[196:199], v228 offset:8192
    v_mfma_f32_16x16x32_bf16 v[148:151], a[248:251], a[232:235], v[148:151]
    v_mfma_f32_16x16x32_bf16 v[148:151], a[252:255], a[236:239], v[148:151]
    s_waitcnt lgkmcnt(6)
    v_mfma_f32_16x16x32_bf16 v[24:27], a[240:243], a[200:203], v[24:27]
    s_waitcnt lgkmcnt(4)
    s_add_u32 s27, s89, 54272
    ds_read_b64_tr_b16 a[248:249], v236 offset:16384
    buffer_load_dwordx4 v224, s[4:7], s27 offen offset:3072 lds
    v_mfma_f32_16x16x32_bf16 v[24:27], a[244:247], a[204:207], v[24:27]
    ds_read_b64_tr_b16 a[250:251], v236 offset:17408
    v_mfma_f32_16x16x32_bf16 v[56:59], a[244:247], a[212:215], v[56:59]
    ds_read_b64_tr_b16 a[252:253], v236 offset:24576
    v_mfma_f32_16x16x32_bf16 v[56:59], a[240:243], a[208:211], v[56:59]
    ds_read_b64_tr_b16 a[254:255], v236 offset:25600
    v_mfma_f32_16x16x32_bf16 v[88:91], a[240:243], a[216:219], v[88:91]
    v_mfma_f32_16x16x32_bf16 v[88:91], a[244:247], a[220:223], v[88:91]
    v_mfma_f32_16x16x32_bf16 v[120:123], a[244:247], a[228:231], v[120:123]
    s_add_u32 m0, s35, 49152
    v_mfma_f32_16x16x32_bf16 v[120:123], a[240:243], a[224:227], v[120:123]
    s_add_u32 s27, s89, 65536
    buffer_load_dwordx4 v223, s[4:7], s27 offen lds
    v_mfma_f32_16x16x32_bf16 v[152:155], a[240:243], a[232:235], v[152:155]
    v_mfma_f32_16x16x32_bf16 v[152:155], a[244:247], a[236:239], v[152:155]
    s_waitcnt vmcnt(9) lgkmcnt(0)
    s_barrier
    v_mfma_f32_16x16x32_bf16 v[28:31], a[248:251], a[200:203], v[28:31]
    ds_read_b64_tr_b16 a[240:241], v229 offset:32768
    v_mfma_f32_16x16x32_bf16 v[28:31], a[252:255], a[204:207], v[28:31]
    ds_read_b64_tr_b16 a[242:243], v229 offset:33792
    v_mfma_f32_16x16x32_bf16 v[60:63], a[252:255], a[212:215], v[60:63]
    ds_read_b64_tr_b16 a[244:245], v229 offset:40960
    v_mfma_f32_16x16x32_bf16 v[60:63], a[248:251], a[208:211], v[60:63]
    ds_read_b64_tr_b16 a[246:247], v229 offset:41984
    v_mfma_f32_16x16x32_bf16 v[92:95], a[248:251], a[216:219], v[92:95]
    s_add_u32 s27, s89, 72704
    buffer_load_dwordx4 v224, s[4:7], s27 offen offset:1024 lds
    v_mfma_f32_16x16x32_bf16 v[92:95], a[252:255], a[220:223], v[92:95]
    v_mfma_f32_16x16x32_bf16 v[124:127], a[252:255], a[228:231], v[124:127]
    v_mfma_f32_16x16x32_bf16 v[124:127], a[248:251], a[224:227], v[124:127]
    v_mfma_f32_16x16x32_bf16 v[156:159], a[248:251], a[232:235], v[156:159]
    v_mfma_f32_16x16x32_bf16 v[156:159], a[252:255], a[236:239], v[156:159]
    s_waitcnt lgkmcnt(2)
    v_mfma_f32_16x16x32_bf16 v[0:3], a[240:243], a[160:163], v[0:3]
    s_waitcnt lgkmcnt(0)
    ds_read_b64_tr_b16 a[248:249], v230 offset:32768
    v_mfma_f32_16x16x32_bf16 v[0:3], a[244:247], a[164:167], v[0:3]
    ds_read_b64_tr_b16 a[250:251], v230 offset:33792
    v_mfma_f32_16x16x32_bf16 v[32:35], a[244:247], a[172:175], v[32:35]
    ds_read_b64_tr_b16 a[252:253], v230 offset:40960
    v_mfma_f32_16x16x32_bf16 v[32:35], a[240:243], a[168:171], v[32:35]
    ds_read_b64_tr_b16 a[254:255], v230 offset:41984
    v_mfma_f32_16x16x32_bf16 v[64:67], a[240:243], a[176:179], v[64:67]
    v_accvgpr_write_b32 a0, 0
    v_mfma_f32_16x16x32_bf16 v[64:67], a[244:247], a[180:183], v[64:67]
    v_accvgpr_write_b32 a1, 0
    v_mfma_f32_16x16x32_bf16 v[96:99], a[244:247], a[188:191], v[96:99]
    v_accvgpr_write_b32 a2, 0
    v_mfma_f32_16x16x32_bf16 v[96:99], a[240:243], a[184:187], v[96:99]
    v_accvgpr_write_b32 a3, 0
    v_mfma_f32_16x16x32_bf16 v[128:131], a[240:243], a[192:195], v[128:131]
    v_accvgpr_write_b32 a4, 0
    v_mfma_f32_16x16x32_bf16 v[128:131], a[244:247], a[196:199], v[128:131]
    s_waitcnt lgkmcnt(2)
    v_accvgpr_write_b32 a5, 0
    v_mfma_f32_16x16x32_bf16 v[4:7], a[248:251], a[160:163], v[4:7]
    s_waitcnt lgkmcnt(0)
    ds_read_b64_tr_b16 a[240:241], v231 offset:32768
    v_accvgpr_write_b32 a6, 0
    v_mfma_f32_16x16x32_bf16 v[4:7], a[252:255], a[164:167], v[4:7]
    s_add_u32 m0, s35, 0
    ds_read_b64_tr_b16 a[242:243], v231 offset:33792
    v_accvgpr_write_b32 a7, 0
    v_mfma_f32_16x16x32_bf16 v[36:39], a[252:255], a[172:175], v[36:39]
    s_add_u32 s27, s90, 0
    ds_read_b64_tr_b16 a[244:245], v231 offset:40960
    buffer_load_dwordx4 v223, s[4:7], s27 offen lds
    v_accvgpr_write_b32 a8, 0
    v_mfma_f32_16x16x32_bf16 v[36:39], a[248:251], a[168:171], v[36:39]
    ds_read_b64_tr_b16 a[246:247], v231 offset:41984
    v_accvgpr_write_b32 a9, 0
    v_mfma_f32_16x16x32_bf16 v[68:71], a[248:251], a[176:179], v[68:71]
    v_accvgpr_write_b32 a10, 0
    v_mfma_f32_16x16x32_bf16 v[68:71], a[252:255], a[180:183], v[68:71]
    v_accvgpr_write_b32 a11, 0
    v_mfma_f32_16x16x32_bf16 v[100:103], a[252:255], a[188:191], v[100:103]
    v_accvgpr_write_b32 a12, 0
    v_mfma_f32_16x16x32_bf16 v[100:103], a[248:251], a[184:187], v[100:103]
    v_accvgpr_write_b32 a13, 0
    v_mfma_f32_16x16x32_bf16 v[132:135], a[248:251], a[192:195], v[132:135]
    s_add_u32 s27, s90, 7168
    buffer_load_dwordx4 v224, s[4:7], s27 offen offset:1024 lds
    v_accvgpr_write_b32 a14, 0
    v_mfma_f32_16x16x32_bf16 v[132:135], a[252:255], a[196:199], v[132:135]
    s_waitcnt lgkmcnt(2)
    v_accvgpr_write_b32 a15, 0
    v_mfma_f32_16x16x32_bf16 v[8:11], a[240:243], a[160:163], v[8:11]
    s_waitcnt lgkmcnt(0)
    ds_read_b64_tr_b16 a[248:249], v232 offset:32768
    v_accvgpr_write_b32 a16, 0
    v_mfma_f32_16x16x32_bf16 v[8:11], a[244:247], a[164:167], v[8:11]
    ds_read_b64_tr_b16 a[250:251], v232 offset:33792
    v_accvgpr_write_b32 a17, 0
    v_mfma_f32_16x16x32_bf16 v[40:43], a[244:247], a[172:175], v[40:43]
    ds_read_b64_tr_b16 a[252:253], v232 offset:40960
    v_accvgpr_write_b32 a18, 0
    v_mfma_f32_16x16x32_bf16 v[40:43], a[240:243], a[168:171], v[40:43]
    ds_read_b64_tr_b16 a[254:255], v232 offset:41984
    v_accvgpr_write_b32 a19, 0
    v_mfma_f32_16x16x32_bf16 v[72:75], a[240:243], a[176:179], v[72:75]
    v_accvgpr_write_b32 a20, 0
    v_mfma_f32_16x16x32_bf16 v[72:75], a[244:247], a[180:183], v[72:75]
    s_add_u32 s27, s90, 14336
    buffer_load_dwordx4 v223, s[4:7], s27 offen offset:2048 lds
    v_accvgpr_write_b32 a21, 0
    v_mfma_f32_16x16x32_bf16 v[104:107], a[244:247], a[188:191], v[104:107]
    v_accvgpr_write_b32 a22, 0
    v_mfma_f32_16x16x32_bf16 v[104:107], a[240:243], a[184:187], v[104:107]
    v_accvgpr_write_b32 a23, 0
    v_mfma_f32_16x16x32_bf16 v[136:139], a[240:243], a[192:195], v[136:139]
    v_accvgpr_write_b32 a24, 0
    v_mfma_f32_16x16x32_bf16 v[136:139], a[244:247], a[196:199], v[136:139]
    s_waitcnt lgkmcnt(2)
    v_accvgpr_write_b32 a25, 0
    v_mfma_f32_16x16x32_bf16 v[12:15], a[248:251], a[160:163], v[12:15]
    s_waitcnt lgkmcnt(0)
    ds_read_b64_tr_b16 a[240:241], v233 offset:32768
    v_accvgpr_write_b32 a26, 0
    v_mfma_f32_16x16x32_bf16 v[12:15], a[252:255], a[164:167], v[12:15]
    ds_read_b64_tr_b16 a[242:243], v233 offset:33792
    v_accvgpr_write_b32 a27, 0
    v_mfma_f32_16x16x32_bf16 v[44:47], a[252:255], a[172:175], v[44:47]
    s_add_u32 s27, s90, 21504
    ds_read_b64_tr_b16 a[244:245], v233 offset:40960
    buffer_load_dwordx4 v224, s[4:7], s27 offen offset:3072 lds
    v_accvgpr_write_b32 a28, 0
    v_mfma_f32_16x16x32_bf16 v[44:47], a[248:251], a[168:171], v[44:47]
    ds_read_b64_tr_b16 a[246:247], v233 offset:41984
    v_accvgpr_write_b32 a29, 0
    v_mfma_f32_16x16x32_bf16 v[76:79], a[248:251], a[176:179], v[76:79]
    v_accvgpr_write_b32 a30, 0
    v_mfma_f32_16x16x32_bf16 v[76:79], a[252:255], a[180:183], v[76:79]
    v_accvgpr_write_b32 a31, 0
    v_mfma_f32_16x16x32_bf16 v[108:111], a[252:255], a[188:191], v[108:111]
    v_accvgpr_write_b32 a32, 0
    v_mfma_f32_16x16x32_bf16 v[108:111], a[248:251], a[184:187], v[108:111]
    v_accvgpr_write_b32 a33, 0
    v_mfma_f32_16x16x32_bf16 v[140:143], a[248:251], a[192:195], v[140:143]
    s_add_u32 m0, s35, 4096
    v_accvgpr_write_b32 a34, 0
    v_mfma_f32_16x16x32_bf16 v[140:143], a[252:255], a[196:199], v[140:143]
    s_waitcnt lgkmcnt(2)
    s_add_u32 s27, s90, 32768
    buffer_load_dwordx4 v223, s[4:7], s27 offen lds
    v_accvgpr_write_b32 a35, 0
    v_mfma_f32_16x16x32_bf16 v[16:19], a[240:243], a[160:163], v[16:19]
    s_waitcnt lgkmcnt(0)
    ds_read_b64_tr_b16 a[248:249], v234 offset:32768
    v_accvgpr_write_b32 a36, 0
    v_mfma_f32_16x16x32_bf16 v[16:19], a[244:247], a[164:167], v[16:19]
    ds_read_b64_tr_b16 a[250:251], v234 offset:33792
    v_accvgpr_write_b32 a37, 0
    v_mfma_f32_16x16x32_bf16 v[48:51], a[244:247], a[172:175], v[48:51]
    ds_read_b64_tr_b16 a[252:253], v234 offset:40960
    v_accvgpr_write_b32 a38, 0
    v_mfma_f32_16x16x32_bf16 v[48:51], a[240:243], a[168:171], v[48:51]
    s_waitcnt vmcnt(5)
    ds_read_b64_tr_b16 a[254:255], v234 offset:41984
    v_accvgpr_write_b32 a39, 0
    v_mfma_f32_16x16x32_bf16 v[80:83], a[240:243], a[176:179], v[80:83]
    ds_read_b128 a[200:203], v227 offset:40960
    v_accvgpr_write_b32 a40, 0
    v_mfma_f32_16x16x32_bf16 v[80:83], a[244:247], a[180:183], v[80:83]
    ds_read_b128 a[204:207], v228 offset:40960
    v_accvgpr_write_b32 a41, 0
    v_mfma_f32_16x16x32_bf16 v[112:115], a[244:247], a[188:191], v[112:115]
    s_add_u32 s27, s90, 39936
    buffer_load_dwordx4 v224, s[4:7], s27 offen offset:1024 lds
    ds_read_b128 a[208:211], v227 offset:43008
    v_accvgpr_write_b32 a42, 0
    v_mfma_f32_16x16x32_bf16 v[112:115], a[240:243], a[184:187], v[112:115]
    ds_read_b128 a[212:215], v228 offset:43008
    v_accvgpr_write_b32 a43, 0
    v_mfma_f32_16x16x32_bf16 v[144:147], a[240:243], a[192:195], v[144:147]
    ds_read_b128 a[216:219], v227 offset:45056
    v_accvgpr_write_b32 a44, 0
    v_mfma_f32_16x16x32_bf16 v[144:147], a[244:247], a[196:199], v[144:147]
    s_waitcnt lgkmcnt(7)
    ds_read_b128 a[220:223], v228 offset:45056
    v_accvgpr_write_b32 a45, 0
    v_mfma_f32_16x16x32_bf16 v[20:23], a[248:251], a[160:163], v[20:23]
    s_waitcnt lgkmcnt(6)
    ds_read_b64_tr_b16 a[240:241], v235 offset:32768
    v_accvgpr_write_b32 a46, 0
    v_mfma_f32_16x16x32_bf16 v[20:23], a[252:255], a[164:167], v[20:23]
    ds_read_b64_tr_b16 a[242:243], v235 offset:33792
    v_accvgpr_write_b32 a47, 0
    v_mfma_f32_16x16x32_bf16 v[52:55], a[252:255], a[172:175], v[52:55]
    ds_read_b64_tr_b16 a[244:245], v235 offset:40960
    v_accvgpr_write_b32 a48, 0
    v_mfma_f32_16x16x32_bf16 v[52:55], a[248:251], a[168:171], v[52:55]
    s_add_u32 s27, s90, 47104
    ds_read_b64_tr_b16 a[246:247], v235 offset:41984
    buffer_load_dwordx4 v223, s[4:7], s27 offen offset:2048 lds
    v_accvgpr_write_b32 a49, 0
    v_mfma_f32_16x16x32_bf16 v[84:87], a[248:251], a[176:179], v[84:87]
    ds_read_b128 a[224:227], v227 offset:47104
    v_accvgpr_write_b32 a50, 0
    v_mfma_f32_16x16x32_bf16 v[84:87], a[252:255], a[180:183], v[84:87]
    ds_read_b128 a[228:231], v228 offset:47104
    v_accvgpr_write_b32 a51, 0
    v_mfma_f32_16x16x32_bf16 v[116:119], a[252:255], a[188:191], v[116:119]
    ds_read_b128 a[232:235], v227 offset:49152
    v_accvgpr_write_b32 a52, 0
    v_mfma_f32_16x16x32_bf16 v[116:119], a[248:251], a[184:187], v[116:119]
    ds_read_b128 a[236:239], v228 offset:49152
    v_accvgpr_write_b32 a53, 0
    v_mfma_f32_16x16x32_bf16 v[148:151], a[248:251], a[192:195], v[148:151]
    v_accvgpr_write_b32 a54, 0
    v_mfma_f32_16x16x32_bf16 v[148:151], a[252:255], a[196:199], v[148:151]
    s_waitcnt lgkmcnt(6)
    v_mfma_f32_16x16x32_bf16 v[24:27], a[240:243], a[160:163], v[24:27]
    s_waitcnt lgkmcnt(4)
    s_add_u32 s27, s90, 54272
    ds_read_b64_tr_b16 a[248:249], v236 offset:32768
    buffer_load_dwordx4 v224, s[4:7], s27 offen offset:3072 lds
    v_mfma_f32_16x16x32_bf16 v[24:27], a[244:247], a[164:167], v[24:27]
    ds_read_b64_tr_b16 a[250:251], v236 offset:33792
    v_mfma_f32_16x16x32_bf16 v[56:59], a[244:247], a[172:175], v[56:59]
    ds_read_b64_tr_b16 a[252:253], v236 offset:40960
    v_mfma_f32_16x16x32_bf16 v[56:59], a[240:243], a[168:171], v[56:59]
    ds_read_b64_tr_b16 a[254:255], v236 offset:41984
    v_mfma_f32_16x16x32_bf16 v[88:91], a[240:243], a[176:179], v[88:91]
    v_mfma_f32_16x16x32_bf16 v[88:91], a[244:247], a[180:183], v[88:91]
    v_mfma_f32_16x16x32_bf16 v[120:123], a[244:247], a[188:191], v[120:123]
    s_add_u32 m0, s35, 8192
    v_mfma_f32_16x16x32_bf16 v[120:123], a[240:243], a[184:187], v[120:123]
    s_add_u32 s27, s90, 65536
    buffer_load_dwordx4 v223, s[4:7], s27 offen lds
    v_mfma_f32_16x16x32_bf16 v[152:155], a[240:243], a[192:195], v[152:155]
    v_mfma_f32_16x16x32_bf16 v[152:155], a[244:247], a[196:199], v[152:155]
    s_waitcnt vmcnt(9) lgkmcnt(0)
    s_barrier
    v_mfma_f32_16x16x32_bf16 v[28:31], a[248:251], a[160:163], v[28:31]
    ds_read_b64_tr_b16 a[240:241], v229 offset:0
    v_mfma_f32_16x16x32_bf16 v[28:31], a[252:255], a[164:167], v[28:31]
    ds_read_b64_tr_b16 a[242:243], v229 offset:1024
    v_mfma_f32_16x16x32_bf16 v[60:63], a[252:255], a[172:175], v[60:63]
    ds_read_b64_tr_b16 a[244:245], v229 offset:8192
    v_mfma_f32_16x16x32_bf16 v[60:63], a[248:251], a[168:171], v[60:63]
    ds_read_b64_tr_b16 a[246:247], v229 offset:9216
    v_mfma_f32_16x16x32_bf16 v[92:95], a[248:251], a[176:179], v[92:95]
    s_add_u32 s27, s90, 72704
    buffer_load_dwordx4 v224, s[4:7], s27 offen offset:1024 lds
    v_mfma_f32_16x16x32_bf16 v[92:95], a[252:255], a[180:183], v[92:95]
    v_mfma_f32_16x16x32_bf16 v[124:127], a[252:255], a[188:191], v[124:127]
    v_mfma_f32_16x16x32_bf16 v[124:127], a[248:251], a[184:187], v[124:127]
    v_mfma_f32_16x16x32_bf16 v[156:159], a[248:251], a[192:195], v[156:159]
    v_mfma_f32_16x16x32_bf16 v[156:159], a[252:255], a[196:199], v[156:159]
    s_waitcnt lgkmcnt(2)
    v_mfma_f32_16x16x32_bf16 v[0:3], a[240:243], a[200:203], v[0:3]
    s_waitcnt lgkmcnt(0)
    ds_read_b64_tr_b16 a[248:249], v230 offset:0
    v_mfma_f32_16x16x32_bf16 v[0:3], a[244:247], a[204:207], v[0:3]
    ds_read_b64_tr_b16 a[250:251], v230 offset:1024
    v_mfma_f32_16x16x32_bf16 v[32:35], a[244:247], a[212:215], v[32:35]
    ds_read_b64_tr_b16 a[252:253], v230 offset:8192
    v_mfma_f32_16x16x32_bf16 v[32:35], a[240:243], a[208:211], v[32:35]
    ds_read_b64_tr_b16 a[254:255], v230 offset:9216
    v_mfma_f32_16x16x32_bf16 v[64:67], a[240:243], a[216:219], v[64:67]
    v_accvgpr_write_b32 a55, 0
    v_mfma_f32_16x16x32_bf16 v[64:67], a[244:247], a[220:223], v[64:67]
    v_accvgpr_write_b32 a56, 0
    v_mfma_f32_16x16x32_bf16 v[96:99], a[244:247], a[228:231], v[96:99]
    v_accvgpr_write_b32 a57, 0
    v_mfma_f32_16x16x32_bf16 v[96:99], a[240:243], a[224:227], v[96:99]
    v_accvgpr_write_b32 a58, 0
    v_mfma_f32_16x16x32_bf16 v[128:131], a[240:243], a[232:235], v[128:131]
    v_accvgpr_write_b32 a59, 0
    v_mfma_f32_16x16x32_bf16 v[128:131], a[244:247], a[236:239], v[128:131]
    s_waitcnt lgkmcnt(2)
    v_accvgpr_write_b32 a60, 0
    v_mfma_f32_16x16x32_bf16 v[4:7], a[248:251], a[200:203], v[4:7]
    s_waitcnt lgkmcnt(0)
    ds_read_b64_tr_b16 a[240:241], v231 offset:0
    v_accvgpr_write_b32 a61, 0
    v_mfma_f32_16x16x32_bf16 v[4:7], a[252:255], a[204:207], v[4:7]
    s_add_u32 m0, s35, 40960
    ds_read_b64_tr_b16 a[242:243], v231 offset:1024
    v_accvgpr_write_b32 a62, 0
    v_mfma_f32_16x16x32_bf16 v[36:39], a[252:255], a[212:215], v[36:39]
    s_add_u32 s27, s91, 0
    ds_read_b64_tr_b16 a[244:245], v231 offset:8192
    buffer_load_dwordx4 v223, s[4:7], s27 offen lds
    v_accvgpr_write_b32 a63, 0
    v_mfma_f32_16x16x32_bf16 v[36:39], a[248:251], a[208:211], v[36:39]
    ds_read_b64_tr_b16 a[246:247], v231 offset:9216
    v_accvgpr_write_b32 a64, 0
    v_mfma_f32_16x16x32_bf16 v[68:71], a[248:251], a[216:219], v[68:71]
    v_accvgpr_write_b32 a65, 0
    v_mfma_f32_16x16x32_bf16 v[68:71], a[252:255], a[220:223], v[68:71]
    v_accvgpr_write_b32 a66, 0
    v_mfma_f32_16x16x32_bf16 v[100:103], a[252:255], a[228:231], v[100:103]
    v_accvgpr_write_b32 a67, 0
    v_mfma_f32_16x16x32_bf16 v[100:103], a[248:251], a[224:227], v[100:103]
    v_accvgpr_write_b32 a68, 0
    v_mfma_f32_16x16x32_bf16 v[132:135], a[248:251], a[232:235], v[132:135]
    s_add_u32 s27, s91, 7168
    buffer_load_dwordx4 v224, s[4:7], s27 offen offset:1024 lds
    v_accvgpr_write_b32 a69, 0
    v_mfma_f32_16x16x32_bf16 v[132:135], a[252:255], a[236:239], v[132:135]
    s_waitcnt lgkmcnt(2)
    v_accvgpr_write_b32 a70, 0
    v_mfma_f32_16x16x32_bf16 v[8:11], a[240:243], a[200:203], v[8:11]
    s_waitcnt lgkmcnt(0)
    ds_read_b64_tr_b16 a[248:249], v232 offset:0
    v_accvgpr_write_b32 a71, 0
    v_mfma_f32_16x16x32_bf16 v[8:11], a[244:247], a[204:207], v[8:11]
    ds_read_b64_tr_b16 a[250:251], v232 offset:1024
    v_accvgpr_write_b32 a72, 0
    v_mfma_f32_16x16x32_bf16 v[40:43], a[244:247], a[212:215], v[40:43]
    ds_read_b64_tr_b16 a[252:253], v232 offset:8192
    v_accvgpr_write_b32 a73, 0
    v_mfma_f32_16x16x32_bf16 v[40:43], a[240:243], a[208:211], v[40:43]
    ds_read_b64_tr_b16 a[254:255], v232 offset:9216
    v_accvgpr_write_b32 a74, 0
    v_mfma_f32_16x16x32_bf16 v[72:75], a[240:243], a[216:219], v[72:75]
    v_accvgpr_write_b32 a75, 0
    v_mfma_f32_16x16x32_bf16 v[72:75], a[244:247], a[220:223], v[72:75]
    s_add_u32 s27, s91, 14336
    buffer_load_dwordx4 v223, s[4:7], s27 offen offset:2048 lds
    v_accvgpr_write_b32 a76, 0
    v_mfma_f32_16x16x32_bf16 v[104:107], a[244:247], a[228:231], v[104:107]
    v_accvgpr_write_b32 a77, 0
    v_mfma_f32_16x16x32_bf16 v[104:107], a[240:243], a[224:227], v[104:107]
    v_accvgpr_write_b32 a78, 0
    v_mfma_f32_16x16x32_bf16 v[136:139], a[240:243], a[232:235], v[136:139]
    v_accvgpr_write_b32 a79, 0
    v_mfma_f32_16x16x32_bf16 v[136:139], a[244:247], a[236:239], v[136:139]
    s_waitcnt lgkmcnt(2)
    v_accvgpr_write_b32 a80, 0
    v_mfma_f32_16x16x32_bf16 v[12:15], a[248:251], a[200:203], v[12:15]
    s_waitcnt lgkmcnt(0)
    ds_read_b64_tr_b16 a[240:241], v233 offset:0
    v_accvgpr_write_b32 a81, 0
    v_mfma_f32_16x16x32_bf16 v[12:15], a[252:255], a[204:207], v[12:15]
    ds_read_b64_tr_b16 a[242:243], v233 offset:1024
    v_accvgpr_write_b32 a82, 0
    v_mfma_f32_16x16x32_bf16 v[44:47], a[252:255], a[212:215], v[44:47]
    s_add_u32 s27, s91, 21504
    ds_read_b64_tr_b16 a[244:245], v233 offset:8192
    buffer_load_dwordx4 v224, s[4:7], s27 offen offset:3072 lds
    v_accvgpr_write_b32 a83, 0
    v_mfma_f32_16x16x32_bf16 v[44:47], a[248:251], a[208:211], v[44:47]
    ds_read_b64_tr_b16 a[246:247], v233 offset:9216
    v_accvgpr_write_b32 a84, 0
    v_mfma_f32_16x16x32_bf16 v[76:79], a[248:251], a[216:219], v[76:79]
    v_accvgpr_write_b32 a85, 0
    v_mfma_f32_16x16x32_bf16 v[76:79], a[252:255], a[220:223], v[76:79]
    v_accvgpr_write_b32 a86, 0
    v_mfma_f32_16x16x32_bf16 v[108:111], a[252:255], a[228:231], v[108:111]
    v_accvgpr_write_b32 a87, 0
    v_mfma_f32_16x16x32_bf16 v[108:111], a[248:251], a[224:227], v[108:111]
    v_accvgpr_write_b32 a88, 0
    v_mfma_f32_16x16x32_bf16 v[140:143], a[248:251], a[232:235], v[140:143]
    s_add_u32 m0, s35, 45056
    v_accvgpr_write_b32 a89, 0
    v_mfma_f32_16x16x32_bf16 v[140:143], a[252:255], a[236:239], v[140:143]
    s_waitcnt lgkmcnt(2)
    s_add_u32 s27, s91, 32768
    buffer_load_dwordx4 v223, s[4:7], s27 offen lds
    v_accvgpr_write_b32 a90, 0
    v_mfma_f32_16x16x32_bf16 v[16:19], a[240:243], a[200:203], v[16:19]
    s_waitcnt lgkmcnt(0)
    ds_read_b64_tr_b16 a[248:249], v234 offset:0
    v_accvgpr_write_b32 a91, 0
    v_mfma_f32_16x16x32_bf16 v[16:19], a[244:247], a[204:207], v[16:19]
    ds_read_b64_tr_b16 a[250:251], v234 offset:1024
    v_accvgpr_write_b32 a92, 0
    v_mfma_f32_16x16x32_bf16 v[48:51], a[244:247], a[212:215], v[48:51]
    ds_read_b64_tr_b16 a[252:253], v234 offset:8192
    v_accvgpr_write_b32 a93, 0
    v_mfma_f32_16x16x32_bf16 v[48:51], a[240:243], a[208:211], v[48:51]
    s_waitcnt vmcnt(5)
    ds_read_b64_tr_b16 a[254:255], v234 offset:9216
    v_accvgpr_write_b32 a94, 0
    v_mfma_f32_16x16x32_bf16 v[80:83], a[240:243], a[216:219], v[80:83]
    ds_read_b128 a[160:163], v227 offset:0
    v_accvgpr_write_b32 a95, 0
    v_mfma_f32_16x16x32_bf16 v[80:83], a[244:247], a[220:223], v[80:83]
    ds_read_b128 a[164:167], v228 offset:0
    v_accvgpr_write_b32 a96, 0
    v_mfma_f32_16x16x32_bf16 v[112:115], a[244:247], a[228:231], v[112:115]
    s_add_u32 s27, s91, 39936
    buffer_load_dwordx4 v224, s[4:7], s27 offen offset:1024 lds
    ds_read_b128 a[168:171], v227 offset:2048
    v_accvgpr_write_b32 a97, 0
    v_mfma_f32_16x16x32_bf16 v[112:115], a[240:243], a[224:227], v[112:115]
    ds_read_b128 a[172:175], v228 offset:2048
    v_accvgpr_write_b32 a98, 0
    v_mfma_f32_16x16x32_bf16 v[144:147], a[240:243], a[232:235], v[144:147]
    ds_read_b128 a[176:179], v227 offset:4096
    v_accvgpr_write_b32 a99, 0
    v_mfma_f32_16x16x32_bf16 v[144:147], a[244:247], a[236:239], v[144:147]
    s_waitcnt lgkmcnt(7)
    ds_read_b128 a[180:183], v228 offset:4096
    v_accvgpr_write_b32 a100, 0
    v_mfma_f32_16x16x32_bf16 v[20:23], a[248:251], a[200:203], v[20:23]
    s_waitcnt lgkmcnt(6)
    ds_read_b64_tr_b16 a[240:241], v235 offset:0
    v_accvgpr_write_b32 a101, 0
    v_mfma_f32_16x16x32_bf16 v[20:23], a[252:255], a[204:207], v[20:23]
    ds_read_b64_tr_b16 a[242:243], v235 offset:1024
    v_accvgpr_write_b32 a102, 0
    v_mfma_f32_16x16x32_bf16 v[52:55], a[252:255], a[212:215], v[52:55]
    ds_read_b64_tr_b16 a[244:245], v235 offset:8192
    v_accvgpr_write_b32 a103, 0
    v_mfma_f32_16x16x32_bf16 v[52:55], a[248:251], a[208:211], v[52:55]
    s_add_u32 s27, s91, 47104
    ds_read_b64_tr_b16 a[246:247], v235 offset:9216
    buffer_load_dwordx4 v223, s[4:7], s27 offen offset:2048 lds
    v_accvgpr_write_b32 a104, 0
    v_mfma_f32_16x16x32_bf16 v[84:87], a[248:251], a[216:219], v[84:87]
    ds_read_b128 a[184:187], v227 offset:6144
    v_accvgpr_write_b32 a105, 0
    v_mfma_f32_16x16x32_bf16 v[84:87], a[252:255], a[220:223], v[84:87]
    ds_read_b128 a[188:191], v228 offset:6144
    v_accvgpr_write_b32 a106, 0
    v_mfma_f32_16x16x32_bf16 v[116:119], a[252:255], a[228:231], v[116:119]
    ds_read_b128 a[192:195], v227 offset:8192
    v_accvgpr_write_b32 a107, 0
    v_mfma_f32_16x16x32_bf16 v[116:119], a[248:251], a[224:227], v[116:119]
    ds_read_b128 a[196:199], v228 offset:8192
    v_accvgpr_write_b32 a108, 0
    v_mfma_f32_16x16x32_bf16 v[148:151], a[248:251], a[232:235], v[148:151]
    v_accvgpr_write_b32 a109, 0
    v_mfma_f32_16x16x32_bf16 v[148:151], a[252:255], a[236:239], v[148:151]
    s_waitcnt lgkmcnt(6)
    v_mfma_f32_16x16x32_bf16 v[24:27], a[240:243], a[200:203], v[24:27]
    s_waitcnt lgkmcnt(4)
    s_add_u32 s27, s91, 54272
    ds_read_b64_tr_b16 a[248:249], v236 offset:0
    buffer_load_dwordx4 v224, s[4:7], s27 offen offset:3072 lds
    v_mfma_f32_16x16x32_bf16 v[24:27], a[244:247], a[204:207], v[24:27]
    ds_read_b64_tr_b16 a[250:251], v236 offset:1024
    v_mfma_f32_16x16x32_bf16 v[56:59], a[244:247], a[212:215], v[56:59]
    ds_read_b64_tr_b16 a[252:253], v236 offset:8192
    v_mfma_f32_16x16x32_bf16 v[56:59], a[240:243], a[208:211], v[56:59]
    ds_read_b64_tr_b16 a[254:255], v236 offset:9216
    v_mfma_f32_16x16x32_bf16 v[88:91], a[240:243], a[216:219], v[88:91]
    v_mfma_f32_16x16x32_bf16 v[88:91], a[244:247], a[220:223], v[88:91]
    v_mfma_f32_16x16x32_bf16 v[120:123], a[244:247], a[228:231], v[120:123]
    s_add_u32 m0, s35, 49152
    v_mfma_f32_16x16x32_bf16 v[120:123], a[240:243], a[224:227], v[120:123]
    s_add_u32 s27, s91, 65536
    buffer_load_dwordx4 v223, s[4:7], s27 offen lds
    v_mfma_f32_16x16x32_bf16 v[152:155], a[240:243], a[232:235], v[152:155]
    v_mfma_f32_16x16x32_bf16 v[152:155], a[244:247], a[236:239], v[152:155]
    s_waitcnt vmcnt(9) lgkmcnt(0)
    s_barrier
    v_mfma_f32_16x16x32_bf16 v[28:31], a[248:251], a[200:203], v[28:31]
    ds_read_b64_tr_b16 a[240:241], v229 offset:16384
    v_mfma_f32_16x16x32_bf16 v[28:31], a[252:255], a[204:207], v[28:31]
    ds_read_b64_tr_b16 a[242:243], v229 offset:17408
    v_mfma_f32_16x16x32_bf16 v[60:63], a[252:255], a[212:215], v[60:63]
    ds_read_b64_tr_b16 a[244:245], v229 offset:24576
    v_mfma_f32_16x16x32_bf16 v[60:63], a[248:251], a[208:211], v[60:63]
    ds_read_b64_tr_b16 a[246:247], v229 offset:25600
    v_mfma_f32_16x16x32_bf16 v[92:95], a[248:251], a[216:219], v[92:95]
    s_add_u32 s27, s91, 72704
    buffer_load_dwordx4 v224, s[4:7], s27 offen offset:1024 lds
    v_mfma_f32_16x16x32_bf16 v[92:95], a[252:255], a[220:223], v[92:95]
    v_mfma_f32_16x16x32_bf16 v[124:127], a[252:255], a[228:231], v[124:127]
    v_mfma_f32_16x16x32_bf16 v[124:127], a[248:251], a[224:227], v[124:127]
    v_mfma_f32_16x16x32_bf16 v[156:159], a[248:251], a[232:235], v[156:159]
    v_mfma_f32_16x16x32_bf16 v[156:159], a[252:255], a[236:239], v[156:159]
    s_waitcnt lgkmcnt(2)
    v_mfma_f32_16x16x32_bf16 v[0:3], a[240:243], a[160:163], v[0:3]
    s_waitcnt lgkmcnt(0)
    ds_read_b64_tr_b16 a[248:249], v230 offset:16384
    v_mfma_f32_16x16x32_bf16 v[0:3], a[244:247], a[164:167], v[0:3]
    ds_read_b64_tr_b16 a[250:251], v230 offset:17408
    v_mfma_f32_16x16x32_bf16 v[32:35], a[244:247], a[172:175], v[32:35]
    ds_read_b64_tr_b16 a[252:253], v230 offset:24576
    v_mfma_f32_16x16x32_bf16 v[32:35], a[240:243], a[168:171], v[32:35]
    ds_read_b64_tr_b16 a[254:255], v230 offset:25600
    v_mfma_f32_16x16x32_bf16 v[64:67], a[240:243], a[176:179], v[64:67]
    v_mfma_f32_16x16x32_bf16 v[64:67], a[244:247], a[180:183], v[64:67]
    v_mfma_f32_16x16x32_bf16 v[96:99], a[244:247], a[188:191], v[96:99]
    v_mfma_f32_16x16x32_bf16 v[96:99], a[240:243], a[184:187], v[96:99]
    v_mfma_f32_16x16x32_bf16 v[128:131], a[240:243], a[192:195], v[128:131]
    v_mfma_f32_16x16x32_bf16 v[128:131], a[244:247], a[196:199], v[128:131]
    s_waitcnt lgkmcnt(2)
    v_mfma_f32_16x16x32_bf16 v[4:7], a[248:251], a[160:163], v[4:7]
    s_waitcnt lgkmcnt(0)
    ds_read_b64_tr_b16 a[240:241], v231 offset:16384
    v_mfma_f32_16x16x32_bf16 v[4:7], a[252:255], a[164:167], v[4:7]
    s_add_u32 m0, s35, 0
    ds_read_b64_tr_b16 a[242:243], v231 offset:17408
    v_mfma_f32_16x16x32_bf16 v[36:39], a[252:255], a[172:175], v[36:39]
    s_add_u32 s27, s92, 0
    ds_read_b64_tr_b16 a[244:245], v231 offset:24576
    buffer_load_dwordx4 v223, s[4:7], s27 offen lds
    v_mfma_f32_16x16x32_bf16 v[36:39], a[248:251], a[168:171], v[36:39]
    ds_read_b64_tr_b16 a[246:247], v231 offset:25600
    v_mfma_f32_16x16x32_bf16 v[68:71], a[248:251], a[176:179], v[68:71]
    v_mfma_f32_16x16x32_bf16 v[68:71], a[252:255], a[180:183], v[68:71]
    v_mfma_f32_16x16x32_bf16 v[100:103], a[252:255], a[188:191], v[100:103]
    v_mfma_f32_16x16x32_bf16 v[100:103], a[248:251], a[184:187], v[100:103]
    v_mfma_f32_16x16x32_bf16 v[132:135], a[248:251], a[192:195], v[132:135]
    s_add_u32 s27, s92, 7168
    buffer_load_dwordx4 v224, s[4:7], s27 offen offset:1024 lds
    v_mfma_f32_16x16x32_bf16 v[132:135], a[252:255], a[196:199], v[132:135]
    s_waitcnt lgkmcnt(2)
    v_mfma_f32_16x16x32_bf16 v[8:11], a[240:243], a[160:163], v[8:11]
    s_waitcnt lgkmcnt(0)
    ds_read_b64_tr_b16 a[248:249], v232 offset:16384
    v_mfma_f32_16x16x32_bf16 v[8:11], a[244:247], a[164:167], v[8:11]
    ds_read_b64_tr_b16 a[250:251], v232 offset:17408
    v_mfma_f32_16x16x32_bf16 v[40:43], a[244:247], a[172:175], v[40:43]
    ds_read_b64_tr_b16 a[252:253], v232 offset:24576
    v_mfma_f32_16x16x32_bf16 v[40:43], a[240:243], a[168:171], v[40:43]
    ds_read_b64_tr_b16 a[254:255], v232 offset:25600
    v_mfma_f32_16x16x32_bf16 v[72:75], a[240:243], a[176:179], v[72:75]
    v_mfma_f32_16x16x32_bf16 v[72:75], a[244:247], a[180:183], v[72:75]
    s_add_u32 s27, s92, 14336
    buffer_load_dwordx4 v223, s[4:7], s27 offen offset:2048 lds
    v_mfma_f32_16x16x32_bf16 v[104:107], a[244:247], a[188:191], v[104:107]
    v_mfma_f32_16x16x32_bf16 v[104:107], a[240:243], a[184:187], v[104:107]
    v_mfma_f32_16x16x32_bf16 v[136:139], a[240:243], a[192:195], v[136:139]
    v_mfma_f32_16x16x32_bf16 v[136:139], a[244:247], a[196:199], v[136:139]
    s_waitcnt lgkmcnt(2)
    v_mfma_f32_16x16x32_bf16 v[12:15], a[248:251], a[160:163], v[12:15]
    s_waitcnt lgkmcnt(0)
    ds_read_b64_tr_b16 a[240:241], v233 offset:16384
    v_mfma_f32_16x16x32_bf16 v[12:15], a[252:255], a[164:167], v[12:15]
    ds_read_b64_tr_b16 a[242:243], v233 offset:17408
    v_mfma_f32_16x16x32_bf16 v[44:47], a[252:255], a[172:175], v[44:47]
    s_add_u32 s27, s92, 21504
    ds_read_b64_tr_b16 a[244:245], v233 offset:24576
    buffer_load_dwordx4 v224, s[4:7], s27 offen offset:3072 lds
    v_mfma_f32_16x16x32_bf16 v[44:47], a[248:251], a[168:171], v[44:47]
    ds_read_b64_tr_b16 a[246:247], v233 offset:25600
    v_mfma_f32_16x16x32_bf16 v[76:79], a[248:251], a[176:179], v[76:79]
    v_mfma_f32_16x16x32_bf16 v[76:79], a[252:255], a[180:183], v[76:79]
    v_mfma_f32_16x16x32_bf16 v[108:111], a[252:255], a[188:191], v[108:111]
    v_mfma_f32_16x16x32_bf16 v[108:111], a[248:251], a[184:187], v[108:111]
    v_mfma_f32_16x16x32_bf16 v[140:143], a[248:251], a[192:195], v[140:143]
    s_add_u32 m0, s35, 4096
    v_mfma_f32_16x16x32_bf16 v[140:143], a[252:255], a[196:199], v[140:143]
    s_waitcnt lgkmcnt(2)
    s_add_u32 s27, s92, 32768
    buffer_load_dwordx4 v223, s[4:7], s27 offen lds
    v_mfma_f32_16x16x32_bf16 v[16:19], a[240:243], a[160:163], v[16:19]
    s_waitcnt lgkmcnt(0)
    ds_read_b64_tr_b16 a[248:249], v234 offset:16384
    v_mfma_f32_16x16x32_bf16 v[16:19], a[244:247], a[164:167], v[16:19]
    ds_read_b64_tr_b16 a[250:251], v234 offset:17408
    v_mfma_f32_16x16x32_bf16 v[48:51], a[244:247], a[172:175], v[48:51]
    ds_read_b64_tr_b16 a[252:253], v234 offset:24576
    v_mfma_f32_16x16x32_bf16 v[48:51], a[240:243], a[168:171], v[48:51]
    s_waitcnt vmcnt(5)
    ds_read_b64_tr_b16 a[254:255], v234 offset:25600
    v_mfma_f32_16x16x32_bf16 v[80:83], a[240:243], a[176:179], v[80:83]
    ds_read_b128 a[200:203], v227 offset:40960
    v_mfma_f32_16x16x32_bf16 v[80:83], a[244:247], a[180:183], v[80:83]
    ds_read_b128 a[204:207], v228 offset:40960
    v_mfma_f32_16x16x32_bf16 v[112:115], a[244:247], a[188:191], v[112:115]
    s_add_u32 s27, s92, 39936
    buffer_load_dwordx4 v224, s[4:7], s27 offen offset:1024 lds
    ds_read_b128 a[208:211], v227 offset:43008
    v_mfma_f32_16x16x32_bf16 v[112:115], a[240:243], a[184:187], v[112:115]
    ds_read_b128 a[212:215], v228 offset:43008
    v_mfma_f32_16x16x32_bf16 v[144:147], a[240:243], a[192:195], v[144:147]
    ds_read_b128 a[216:219], v227 offset:45056
    v_mfma_f32_16x16x32_bf16 v[144:147], a[244:247], a[196:199], v[144:147]
    s_waitcnt lgkmcnt(7)
    ds_read_b128 a[220:223], v228 offset:45056
    v_mfma_f32_16x16x32_bf16 v[20:23], a[248:251], a[160:163], v[20:23]
    s_waitcnt lgkmcnt(6)
    ds_read_b64_tr_b16 a[240:241], v235 offset:16384
    v_mfma_f32_16x16x32_bf16 v[20:23], a[252:255], a[164:167], v[20:23]
    ds_read_b64_tr_b16 a[242:243], v235 offset:17408
    v_mfma_f32_16x16x32_bf16 v[52:55], a[252:255], a[172:175], v[52:55]
    ds_read_b64_tr_b16 a[244:245], v235 offset:24576
    v_mfma_f32_16x16x32_bf16 v[52:55], a[248:251], a[168:171], v[52:55]
    s_add_u32 s27, s92, 47104
    ds_read_b64_tr_b16 a[246:247], v235 offset:25600
    buffer_load_dwordx4 v223, s[4:7], s27 offen offset:2048 lds
    v_mfma_f32_16x16x32_bf16 v[84:87], a[248:251], a[176:179], v[84:87]
    ds_read_b128 a[224:227], v227 offset:47104
    v_mfma_f32_16x16x32_bf16 v[84:87], a[252:255], a[180:183], v[84:87]
    ds_read_b128 a[228:231], v228 offset:47104
    v_mfma_f32_16x16x32_bf16 v[116:119], a[252:255], a[188:191], v[116:119]
    ds_read_b128 a[232:235], v227 offset:49152
    v_mfma_f32_16x16x32_bf16 v[116:119], a[248:251], a[184:187], v[116:119]
    ds_read_b128 a[236:239], v228 offset:49152
    v_mfma_f32_16x16x32_bf16 v[148:151], a[248:251], a[192:195], v[148:151]
    v_mfma_f32_16x16x32_bf16 v[148:151], a[252:255], a[196:199], v[148:151]
    s_waitcnt lgkmcnt(6)
    v_mfma_f32_16x16x32_bf16 v[24:27], a[240:243], a[160:163], v[24:27]
    s_waitcnt lgkmcnt(4)
    s_add_u32 s27, s92, 54272
    ds_read_b64_tr_b16 a[248:249], v236 offset:16384
    buffer_load_dwordx4 v224, s[4:7], s27 offen offset:3072 lds
    v_mfma_f32_16x16x32_bf16 v[24:27], a[244:247], a[164:167], v[24:27]
    ds_read_b64_tr_b16 a[250:251], v236 offset:17408
    v_mfma_f32_16x16x32_bf16 v[56:59], a[244:247], a[172:175], v[56:59]
    ds_read_b64_tr_b16 a[252:253], v236 offset:24576
    v_mfma_f32_16x16x32_bf16 v[56:59], a[240:243], a[168:171], v[56:59]
    ds_read_b64_tr_b16 a[254:255], v236 offset:25600
    v_mfma_f32_16x16x32_bf16 v[88:91], a[240:243], a[176:179], v[88:91]
    v_mfma_f32_16x16x32_bf16 v[88:91], a[244:247], a[180:183], v[88:91]
    v_mfma_f32_16x16x32_bf16 v[120:123], a[244:247], a[188:191], v[120:123]
    s_add_u32 m0, s35, 8192
    v_mfma_f32_16x16x32_bf16 v[120:123], a[240:243], a[184:187], v[120:123]
    s_add_u32 s27, s92, 65536
    buffer_load_dwordx4 v223, s[4:7], s27 offen lds
    v_mfma_f32_16x16x32_bf16 v[152:155], a[240:243], a[192:195], v[152:155]
    v_mfma_f32_16x16x32_bf16 v[152:155], a[244:247], a[196:199], v[152:155]
    s_waitcnt vmcnt(9) lgkmcnt(0)
    s_barrier
    v_mfma_f32_16x16x32_bf16 v[28:31], a[248:251], a[160:163], v[28:31]
    ds_read_b64_tr_b16 a[240:241], v229 offset:32768
    v_mfma_f32_16x16x32_bf16 v[28:31], a[252:255], a[164:167], v[28:31]
    ds_read_b64_tr_b16 a[242:243], v229 offset:33792
    v_mfma_f32_16x16x32_bf16 v[60:63], a[252:255], a[172:175], v[60:63]
    ds_read_b64_tr_b16 a[244:245], v229 offset:40960
    v_mfma_f32_16x16x32_bf16 v[60:63], a[248:251], a[168:171], v[60:63]
    ds_read_b64_tr_b16 a[246:247], v229 offset:41984
    v_mfma_f32_16x16x32_bf16 v[92:95], a[248:251], a[176:179], v[92:95]
    s_add_u32 s27, s92, 72704
    buffer_load_dwordx4 v224, s[4:7], s27 offen offset:1024 lds
    v_mfma_f32_16x16x32_bf16 v[92:95], a[252:255], a[180:183], v[92:95]
    v_mfma_f32_16x16x32_bf16 v[124:127], a[252:255], a[188:191], v[124:127]
    v_mfma_f32_16x16x32_bf16 v[124:127], a[248:251], a[184:187], v[124:127]
    v_mfma_f32_16x16x32_bf16 v[156:159], a[248:251], a[192:195], v[156:159]
    v_mfma_f32_16x16x32_bf16 v[156:159], a[252:255], a[196:199], v[156:159]
    s_waitcnt lgkmcnt(2)
    v_mfma_f32_16x16x32_bf16 v[0:3], a[240:243], a[200:203], v[0:3]
    s_waitcnt lgkmcnt(0)
    ds_read_b64_tr_b16 a[248:249], v230 offset:32768
    v_mfma_f32_16x16x32_bf16 v[0:3], a[244:247], a[204:207], v[0:3]
    ds_read_b64_tr_b16 a[250:251], v230 offset:33792
    v_mfma_f32_16x16x32_bf16 v[32:35], a[244:247], a[212:215], v[32:35]
    ds_read_b64_tr_b16 a[252:253], v230 offset:40960
    v_mfma_f32_16x16x32_bf16 v[32:35], a[240:243], a[208:211], v[32:35]
    ds_read_b64_tr_b16 a[254:255], v230 offset:41984
    v_mfma_f32_16x16x32_bf16 v[64:67], a[240:243], a[216:219], v[64:67]
    v_accvgpr_write_b32 a110, 0
    v_mfma_f32_16x16x32_bf16 v[64:67], a[244:247], a[220:223], v[64:67]
    v_accvgpr_write_b32 a111, 0
    v_mfma_f32_16x16x32_bf16 v[96:99], a[244:247], a[228:231], v[96:99]
    v_accvgpr_write_b32 a112, 0
    v_mfma_f32_16x16x32_bf16 v[96:99], a[240:243], a[224:227], v[96:99]
    v_accvgpr_write_b32 a113, 0
    v_mfma_f32_16x16x32_bf16 v[128:131], a[240:243], a[232:235], v[128:131]
    v_accvgpr_write_b32 a114, 0
    v_mfma_f32_16x16x32_bf16 v[128:131], a[244:247], a[236:239], v[128:131]
    s_waitcnt lgkmcnt(2)
    v_accvgpr_write_b32 a115, 0
    v_mfma_f32_16x16x32_bf16 v[4:7], a[248:251], a[200:203], v[4:7]
    s_waitcnt lgkmcnt(0)
    ds_read_b64_tr_b16 a[240:241], v231 offset:32768
    v_accvgpr_write_b32 a116, 0
    v_mfma_f32_16x16x32_bf16 v[4:7], a[252:255], a[204:207], v[4:7]
    s_add_u32 m0, s35, 40960
    ds_read_b64_tr_b16 a[242:243], v231 offset:33792
    v_accvgpr_write_b32 a117, 0
    v_mfma_f32_16x16x32_bf16 v[36:39], a[252:255], a[212:215], v[36:39]
    s_add_u32 s27, s93, 0
    ds_read_b64_tr_b16 a[244:245], v231 offset:40960
    buffer_load_dwordx4 v223, s[4:7], s27 offen lds
    v_accvgpr_write_b32 a118, 0
    v_mfma_f32_16x16x32_bf16 v[36:39], a[248:251], a[208:211], v[36:39]
    ds_read_b64_tr_b16 a[246:247], v231 offset:41984
    v_accvgpr_write_b32 a119, 0
    v_mfma_f32_16x16x32_bf16 v[68:71], a[248:251], a[216:219], v[68:71]
    v_accvgpr_write_b32 a120, 0
    v_mfma_f32_16x16x32_bf16 v[68:71], a[252:255], a[220:223], v[68:71]
    v_accvgpr_write_b32 a121, 0
    v_mfma_f32_16x16x32_bf16 v[100:103], a[252:255], a[228:231], v[100:103]
    v_accvgpr_write_b32 a122, 0
    v_mfma_f32_16x16x32_bf16 v[100:103], a[248:251], a[224:227], v[100:103]
    v_accvgpr_write_b32 a123, 0
    v_mfma_f32_16x16x32_bf16 v[132:135], a[248:251], a[232:235], v[132:135]
    s_add_u32 s27, s93, 7168
    buffer_load_dwordx4 v224, s[4:7], s27 offen offset:1024 lds
    v_accvgpr_write_b32 a124, 0
    v_mfma_f32_16x16x32_bf16 v[132:135], a[252:255], a[236:239], v[132:135]
    s_waitcnt lgkmcnt(2)
    v_accvgpr_write_b32 a125, 0
    v_mfma_f32_16x16x32_bf16 v[8:11], a[240:243], a[200:203], v[8:11]
    s_waitcnt lgkmcnt(0)
    ds_read_b64_tr_b16 a[248:249], v232 offset:32768
    v_accvgpr_write_b32 a126, 0
    v_mfma_f32_16x16x32_bf16 v[8:11], a[244:247], a[204:207], v[8:11]
    ds_read_b64_tr_b16 a[250:251], v232 offset:33792
    v_accvgpr_write_b32 a127, 0
    v_mfma_f32_16x16x32_bf16 v[40:43], a[244:247], a[212:215], v[40:43]
    ds_read_b64_tr_b16 a[252:253], v232 offset:40960
    v_accvgpr_write_b32 a128, 0
    v_mfma_f32_16x16x32_bf16 v[40:43], a[240:243], a[208:211], v[40:43]
    ds_read_b64_tr_b16 a[254:255], v232 offset:41984
    v_accvgpr_write_b32 a129, 0
    v_mfma_f32_16x16x32_bf16 v[72:75], a[240:243], a[216:219], v[72:75]
    v_accvgpr_write_b32 a130, 0
    v_mfma_f32_16x16x32_bf16 v[72:75], a[244:247], a[220:223], v[72:75]
    s_add_u32 s27, s93, 14336
    buffer_load_dwordx4 v223, s[4:7], s27 offen offset:2048 lds
    v_accvgpr_write_b32 a131, 0
    v_mfma_f32_16x16x32_bf16 v[104:107], a[244:247], a[228:231], v[104:107]
    v_accvgpr_write_b32 a132, 0
    v_mfma_f32_16x16x32_bf16 v[104:107], a[240:243], a[224:227], v[104:107]
    v_accvgpr_write_b32 a133, 0
    v_mfma_f32_16x16x32_bf16 v[136:139], a[240:243], a[232:235], v[136:139]
    v_accvgpr_write_b32 a134, 0
    v_mfma_f32_16x16x32_bf16 v[136:139], a[244:247], a[236:239], v[136:139]
    s_waitcnt lgkmcnt(2)
    v_accvgpr_write_b32 a135, 0
    v_mfma_f32_16x16x32_bf16 v[12:15], a[248:251], a[200:203], v[12:15]
    s_waitcnt lgkmcnt(0)
    ds_read_b64_tr_b16 a[240:241], v233 offset:32768
    v_accvgpr_write_b32 a136, 0
    v_mfma_f32_16x16x32_bf16 v[12:15], a[252:255], a[204:207], v[12:15]
    ds_read_b64_tr_b16 a[242:243], v233 offset:33792
    v_accvgpr_write_b32 a137, 0
    v_mfma_f32_16x16x32_bf16 v[44:47], a[252:255], a[212:215], v[44:47]
    s_add_u32 s27, s93, 21504
    ds_read_b64_tr_b16 a[244:245], v233 offset:40960
    buffer_load_dwordx4 v224, s[4:7], s27 offen offset:3072 lds
    v_accvgpr_write_b32 a138, 0
    v_mfma_f32_16x16x32_bf16 v[44:47], a[248:251], a[208:211], v[44:47]
    ds_read_b64_tr_b16 a[246:247], v233 offset:41984
    v_accvgpr_write_b32 a139, 0
    v_mfma_f32_16x16x32_bf16 v[76:79], a[248:251], a[216:219], v[76:79]
    v_accvgpr_write_b32 a140, 0
    v_mfma_f32_16x16x32_bf16 v[76:79], a[252:255], a[220:223], v[76:79]
    v_accvgpr_write_b32 a141, 0
    v_mfma_f32_16x16x32_bf16 v[108:111], a[252:255], a[228:231], v[108:111]
    v_accvgpr_write_b32 a142, 0
    v_mfma_f32_16x16x32_bf16 v[108:111], a[248:251], a[224:227], v[108:111]
    v_accvgpr_write_b32 a143, 0
    v_mfma_f32_16x16x32_bf16 v[140:143], a[248:251], a[232:235], v[140:143]
    s_add_u32 m0, s35, 45056
    v_accvgpr_write_b32 a144, 0
    v_mfma_f32_16x16x32_bf16 v[140:143], a[252:255], a[236:239], v[140:143]
    s_waitcnt lgkmcnt(2)
    s_add_u32 s27, s93, 32768
    buffer_load_dwordx4 v223, s[4:7], s27 offen lds
    v_accvgpr_write_b32 a145, 0
    v_mfma_f32_16x16x32_bf16 v[16:19], a[240:243], a[200:203], v[16:19]
    s_waitcnt lgkmcnt(0)
    ds_read_b64_tr_b16 a[248:249], v234 offset:32768
    v_accvgpr_write_b32 a146, 0
    v_mfma_f32_16x16x32_bf16 v[16:19], a[244:247], a[204:207], v[16:19]
    ds_read_b64_tr_b16 a[250:251], v234 offset:33792
    v_accvgpr_write_b32 a147, 0
    v_mfma_f32_16x16x32_bf16 v[48:51], a[244:247], a[212:215], v[48:51]
    ds_read_b64_tr_b16 a[252:253], v234 offset:40960
    v_accvgpr_write_b32 a148, 0
    v_mfma_f32_16x16x32_bf16 v[48:51], a[240:243], a[208:211], v[48:51]
    s_waitcnt vmcnt(5)
    ds_read_b64_tr_b16 a[254:255], v234 offset:41984
    v_accvgpr_write_b32 a149, 0
    v_mfma_f32_16x16x32_bf16 v[80:83], a[240:243], a[216:219], v[80:83]
    ds_read_b128 a[160:163], v227 offset:0
    v_accvgpr_write_b32 a150, 0
    v_mfma_f32_16x16x32_bf16 v[80:83], a[244:247], a[220:223], v[80:83]
    ds_read_b128 a[164:167], v228 offset:0
    v_accvgpr_write_b32 a151, 0
    v_mfma_f32_16x16x32_bf16 v[112:115], a[244:247], a[228:231], v[112:115]
    s_add_u32 s27, s93, 39936
    buffer_load_dwordx4 v224, s[4:7], s27 offen offset:1024 lds
    ds_read_b128 a[168:171], v227 offset:2048
    v_accvgpr_write_b32 a152, 0
    v_mfma_f32_16x16x32_bf16 v[112:115], a[240:243], a[224:227], v[112:115]
    ds_read_b128 a[172:175], v228 offset:2048
    v_accvgpr_write_b32 a153, 0
    v_mfma_f32_16x16x32_bf16 v[144:147], a[240:243], a[232:235], v[144:147]
    ds_read_b128 a[176:179], v227 offset:4096
    v_accvgpr_write_b32 a154, 0
    v_mfma_f32_16x16x32_bf16 v[144:147], a[244:247], a[236:239], v[144:147]
    s_waitcnt lgkmcnt(7)
    ds_read_b128 a[180:183], v228 offset:4096
    v_accvgpr_write_b32 a155, 0
    v_mfma_f32_16x16x32_bf16 v[20:23], a[248:251], a[200:203], v[20:23]
    s_waitcnt lgkmcnt(6)
    ds_read_b64_tr_b16 a[240:241], v235 offset:32768
    v_accvgpr_write_b32 a156, 0
    v_mfma_f32_16x16x32_bf16 v[20:23], a[252:255], a[204:207], v[20:23]
    ds_read_b64_tr_b16 a[242:243], v235 offset:33792
    v_accvgpr_write_b32 a157, 0
    v_mfma_f32_16x16x32_bf16 v[52:55], a[252:255], a[212:215], v[52:55]
    ds_read_b64_tr_b16 a[244:245], v235 offset:40960
    v_accvgpr_write_b32 a158, 0
    v_mfma_f32_16x16x32_bf16 v[52:55], a[248:251], a[208:211], v[52:55]
    s_add_u32 s27, s93, 47104
    ds_read_b64_tr_b16 a[246:247], v235 offset:41984
    buffer_load_dwordx4 v223, s[4:7], s27 offen offset:2048 lds
    v_accvgpr_write_b32 a159, 0
    v_mfma_f32_16x16x32_bf16 v[84:87], a[248:251], a[216:219], v[84:87]
    ds_read_b128 a[184:187], v227 offset:6144
    v_mov_b32 v200, 0
    v_mfma_f32_16x16x32_bf16 v[84:87], a[252:255], a[220:223], v[84:87]
    ds_read_b128 a[188:191], v228 offset:6144
    v_mov_b32 v201, 0
    v_mfma_f32_16x16x32_bf16 v[116:119], a[252:255], a[228:231], v[116:119]
    ds_read_b128 a[192:195], v227 offset:8192
    v_mov_b32 v202, 0
    v_mfma_f32_16x16x32_bf16 v[116:119], a[248:251], a[224:227], v[116:119]
    ds_read_b128 a[196:199], v228 offset:8192
    v_mov_b32 v203, 0
    v_mfma_f32_16x16x32_bf16 v[148:151], a[248:251], a[232:235], v[148:151]
    v_mov_b32 v204, 0
    v_mfma_f32_16x16x32_bf16 v[148:151], a[252:255], a[236:239], v[148:151]
    s_waitcnt lgkmcnt(6)
    v_mfma_f32_16x16x32_bf16 v[24:27], a[240:243], a[200:203], v[24:27]
    s_waitcnt lgkmcnt(4)
    s_add_u32 s27, s93, 54272
    ds_read_b64_tr_b16 a[248:249], v236 offset:32768
    buffer_load_dwordx4 v224, s[4:7], s27 offen offset:3072 lds
    v_mfma_f32_16x16x32_bf16 v[24:27], a[244:247], a[204:207], v[24:27]
    ds_read_b64_tr_b16 a[250:251], v236 offset:33792
    v_mfma_f32_16x16x32_bf16 v[56:59], a[244:247], a[212:215], v[56:59]
    ds_read_b64_tr_b16 a[252:253], v236 offset:40960
    v_mfma_f32_16x16x32_bf16 v[56:59], a[240:243], a[208:211], v[56:59]
    ds_read_b64_tr_b16 a[254:255], v236 offset:41984
    v_mfma_f32_16x16x32_bf16 v[88:91], a[240:243], a[216:219], v[88:91]
    v_mfma_f32_16x16x32_bf16 v[88:91], a[244:247], a[220:223], v[88:91]
    v_mfma_f32_16x16x32_bf16 v[120:123], a[244:247], a[228:231], v[120:123]
    s_add_u32 m0, s35, 49152
    v_mfma_f32_16x16x32_bf16 v[120:123], a[240:243], a[224:227], v[120:123]
    s_add_u32 s27, s93, 65536
    buffer_load_dwordx4 v223, s[4:7], s27 offen lds
    v_mfma_f32_16x16x32_bf16 v[152:155], a[240:243], a[232:235], v[152:155]
    v_mfma_f32_16x16x32_bf16 v[152:155], a[244:247], a[236:239], v[152:155]
    s_waitcnt vmcnt(9) lgkmcnt(0)
    s_barrier
    v_mfma_f32_16x16x32_bf16 v[28:31], a[248:251], a[200:203], v[28:31]
    ds_read_b64_tr_b16 a[240:241], v229 offset:0
    v_mfma_f32_16x16x32_bf16 v[28:31], a[252:255], a[204:207], v[28:31]
    ds_read_b64_tr_b16 a[242:243], v229 offset:1024
    v_mfma_f32_16x16x32_bf16 v[60:63], a[252:255], a[212:215], v[60:63]
    ds_read_b64_tr_b16 a[244:245], v229 offset:8192
    v_mfma_f32_16x16x32_bf16 v[60:63], a[248:251], a[208:211], v[60:63]
    ds_read_b64_tr_b16 a[246:247], v229 offset:9216
    v_mfma_f32_16x16x32_bf16 v[92:95], a[248:251], a[216:219], v[92:95]
    s_add_u32 s27, s93, 72704
    buffer_load_dwordx4 v224, s[4:7], s27 offen offset:1024 lds
    v_mfma_f32_16x16x32_bf16 v[92:95], a[252:255], a[220:223], v[92:95]
    v_mfma_f32_16x16x32_bf16 v[124:127], a[252:255], a[228:231], v[124:127]
    v_mfma_f32_16x16x32_bf16 v[124:127], a[248:251], a[224:227], v[124:127]
    v_mfma_f32_16x16x32_bf16 v[156:159], a[248:251], a[232:235], v[156:159]
    v_mfma_f32_16x16x32_bf16 v[156:159], a[252:255], a[236:239], v[156:159]
    s_waitcnt lgkmcnt(2)
    v_mfma_f32_16x16x32_bf16 v[0:3], a[240:243], a[160:163], v[0:3]
    s_waitcnt lgkmcnt(0)
    ds_read_b64_tr_b16 a[248:249], v230 offset:0
    v_mfma_f32_16x16x32_bf16 v[0:3], a[244:247], a[164:167], v[0:3]
    ds_read_b64_tr_b16 a[250:251], v230 offset:1024
    v_mfma_f32_16x16x32_bf16 v[32:35], a[244:247], a[172:175], v[32:35]
    ds_read_b64_tr_b16 a[252:253], v230 offset:8192
    v_mfma_f32_16x16x32_bf16 v[32:35], a[240:243], a[168:171], v[32:35]
    ds_read_b64_tr_b16 a[254:255], v230 offset:9216
    v_mfma_f32_16x16x32_bf16 v[64:67], a[240:243], a[176:179], v[64:67]
    v_and_b32 v243, 1, v239
    v_mfma_f32_16x16x32_bf16 v[64:67], a[244:247], a[180:183], v[64:67]
    v_lshrrev_b32 v244, 1, v241
    v_mfma_f32_16x16x32_bf16 v[96:99], a[244:247], a[188:191], v[96:99]
    v_lshl_add_u32 v243, v243, 1, v244
    v_mfma_f32_16x16x32_bf16 v[96:99], a[240:243], a[184:187], v[96:99]
    v_lshl_add_u32 v244, v239, 2, v241
    v_mfma_f32_16x16x32_bf16 v[128:131], a[240:243], a[192:195], v[128:131]
    v_lshlrev_b32 v244, 7, v244
    v_mfma_f32_16x16x32_bf16 v[128:131], a[244:247], a[196:199], v[128:131]
    s_waitcnt lgkmcnt(2)
    v_lshl_add_u32 v244, v242, 3, v244
    v_mfma_f32_16x16x32_bf16 v[4:7], a[248:251], a[160:163], v[4:7]
    s_waitcnt lgkmcnt(0)
    ds_read_b64_tr_b16 a[240:241], v231 offset:0
    v_lshl_add_u32 v244, v243, 5, v244
    v_mfma_f32_16x16x32_bf16 v[4:7], a[252:255], a[164:167], v[4:7]
    ds_read_b64_tr_b16 a[242:243], v231 offset:1024
    v_add_u32 v244, s34, v244
    v_mfma_f32_16x16x32_bf16 v[36:39], a[252:255], a[172:175], v[36:39]
    ds_read_b64_tr_b16 a[244:245], v231 offset:8192
    v_add_u32 v223, 0x24000, v244
    v_mfma_f32_16x16x32_bf16 v[36:39], a[248:251], a[168:171], v[36:39]
    ds_read_b64_tr_b16 a[246:247], v231 offset:9216
    v_xor_b32 v224, 0x20, v223
    v_mfma_f32_16x16x32_bf16 v[68:71], a[248:251], a[176:179], v[68:71]
    v_xor_b32 v225, 0x40, v223
    v_mfma_f32_16x16x32_bf16 v[68:71], a[252:255], a[180:183], v[68:71]
    v_xor_b32 v226, 0x60, v223
    v_mfma_f32_16x16x32_bf16 v[100:103], a[252:255], a[188:191], v[100:103]
    v_mfma_f32_16x16x32_bf16 v[100:103], a[248:251], a[184:187], v[100:103]
    v_mfma_f32_16x16x32_bf16 v[132:135], a[248:251], a[192:195], v[132:135]
    v_mfma_f32_16x16x32_bf16 v[132:135], a[252:255], a[196:199], v[132:135]
    s_waitcnt lgkmcnt(2)
    v_mfma_f32_16x16x32_bf16 v[8:11], a[240:243], a[160:163], v[8:11]
    s_waitcnt lgkmcnt(0)
    ds_read_b64_tr_b16 a[248:249], v232 offset:0
    v_mfma_f32_16x16x32_bf16 v[8:11], a[244:247], a[164:167], v[8:11]
    ds_read_b64_tr_b16 a[250:251], v232 offset:1024
    v_mfma_f32_16x16x32_bf16 v[40:43], a[244:247], a[172:175], v[40:43]
    ds_read_b64_tr_b16 a[252:253], v232 offset:8192
    v_mfma_f32_16x16x32_bf16 v[40:43], a[240:243], a[168:171], v[40:43]
    ds_read_b64_tr_b16 a[254:255], v232 offset:9216
    v_mfma_f32_16x16x32_bf16 v[72:75], a[240:243], a[176:179], v[72:75]
    v_mfma_f32_16x16x32_bf16 v[72:75], a[244:247], a[180:183], v[72:75]
    v_mfma_f32_16x16x32_bf16 v[104:107], a[244:247], a[188:191], v[104:107]
    v_mfma_f32_16x16x32_bf16 v[104:107], a[240:243], a[184:187], v[104:107]
    v_mfma_f32_16x16x32_bf16 v[136:139], a[240:243], a[192:195], v[136:139]
    v_mfma_f32_16x16x32_bf16 v[136:139], a[244:247], a[196:199], v[136:139]
    s_waitcnt lgkmcnt(2)
    v_mfma_f32_16x16x32_bf16 v[12:15], a[248:251], a[160:163], v[12:15]
    s_waitcnt lgkmcnt(0)
    ds_read_b64_tr_b16 a[240:241], v233 offset:0
    v_mfma_f32_16x16x32_bf16 v[12:15], a[252:255], a[164:167], v[12:15]
    ds_read_b64_tr_b16 a[242:243], v233 offset:1024
    v_mfma_f32_16x16x32_bf16 v[44:47], a[252:255], a[172:175], v[44:47]
    ds_read_b64_tr_b16 a[244:245], v233 offset:8192
    v_mfma_f32_16x16x32_bf16 v[44:47], a[248:251], a[168:171], v[44:47]
    ds_read_b64_tr_b16 a[246:247], v233 offset:9216
    v_mfma_f32_16x16x32_bf16 v[76:79], a[248:251], a[176:179], v[76:79]
    v_mfma_f32_16x16x32_bf16 v[76:79], a[252:255], a[180:183], v[76:79]
    v_mfma_f32_16x16x32_bf16 v[108:111], a[252:255], a[188:191], v[108:111]
    v_mfma_f32_16x16x32_bf16 v[108:111], a[248:251], a[184:187], v[108:111]
    v_mfma_f32_16x16x32_bf16 v[140:143], a[248:251], a[192:195], v[140:143]
    v_mfma_f32_16x16x32_bf16 v[140:143], a[252:255], a[196:199], v[140:143]
    s_waitcnt lgkmcnt(2)
    v_mfma_f32_16x16x32_bf16 v[16:19], a[240:243], a[160:163], v[16:19]
    s_waitcnt lgkmcnt(0)
    ds_read_b64_tr_b16 a[248:249], v234 offset:0
    v_mfma_f32_16x16x32_bf16 v[16:19], a[244:247], a[164:167], v[16:19]
    ds_read_b64_tr_b16 a[250:251], v234 offset:1024
    v_mfma_f32_16x16x32_bf16 v[48:51], a[244:247], a[172:175], v[48:51]
    ds_read_b64_tr_b16 a[252:253], v234 offset:8192
    v_mfma_f32_16x16x32_bf16 v[48:51], a[240:243], a[168:171], v[48:51]
    s_waitcnt vmcnt(0)
    ds_read_b64_tr_b16 a[254:255], v234 offset:9216
    v_mfma_f32_16x16x32_bf16 v[80:83], a[240:243], a[176:179], v[80:83]
    ds_read_b128 a[200:203], v227 offset:40960
    v_mfma_f32_16x16x32_bf16 v[80:83], a[244:247], a[180:183], v[80:83]
    ds_read_b128 a[204:207], v228 offset:40960
    v_mfma_f32_16x16x32_bf16 v[112:115], a[244:247], a[188:191], v[112:115]
    ds_read_b128 a[208:211], v227 offset:43008
    v_mfma_f32_16x16x32_bf16 v[112:115], a[240:243], a[184:187], v[112:115]
    ds_read_b128 a[212:215], v228 offset:43008
    v_mfma_f32_16x16x32_bf16 v[144:147], a[240:243], a[192:195], v[144:147]
    ds_read_b128 a[216:219], v227 offset:45056
    v_mfma_f32_16x16x32_bf16 v[144:147], a[244:247], a[196:199], v[144:147]
    s_waitcnt lgkmcnt(7)
    ds_read_b128 a[220:223], v228 offset:45056
    v_mfma_f32_16x16x32_bf16 v[20:23], a[248:251], a[160:163], v[20:23]
    s_waitcnt lgkmcnt(6)
    ds_read_b64_tr_b16 a[240:241], v235 offset:0
    v_mfma_f32_16x16x32_bf16 v[20:23], a[252:255], a[164:167], v[20:23]
    ds_read_b64_tr_b16 a[242:243], v235 offset:1024
    v_mfma_f32_16x16x32_bf16 v[52:55], a[252:255], a[172:175], v[52:55]
    ds_read_b64_tr_b16 a[244:245], v235 offset:8192
    v_mfma_f32_16x16x32_bf16 v[52:55], a[248:251], a[168:171], v[52:55]
    ds_read_b64_tr_b16 a[246:247], v235 offset:9216
    v_mfma_f32_16x16x32_bf16 v[84:87], a[248:251], a[176:179], v[84:87]
    ds_read_b128 a[224:227], v227 offset:47104
    v_mfma_f32_16x16x32_bf16 v[84:87], a[252:255], a[180:183], v[84:87]
    ds_read_b128 a[228:231], v228 offset:47104
    v_mfma_f32_16x16x32_bf16 v[116:119], a[252:255], a[188:191], v[116:119]
    ds_read_b128 a[232:235], v227 offset:49152
    v_mfma_f32_16x16x32_bf16 v[116:119], a[248:251], a[184:187], v[116:119]
    ds_read_b128 a[236:239], v228 offset:49152
    v_mfma_f32_16x16x32_bf16 v[148:151], a[248:251], a[192:195], v[148:151]
    v_mfma_f32_16x16x32_bf16 v[148:151], a[252:255], a[196:199], v[148:151]
    s_waitcnt lgkmcnt(6)
    v_mfma_f32_16x16x32_bf16 v[24:27], a[240:243], a[160:163], v[24:27]
    s_waitcnt lgkmcnt(4)
    ds_read_b64_tr_b16 a[248:249], v236 offset:0
    v_mfma_f32_16x16x32_bf16 v[24:27], a[244:247], a[164:167], v[24:27]
    ds_read_b64_tr_b16 a[250:251], v236 offset:1024
    v_mfma_f32_16x16x32_bf16 v[56:59], a[244:247], a[172:175], v[56:59]
    ds_read_b64_tr_b16 a[252:253], v236 offset:8192
    v_mfma_f32_16x16x32_bf16 v[56:59], a[240:243], a[168:171], v[56:59]
    ds_read_b64_tr_b16 a[254:255], v236 offset:9216
    v_mfma_f32_16x16x32_bf16 v[88:91], a[240:243], a[176:179], v[88:91]
    v_mfma_f32_16x16x32_bf16 v[88:91], a[244:247], a[180:183], v[88:91]
    v_mfma_f32_16x16x32_bf16 v[120:123], a[244:247], a[188:191], v[120:123]
    v_mfma_f32_16x16x32_bf16 v[120:123], a[240:243], a[184:187], v[120:123]
    v_mfma_f32_16x16x32_bf16 v[152:155], a[240:243], a[192:195], v[152:155]
    v_mfma_f32_16x16x32_bf16 v[152:155], a[244:247], a[196:199], v[152:155]
    s_waitcnt vmcnt(0) lgkmcnt(0)
    s_barrier
    v_mfma_f32_16x16x32_bf16 v[28:31], a[248:251], a[160:163], v[28:31]
    ds_read_b64_tr_b16 a[240:241], v229 offset:16384
    v_mfma_f32_16x16x32_bf16 v[28:31], a[252:255], a[164:167], v[28:31]
    ds_read_b64_tr_b16 a[242:243], v229 offset:17408
    v_mfma_f32_16x16x32_bf16 v[60:63], a[252:255], a[172:175], v[60:63]
    ds_read_b64_tr_b16 a[244:245], v229 offset:24576
    v_mfma_f32_16x16x32_bf16 v[60:63], a[248:251], a[168:171], v[60:63]
    ds_read_b64_tr_b16 a[246:247], v229 offset:25600
    v_mfma_f32_16x16x32_bf16 v[92:95], a[248:251], a[176:179], v[92:95]
    v_mfma_f32_16x16x32_bf16 v[92:95], a[252:255], a[180:183], v[92:95]
    v_mfma_f32_16x16x32_bf16 v[124:127], a[252:255], a[188:191], v[124:127]
    v_mfma_f32_16x16x32_bf16 v[124:127], a[248:251], a[184:187], v[124:127]
    v_mfma_f32_16x16x32_bf16 v[156:159], a[248:251], a[192:195], v[156:159]
    v_mfma_f32_16x16x32_bf16 v[156:159], a[252:255], a[196:199], v[156:159]
    s_waitcnt lgkmcnt(2)
    v_mfma_f32_16x16x32_bf16 v[0:3], a[240:243], a[200:203], v[0:3]
    s_waitcnt lgkmcnt(0)
    ds_read_b64_tr_b16 a[248:249], v230 offset:16384
    v_mfma_f32_16x16x32_bf16 v[0:3], a[244:247], a[204:207], v[0:3]
    s_add_u32 m0, s34, 147456
    ds_read_b64_tr_b16 a[250:251], v230 offset:17408
    v_mfma_f32_16x16x32_bf16 v[32:35], a[244:247], a[212:215], v[32:35]
    s_add_u32 s27, s28, 0
    ds_read_b64_tr_b16 a[252:253], v230 offset:24576
    buffer_load_dwordx4 v251, s[56:59], s27 offen nt lds
    v_mfma_f32_16x16x32_bf16 v[32:35], a[240:243], a[208:211], v[32:35]
    ds_read_b64_tr_b16 a[254:255], v230 offset:25600
    v_mfma_f32_16x16x32_bf16 v[64:67], a[240:243], a[216:219], v[64:67]
    v_mfma_f32_16x16x32_bf16 v[64:67], a[244:247], a[220:223], v[64:67]
    v_mfma_f32_16x16x32_bf16 v[96:99], a[244:247], a[228:231], v[96:99]
    v_mfma_f32_16x16x32_bf16 v[96:99], a[240:243], a[224:227], v[96:99]
    v_mfma_f32_16x16x32_bf16 v[128:131], a[240:243], a[232:235], v[128:131]
    s_add_u32 s27, s28, 7168
    buffer_load_dwordx4 v251, s[56:59], s27 offen offset:1024 nt lds
    v_mfma_f32_16x16x32_bf16 v[128:131], a[244:247], a[236:239], v[128:131]
    s_waitcnt lgkmcnt(2)
    v_mfma_f32_16x16x32_bf16 v[4:7], a[248:251], a[200:203], v[4:7]
    s_waitcnt lgkmcnt(0)
    ds_read_b64_tr_b16 a[240:241], v231 offset:16384
    v_mfma_f32_16x16x32_bf16 v[4:7], a[252:255], a[204:207], v[4:7]
    ds_read_b64_tr_b16 a[242:243], v231 offset:17408
    v_mfma_f32_16x16x32_bf16 v[36:39], a[252:255], a[212:215], v[36:39]
    ds_read_b64_tr_b16 a[244:245], v231 offset:24576
    v_mfma_f32_16x16x32_bf16 v[36:39], a[248:251], a[208:211], v[36:39]
    ds_read_b64_tr_b16 a[246:247], v231 offset:25600
    v_mfma_f32_16x16x32_bf16 v[68:71], a[248:251], a[216:219], v[68:71]
    s_add_u32 s27, s28, 14336
    buffer_load_dwordx4 v251, s[56:59], s27 offen offset:2048 nt lds
    v_mfma_f32_16x16x32_bf16 v[68:71], a[252:255], a[220:223], v[68:71]
    v_mul_f32 v0, s33, v0
    v_mul_f32 v1, s33, v1
    v_mfma_f32_16x16x32_bf16 v[100:103], a[252:255], a[228:231], v[100:103]
    v_mul_f32 v2, s33, v2
    v_mul_f32 v3, s33, v3
    v_mfma_f32_16x16x32_bf16 v[100:103], a[248:251], a[224:227], v[100:103]
    v_mul_f32 v32, s33, v32
    v_mul_f32 v33, s33, v33
    v_mfma_f32_16x16x32_bf16 v[132:135], a[248:251], a[232:235], v[132:135]
    v_mul_f32 v34, s33, v34
    v_mul_f32 v35, s33, v35
    v_mfma_f32_16x16x32_bf16 v[132:135], a[252:255], a[236:239], v[132:135]
    s_waitcnt lgkmcnt(2)
    v_mul_f32 v64, s33, v64
    v_mul_f32 v65, s33, v65
    v_mfma_f32_16x16x32_bf16 v[8:11], a[240:243], a[200:203], v[8:11]
    s_waitcnt lgkmcnt(0)
    s_add_u32 s27, s28, 21504
    ds_read_b64_tr_b16 a[248:249], v232 offset:16384
    buffer_load_dwordx4 v251, s[56:59], s27 offen offset:3072 nt lds
    v_mfma_f32_16x16x32_bf16 v[8:11], a[244:247], a[204:207], v[8:11]
    ds_read_b64_tr_b16 a[250:251], v232 offset:17408
    v_mul_f32 v66, s33, v66
    v_mfma_f32_16x16x32_bf16 v[40:43], a[244:247], a[212:215], v[40:43]
    ds_read_b64_tr_b16 a[252:253], v232 offset:24576
    v_mul_f32 v67, s33, v67
    v_mfma_f32_16x16x32_bf16 v[40:43], a[240:243], a[208:211], v[40:43]
    ds_read_b64_tr_b16 a[254:255], v232 offset:25600
    v_mul_f32 v96, s33, v96
    v_mfma_f32_16x16x32_bf16 v[72:75], a[240:243], a[216:219], v[72:75]
    v_mul_f32 v97, s33, v97
    v_mul_f32 v98, s33, v98
    v_mfma_f32_16x16x32_bf16 v[72:75], a[244:247], a[220:223], v[72:75]
    v_mul_f32 v99, s33, v99
    v_mul_f32 v128, s33, v128
    v_mfma_f32_16x16x32_bf16 v[104:107], a[244:247], a[228:231], v[104:107]
    v_mul_f32 v129, s33, v129
    v_mul_f32 v130, s33, v130
    v_mfma_f32_16x16x32_bf16 v[104:107], a[240:243], a[224:227], v[104:107]
    v_mul_f32 v131, s33, v131
    v_mul_f32 v4, s33, v4
    v_mfma_f32_16x16x32_bf16 v[136:139], a[240:243], a[232:235], v[136:139]
    v_mul_f32 v5, s33, v5
    v_mul_f32 v6, s33, v6
    v_mfma_f32_16x16x32_bf16 v[136:139], a[244:247], a[236:239], v[136:139]
    s_waitcnt lgkmcnt(2)
    v_mul_f32 v7, s33, v7
    v_mul_f32 v36, s33, v36
    v_mfma_f32_16x16x32_bf16 v[12:15], a[248:251], a[200:203], v[12:15]
    s_waitcnt lgkmcnt(0)
    ds_read_b64_tr_b16 a[240:241], v233 offset:16384
    v_mul_f32 v37, s33, v37
    v_mfma_f32_16x16x32_bf16 v[12:15], a[252:255], a[204:207], v[12:15]
    ds_read_b64_tr_b16 a[242:243], v233 offset:17408
    v_mul_f32 v38, s33, v38
    v_mfma_f32_16x16x32_bf16 v[44:47], a[252:255], a[212:215], v[44:47]
    ds_read_b64_tr_b16 a[244:245], v233 offset:24576
    v_mul_f32 v39, s33, v39
    v_mfma_f32_16x16x32_bf16 v[44:47], a[248:251], a[208:211], v[44:47]
    ds_read_b64_tr_b16 a[246:247], v233 offset:25600
    v_mul_f32 v68, s33, v68
    v_mfma_f32_16x16x32_bf16 v[76:79], a[248:251], a[216:219], v[76:79]
    v_mul_f32 v69, s33, v69
    v_mul_f32 v70, s33, v70
    v_mfma_f32_16x16x32_bf16 v[76:79], a[252:255], a[220:223], v[76:79]
    v_mul_f32 v71, s33, v71
    v_mul_f32 v100, s33, v100
    v_mfma_f32_16x16x32_bf16 v[108:111], a[252:255], a[228:231], v[108:111]
    v_mul_f32 v101, s33, v101
    v_mul_f32 v102, s33, v102
    v_mfma_f32_16x16x32_bf16 v[108:111], a[248:251], a[224:227], v[108:111]
    v_mul_f32 v103, s33, v103
    v_mul_f32 v132, s33, v132
    v_mfma_f32_16x16x32_bf16 v[140:143], a[248:251], a[232:235], v[140:143]
    v_mul_f32 v133, s33, v133
    v_mul_f32 v134, s33, v134
    v_mfma_f32_16x16x32_bf16 v[140:143], a[252:255], a[236:239], v[140:143]
    s_waitcnt lgkmcnt(2)
    v_mul_f32 v135, s33, v135
    v_mul_f32 v8, s33, v8
    v_mfma_f32_16x16x32_bf16 v[16:19], a[240:243], a[200:203], v[16:19]
    s_waitcnt lgkmcnt(0)
    ds_read_b64_tr_b16 a[248:249], v234 offset:16384
    v_mul_f32 v9, s33, v9
    v_mfma_f32_16x16x32_bf16 v[16:19], a[244:247], a[204:207], v[16:19]
    ds_read_b64_tr_b16 a[250:251], v234 offset:17408
    v_mul_f32 v10, s33, v10
    v_mfma_f32_16x16x32_bf16 v[48:51], a[244:247], a[212:215], v[48:51]
    ds_read_b64_tr_b16 a[252:253], v234 offset:24576
    v_mul_f32 v11, s33, v11
    v_mfma_f32_16x16x32_bf16 v[48:51], a[240:243], a[208:211], v[48:51]
    ds_read_b64_tr_b16 a[254:255], v234 offset:25600
    v_mul_f32 v40, s33, v40
    v_mfma_f32_16x16x32_bf16 v[80:83], a[240:243], a[216:219], v[80:83]
    v_mul_f32 v41, s33, v41
    v_mul_f32 v42, s33, v42
    v_mfma_f32_16x16x32_bf16 v[80:83], a[244:247], a[220:223], v[80:83]
    v_mul_f32 v43, s33, v43
    v_mul_f32 v72, s33, v72
    v_mfma_f32_16x16x32_bf16 v[112:115], a[244:247], a[228:231], v[112:115]
    v_mul_f32 v73, s33, v73
    v_mul_f32 v74, s33, v74
    v_mfma_f32_16x16x32_bf16 v[112:115], a[240:243], a[224:227], v[112:115]
    v_mul_f32 v75, s33, v75
    v_mul_f32 v104, s33, v104
    v_mfma_f32_16x16x32_bf16 v[144:147], a[240:243], a[232:235], v[144:147]
    v_mul_f32 v105, s33, v105
    v_mul_f32 v106, s33, v106
    v_mfma_f32_16x16x32_bf16 v[144:147], a[244:247], a[236:239], v[144:147]
    s_waitcnt lgkmcnt(2)
    v_mul_f32 v107, s33, v107
    v_mul_f32 v136, s33, v136
    v_mfma_f32_16x16x32_bf16 v[20:23], a[248:251], a[200:203], v[20:23]
    s_waitcnt lgkmcnt(0)
    ds_read_b64_tr_b16 a[240:241], v235 offset:16384
    v_mul_f32 v137, s33, v137
    v_mfma_f32_16x16x32_bf16 v[20:23], a[252:255], a[204:207], v[20:23]
    ds_read_b64_tr_b16 a[242:243], v235 offset:17408
    v_mul_f32 v138, s33, v138
    v_mfma_f32_16x16x32_bf16 v[52:55], a[252:255], a[212:215], v[52:55]
    ds_read_b64_tr_b16 a[244:245], v235 offset:24576
    v_mul_f32 v139, s33, v139
    v_mfma_f32_16x16x32_bf16 v[52:55], a[248:251], a[208:211], v[52:55]
    ds_read_b64_tr_b16 a[246:247], v235 offset:25600
    v_mul_f32 v12, s33, v12
    v_mfma_f32_16x16x32_bf16 v[84:87], a[248:251], a[216:219], v[84:87]
    v_mul_f32 v13, s33, v13
    v_mul_f32 v14, s33, v14
    v_mfma_f32_16x16x32_bf16 v[84:87], a[252:255], a[220:223], v[84:87]
    v_mul_f32 v15, s33, v15
    v_mul_f32 v44, s33, v44
    v_mfma_f32_16x16x32_bf16 v[116:119], a[252:255], a[228:231], v[116:119]
    v_mul_f32 v45, s33, v45
    v_mul_f32 v46, s33, v46
    v_mfma_f32_16x16x32_bf16 v[116:119], a[248:251], a[224:227], v[116:119]
    v_mul_f32 v47, s33, v47
    v_mul_f32 v76, s33, v76
    v_mfma_f32_16x16x32_bf16 v[148:151], a[248:251], a[232:235], v[148:151]
    v_mul_f32 v77, s33, v77
    v_mul_f32 v78, s33, v78
    v_mfma_f32_16x16x32_bf16 v[148:151], a[252:255], a[236:239], v[148:151]
    s_waitcnt lgkmcnt(2)
    v_mul_f32 v79, s33, v79
    v_mul_f32 v108, s33, v108
    v_mfma_f32_16x16x32_bf16 v[24:27], a[240:243], a[200:203], v[24:27]
    s_waitcnt lgkmcnt(0)
    ds_read_b64_tr_b16 a[248:249], v236 offset:16384
    v_mul_f32 v109, s33, v109
    v_mfma_f32_16x16x32_bf16 v[24:27], a[244:247], a[204:207], v[24:27]
    ds_read_b64_tr_b16 a[250:251], v236 offset:17408
    v_mul_f32 v110, s33, v110
    v_mfma_f32_16x16x32_bf16 v[56:59], a[244:247], a[212:215], v[56:59]
    ds_read_b64_tr_b16 a[252:253], v236 offset:24576
    v_mul_f32 v111, s33, v111
    v_mfma_f32_16x16x32_bf16 v[56:59], a[240:243], a[208:211], v[56:59]
    ds_read_b64_tr_b16 a[254:255], v236 offset:25600
    v_mul_f32 v140, s33, v140
    v_mfma_f32_16x16x32_bf16 v[88:91], a[240:243], a[216:219], v[88:91]
    v_mul_f32 v141, s33, v141
    v_mul_f32 v142, s33, v142
    v_mfma_f32_16x16x32_bf16 v[88:91], a[244:247], a[220:223], v[88:91]
    v_mul_f32 v143, s33, v143
    v_mul_f32 v16, s33, v16
    v_mfma_f32_16x16x32_bf16 v[120:123], a[244:247], a[228:231], v[120:123]
    v_mul_f32 v17, s33, v17
    v_mul_f32 v18, s33, v18
    v_mfma_f32_16x16x32_bf16 v[120:123], a[240:243], a[224:227], v[120:123]
    v_mul_f32 v19, s33, v19
    v_mul_f32 v48, s33, v48
    v_mfma_f32_16x16x32_bf16 v[152:155], a[240:243], a[232:235], v[152:155]
    v_mul_f32 v49, s33, v49
    v_mul_f32 v50, s33, v50
    v_mfma_f32_16x16x32_bf16 v[152:155], a[244:247], a[236:239], v[152:155]
    s_waitcnt vmcnt(4) lgkmcnt(0)
    s_barrier
    v_mul_f32 v51, s33, v51
    v_mul_f32 v80, s33, v80
    v_mfma_f32_16x16x32_bf16 v[28:31], a[248:251], a[200:203], v[28:31]
    ds_read_b128 a[160:163], v205 offset:0
    v_mul_f32 v81, s33, v81
    v_mfma_f32_16x16x32_bf16 v[28:31], a[252:255], a[204:207], v[28:31]
    ds_read_b128 a[164:167], v206 offset:0
    v_mul_f32 v82, s33, v82
    v_mfma_f32_16x16x32_bf16 v[60:63], a[252:255], a[212:215], v[60:63]
    ds_read_b128 a[168:171], v207 offset:0
    v_mul_f32 v83, s33, v83
    v_mfma_f32_16x16x32_bf16 v[60:63], a[248:251], a[208:211], v[60:63]
    ds_read_b128 a[172:175], v208 offset:0
    v_mul_f32 v112, s33, v112
    v_mfma_f32_16x16x32_bf16 v[92:95], a[248:251], a[216:219], v[92:95]
    v_mul_f32 v113, s33, v113
    v_mul_f32 v114, s33, v114
    v_mfma_f32_16x16x32_bf16 v[92:95], a[252:255], a[220:223], v[92:95]
    v_mul_f32 v115, s33, v115
    v_mul_f32 v144, s33, v144
    v_mfma_f32_16x16x32_bf16 v[124:127], a[252:255], a[228:231], v[124:127]
    v_mul_f32 v145, s33, v145
    v_mul_f32 v146, s33, v146
    v_mfma_f32_16x16x32_bf16 v[124:127], a[248:251], a[224:227], v[124:127]
    v_mul_f32 v147, s33, v147
    v_mul_f32 v20, s33, v20
    v_mfma_f32_16x16x32_bf16 v[156:159], a[248:251], a[232:235], v[156:159]
    v_mul_f32 v21, s33, v21
    v_mul_f32 v22, s33, v22
    v_mfma_f32_16x16x32_bf16 v[156:159], a[252:255], a[236:239], v[156:159]
    v_mul_f32 v23, s33, v23
    v_mul_f32 v52, s33, v52
    s_cmp_lg_u32 s85, 0
    s_cbranch_scc1 L_sconvA
    s_nop 3
    v_cvt_pk_bf16_f32 v0, v0, v1
    v_cvt_pk_bf16_f32 v1, v2, v3
    v_cvt_pk_bf16_f32 v2, v4, v5
    v_cvt_pk_bf16_f32 v3, v6, v7
    v_cvt_pk_bf16_f32 v8, v8, v9
    v_cvt_pk_bf16_f32 v9, v10, v11
    v_cvt_pk_bf16_f32 v10, v12, v13
    v_cvt_pk_bf16_f32 v11, v14, v15
    v_cvt_pk_bf16_f32 v16, v16, v17
    v_cvt_pk_bf16_f32 v17, v18, v19
    v_cvt_pk_bf16_f32 v18, v20, v21
    v_cvt_pk_bf16_f32 v19, v22, v23
    v_mul_f32 v24, s33, v24
    v_mul_f32 v25, s33, v25
    v_mul_f32 v26, s33, v26
    v_mul_f32 v27, s33, v27
    v_mul_f32 v28, s33, v28
    v_mul_f32 v29, s33, v29
    v_mul_f32 v30, s33, v30
    v_mul_f32 v31, s33, v31
    v_cvt_pk_bf16_f32 v24, v24, v25
    v_cvt_pk_bf16_f32 v25, v26, v27
    v_cvt_pk_bf16_f32 v26, v28, v29
    v_cvt_pk_bf16_f32 v27, v30, v31
    v_permlane16_swap_b32 v0, v2
    v_permlane16_swap_b32 v1, v3
    v_permlane16_swap_b32 v8, v10
    v_permlane16_swap_b32 v9, v11
    v_permlane16_swap_b32 v16, v18
    v_permlane16_swap_b32 v17, v19
    v_permlane16_swap_b32 v24, v26
    v_permlane16_swap_b32 v25, v27
    ds_read_b128 a[176:179], v205 offset:4096
    v_cvt_pk_bf16_f32 v32, v32, v33
    v_cvt_pk_bf16_f32 v33, v34, v35
    s_waitcnt lgkmcnt(4)
    v_mfma_f32_16x16x32_bf16 v[160:163], a[160:163], v[0:3], 0
    s_waitcnt lgkmcnt(3)
    v_cvt_pk_bf16_f32 v34, v36, v37
    v_cvt_pk_bf16_f32 v35, v38, v39
    v_cvt_pk_bf16_f32 v40, v40, v41
    v_cvt_pk_bf16_f32 v41, v42, v43
    v_cvt_pk_bf16_f32 v42, v44, v45
    v_cvt_pk_bf16_f32 v43, v46, v47
    v_mul_f32 v53, s33, v53
    v_mul_f32 v54, s33, v54
    v_mfma_f32_16x16x32_bf16 v[160:163], a[164:167], v[8:11], v[160:163]
    s_waitcnt lgkmcnt(2)
    v_mul_f32 v55, s33, v55
    v_cvt_pk_bf16_f32 v48, v48, v49
    v_cvt_pk_bf16_f32 v49, v50, v51
    v_cvt_pk_bf16_f32 v50, v52, v53
    v_cvt_pk_bf16_f32 v51, v54, v55
    v_mul_f32 v56, s33, v56
    v_mul_f32 v57, s33, v57
    v_mul_f32 v58, s33, v58
    v_mfma_f32_16x16x32_bf16 v[160:163], a[168:171], v[16:19], v[160:163]
    s_waitcnt lgkmcnt(1)
    v_mul_f32 v59, s33, v59
    v_mul_f32 v60, s33, v60
    v_mul_f32 v61, s33, v61
    v_mul_f32 v62, s33, v62
    v_mul_f32 v63, s33, v63
    v_cvt_pk_bf16_f32 v56, v56, v57
    v_cvt_pk_bf16_f32 v57, v58, v59
    v_cvt_pk_bf16_f32 v58, v60, v61
    v_mfma_f32_16x16x32_bf16 v[160:163], a[172:175], v[24:27], v[160:163]
    v_cvt_pk_bf16_f32 v59, v62, v63
    v_permlane16_swap_b32 v32, v34
    v_permlane16_swap_b32 v33, v35
    v_permlane16_swap_b32 v40, v42
    v_permlane16_swap_b32 v41, v43
    v_permlane16_swap_b32 v48, v50
    v_permlane16_swap_b32 v49, v51
    v_permlane16_swap_b32 v56, v58
    v_permlane16_swap_b32 v57, v59
    ds_read_b128 a[180:183], v206 offset:4096
    v_cvt_pk_bf16_f32 v64, v64, v65
    v_cvt_pk_bf16_f32 v65, v66, v67
    v_mfma_f32_16x16x32_bf16 v[164:167], a[172:175], v[56:59], 0
    v_cvt_pk_bf16_f32 v66, v68, v69
    v_cvt_pk_bf16_f32 v67, v70, v71
    v_max3_f32 v239, v160, v161, v162
    v_cvt_pk_bf16_f32 v72, v72, v73
    v_cvt_pk_bf16_f32 v73, v74, v75
    v_max_f32 v239, v239, v163
    v_cvt_pk_bf16_f32 v74, v76, v77
    v_cvt_pk_bf16_f32 v75, v78, v79
    v_mov_b32 v240, v239
    v_mul_f32 v84, s33, v84
    v_mul_f32 v85, s33, v85
    v_permlane16_swap_b32 v239, v240
    v_mfma_f32_16x16x32_bf16 v[164:167], a[168:171], v[48:51], v[164:167]
    v_mul_f32 v86, s33, v86
    v_mul_f32 v87, s33, v87
    v_max_f32 v239, v239, v240
    v_cvt_pk_bf16_f32 v80, v80, v81
    v_cvt_pk_bf16_f32 v81, v82, v83
    v_mov_b32 v240, v239
    v_cvt_pk_bf16_f32 v82, v84, v85
    v_cvt_pk_bf16_f32 v83, v86, v87
    v_permlane32_swap_b32 v239, v240
    v_mul_f32 v88, s33, v88
    v_mul_f32 v89, s33, v89
    v_max_f32 v239, v239, v240
    v_mfma_f32_16x16x32_bf16 v[164:167], a[164:167], v[40:43], v[164:167]
    v_mul_f32 v90, s33, v90
    v_mul_f32 v91, s33, v91
    v_sub_f32 v180, 0, v239
    v_mul_f32 v92, s33, v92
    v_mul_f32 v93, s33, v93
    v_sub_f32 v181, 0, v239
    v_mul_f32 v94, s33, v94
    v_mul_f32 v95, s33, v95
    v_sub_f32 v182, 0, v239
    v_cvt_pk_bf16_f32 v88, v88, v89
    v_cvt_pk_bf16_f32 v89, v90, v91
    v_sub_f32 v183, 0, v239
    v_mfma_f32_16x16x32_bf16 v[164:167], a[160:163], v[32:35], v[164:167]
    v_cvt_pk_bf16_f32 v90, v92, v93
    v_cvt_pk_bf16_f32 v91, v94, v95
    v_add_f32 v160, v160, v180
    v_permlane16_swap_b32 v64, v66
    v_permlane16_swap_b32 v65, v67
    v_add_f32 v161, v161, v180
    v_permlane16_swap_b32 v72, v74
    v_permlane16_swap_b32 v73, v75
    v_add_f32 v162, v162, v180
    v_permlane16_swap_b32 v80, v82
    v_permlane16_swap_b32 v81, v83
    v_add_f32 v163, v163, v180
    v_permlane16_swap_b32 v88, v90
    v_permlane16_swap_b32 v89, v91
    ds_read_b128 a[184:187], v207 offset:4096
    v_cvt_pk_bf16_f32 v96, v96, v97
    v_cvt_pk_bf16_f32 v97, v98, v99
    v_mfma_f32_16x16x32_bf16 v[168:171], a[160:163], v[64:67], 0
    v_cvt_pk_bf16_f32 v98, v100, v101
    v_cvt_pk_bf16_f32 v99, v102, v103
    v_max3_f32 v241, v164, v165, v166
    v_cvt_pk_bf16_f32 v104, v104, v105
    v_cvt_pk_bf16_f32 v105, v106, v107
    v_max_f32 v241, v241, v167
    v_cvt_pk_bf16_f32 v106, v108, v109
    v_cvt_pk_bf16_f32 v107, v110, v111
    v_mov_b32 v242, v241
    v_mul_f32 v116, s33, v116
    v_mul_f32 v117, s33, v117
    v_permlane16_swap_b32 v241, v242
    v_mfma_f32_16x16x32_bf16 v[168:171], a[164:167], v[72:75], v[168:171]
    v_mul_f32 v118, s33, v118
    v_mul_f32 v119, s33, v119
    v_max_f32 v241, v241, v242
    v_cvt_pk_bf16_f32 v112, v112, v113
    v_cvt_pk_bf16_f32 v113, v114, v115
    v_mov_b32 v242, v241
    v_cvt_pk_bf16_f32 v114, v116, v117
    v_cvt_pk_bf16_f32 v115, v118, v119
    v_permlane32_swap_b32 v241, v242
    v_mul_f32 v120, s33, v120
    v_mul_f32 v121, s33, v121
    v_max_f32 v241, v241, v242
    v_mfma_f32_16x16x32_bf16 v[168:171], a[168:171], v[80:83], v[168:171]
    v_mul_f32 v122, s33, v122
    v_mul_f32 v123, s33, v123
    v_sub_f32 v184, 0, v241
    v_mul_f32 v124, s33, v124
    v_mul_f32 v125, s33, v125
    v_sub_f32 v185, 0, v241
    v_mul_f32 v126, s33, v126
    v_mul_f32 v127, s33, v127
    v_sub_f32 v186, 0, v241
    v_cvt_pk_bf16_f32 v120, v120, v121
    v_cvt_pk_bf16_f32 v121, v122, v123
    v_sub_f32 v187, 0, v241
    v_mfma_f32_16x16x32_bf16 v[168:171], a[172:175], v[88:91], v[168:171]
    v_cvt_pk_bf16_f32 v122, v124, v125
    v_cvt_pk_bf16_f32 v123, v126, v127
    v_add_f32 v164, v164, v184
    v_permlane16_swap_b32 v96, v98
    v_permlane16_swap_b32 v97, v99
    v_add_f32 v165, v165, v184
    v_permlane16_swap_b32 v104, v106
    v_permlane16_swap_b32 v105, v107
    v_add_f32 v166, v166, v184
    v_permlane16_swap_b32 v112, v114
    v_permlane16_swap_b32 v113, v115
    v_add_f32 v167, v167, v184
    v_permlane16_swap_b32 v120, v122
    v_permlane16_swap_b32 v121, v123
    ds_read_b128 a[188:191], v208 offset:4096
    v_cvt_pk_bf16_f32 v128, v128, v129
    v_cvt_pk_bf16_f32 v129, v130, v131
    v_mfma_f32_16x16x32_bf16 v[172:175], a[172:175], v[120:123], 0
    v_cvt_pk_bf16_f32 v130, v132, v133
    v_cvt_pk_bf16_f32 v131, v134, v135
    v_max3_f32 v243, v168, v169, v170
    v_cvt_pk_bf16_f32 v136, v136, v137
    v_cvt_pk_bf16_f32 v137, v138, v139
    v_max_f32 v243, v243, v171
    v_cvt_pk_bf16_f32 v138, v140, v141
    v_cvt_pk_bf16_f32 v139, v142, v143
    v_mov_b32 v244, v243
    v_mul_f32 v148, s33, v148
    v_mul_f32 v149, s33, v149
    v_permlane16_swap_b32 v243, v244
    v_mfma_f32_16x16x32_bf16 v[172:175], a[168:171], v[112:115], v[172:175]
    v_mul_f32 v150, s33, v150
    v_mul_f32 v151, s33, v151
    v_max_f32 v243, v243, v244
    v_cvt_pk_bf16_f32 v144, v144, v145
    v_cvt_pk_bf16_f32 v145, v146, v147
    v_mov_b32 v244, v243
    v_cvt_pk_bf16_f32 v146, v148, v149
    v_cvt_pk_bf16_f32 v147, v150, v151
    v_permlane32_swap_b32 v243, v244
    v_mul_f32 v152, s33, v152
    v_mul_f32 v153, s33, v153
    v_max_f32 v243, v243, v244
    v_mfma_f32_16x16x32_bf16 v[172:175], a[164:167], v[104:107], v[172:175]
    v_mul_f32 v154, s33, v154
    v_mul_f32 v155, s33, v155
    v_sub_f32 v188, 0, v243
    v_mul_f32 v156, s33, v156
    v_mul_f32 v157, s33, v157
    v_sub_f32 v189, 0, v243
    v_mul_f32 v158, s33, v158
    v_mul_f32 v159, s33, v159
    v_sub_f32 v190, 0, v243
    v_cvt_pk_bf16_f32 v152, v152, v153
    v_cvt_pk_bf16_f32 v153, v154, v155
    v_sub_f32 v191, 0, v243
    v_mfma_f32_16x16x32_bf16 v[172:175], a[160:163], v[96:99], v[172:175]
    v_cvt_pk_bf16_f32 v154, v156, v157
    v_cvt_pk_bf16_f32 v155, v158, v159
    v_add_f32 v168, v168, v188
    v_permlane16_swap_b32 v128, v130
    v_permlane16_swap_b32 v129, v131
    v_add_f32 v169, v169, v188
    v_permlane16_swap_b32 v136, v138
    v_permlane16_swap_b32 v137, v139
    v_add_f32 v170, v170, v188
    v_permlane16_swap_b32 v144, v146
    v_permlane16_swap_b32 v145, v147
    v_add_f32 v171, v171, v188
    v_permlane16_swap_b32 v152, v154
    v_permlane16_swap_b32 v153, v155
    v_exp_f32 v160, v160
    v_exp_f32 v161, v161
    v_mfma_f32_16x16x32_bf16 v[176:179], a[160:163], v[128:131], 0
    v_add_f32 v200, v160, v200
    v_exp_f32 v162, v162
    v_max3_f32 v245, v172, v173, v174
    v_add_f32 v200, v161, v200
    v_cvt_pk_bf16_f32 v4, v160, v161
    v_max_f32 v245, v245, v175
    v_mfma_f32_16x16x32_bf16 v[176:179], a[164:167], v[136:139], v[176:179]
    v_exp_f32 v163, v163
    v_add_f32 v200, v162, v200
    v_mov_b32 v246, v245
    v_exp_f32 v164, v164
    v_add_f32 v200, v163, v200
    v_permlane16_swap_b32 v245, v246
    v_mfma_f32_16x16x32_bf16 v[176:179], a[168:171], v[144:147], v[176:179]
    v_cvt_pk_bf16_f32 v5, v162, v163
    v_max_f32 v245, v245, v246
    v_mov_b32 v246, v245
    s_nop 1
    v_permlane32_swap_b32 v245, v246
    v_max_f32 v245, v245, v246
    v_sub_f32 v192, 0, v245
    v_mfma_f32_16x16x32_bf16 v[176:179], a[172:175], v[152:155], v[176:179]
    s_waitcnt lgkmcnt(3)
    v_sub_f32 v193, 0, v245
    v_sub_f32 v194, 0, v245
    v_sub_f32 v195, 0, v245
    v_add_f32 v172, v172, v192
    v_add_f32 v173, v173, v192
    v_add_f32 v174, v174, v192
    v_add_f32 v175, v175, v192
    v_exp_f32 v165, v165
    v_add_f32 v201, v164, v201
    v_exp_f32 v166, v166
    v_add_f32 v201, v165, v201
    v_cvt_pk_bf16_f32 v20, v164, v165
    v_exp_f32 v167, v167
    v_max3_f32 v247, v176, v177, v178
    v_add_f32 v201, v166, v201
    v_exp_f32 v168, v168
    v_max_f32 v247, v247, v179
    v_add_f32 v201, v167, v201
    v_cvt_pk_bf16_f32 v21, v166, v167
    v_mov_b32 v248, v247
    s_nop 1
    v_permlane16_swap_b32 v247, v248
    v_max_f32 v247, v247, v248
    v_mov_b32 v248, v247
    s_nop 1
    v_permlane32_swap_b32 v247, v248
    v_max_f32 v247, v247, v248
    v_sub_f32 v196, 0, v247
    v_sub_f32 v197, 0, v247
    v_sub_f32 v198, 0, v247
    v_sub_f32 v199, 0, v247
    v_add_f32 v176, v176, v196
    v_add_f32 v177, v177, v196
    v_add_f32 v178, v178, v196
    v_add_f32 v179, v179, v196
    v_mfma_f32_16x16x32_bf16 v[160:163], a[176:179], v[0:3], v[180:183]
    s_waitcnt lgkmcnt(2)
    ds_read_b128 a[160:163], v205 offset:8192
    v_exp_f32 v169, v169
    v_add_f32 v202, v168, v202
    v_mfma_f32_16x16x32_bf16 v[160:163], a[180:183], v[8:11], v[160:163]
    s_waitcnt lgkmcnt(2)
    v_exp_f32 v170, v170
    v_add_f32 v202, v169, v202
    v_cvt_pk_bf16_f32 v36, v168, v169
    v_mfma_f32_16x16x32_bf16 v[160:163], a[184:187], v[16:19], v[160:163]
    s_waitcnt lgkmcnt(1)
    ds_read_b128 a[164:167], v206 offset:8192
    v_exp_f32 v171, v171
    v_add_f32 v202, v170, v202
    v_mfma_f32_16x16x32_bf16 v[160:163], a[188:191], v[24:27], v[160:163]
    s_lshl_b32 s32, s0, 1
    v_exp_f32 v172, v172
    v_add_f32 v202, v171, v202
    v_cvt_pk_bf16_f32 v37, v170, v171
    v_mfma_f32_16x16x32_bf16 v[164:167], a[188:191], v[56:59], v[184:187]
    s_lshr_b32 s27, s1, 4
    ds_read_b128 a[168:171], v207 offset:8192
    v_exp_f32 v173, v173
    v_add_f32 v203, v172, v203
    v_mfma_f32_16x16x32_bf16 v[164:167], a[184:187], v[48:51], v[164:167]
    s_add_u32 s32, s32, s27
    v_exp_f32 v174, v174
    v_add_f32 v203, v173, v203
    v_cvt_pk_bf16_f32 v52, v172, v173
    v_mfma_f32_16x16x32_bf16 v[164:167], a[180:183], v[40:43], v[164:167]
    s_lshl_b32 s32, s32, 2
    ds_read_b128 a[172:175], v208 offset:8192
    v_exp_f32 v175, v175
    v_add_f32 v203, v174, v203
    v_mfma_f32_16x16x32_bf16 v[164:167], a[176:179], v[32:35], v[164:167]
    s_add_u32 s32, s32, s24
    v_exp_f32 v176, v176
    v_add_f32 v203, v175, v203
    v_cvt_pk_bf16_f32 v53, v174, v175
    v_mfma_f32_16x16x32_bf16 v[168:171], a[176:179], v[64:67], v[188:191]
    s_and_b32 s27, s1, 15
    v_exp_f32 v177, v177
    v_add_f32 v204, v176, v204
    v_mfma_f32_16x16x32_bf16 v[168:171], a[180:183], v[72:75], v[168:171]
    s_lshl_b32 s27, s27, 6
    v_exp_f32 v178, v178
    v_add_f32 v204, v177, v204
    v_cvt_pk_bf16_f32 v68, v176, v177
    v_mfma_f32_16x16x32_bf16 v[168:171], a[184:187], v[80:83], v[168:171]
    s_add_u32 s32, s32, s27
    v_exp_f32 v179, v179
    v_add_f32 v204, v178, v204
    v_mfma_f32_16x16x32_bf16 v[168:171], a[188:191], v[88:91], v[168:171]
    s_lshl_b32 s32, s32, 12
    v_exp_f32 v160, v160
    v_add_f32 v204, v179, v204
    v_cvt_pk_bf16_f32 v69, v178, v179
    v_mfma_f32_16x16x32_bf16 v[172:175], a[188:191], v[120:123], v[192:195]
    s_add_u32 s32, s32, 0x2800000
    v_exp_f32 v161, v161
    v_add_f32 v200, v160, v200
    v_mfma_f32_16x16x32_bf16 v[172:175], a[184:187], v[112:115], v[172:175]
    s_add_u32 s8, s50, s32
    v_exp_f32 v162, v162
    v_add_f32 v200, v161, v200
    v_cvt_pk_bf16_f32 v6, v160, v161
    v_mfma_f32_16x16x32_bf16 v[172:175], a[180:183], v[104:107], v[172:175]
    s_addc_u32 s9, s51, 0
    v_exp_f32 v163, v163
    v_add_f32 v200, v162, v200
    v_mfma_f32_16x16x32_bf16 v[172:175], a[176:179], v[96:99], v[172:175]
    s_mov_b32 s10, 4096
    v_exp_f32 v164, v164
    v_add_f32 v200, v163, v200
    v_cvt_pk_bf16_f32 v7, v162, v163
    v_mfma_f32_16x16x32_bf16 v[176:179], a[176:179], v[128:131], v[196:199]
    s_mov_b32 s11, 0x20000
    v_exp_f32 v165, v165
    v_add_f32 v201, v164, v201
    v_mfma_f32_16x16x32_bf16 v[176:179], a[180:183], v[136:139], v[176:179]
    s_lshl_b32 s32, s54, 1
    v_exp_f32 v166, v166
    v_add_f32 v201, v165, v201
    v_cvt_pk_bf16_f32 v22, v164, v165
    v_mfma_f32_16x16x32_bf16 v[176:179], a[184:187], v[144:147], v[176:179]
    s_and_b32 s27, s55, 1
    v_exp_f32 v167, v167
    v_add_f32 v201, v166, v201
    v_mfma_f32_16x16x32_bf16 v[176:179], a[188:191], v[152:155], v[176:179]
    s_waitcnt lgkmcnt(3)
    s_add_u32 s32, s32, s27
    v_exp_f32 v168, v168
    v_add_f32 v201, v167, v201
    v_cvt_pk_bf16_f32 v23, v166, v167
    v_mfma_f32_16x16x32_bf16 v[160:163], a[160:163], v[0:3], v[180:183]
    s_waitcnt lgkmcnt(2)
    s_lshl_b32 s32, s32, 2
    ds_read_b128 a[176:179], v205 offset:12288
    v_exp_f32 v169, v169
    v_add_f32 v202, v168, v202
    v_mfma_f32_16x16x32_bf16 v[160:163], a[164:167], v[8:11], v[160:163]
    s_waitcnt lgkmcnt(2)
    s_add_u32 s32, s32, s24
    v_exp_f32 v170, v170
    v_add_f32 v202, v169, v202
    v_cvt_pk_bf16_f32 v38, v168, v169
    v_mfma_f32_16x16x32_bf16 v[160:163], a[168:171], v[16:19], v[160:163]
    s_waitcnt lgkmcnt(1)
    s_lshl_b32 s32, s32, 12
    ds_read_b128 a[180:183], v206 offset:12288
    v_exp_f32 v171, v171
    v_add_f32 v202, v170, v202
    v_mfma_f32_16x16x32_bf16 v[160:163], a[172:175], v[24:27], v[160:163]
    s_add_u32 s32, s32, 0x2800000
    v_exp_f32 v172, v172
    v_add_f32 v202, v171, v202
    v_cvt_pk_bf16_f32 v39, v170, v171
    v_mfma_f32_16x16x32_bf16 v[164:167], a[172:175], v[56:59], v[184:187]
    s_add_u32 s56, s50, s32
    ds_read_b128 a[184:187], v207 offset:12288
    v_exp_f32 v173, v173
    v_add_f32 v203, v172, v203
    v_mfma_f32_16x16x32_bf16 v[164:167], a[168:171], v[48:51], v[164:167]
    s_addc_u32 s57, s51, 0
    v_exp_f32 v174, v174
    v_add_f32 v203, v173, v203
    v_cvt_pk_bf16_f32 v54, v172, v173
    v_mfma_f32_16x16x32_bf16 v[164:167], a[164:167], v[40:43], v[164:167]
    s_mov_b32 s58, 3936256
    ds_read_b128 a[188:191], v208 offset:12288
    v_exp_f32 v175, v175
    v_add_f32 v203, v174, v203
    v_mfma_f32_16x16x32_bf16 v[164:167], a[160:163], v[32:35], v[164:167]
    s_mov_b32 s59, 0x20000
    s_waitcnt vmcnt(0)
    v_exp_f32 v176, v176
    v_add_f32 v203, v175, v203
    v_cvt_pk_bf16_f32 v55, v174, v175
    v_mfma_f32_16x16x32_bf16 v[168:171], a[160:163], v[64:67], v[188:191]
    s_mov_b32 s31, 4
    ds_read_b64_tr_b16 a[192:193], v223 offset:0
    v_exp_f32 v177, v177
    v_add_f32 v204, v176, v204
    v_mfma_f32_16x16x32_bf16 v[168:171], a[164:167], v[72:75], v[168:171]
    s_mov_b32 s20, s48
    ds_read_b64_tr_b16 a[194:195], v223 offset:2048
    v_exp_f32 v178, v178
    v_add_f32 v204, v177, v204
    v_cvt_pk_bf16_f32 v70, v176, v177
    v_mfma_f32_16x16x32_bf16 v[168:171], a[168:171], v[80:83], v[168:171]
    s_mov_b32 s21, s49
    ds_read_b64_tr_b16 a[196:197], v224 offset:0
    v_exp_f32 v179, v179
    v_add_f32 v204, v178, v204
    v_mfma_f32_16x16x32_bf16 v[168:171], a[172:175], v[88:91], v[168:171]
    s_mov_b32 s22, 256
    ds_read_b64_tr_b16 a[198:199], v224 offset:2048
    v_exp_f32 v160, v160
    v_add_f32 v204, v179, v204
    v_cvt_pk_bf16_f32 v71, v178, v179
    v_mfma_f32_16x16x32_bf16 v[172:175], a[172:175], v[120:123], v[192:195]
    s_mov_b32 s23, 0x20000
    ds_read_b64_tr_b16 a[200:201], v225 offset:0
    v_exp_f32 v161, v161
    v_add_f32 v200, v160, v200
    v_mfma_f32_16x16x32_bf16 v[172:175], a[168:171], v[112:115], v[172:175]
    ds_read_b64_tr_b16 a[202:203], v225 offset:2048
    v_exp_f32 v162, v162
    v_add_f32 v200, v161, v200
    v_cvt_pk_bf16_f32 v12, v160, v161
    v_mfma_f32_16x16x32_bf16 v[172:175], a[164:167], v[104:107], v[172:175]
    ds_read_b64_tr_b16 a[204:205], v226 offset:0
    v_exp_f32 v163, v163
    v_add_f32 v200, v162, v200
    v_mfma_f32_16x16x32_bf16 v[172:175], a[160:163], v[96:99], v[172:175]
    ds_read_b64_tr_b16 a[206:207], v226 offset:2048
    v_exp_f32 v164, v164
    v_add_f32 v200, v163, v200
    v_cvt_pk_bf16_f32 v13, v162, v163
    v_mfma_f32_16x16x32_bf16 v[176:179], a[160:163], v[128:131], v[196:199]
    v_exp_f32 v165, v165
    v_add_f32 v201, v164, v201
    v_mfma_f32_16x16x32_bf16 v[176:179], a[164:167], v[136:139], v[176:179]
    v_exp_f32 v166, v166
    v_add_f32 v201, v165, v201
    v_cvt_pk_bf16_f32 v28, v164, v165
    v_mfma_f32_16x16x32_bf16 v[176:179], a[168:171], v[144:147], v[176:179]
    v_exp_f32 v167, v167
    v_add_f32 v201, v166, v201
    v_mfma_f32_16x16x32_bf16 v[176:179], a[172:175], v[152:155], v[176:179]
    s_waitcnt lgkmcnt(11)
    v_exp_f32 v168, v168
    v_add_f32 v201, v167, v201
    v_cvt_pk_bf16_f32 v29, v166, v167
    v_mfma_f32_16x16x32_bf16 v[160:163], a[176:179], v[0:3], v[180:183]
    s_waitcnt lgkmcnt(10)
    v_exp_f32 v169, v169
    v_add_f32 v202, v168, v202
    v_mfma_f32_16x16x32_bf16 v[160:163], a[180:183], v[8:11], v[160:163]
    s_waitcnt lgkmcnt(9)
    v_exp_f32 v170, v170
    v_add_f32 v202, v169, v202
    v_cvt_pk_bf16_f32 v44, v168, v169
    v_mfma_f32_16x16x32_bf16 v[160:163], a[184:187], v[16:19], v[160:163]
    s_waitcnt vmcnt(0) lgkmcnt(0)
    v_exp_f32 v171, v171
    v_add_f32 v202, v170, v202
    v_mfma_f32_16x16x32_bf16 v[160:163], a[188:191], v[24:27], v[160:163]
    s_barrier
    v_exp_f32 v172, v172
    v_add_f32 v202, v171, v202
    v_cvt_pk_bf16_f32 v45, v170, v171
    v_mfma_f32_16x16x32_bf16 v[164:167], a[188:191], v[56:59], v[184:187]
    ds_read_b128 a[160:163], v205 offset:16384
    v_exp_f32 v173, v173
    v_add_f32 v203, v172, v203
    v_mfma_f32_16x16x32_bf16 v[164:167], a[184:187], v[48:51], v[164:167]
    buffer_store_dwordx4 a[192:195], v238, s[8:11], 0 offen sc0 sc1
    v_exp_f32 v174, v174
    v_add_f32 v203, v173, v203
    v_cvt_pk_bf16_f32 v60, v172, v173
    v_mfma_f32_16x16x32_bf16 v[164:167], a[180:183], v[40:43], v[164:167]
    ds_read_b128 a[164:167], v206 offset:16384
    v_exp_f32 v175, v175
    v_add_f32 v203, v174, v203
    v_mfma_f32_16x16x32_bf16 v[164:167], a[176:179], v[32:35], v[164:167]
    buffer_store_dwordx4 a[196:199], v238, s[8:11], 0 offen offset:1024 sc0 sc1
    v_exp_f32 v176, v176
    v_add_f32 v203, v175, v203
    v_cvt_pk_bf16_f32 v61, v174, v175
    v_mfma_f32_16x16x32_bf16 v[168:171], a[176:179], v[64:67], v[188:191]
    ds_read_b128 a[168:171], v207 offset:16384
    v_exp_f32 v177, v177
    v_add_f32 v204, v176, v204
    v_mfma_f32_16x16x32_bf16 v[168:171], a[180:183], v[72:75], v[168:171]
    buffer_store_dwordx4 a[200:203], v238, s[8:11], 0 offen offset:2048 sc0 sc1
    v_exp_f32 v178, v178
    v_add_f32 v204, v177, v204
    v_cvt_pk_bf16_f32 v76, v176, v177
    v_mfma_f32_16x16x32_bf16 v[168:171], a[184:187], v[80:83], v[168:171]
    ds_read_b128 a[172:175], v208 offset:16384
    v_exp_f32 v179, v179
    v_add_f32 v204, v178, v204
    v_mfma_f32_16x16x32_bf16 v[168:171], a[188:191], v[88:91], v[168:171]
    buffer_store_dwordx4 a[204:207], v238, s[8:11], 0 offen offset:3072 sc0 sc1
    v_exp_f32 v160, v160
    v_add_f32 v204, v179, v204
    v_cvt_pk_bf16_f32 v77, v178, v179
    v_mfma_f32_16x16x32_bf16 v[172:175], a[188:191], v[120:123], v[192:195]
    v_exp_f32 v161, v161
    v_add_f32 v200, v160, v200
    v_mfma_f32_16x16x32_bf16 v[172:175], a[184:187], v[112:115], v[172:175]
    v_exp_f32 v162, v162
    v_add_f32 v200, v161, v200
    v_cvt_pk_bf16_f32 v14, v160, v161
    v_mfma_f32_16x16x32_bf16 v[172:175], a[180:183], v[104:107], v[172:175]
    v_exp_f32 v163, v163
    v_add_f32 v200, v162, v200
    v_mfma_f32_16x16x32_bf16 v[172:175], a[176:179], v[96:99], v[172:175]
    v_exp_f32 v164, v164
    v_add_f32 v200, v163, v200
    v_cvt_pk_bf16_f32 v15, v162, v163
    v_mfma_f32_16x16x32_bf16 v[176:179], a[176:179], v[128:131], v[196:199]
    v_exp_f32 v165, v165
    v_add_f32 v201, v164, v201
    v_mfma_f32_16x16x32_bf16 v[176:179], a[180:183], v[136:139], v[176:179]
    v_exp_f32 v166, v166
    v_add_f32 v201, v165, v201
    v_cvt_pk_bf16_f32 v30, v164, v165
    v_mov_b32 v250, 1
    v_mfma_f32_16x16x32_bf16 v[176:179], a[184:187], v[144:147], v[176:179]
    s_lshl_b32 s33, s0, 5
    s_cmp_eq_u32 s24, 0
    s_cselect_b32 s33, s33, 0x1000
    v_exp_f32 v167, v167
    v_add_f32 v201, v166, v201
    v_mfma_f32_16x16x32_bf16 v[176:179], a[188:191], v[152:155], v[176:179]
    v_exp_f32 v168, v168
    v_add_f32 v201, v167, v201
    v_cvt_pk_bf16_f32 v31, v166, v167
    v_exp_f32 v169, v169
    v_add_f32 v202, v168, v202
    v_exp_f32 v170, v170
    v_add_f32 v202, v169, v202
    v_cvt_pk_bf16_f32 v46, v168, v169
    v_exp_f32 v171, v171
    v_add_f32 v202, v170, v202
    v_exp_f32 v172, v172
    v_add_f32 v202, v171, v202
    v_cvt_pk_bf16_f32 v47, v170, v171
    v_exp_f32 v173, v173
    v_add_f32 v203, v172, v203
    v_exp_f32 v174, v174
    v_add_f32 v203, v173, v203
    v_cvt_pk_bf16_f32 v62, v172, v173
    v_exp_f32 v175, v175
    v_add_f32 v203, v174, v203
    v_exp_f32 v176, v176
    v_add_f32 v203, v175, v203
    v_cvt_pk_bf16_f32 v63, v174, v175
.p2align 6
L_loopA:
    s_waitcnt lgkmcnt(3)
    v_mfma_f32_16x16x32_bf16 v[160:163], a[160:163], v[0:3], v[180:183]
    s_waitcnt lgkmcnt(2)
    s_lshl_b32 s29, s31, 12
    s_sub_u32 s29, 8192, s29
    s_max_i32 s28, s29, 0
    s_lshl_b32 s28, s28, 2
    s_add_u32 s28, s28, 131072
    s_lshl_b32 s29, s29, 6
    ds_read_b64_tr_b16 a[176:177], v209 offset:0
    v_add_f32 v204, v176, v204
    v_mfma_f32_16x16x32_bf16 v[160:163], a[164:167], v[8:11], v[160:163]
    s_waitcnt lgkmcnt(2)
    v_exp_f32 v177, v177
    v_mfma_f32_16x16x32_bf16 v[160:163], a[168:171], v[16:19], v[160:163]
    s_waitcnt lgkmcnt(1)
    s_add_u32 m0, s34, s28
    v_add_f32 v204, v177, v204
    v_cvt_pk_bf16_f32 v78, v176, v177
    v_mfma_f32_16x16x32_bf16 v[160:163], a[172:175], v[24:27], v[160:163]
    s_or_b32 s27, s29, 0x200000
    buffer_load_dwordx4 v238, s[56:59], s27 offen sc1 lds
    v_exp_f32 v178, v178
    v_mfma_f32_16x16x32_bf16 v[164:167], a[172:175], v[56:59], v[184:187]
    ds_read_b64_tr_b16 a[178:179], v209 offset:4096
    v_add_f32 v204, v178, v204
    v_mfma_f32_16x16x32_bf16 v[164:167], a[168:171], v[48:51], v[164:167]
    v_exp_f32 v179, v179
    v_mfma_f32_16x16x32_bf16 v[164:167], a[164:167], v[40:43], v[164:167]
    v_add_f32 v204, v179, v204
    v_cvt_pk_bf16_f32 v79, v178, v179
    v_mfma_f32_16x16x32_bf16 v[164:167], a[160:163], v[32:35], v[164:167]
    v_exp_f32 v160, v160
    v_mfma_f32_16x16x32_bf16 v[168:171], a[160:163], v[64:67], v[188:191]
    ds_read_b64_tr_b16 a[180:181], v209 offset:8192
    v_add_f32 v200, v160, v200
    v_mfma_f32_16x16x32_bf16 v[168:171], a[164:167], v[72:75], v[168:171]
    v_exp_f32 v161, v161
    v_mfma_f32_16x16x32_bf16 v[168:171], a[168:171], v[80:83], v[168:171]
    v_add_f32 v200, v161, v200
    v_cvt_pk_bf16_f32 v84, v160, v161
    v_mfma_f32_16x16x32_bf16 v[168:171], a[172:175], v[88:91], v[168:171]
    v_exp_f32 v162, v162
    v_mfma_f32_16x16x32_bf16 v[172:175], a[172:175], v[120:123], v[192:195]
    ds_read_b64_tr_b16 a[182:183], v209 offset:12288
    v_add_f32 v200, v162, v200
    v_mfma_f32_16x16x32_bf16 v[172:175], a[168:171], v[112:115], v[172:175]
    v_exp_f32 v163, v163
    v_mfma_f32_16x16x32_bf16 v[172:175], a[164:167], v[104:107], v[172:175]
    ds_read_b64_tr_b16 a[184:185], v210 offset:0
    v_add_f32 v200, v163, v200
    v_cvt_pk_bf16_f32 v85, v162, v163
    v_mfma_f32_16x16x32_bf16 v[172:175], a[160:163], v[96:99], v[172:175]
    v_exp_f32 v164, v164
    v_mfma_f32_16x16x32_bf16 v[176:179], a[160:163], v[128:131], v[196:199]
    ds_read_b64_tr_b16 a[186:187], v210 offset:4096
    v_add_f32 v201, v164, v201
    v_mfma_f32_16x16x32_bf16 v[176:179], a[164:167], v[136:139], v[176:179]
    v_exp_f32 v165, v165
    v_mfma_f32_16x16x32_bf16 v[176:179], a[168:171], v[144:147], v[176:179]
    ds_read_b64_tr_b16 a[188:189], v210 offset:8192
    v_add_f32 v201, v165, v201
    v_cvt_pk_bf16_f32 v100, v164, v165
    v_mfma_f32_16x16x32_bf16 v[176:179], a[172:175], v[152:155], v[176:179]
    s_waitcnt lgkmcnt(5)
    v_exp_f32 v166, v166
    v_mfma_f32_16x16x32_bf16 a[0:3], a[176:179], v[4:7], a[0:3]
    s_waitcnt lgkmcnt(3)
    ds_read_b64_tr_b16 a[190:191], v210 offset:12288
    v_add_f32 v201, v166, v201
    v_mfma_f32_16x16x32_bf16 a[0:3], a[180:183], v[12:15], a[0:3]
    v_exp_f32 v167, v167
    v_mfma_f32_16x16x32_bf16 a[32:35], a[180:183], v[28:31], a[32:35]
    v_add_f32 v201, v167, v201
    v_cvt_pk_bf16_f32 v101, v166, v167
    v_mfma_f32_16x16x32_bf16 a[32:35], a[176:179], v[20:23], a[32:35]
    v_exp_f32 v168, v168
    v_mfma_f32_16x16x32_bf16 a[64:67], a[176:179], v[36:39], a[64:67]
    ds_read_b128 a[160:163], v205 offset:20480
    v_add_f32 v202, v168, v202
    v_mfma_f32_16x16x32_bf16 a[64:67], a[180:183], v[44:47], a[64:67]
    v_exp_f32 v169, v169
    v_mfma_f32_16x16x32_bf16 a[96:99], a[180:183], v[60:63], a[96:99]
    v_add_f32 v202, v169, v202
    v_cvt_pk_bf16_f32 v116, v168, v169
    v_mfma_f32_16x16x32_bf16 a[96:99], a[176:179], v[52:55], a[96:99]
    v_exp_f32 v170, v170
    v_mfma_f32_16x16x32_bf16 a[128:131], a[176:179], v[68:71], a[128:131]
    ds_read_b128 a[164:167], v206 offset:20480
    v_add_f32 v202, v170, v202
    v_mfma_f32_16x16x32_bf16 a[128:131], a[180:183], v[76:79], a[128:131]
    s_waitcnt lgkmcnt(4)
    v_exp_f32 v171, v171
    v_mfma_f32_16x16x32_bf16 a[4:7], a[184:187], v[4:7], a[4:7]
    s_waitcnt lgkmcnt(2)
    v_add_f32 v202, v171, v202
    v_cvt_pk_bf16_f32 v117, v170, v171
    v_mfma_f32_16x16x32_bf16 a[4:7], a[188:191], v[12:15], a[4:7]
    v_exp_f32 v172, v172
    v_mfma_f32_16x16x32_bf16 a[36:39], a[188:191], v[28:31], a[36:39]
    ds_read_b128 a[168:171], v207 offset:20480
    v_add_f32 v203, v172, v203
    v_mfma_f32_16x16x32_bf16 a[36:39], a[184:187], v[20:23], a[36:39]
    v_exp_f32 v173, v173
    v_mfma_f32_16x16x32_bf16 a[68:71], a[184:187], v[36:39], a[68:71]
    v_add_f32 v203, v173, v203
    v_cvt_pk_bf16_f32 v132, v172, v173
    v_mfma_f32_16x16x32_bf16 a[68:71], a[188:191], v[44:47], a[68:71]
    v_exp_f32 v174, v174
    v_mfma_f32_16x16x32_bf16 a[100:103], a[188:191], v[60:63], a[100:103]
    ds_read_b128 a[172:175], v208 offset:20480
    v_add_f32 v203, v174, v203
    v_mfma_f32_16x16x32_bf16 a[100:103], a[184:187], v[52:55], a[100:103]
    v_exp_f32 v175, v175
    v_mfma_f32_16x16x32_bf16 a[132:135], a[184:187], v[68:71], a[132:135]
    v_add_f32 v203, v175, v203
    v_cvt_pk_bf16_f32 v133, v174, v175
    v_mfma_f32_16x16x32_bf16 a[132:135], a[188:191], v[76:79], a[132:135]
    s_waitcnt lgkmcnt(3)
    v_exp_f32 v176, v176
    v_mfma_f32_16x16x32_bf16 v[160:163], a[160:163], v[0:3], v[180:183]
    s_waitcnt lgkmcnt(2)
    ds_read_b64_tr_b16 a[176:177], v211 offset:0
    v_add_f32 v204, v176, v204
    v_mfma_f32_16x16x32_bf16 v[160:163], a[164:167], v[8:11], v[160:163]
    s_waitcnt lgkmcnt(2)
    v_exp_f32 v177, v177
    v_mfma_f32_16x16x32_bf16 v[160:163], a[168:171], v[16:19], v[160:163]
    s_waitcnt lgkmcnt(1)
    v_add_f32 v204, v177, v204
    v_cvt_pk_bf16_f32 v148, v176, v177
    v_mfma_f32_16x16x32_bf16 v[160:163], a[172:175], v[24:27], v[160:163]
    v_exp_f32 v178, v178
    v_mfma_f32_16x16x32_bf16 v[164:167], a[172:175], v[56:59], v[184:187]
    ds_read_b64_tr_b16 a[178:179], v211 offset:4096
    v_add_f32 v204, v178, v204
    v_mfma_f32_16x16x32_bf16 v[164:167], a[168:171], v[48:51], v[164:167]
    v_exp_f32 v179, v179
    v_mfma_f32_16x16x32_bf16 v[164:167], a[164:167], v[40:43], v[164:167]
    v_add_f32 v204, v179, v204
    v_cvt_pk_bf16_f32 v149, v178, v179
    v_mfma_f32_16x16x32_bf16 v[164:167], a[160:163], v[32:35], v[164:167]
    v_exp_f32 v160, v160
    v_mfma_f32_16x16x32_bf16 v[168:171], a[160:163], v[64:67], v[188:191]
    ds_read_b64_tr_b16 a[180:181], v211 offset:8192
    v_add_f32 v200, v160, v200
    v_mfma_f32_16x16x32_bf16 v[168:171], a[164:167], v[72:75], v[168:171]
    v_exp_f32 v161, v161
    v_mfma_f32_16x16x32_bf16 v[168:171], a[168:171], v[80:83], v[168:171]
    v_add_f32 v200, v161, v200
    v_cvt_pk_bf16_f32 v86, v160, v161
    v_mfma_f32_16x16x32_bf16 v[168:171], a[172:175], v[88:91], v[168:171]
    v_exp_f32 v162, v162
    v_mfma_f32_16x16x32_bf16 v[172:175], a[172:175], v[120:123], v[192:195]
    ds_read_b64_tr_b16 a[182:183], v211 offset:12288
    v_add_f32 v200, v162, v200
    v_mfma_f32_16x16x32_bf16 v[172:175], a[168:171], v[112:115], v[172:175]
    v_exp_f32 v163, v163
    v_mfma_f32_16x16x32_bf16 v[172:175], a[164:167], v[104:107], v[172:175]
    ds_read_b64_tr_b16 a[184:185], v212 offset:0
    buffer_load_dwordx4 v238, s[56:59], s27 offen offset:1024 sc1 lds
    v_add_f32 v200, v163, v200
    v_cvt_pk_bf16_f32 v87, v162, v163
    v_mfma_f32_16x16x32_bf16 v[172:175], a[160:163], v[96:99], v[172:175]
    v_exp_f32 v164, v164
    v_mfma_f32_16x16x32_bf16 v[176:179], a[160:163], v[128:131], v[196:199]
    ds_read_b64_tr_b16 a[186:187], v212 offset:4096
    v_add_f32 v201, v164, v201
    v_mfma_f32_16x16x32_bf16 v[176:179], a[164:167], v[136:139], v[176:179]
    v_exp_f32 v165, v165
    v_mfma_f32_16x16x32_bf16 v[176:179], a[168:171], v[144:147], v[176:179]
    ds_read_b64_tr_b16 a[188:189], v212 offset:8192
    v_add_f32 v201, v165, v201
    v_cvt_pk_bf16_f32 v102, v164, v165
    v_mfma_f32_16x16x32_bf16 v[176:179], a[172:175], v[152:155], v[176:179]
    s_waitcnt lgkmcnt(5)
    v_exp_f32 v166, v166
    v_mfma_f32_16x16x32_bf16 a[8:11], a[176:179], v[4:7], a[8:11]
    s_waitcnt lgkmcnt(3)
    ds_read_b64_tr_b16 a[190:191], v212 offset:12288
    v_add_f32 v201, v166, v201
    v_mfma_f32_16x16x32_bf16 a[8:11], a[180:183], v[12:15], a[8:11]
    v_exp_f32 v167, v167
    v_mfma_f32_16x16x32_bf16 a[40:43], a[180:183], v[28:31], a[40:43]
    v_add_f32 v201, v167, v201
    v_cvt_pk_bf16_f32 v103, v166, v167
    v_mfma_f32_16x16x32_bf16 a[40:43], a[176:179], v[20:23], a[40:43]
    v_exp_f32 v168, v168
    v_mfma_f32_16x16x32_bf16 a[72:75], a[176:179], v[36:39], a[72:75]
    ds_read_b128 a[160:163], v205 offset:24576
    v_add_f32 v202, v168, v202
    v_mfma_f32_16x16x32_bf16 a[72:75], a[180:183], v[44:47], a[72:75]
    v_exp_f32 v169, v169
    v_mfma_f32_16x16x32_bf16 a[104:107], a[180:183], v[60:63], a[104:107]
    v_add_f32 v202, v169, v202
    v_cvt_pk_bf16_f32 v118, v168, v169
    v_mfma_f32_16x16x32_bf16 a[104:107], a[176:179], v[52:55], a[104:107]
    v_exp_f32 v170, v170
    v_mfma_f32_16x16x32_bf16 a[136:139], a[176:179], v[68:71], a[136:139]
    ds_read_b128 a[164:167], v206 offset:24576
    v_add_f32 v202, v170, v202
    v_mfma_f32_16x16x32_bf16 a[136:139], a[180:183], v[76:79], a[136:139]
    s_waitcnt lgkmcnt(4)
    v_exp_f32 v171, v171
    v_mfma_f32_16x16x32_bf16 a[12:15], a[184:187], v[4:7], a[12:15]
    s_waitcnt lgkmcnt(2)
    v_add_f32 v202, v171, v202
    v_cvt_pk_bf16_f32 v119, v170, v171
    v_mfma_f32_16x16x32_bf16 a[12:15], a[188:191], v[12:15], a[12:15]
    v_exp_f32 v172, v172
    v_mfma_f32_16x16x32_bf16 a[44:47], a[188:191], v[28:31], a[44:47]
    ds_read_b128 a[168:171], v207 offset:24576
    v_add_f32 v203, v172, v203
    v_mfma_f32_16x16x32_bf16 a[44:47], a[184:187], v[20:23], a[44:47]
    v_exp_f32 v173, v173
    v_mfma_f32_16x16x32_bf16 a[76:79], a[184:187], v[36:39], a[76:79]
    v_add_f32 v203, v173, v203
    v_cvt_pk_bf16_f32 v134, v172, v173
    v_mfma_f32_16x16x32_bf16 a[76:79], a[188:191], v[44:47], a[76:79]
    v_exp_f32 v174, v174
    v_mfma_f32_16x16x32_bf16 a[108:111], a[188:191], v[60:63], a[108:111]
    ds_read_b128 a[172:175], v208 offset:24576
    v_add_f32 v203, v174, v203
    v_mfma_f32_16x16x32_bf16 a[108:111], a[184:187], v[52:55], a[108:111]
    v_exp_f32 v175, v175
    v_mfma_f32_16x16x32_bf16 a[140:143], a[184:187], v[68:71], a[140:143]
    v_add_f32 v203, v175, v203
    v_cvt_pk_bf16_f32 v135, v174, v175
    v_mfma_f32_16x16x32_bf16 a[140:143], a[188:191], v[76:79], a[140:143]
    s_waitcnt lgkmcnt(3)
    v_exp_f32 v176, v176
    v_mfma_f32_16x16x32_bf16 v[160:163], a[160:163], v[0:3], v[180:183]
    s_waitcnt lgkmcnt(2)
    ds_read_b64_tr_b16 a[176:177], v213 offset:0
    v_add_f32 v204, v176, v204
    v_mfma_f32_16x16x32_bf16 v[160:163], a[164:167], v[8:11], v[160:163]
    s_waitcnt lgkmcnt(2)
    v_exp_f32 v177, v177
    v_mfma_f32_16x16x32_bf16 v[160:163], a[168:171], v[16:19], v[160:163]
    s_waitcnt lgkmcnt(1)
    v_add_f32 v204, v177, v204
    v_cvt_pk_bf16_f32 v150, v176, v177
    v_mfma_f32_16x16x32_bf16 v[160:163], a[172:175], v[24:27], v[160:163]
    v_exp_f32 v178, v178
    v_mfma_f32_16x16x32_bf16 v[164:167], a[172:175], v[56:59], v[184:187]
    ds_read_b64_tr_b16 a[178:179], v213 offset:4096
    v_add_f32 v204, v178, v204
    v_mfma_f32_16x16x32_bf16 v[164:167], a[168:171], v[48:51], v[164:167]
    v_exp_f32 v179, v179
    v_mfma_f32_16x16x32_bf16 v[164:167], a[164:167], v[40:43], v[164:167]
    v_add_f32 v204, v179, v204
    v_cvt_pk_bf16_f32 v151, v178, v179
    v_mfma_f32_16x16x32_bf16 v[164:167], a[160:163], v[32:35], v[164:167]
    v_exp_f32 v160, v160
    v_mfma_f32_16x16x32_bf16 v[168:171], a[160:163], v[64:67], v[188:191]
    ds_read_b64_tr_b16 a[180:181], v213 offset:8192
    v_add_f32 v200, v160, v200
    v_mfma_f32_16x16x32_bf16 v[168:171], a[164:167], v[72:75], v[168:171]
    v_exp_f32 v161, v161
    v_mfma_f32_16x16x32_bf16 v[168:171], a[168:171], v[80:83], v[168:171]
    v_add_f32 v200, v161, v200
    v_cvt_pk_bf16_f32 v92, v160, v161
    v_mfma_f32_16x16x32_bf16 v[168:171], a[172:175], v[88:91], v[168:171]
    v_exp_f32 v162, v162
    v_mfma_f32_16x16x32_bf16 v[172:175], a[172:175], v[120:123], v[192:195]
    ds_read_b64_tr_b16 a[182:183], v213 offset:12288
    v_add_f32 v200, v162, v200
    v_mfma_f32_16x16x32_bf16 v[172:175], a[168:171], v[112:115], v[172:175]
    v_exp_f32 v163, v163
    v_mfma_f32_16x16x32_bf16 v[172:175], a[164:167], v[104:107], v[172:175]
    ds_read_b64_tr_b16 a[184:185], v214 offset:0
    v_add_f32 v200, v163, v200
    v_cvt_pk_bf16_f32 v93, v162, v163
    v_mfma_f32_16x16x32_bf16 v[172:175], a[160:163], v[96:99], v[172:175]
    v_exp_f32 v164, v164
    v_mfma_f32_16x16x32_bf16 v[176:179], a[160:163], v[128:131], v[196:199]
    ds_read_b64_tr_b16 a[186:187], v214 offset:4096
    v_add_f32 v201, v164, v201
    v_mfma_f32_16x16x32_bf16 v[176:179], a[164:167], v[136:139], v[176:179]
    v_exp_f32 v165, v165
    v_mfma_f32_16x16x32_bf16 v[176:179], a[168:171], v[144:147], v[176:179]
    ds_read_b64_tr_b16 a[188:189], v214 offset:8192
    v_add_f32 v201, v165, v201
    v_cvt_pk_bf16_f32 v108, v164, v165
    v_mfma_f32_16x16x32_bf16 v[176:179], a[172:175], v[152:155], v[176:179]
    s_waitcnt lgkmcnt(5)
    v_exp_f32 v166, v166
    v_mfma_f32_16x16x32_bf16 a[16:19], a[176:179], v[4:7], a[16:19]
    s_waitcnt lgkmcnt(3)
    ds_read_b64_tr_b16 a[190:191], v214 offset:12288
    v_add_f32 v201, v166, v201
    v_mfma_f32_16x16x32_bf16 a[16:19], a[180:183], v[12:15], a[16:19]
    v_exp_f32 v167, v167
    v_mfma_f32_16x16x32_bf16 a[48:51], a[180:183], v[28:31], a[48:51]
    v_add_f32 v201, v167, v201
    v_cvt_pk_bf16_f32 v109, v166, v167
    v_mfma_f32_16x16x32_bf16 a[48:51], a[176:179], v[20:23], a[48:51]
    v_exp_f32 v168, v168
    v_mfma_f32_16x16x32_bf16 a[80:83], a[176:179], v[36:39], a[80:83]
    ds_read_b128 a[160:163], v205 offset:28672
    v_add_f32 v202, v168, v202
    v_mfma_f32_16x16x32_bf16 a[80:83], a[180:183], v[44:47], a[80:83]
    buffer_load_dwordx4 v238, s[56:59], s27 offen offset:2048 sc1 lds
    v_exp_f32 v169, v169
    v_mfma_f32_16x16x32_bf16 a[112:115], a[180:183], v[60:63], a[112:115]
    v_add_f32 v202, v169, v202
    v_cvt_pk_bf16_f32 v124, v168, v169
    v_mfma_f32_16x16x32_bf16 a[112:115], a[176:179], v[52:55], a[112:115]
    v_exp_f32 v170, v170
    v_mfma_f32_16x16x32_bf16 a[144:147], a[176:179], v[68:71], a[144:147]
    ds_read_b128 a[164:167], v206 offset:28672
    v_add_f32 v202, v170, v202
    v_mfma_f32_16x16x32_bf16 a[144:147], a[180:183], v[76:79], a[144:147]
    s_waitcnt lgkmcnt(4)
    v_exp_f32 v171, v171
    v_mfma_f32_16x16x32_bf16 a[20:23], a[184:187], v[4:7], a[20:23]
    s_waitcnt lgkmcnt(2)
    v_add_f32 v202, v171, v202
    v_cvt_pk_bf16_f32 v125, v170, v171
    v_mfma_f32_16x16x32_bf16 a[20:23], a[188:191], v[12:15], a[20:23]
    v_exp_f32 v172, v172
    v_mfma_f32_16x16x32_bf16 a[52:55], a[188:191], v[28:31], a[52:55]
    ds_read_b128 a[168:171], v207 offset:28672
    v_add_f32 v203, v172, v203
    v_mfma_f32_16x16x32_bf16 a[52:55], a[184:187], v[20:23], a[52:55]
    v_exp_f32 v173, v173
    v_mfma_f32_16x16x32_bf16 a[84:87], a[184:187], v[36:39], a[84:87]
    v_add_f32 v203, v173, v203
    v_cvt_pk_bf16_f32 v140, v172, v173
    v_mfma_f32_16x16x32_bf16 a[84:87], a[188:191], v[44:47], a[84:87]
    v_exp_f32 v174, v174
    v_mfma_f32_16x16x32_bf16 a[116:119], a[188:191], v[60:63], a[116:119]
    ds_read_b128 a[172:175], v208 offset:28672
    v_add_f32 v203, v174, v203
    v_mfma_f32_16x16x32_bf16 a[116:119], a[184:187], v[52:55], a[116:119]
    v_exp_f32 v175, v175
    v_mfma_f32_16x16x32_bf16 a[148:151], a[184:187], v[68:71], a[148:151]
    v_add_f32 v203, v175, v203
    v_cvt_pk_bf16_f32 v141, v174, v175
    v_mfma_f32_16x16x32_bf16 a[148:151], a[188:191], v[76:79], a[148:151]
    s_waitcnt lgkmcnt(3)
    v_exp_f32 v176, v176
    v_mfma_f32_16x16x32_bf16 v[160:163], a[160:163], v[0:3], v[180:183]
    s_waitcnt lgkmcnt(2)
    ds_read_b64_tr_b16 a[176:177], v215 offset:0
    v_add_f32 v204, v176, v204
    v_mfma_f32_16x16x32_bf16 v[160:163], a[164:167], v[8:11], v[160:163]
    s_waitcnt lgkmcnt(2)
    v_exp_f32 v177, v177
    v_mfma_f32_16x16x32_bf16 v[160:163], a[168:171], v[16:19], v[160:163]
    s_waitcnt lgkmcnt(1)
    v_add_f32 v204, v177, v204
    v_cvt_pk_bf16_f32 v156, v176, v177
    v_mfma_f32_16x16x32_bf16 v[160:163], a[172:175], v[24:27], v[160:163]
    v_exp_f32 v178, v178
    v_mfma_f32_16x16x32_bf16 v[164:167], a[172:175], v[56:59], v[184:187]
    ds_read_b64_tr_b16 a[178:179], v215 offset:4096
    v_add_f32 v204, v178, v204
    v_mfma_f32_16x16x32_bf16 v[164:167], a[168:171], v[48:51], v[164:167]
    v_exp_f32 v179, v179
    v_mfma_f32_16x16x32_bf16 v[164:167], a[164:167], v[40:43], v[164:167]
    v_add_f32 v204, v179, v204
    v_cvt_pk_bf16_f32 v157, v178, v179
    v_mfma_f32_16x16x32_bf16 v[164:167], a[160:163], v[32:35], v[164:167]
    v_exp_f32 v160, v160
    v_mfma_f32_16x16x32_bf16 v[168:171], a[160:163], v[64:67], v[188:191]
    ds_read_b64_tr_b16 a[180:181], v215 offset:8192
    v_add_f32 v200, v160, v200
    v_mfma_f32_16x16x32_bf16 v[168:171], a[164:167], v[72:75], v[168:171]
    v_exp_f32 v161, v161
    v_mfma_f32_16x16x32_bf16 v[168:171], a[168:171], v[80:83], v[168:171]
    v_add_f32 v200, v161, v200
    v_cvt_pk_bf16_f32 v94, v160, v161
    v_mfma_f32_16x16x32_bf16 v[168:171], a[172:175], v[88:91], v[168:171]
    v_exp_f32 v162, v162
    v_mfma_f32_16x16x32_bf16 v[172:175], a[172:175], v[120:123], v[192:195]
    ds_read_b64_tr_b16 a[182:183], v215 offset:12288
    v_add_f32 v200, v162, v200
    v_mfma_f32_16x16x32_bf16 v[172:175], a[168:171], v[112:115], v[172:175]
    v_exp_f32 v163, v163
    v_mfma_f32_16x16x32_bf16 v[172:175], a[164:167], v[104:107], v[172:175]
    ds_read_b64_tr_b16 a[184:185], v216 offset:0
    v_add_f32 v200, v163, v200
    v_cvt_pk_bf16_f32 v95, v162, v163
    v_mfma_f32_16x16x32_bf16 v[172:175], a[160:163], v[96:99], v[172:175]
    v_exp_f32 v164, v164
    v_mfma_f32_16x16x32_bf16 v[176:179], a[160:163], v[128:131], v[196:199]
    ds_read_b64_tr_b16 a[186:187], v216 offset:4096
    v_add_f32 v201, v164, v201
    v_mfma_f32_16x16x32_bf16 v[176:179], a[164:167], v[136:139], v[176:179]
    v_exp_f32 v165, v165
    v_mfma_f32_16x16x32_bf16 v[176:179], a[168:171], v[144:147], v[176:179]
    ds_read_b64_tr_b16 a[188:189], v216 offset:8192
    v_add_f32 v201, v165, v201
    v_cvt_pk_bf16_f32 v110, v164, v165
    v_mfma_f32_16x16x32_bf16 v[176:179], a[172:175], v[152:155], v[176:179]
    s_waitcnt lgkmcnt(5)
    v_exp_f32 v166, v166
    v_mfma_f32_16x16x32_bf16 a[24:27], a[176:179], v[4:7], a[24:27]
    s_waitcnt lgkmcnt(3)
    ds_read_b64_tr_b16 a[190:191], v216 offset:12288
    v_add_f32 v201, v166, v201
    v_mfma_f32_16x16x32_bf16 a[24:27], a[180:183], v[12:15], a[24:27]
    v_exp_f32 v167, v167
    v_mfma_f32_16x16x32_bf16 a[56:59], a[180:183], v[28:31], a[56:59]
    v_add_f32 v201, v167, v201
    v_cvt_pk_bf16_f32 v111, v166, v167
    v_mfma_f32_16x16x32_bf16 a[56:59], a[176:179], v[20:23], a[56:59]
    v_exp_f32 v168, v168
    v_mfma_f32_16x16x32_bf16 a[88:91], a[176:179], v[36:39], a[88:91]
    v_add_f32 v202, v168, v202
    v_mfma_f32_16x16x32_bf16 a[88:91], a[180:183], v[44:47], a[88:91]
    v_exp_f32 v169, v169
    v_mfma_f32_16x16x32_bf16 a[120:123], a[180:183], v[60:63], a[120:123]
    s_waitcnt vmcnt(3) lgkmcnt(0)
    v_add_f32 v202, v169, v202
    v_cvt_pk_bf16_f32 v126, v168, v169
    v_mfma_f32_16x16x32_bf16 a[120:123], a[176:179], v[52:55], a[120:123]
    s_barrier
    v_exp_f32 v170, v170
    v_mfma_f32_16x16x32_bf16 a[152:155], a[176:179], v[68:71], a[152:155]
    ds_read_b128 a[160:163], v205 offset:32768
    v_add_f32 v202, v170, v202
    v_mfma_f32_16x16x32_bf16 a[152:155], a[180:183], v[76:79], a[152:155]
    v_exp_f32 v171, v171
    v_mfma_f32_16x16x32_bf16 a[28:31], a[184:187], v[4:7], a[28:31]
    ds_read_b128 a[164:167], v206 offset:32768
    v_add_f32 v202, v171, v202
    v_cvt_pk_bf16_f32 v127, v170, v171
    v_mfma_f32_16x16x32_bf16 a[28:31], a[188:191], v[12:15], a[28:31]
    v_exp_f32 v172, v172
    v_mfma_f32_16x16x32_bf16 a[60:63], a[188:191], v[28:31], a[60:63]
    ds_read_b128 a[168:171], v207 offset:32768
    v_add_f32 v203, v172, v203
    v_mfma_f32_16x16x32_bf16 a[60:63], a[184:187], v[20:23], a[60:63]
    v_exp_f32 v173, v173
    v_mfma_f32_16x16x32_bf16 a[92:95], a[184:187], v[36:39], a[92:95]
    v_add_f32 v203, v173, v203
    v_cvt_pk_bf16_f32 v142, v172, v173
    v_mfma_f32_16x16x32_bf16 a[92:95], a[188:191], v[44:47], a[92:95]
    v_exp_f32 v174, v174
    v_mfma_f32_16x16x32_bf16 a[124:127], a[188:191], v[60:63], a[124:127]
    ds_read_b128 a[172:175], v208 offset:32768
    v_add_f32 v203, v174, v203
    v_mfma_f32_16x16x32_bf16 a[124:127], a[184:187], v[52:55], a[124:127]
    buffer_load_dwordx4 v238, s[56:59], s27 offen offset:3072 sc1 lds
    v_exp_f32 v175, v175
    v_mfma_f32_16x16x32_bf16 a[156:159], a[184:187], v[68:71], a[156:159]
    v_add_f32 v203, v175, v203
    v_cvt_pk_bf16_f32 v143, v174, v175
    v_mfma_f32_16x16x32_bf16 a[156:159], a[188:191], v[76:79], a[156:159]
    v_exp_f32 v176, v176
    s_sub_u32 s31, s31, 1
    s_cmp_eq_u32 s31, 0
    s_cbranch_scc1 L_p14A
    s_waitcnt lgkmcnt(3)
    v_mfma_f32_16x16x32_bf16 v[160:163], a[160:163], v[0:3], v[180:183]
    s_waitcnt lgkmcnt(2)
    ds_read_b64_tr_b16 a[176:177], v209 offset:16384
    v_add_f32 v204, v176, v204
    v_mfma_f32_16x16x32_bf16 v[160:163], a[164:167], v[8:11], v[160:163]
    s_waitcnt lgkmcnt(2)
    v_exp_f32 v177, v177
    v_mfma_f32_16x16x32_bf16 v[160:163], a[168:171], v[16:19], v[160:163]
    s_waitcnt lgkmcnt(1)
    v_add_f32 v204, v177, v204
    v_cvt_pk_bf16_f32 v158, v176, v177
    v_mfma_f32_16x16x32_bf16 v[160:163], a[172:175], v[24:27], v[160:163]
    buffer_load_dword v254, v255, s[20:23], 0 offen sc0 sc1
    v_exp_f32 v178, v178
    v_mfma_f32_16x16x32_bf16 v[164:167], a[172:175], v[56:59], v[184:187]
    ds_read_b64_tr_b16 a[178:179], v209 offset:20480
    v_add_f32 v204, v178, v204
    v_mfma_f32_16x16x32_bf16 v[164:167], a[168:171], v[48:51], v[164:167]
    v_exp_f32 v179, v179
    v_mfma_f32_16x16x32_bf16 v[164:167], a[164:167], v[40:43], v[164:167]
    v_add_f32 v204, v179, v204
    v_cvt_pk_bf16_f32 v159, v178, v179
    v_mfma_f32_16x16x32_bf16 v[164:167], a[160:163], v[32:35], v[164:167]
    v_exp_f32 v160, v160
    v_mfma_f32_16x16x32_bf16 v[168:171], a[160:163], v[64:67], v[188:191]
    ds_read_b64_tr_b16 a[180:181], v209 offset:24576
    v_add_f32 v200, v160, v200
    v_mfma_f32_16x16x32_bf16 v[168:171], a[164:167], v[72:75], v[168:171]
    v_exp_f32 v161, v161
    v_mfma_f32_16x16x32_bf16 v[168:171], a[168:171], v[80:83], v[168:171]
    v_add_f32 v200, v161, v200
    v_cvt_pk_bf16_f32 v4, v160, v161
    v_mfma_f32_16x16x32_bf16 v[168:171], a[172:175], v[88:91], v[168:171]
    v_exp_f32 v162, v162
    v_mfma_f32_16x16x32_bf16 v[172:175], a[172:175], v[120:123], v[192:195]
    ds_read_b64_tr_b16 a[182:183], v209 offset:28672
    v_add_f32 v200, v162, v200
    v_mfma_f32_16x16x32_bf16 v[172:175], a[168:171], v[112:115], v[172:175]
    v_exp_f32 v163, v163
    v_mfma_f32_16x16x32_bf16 v[172:175], a[164:167], v[104:107], v[172:175]
    ds_read_b64_tr_b16 a[184:185], v210 offset:16384
    v_add_f32 v200, v163, v200
    v_cvt_pk_bf16_f32 v5, v162, v163
    v_mfma_f32_16x16x32_bf16 v[172:175], a[160:163], v[96:99], v[172:175]
    v_exp_f32 v164, v164
    v_mfma_f32_16x16x32_bf16 v[176:179], a[160:163], v[128:131], v[196:199]
    ds_read_b64_tr_b16 a[186:187], v210 offset:20480
    v_add_f32 v201, v164, v201
    v_mfma_f32_16x16x32_bf16 v[176:179], a[164:167], v[136:139], v[176:179]
    v_exp_f32 v165, v165
    v_mfma_f32_16x16x32_bf16 v[176:179], a[168:171], v[144:147], v[176:179]
    ds_read_b64_tr_b16 a[188:189], v210 offset:24576
    v_add_f32 v201, v165, v201
    v_cvt_pk_bf16_f32 v20, v164, v165
    v_mfma_f32_16x16x32_bf16 v[176:179], a[172:175], v[152:155], v[176:179]
    s_waitcnt lgkmcnt(5)
    v_exp_f32 v166, v166
    v_mfma_f32_16x16x32_bf16 a[0:3], a[176:179], v[84:87], a[0:3]
    s_waitcnt lgkmcnt(3)
    ds_read_b64_tr_b16 a[190:191], v210 offset:28672
    v_add_f32 v201, v166, v201
    v_mfma_f32_16x16x32_bf16 a[0:3], a[180:183], v[92:95], a[0:3]
    v_exp_f32 v167, v167
    v_mfma_f32_16x16x32_bf16 a[32:35], a[180:183], v[108:111], a[32:35]
    v_add_f32 v201, v167, v201
    v_cvt_pk_bf16_f32 v21, v166, v167
    v_mfma_f32_16x16x32_bf16 a[32:35], a[176:179], v[100:103], a[32:35]
    v_exp_f32 v168, v168
    v_mfma_f32_16x16x32_bf16 a[64:67], a[176:179], v[116:119], a[64:67]
    ds_read_b128 a[160:163], v205 offset:36864
    v_add_f32 v202, v168, v202
    v_mfma_f32_16x16x32_bf16 a[64:67], a[180:183], v[124:127], a[64:67]
    v_exp_f32 v169, v169
    v_mfma_f32_16x16x32_bf16 a[96:99], a[180:183], v[140:143], a[96:99]
    v_add_f32 v202, v169, v202
    v_cvt_pk_bf16_f32 v36, v168, v169
    v_mfma_f32_16x16x32_bf16 a[96:99], a[176:179], v[132:135], a[96:99]
    v_exp_f32 v170, v170
    v_mfma_f32_16x16x32_bf16 a[128:131], a[176:179], v[148:151], a[128:131]
    ds_read_b128 a[164:167], v206 offset:36864
    v_add_f32 v202, v170, v202
    v_mfma_f32_16x16x32_bf16 a[128:131], a[180:183], v[156:159], a[128:131]
    s_waitcnt lgkmcnt(4)
    v_exp_f32 v171, v171
    v_mfma_f32_16x16x32_bf16 a[4:7], a[184:187], v[84:87], a[4:7]
    s_waitcnt lgkmcnt(2)
    v_add_f32 v202, v171, v202
    v_cvt_pk_bf16_f32 v37, v170, v171
    v_mfma_f32_16x16x32_bf16 a[4:7], a[188:191], v[92:95], a[4:7]
    v_exp_f32 v172, v172
    v_mfma_f32_16x16x32_bf16 a[36:39], a[188:191], v[108:111], a[36:39]
    ds_read_b128 a[168:171], v207 offset:36864
    v_add_f32 v203, v172, v203
    v_mfma_f32_16x16x32_bf16 a[36:39], a[184:187], v[100:103], a[36:39]
    v_exp_f32 v173, v173
    v_mfma_f32_16x16x32_bf16 a[68:71], a[184:187], v[116:119], a[68:71]
    v_add_f32 v203, v173, v203
    v_cvt_pk_bf16_f32 v52, v172, v173
    v_mfma_f32_16x16x32_bf16 a[68:71], a[188:191], v[124:127], a[68:71]
    v_exp_f32 v174, v174
    v_mfma_f32_16x16x32_bf16 a[100:103], a[188:191], v[140:143], a[100:103]
    ds_read_b128 a[172:175], v208 offset:36864
    v_add_f32 v203, v174, v203
    v_mfma_f32_16x16x32_bf16 a[100:103], a[184:187], v[132:135], a[100:103]
    v_exp_f32 v175, v175
    v_mfma_f32_16x16x32_bf16 a[132:135], a[184:187], v[148:151], a[132:135]
    v_add_f32 v203, v175, v203
    v_cvt_pk_bf16_f32 v53, v174, v175
    v_mfma_f32_16x16x32_bf16 a[132:135], a[188:191], v[156:159], a[132:135]
    s_waitcnt lgkmcnt(3)
    v_exp_f32 v176, v176
    v_mfma_f32_16x16x32_bf16 v[160:163], a[160:163], v[0:3], v[180:183]
    s_waitcnt lgkmcnt(2)
    ds_read_b64_tr_b16 a[176:177], v211 offset:16384
    v_add_f32 v204, v176, v204
    v_mfma_f32_16x16x32_bf16 v[160:163], a[164:167], v[8:11], v[160:163]
    s_waitcnt lgkmcnt(2)
    v_exp_f32 v177, v177
    v_mfma_f32_16x16x32_bf16 v[160:163], a[168:171], v[16:19], v[160:163]
    s_waitcnt lgkmcnt(1)
    v_add_f32 v204, v177, v204
    v_cvt_pk_bf16_f32 v68, v176, v177
    v_mfma_f32_16x16x32_bf16 v[160:163], a[172:175], v[24:27], v[160:163]
    v_exp_f32 v178, v178
    v_mfma_f32_16x16x32_bf16 v[164:167], a[172:175], v[56:59], v[184:187]
    ds_read_b64_tr_b16 a[178:179], v211 offset:20480
    v_add_f32 v204, v178, v204
    v_mfma_f32_16x16x32_bf16 v[164:167], a[168:171], v[48:51], v[164:167]
    v_exp_f32 v179, v179
    v_mfma_f32_16x16x32_bf16 v[164:167], a[164:167], v[40:43], v[164:167]
    v_add_f32 v204, v179, v204
    v_cvt_pk_bf16_f32 v69, v178, v179
    v_mfma_f32_16x16x32_bf16 v[164:167], a[160:163], v[32:35], v[164:167]
    v_exp_f32 v160, v160
    v_mfma_f32_16x16x32_bf16 v[168:171], a[160:163], v[64:67], v[188:191]
    ds_read_b64_tr_b16 a[180:181], v211 offset:24576
    v_add_f32 v200, v160, v200
    v_mfma_f32_16x16x32_bf16 v[168:171], a[164:167], v[72:75], v[168:171]
    v_exp_f32 v161, v161
    v_mfma_f32_16x16x32_bf16 v[168:171], a[168:171], v[80:83], v[168:171]
    v_add_f32 v200, v161, v200
    v_cvt_pk_bf16_f32 v6, v160, v161
    v_mfma_f32_16x16x32_bf16 v[168:171], a[172:175], v[88:91], v[168:171]
    v_exp_f32 v162, v162
    v_mfma_f32_16x16x32_bf16 v[172:175], a[172:175], v[120:123], v[192:195]
    ds_read_b64_tr_b16 a[182:183], v211 offset:28672
    v_add_f32 v200, v162, v200
    v_mfma_f32_16x16x32_bf16 v[172:175], a[168:171], v[112:115], v[172:175]
    v_exp_f32 v163, v163
    v_mfma_f32_16x16x32_bf16 v[172:175], a[164:167], v[104:107], v[172:175]
    ds_read_b64_tr_b16 a[184:185], v212 offset:16384
    v_add_f32 v200, v163, v200
    v_cvt_pk_bf16_f32 v7, v162, v163
    v_mfma_f32_16x16x32_bf16 v[172:175], a[160:163], v[96:99], v[172:175]
    v_exp_f32 v164, v164
    v_mfma_f32_16x16x32_bf16 v[176:179], a[160:163], v[128:131], v[196:199]
    ds_read_b64_tr_b16 a[186:187], v212 offset:20480
    v_add_f32 v201, v164, v201
    v_mfma_f32_16x16x32_bf16 v[176:179], a[164:167], v[136:139], v[176:179]
    v_exp_f32 v165, v165
    v_mfma_f32_16x16x32_bf16 v[176:179], a[168:171], v[144:147], v[176:179]
    ds_read_b64_tr_b16 a[188:189], v212 offset:24576
    v_add_f32 v201, v165, v201
    v_cvt_pk_bf16_f32 v22, v164, v165
    v_mfma_f32_16x16x32_bf16 v[176:179], a[172:175], v[152:155], v[176:179]
    s_waitcnt lgkmcnt(5)
    v_exp_f32 v166, v166
    v_mfma_f32_16x16x32_bf16 a[8:11], a[176:179], v[84:87], a[8:11]
    s_waitcnt lgkmcnt(3)
    ds_read_b64_tr_b16 a[190:191], v212 offset:28672
    v_add_f32 v201, v166, v201
    v_mfma_f32_16x16x32_bf16 a[8:11], a[180:183], v[92:95], a[8:11]
    v_exp_f32 v167, v167
    v_mfma_f32_16x16x32_bf16 a[40:43], a[180:183], v[108:111], a[40:43]
    v_add_f32 v201, v167, v201
    v_cvt_pk_bf16_f32 v23, v166, v167
    v_mfma_f32_16x16x32_bf16 a[40:43], a[176:179], v[100:103], a[40:43]
    v_exp_f32 v168, v168
    v_mfma_f32_16x16x32_bf16 a[72:75], a[176:179], v[116:119], a[72:75]
    ds_read_b128 a[160:163], v205 offset:40960
    v_add_f32 v202, v168, v202
    v_mfma_f32_16x16x32_bf16 a[72:75], a[180:183], v[124:127], a[72:75]
    v_exp_f32 v169, v169
    v_mfma_f32_16x16x32_bf16 a[104:107], a[180:183], v[140:143], a[104:107]
    v_add_f32 v202, v169, v202
    v_cvt_pk_bf16_f32 v38, v168, v169
    v_mfma_f32_16x16x32_bf16 a[104:107], a[176:179], v[132:135], a[104:107]
    v_exp_f32 v170, v170
    v_mfma_f32_16x16x32_bf16 a[136:139], a[176:179], v[148:151], a[136:139]
    ds_read_b128 a[164:167], v206 offset:40960
    v_add_f32 v202, v170, v202
    v_mfma_f32_16x16x32_bf16 a[136:139], a[180:183], v[156:159], a[136:139]
    s_waitcnt lgkmcnt(4)
    v_exp_f32 v171, v171
    v_mfma_f32_16x16x32_bf16 a[12:15], a[184:187], v[84:87], a[12:15]
    s_waitcnt lgkmcnt(2)
    v_add_f32 v202, v171, v202
    v_cvt_pk_bf16_f32 v39, v170, v171
    v_mfma_f32_16x16x32_bf16 a[12:15], a[188:191], v[92:95], a[12:15]
    v_exp_f32 v172, v172
    v_mfma_f32_16x16x32_bf16 a[44:47], a[188:191], v[108:111], a[44:47]
    ds_read_b128 a[168:171], v207 offset:40960
    v_add_f32 v203, v172, v203
    v_mfma_f32_16x16x32_bf16 a[44:47], a[184:187], v[100:103], a[44:47]
    v_exp_f32 v173, v173
    v_mfma_f32_16x16x32_bf16 a[76:79], a[184:187], v[116:119], a[76:79]
    v_add_f32 v203, v173, v203
    v_cvt_pk_bf16_f32 v54, v172, v173
    v_mfma_f32_16x16x32_bf16 a[76:79], a[188:191], v[124:127], a[76:79]
    v_exp_f32 v174, v174
    v_mfma_f32_16x16x32_bf16 a[108:111], a[188:191], v[140:143], a[108:111]
    ds_read_b128 a[172:175], v208 offset:40960
    v_add_f32 v203, v174, v203
    v_mfma_f32_16x16x32_bf16 a[108:111], a[184:187], v[132:135], a[108:111]
    v_exp_f32 v175, v175
    v_mfma_f32_16x16x32_bf16 a[140:143], a[184:187], v[148:151], a[140:143]
    v_add_f32 v203, v175, v203
    v_cvt_pk_bf16_f32 v55, v174, v175
    v_mfma_f32_16x16x32_bf16 a[140:143], a[188:191], v[156:159], a[140:143]
    s_waitcnt lgkmcnt(3)
    v_exp_f32 v176, v176
    v_mfma_f32_16x16x32_bf16 v[160:163], a[160:163], v[0:3], v[180:183]
    s_waitcnt lgkmcnt(2)
    ds_read_b64_tr_b16 a[176:177], v213 offset:16384
    v_add_f32 v204, v176, v204
    v_mfma_f32_16x16x32_bf16 v[160:163], a[164:167], v[8:11], v[160:163]
    s_waitcnt lgkmcnt(2)
    v_exp_f32 v177, v177
    v_mfma_f32_16x16x32_bf16 v[160:163], a[168:171], v[16:19], v[160:163]
    s_waitcnt lgkmcnt(1)
    v_add_f32 v204, v177, v204
    v_cvt_pk_bf16_f32 v70, v176, v177
    v_mfma_f32_16x16x32_bf16 v[160:163], a[172:175], v[24:27], v[160:163]
    v_exp_f32 v178, v178
    v_mfma_f32_16x16x32_bf16 v[164:167], a[172:175], v[56:59], v[184:187]
    ds_read_b64_tr_b16 a[178:179], v213 offset:20480
    v_add_f32 v204, v178, v204
    v_mfma_f32_16x16x32_bf16 v[164:167], a[168:171], v[48:51], v[164:167]
    v_exp_f32 v179, v179
    v_mfma_f32_16x16x32_bf16 v[164:167], a[164:167], v[40:43], v[164:167]
    v_add_f32 v204, v179, v204
    v_cvt_pk_bf16_f32 v71, v178, v179
    v_mfma_f32_16x16x32_bf16 v[164:167], a[160:163], v[32:35], v[164:167]
    v_exp_f32 v160, v160
    v_mfma_f32_16x16x32_bf16 v[168:171], a[160:163], v[64:67], v[188:191]
    ds_read_b64_tr_b16 a[180:181], v213 offset:24576
    v_add_f32 v200, v160, v200
    v_mfma_f32_16x16x32_bf16 v[168:171], a[164:167], v[72:75], v[168:171]
    v_exp_f32 v161, v161
    v_mfma_f32_16x16x32_bf16 v[168:171], a[168:171], v[80:83], v[168:171]
    v_add_f32 v200, v161, v200
    v_cvt_pk_bf16_f32 v12, v160, v161
    v_mfma_f32_16x16x32_bf16 v[168:171], a[172:175], v[88:91], v[168:171]
    v_exp_f32 v162, v162
    v_mfma_f32_16x16x32_bf16 v[172:175], a[172:175], v[120:123], v[192:195]
    ds_read_b64_tr_b16 a[182:183], v213 offset:28672
    v_add_f32 v200, v162, v200
    v_mfma_f32_16x16x32_bf16 v[172:175], a[168:171], v[112:115], v[172:175]
    v_exp_f32 v163, v163
    v_mfma_f32_16x16x32_bf16 v[172:175], a[164:167], v[104:107], v[172:175]
    ds_read_b64_tr_b16 a[184:185], v214 offset:16384
    v_add_f32 v200, v163, v200
    v_cvt_pk_bf16_f32 v13, v162, v163
    v_mfma_f32_16x16x32_bf16 v[172:175], a[160:163], v[96:99], v[172:175]
    v_exp_f32 v164, v164
    v_mfma_f32_16x16x32_bf16 v[176:179], a[160:163], v[128:131], v[196:199]
    ds_read_b64_tr_b16 a[186:187], v214 offset:20480
    v_add_f32 v201, v164, v201
    v_mfma_f32_16x16x32_bf16 v[176:179], a[164:167], v[136:139], v[176:179]
    v_exp_f32 v165, v165
    v_mfma_f32_16x16x32_bf16 v[176:179], a[168:171], v[144:147], v[176:179]
    ds_read_b64_tr_b16 a[188:189], v214 offset:24576
    v_add_f32 v201, v165, v201
    v_cvt_pk_bf16_f32 v28, v164, v165
    v_mfma_f32_16x16x32_bf16 v[176:179], a[172:175], v[152:155], v[176:179]
    s_waitcnt lgkmcnt(5)
    v_exp_f32 v166, v166
    v_mfma_f32_16x16x32_bf16 a[16:19], a[176:179], v[84:87], a[16:19]
    s_waitcnt lgkmcnt(3)
    ds_read_b64_tr_b16 a[190:191], v214 offset:28672
    v_add_f32 v201, v166, v201
    v_mfma_f32_16x16x32_bf16 a[16:19], a[180:183], v[92:95], a[16:19]
    v_exp_f32 v167, v167
    v_mfma_f32_16x16x32_bf16 a[48:51], a[180:183], v[108:111], a[48:51]
    v_add_f32 v201, v167, v201
    v_cvt_pk_bf16_f32 v29, v166, v167
    v_mfma_f32_16x16x32_bf16 a[48:51], a[176:179], v[100:103], a[48:51]
    v_exp_f32 v168, v168
    v_mfma_f32_16x16x32_bf16 a[80:83], a[176:179], v[116:119], a[80:83]
    ds_read_b128 a[160:163], v205 offset:45056
    v_add_f32 v202, v168, v202
    v_mfma_f32_16x16x32_bf16 a[80:83], a[180:183], v[124:127], a[80:83]
    v_exp_f32 v169, v169
    v_mfma_f32_16x16x32_bf16 a[112:115], a[180:183], v[140:143], a[112:115]
    v_add_f32 v202, v169, v202
    v_cvt_pk_bf16_f32 v44, v168, v169
    v_mfma_f32_16x16x32_bf16 a[112:115], a[176:179], v[132:135], a[112:115]
    v_exp_f32 v170, v170
    v_mfma_f32_16x16x32_bf16 a[144:147], a[176:179], v[148:151], a[144:147]
    ds_read_b128 a[164:167], v206 offset:45056
    v_add_f32 v202, v170, v202
    v_mfma_f32_16x16x32_bf16 a[144:147], a[180:183], v[156:159], a[144:147]
    s_waitcnt lgkmcnt(4)
    v_exp_f32 v171, v171
    v_mfma_f32_16x16x32_bf16 a[20:23], a[184:187], v[84:87], a[20:23]
    s_waitcnt lgkmcnt(2)
    v_add_f32 v202, v171, v202
    v_cvt_pk_bf16_f32 v45, v170, v171
    v_mfma_f32_16x16x32_bf16 a[20:23], a[188:191], v[92:95], a[20:23]
    v_exp_f32 v172, v172
    v_mfma_f32_16x16x32_bf16 a[52:55], a[188:191], v[108:111], a[52:55]
    ds_read_b128 a[168:171], v207 offset:45056
    v_add_f32 v203, v172, v203
    v_mfma_f32_16x16x32_bf16 a[52:55], a[184:187], v[100:103], a[52:55]
    v_exp_f32 v173, v173
    v_mfma_f32_16x16x32_bf16 a[84:87], a[184:187], v[116:119], a[84:87]
    v_add_f32 v203, v173, v203
    v_cvt_pk_bf16_f32 v60, v172, v173
    v_mfma_f32_16x16x32_bf16 a[84:87], a[188:191], v[124:127], a[84:87]
    v_exp_f32 v174, v174
    v_mfma_f32_16x16x32_bf16 a[116:119], a[188:191], v[140:143], a[116:119]
    ds_read_b128 a[172:175], v208 offset:45056
    v_add_f32 v203, v174, v203
    v_mfma_f32_16x16x32_bf16 a[116:119], a[184:187], v[132:135], a[116:119]
    v_exp_f32 v175, v175
    v_mfma_f32_16x16x32_bf16 a[148:151], a[184:187], v[148:151], a[148:151]
    v_add_f32 v203, v175, v203
    v_cvt_pk_bf16_f32 v61, v174, v175
    v_mfma_f32_16x16x32_bf16 a[148:151], a[188:191], v[156:159], a[148:151]
    s_waitcnt lgkmcnt(3)
    v_exp_f32 v176, v176
    v_mfma_f32_16x16x32_bf16 v[160:163], a[160:163], v[0:3], v[180:183]
    s_waitcnt lgkmcnt(2)
    ds_read_b64_tr_b16 a[176:177], v215 offset:16384
    v_add_f32 v204, v176, v204
    v_mfma_f32_16x16x32_bf16 v[160:163], a[164:167], v[8:11], v[160:163]
    s_waitcnt lgkmcnt(2)
    v_exp_f32 v177, v177
    v_mfma_f32_16x16x32_bf16 v[160:163], a[168:171], v[16:19], v[160:163]
    s_waitcnt lgkmcnt(1)
    v_add_f32 v204, v177, v204
    v_cvt_pk_bf16_f32 v76, v176, v177
    v_mfma_f32_16x16x32_bf16 v[160:163], a[172:175], v[24:27], v[160:163]
    v_exp_f32 v178, v178
    v_mfma_f32_16x16x32_bf16 v[164:167], a[172:175], v[56:59], v[184:187]
    ds_read_b64_tr_b16 a[178:179], v215 offset:20480
    v_add_f32 v204, v178, v204
    v_mfma_f32_16x16x32_bf16 v[164:167], a[168:171], v[48:51], v[164:167]
    v_exp_f32 v179, v179
    v_mfma_f32_16x16x32_bf16 v[164:167], a[164:167], v[40:43], v[164:167]
    v_add_f32 v204, v179, v204
    v_cvt_pk_bf16_f32 v77, v178, v179
    v_mfma_f32_16x16x32_bf16 v[164:167], a[160:163], v[32:35], v[164:167]
    v_exp_f32 v160, v160
    v_mfma_f32_16x16x32_bf16 v[168:171], a[160:163], v[64:67], v[188:191]
    ds_read_b64_tr_b16 a[180:181], v215 offset:24576
    v_add_f32 v200, v160, v200
    v_mfma_f32_16x16x32_bf16 v[168:171], a[164:167], v[72:75], v[168:171]
    v_exp_f32 v161, v161
    v_mfma_f32_16x16x32_bf16 v[168:171], a[168:171], v[80:83], v[168:171]
    v_add_f32 v200, v161, v200
    v_cvt_pk_bf16_f32 v14, v160, v161
    v_mfma_f32_16x16x32_bf16 v[168:171], a[172:175], v[88:91], v[168:171]
    v_exp_f32 v162, v162
    v_mfma_f32_16x16x32_bf16 v[172:175], a[172:175], v[120:123], v[192:195]
    ds_read_b64_tr_b16 a[182:183], v215 offset:28672
    v_add_f32 v200, v162, v200
    v_mfma_f32_16x16x32_bf16 v[172:175], a[168:171], v[112:115], v[172:175]
    v_exp_f32 v163, v163
    v_mfma_f32_16x16x32_bf16 v[172:175], a[164:167], v[104:107], v[172:175]
    ds_read_b64_tr_b16 a[184:185], v216 offset:16384
    v_add_f32 v200, v163, v200
    v_cvt_pk_bf16_f32 v15, v162, v163
    v_mfma_f32_16x16x32_bf16 v[172:175], a[160:163], v[96:99], v[172:175]
    v_exp_f32 v164, v164
    v_mfma_f32_16x16x32_bf16 v[176:179], a[160:163], v[128:131], v[196:199]
    ds_read_b64_tr_b16 a[186:187], v216 offset:20480
    v_add_f32 v201, v164, v201
    v_mfma_f32_16x16x32_bf16 v[176:179], a[164:167], v[136:139], v[176:179]
    v_exp_f32 v165, v165
    v_mfma_f32_16x16x32_bf16 v[176:179], a[168:171], v[144:147], v[176:179]
    ds_read_b64_tr_b16 a[188:189], v216 offset:24576
    v_add_f32 v201, v165, v201
    v_cvt_pk_bf16_f32 v30, v164, v165
    v_mfma_f32_16x16x32_bf16 v[176:179], a[172:175], v[152:155], v[176:179]
    s_waitcnt lgkmcnt(5)
    v_exp_f32 v166, v166
    v_mfma_f32_16x16x32_bf16 a[24:27], a[176:179], v[84:87], a[24:27]
    s_waitcnt lgkmcnt(3)
    ds_read_b64_tr_b16 a[190:191], v216 offset:28672
    v_add_f32 v201, v166, v201
    v_mfma_f32_16x16x32_bf16 a[24:27], a[180:183], v[92:95], a[24:27]
    v_exp_f32 v167, v167
    v_mfma_f32_16x16x32_bf16 a[56:59], a[180:183], v[108:111], a[56:59]
    v_add_f32 v201, v167, v201
    v_cvt_pk_bf16_f32 v31, v166, v167
    v_mfma_f32_16x16x32_bf16 a[56:59], a[176:179], v[100:103], a[56:59]
    v_exp_f32 v168, v168
    v_mfma_f32_16x16x32_bf16 a[88:91], a[176:179], v[116:119], a[88:91]
    v_add_f32 v202, v168, v202
    v_mfma_f32_16x16x32_bf16 a[88:91], a[180:183], v[124:127], a[88:91]
    v_exp_f32 v169, v169
    v_mfma_f32_16x16x32_bf16 a[120:123], a[180:183], v[140:143], a[120:123]
    s_waitcnt vmcnt(1) lgkmcnt(0)
    v_add_f32 v202, v169, v202
    v_cvt_pk_bf16_f32 v46, v168, v169
    v_mfma_f32_16x16x32_bf16 a[120:123], a[176:179], v[132:135], a[120:123]
    s_barrier
    v_exp_f32 v170, v170
    v_mfma_f32_16x16x32_bf16 a[152:155], a[176:179], v[148:151], a[152:155]
    ds_read_b128 a[160:163], v205 offset:49152
    v_add_f32 v202, v170, v202
    v_mfma_f32_16x16x32_bf16 a[152:155], a[180:183], v[156:159], a[152:155]
    v_exp_f32 v171, v171
    v_mfma_f32_16x16x32_bf16 a[28:31], a[184:187], v[84:87], a[28:31]
    ds_read_b128 a[164:167], v206 offset:49152
    v_add_f32 v202, v171, v202
    v_cvt_pk_bf16_f32 v47, v170, v171
    v_mfma_f32_16x16x32_bf16 a[28:31], a[188:191], v[92:95], a[28:31]
    v_exp_f32 v172, v172
    v_mfma_f32_16x16x32_bf16 a[60:63], a[188:191], v[108:111], a[60:63]
    ds_read_b128 a[168:171], v207 offset:49152
    v_add_f32 v203, v172, v203
    v_mfma_f32_16x16x32_bf16 a[60:63], a[184:187], v[100:103], a[60:63]
    v_exp_f32 v173, v173
    v_mfma_f32_16x16x32_bf16 a[92:95], a[184:187], v[116:119], a[92:95]
    v_add_f32 v203, v173, v203
    v_cvt_pk_bf16_f32 v62, v172, v173
    v_mfma_f32_16x16x32_bf16 a[92:95], a[188:191], v[124:127], a[92:95]
    v_exp_f32 v174, v174
    v_mfma_f32_16x16x32_bf16 a[124:127], a[188:191], v[140:143], a[124:127]
    ds_read_b128 a[172:175], v208 offset:49152
    v_add_f32 v203, v174, v203
    v_mfma_f32_16x16x32_bf16 a[124:127], a[184:187], v[132:135], a[124:127]
    v_exp_f32 v175, v175
    v_mfma_f32_16x16x32_bf16 a[156:159], a[184:187], v[148:151], a[156:159]
    v_add_f32 v203, v175, v203
    v_cvt_pk_bf16_f32 v63, v174, v175
    v_mfma_f32_16x16x32_bf16 a[156:159], a[188:191], v[156:159], a[156:159]
    s_waitcnt lgkmcnt(3)
    v_exp_f32 v176, v176
    v_mfma_f32_16x16x32_bf16 v[160:163], a[160:163], v[0:3], v[180:183]
    s_waitcnt lgkmcnt(2)
    ds_read_b64_tr_b16 a[176:177], v209 offset:32768
    v_add_f32 v204, v176, v204
    v_mfma_f32_16x16x32_bf16 v[160:163], a[164:167], v[8:11], v[160:163]
    s_waitcnt lgkmcnt(2)
    v_exp_f32 v177, v177
    v_mfma_f32_16x16x32_bf16 v[160:163], a[168:171], v[16:19], v[160:163]
    s_waitcnt lgkmcnt(1)
    v_add_f32 v204, v177, v204
    v_cvt_pk_bf16_f32 v78, v176, v177
    v_mfma_f32_16x16x32_bf16 v[160:163], a[172:175], v[24:27], v[160:163]
    buffer_atomic_add v250, v253, s[20:23], s33 offen sc1
    v_exp_f32 v178, v178
    v_mfma_f32_16x16x32_bf16 v[164:167], a[172:175], v[56:59], v[184:187]
    ds_read_b64_tr_b16 a[178:179], v209 offset:36864
    v_add_f32 v204, v178, v204
    v_mfma_f32_16x16x32_bf16 v[164:167], a[168:171], v[48:51], v[164:167]
    v_exp_f32 v179, v179
    v_mfma_f32_16x16x32_bf16 v[164:167], a[164:167], v[40:43], v[164:167]
    v_add_f32 v204, v179, v204
    v_cvt_pk_bf16_f32 v79, v178, v179
    v_mfma_f32_16x16x32_bf16 v[164:167], a[160:163], v[32:35], v[164:167]
    v_exp_f32 v160, v160
    v_mfma_f32_16x16x32_bf16 v[168:171], a[160:163], v[64:67], v[188:191]
    ds_read_b64_tr_b16 a[180:181], v209 offset:40960
    v_add_f32 v200, v160, v200
    v_mfma_f32_16x16x32_bf16 v[168:171], a[164:167], v[72:75], v[168:171]
    v_exp_f32 v161, v161
    v_mfma_f32_16x16x32_bf16 v[168:171], a[168:171], v[80:83], v[168:171]
    v_add_f32 v200, v161, v200
    v_cvt_pk_bf16_f32 v84, v160, v161
    v_mfma_f32_16x16x32_bf16 v[168:171], a[172:175], v[88:91], v[168:171]
    v_exp_f32 v162, v162
    v_mfma_f32_16x16x32_bf16 v[172:175], a[172:175], v[120:123], v[192:195]
    ds_read_b64_tr_b16 a[182:183], v209 offset:45056
    v_add_f32 v200, v162, v200
    v_mfma_f32_16x16x32_bf16 v[172:175], a[168:171], v[112:115], v[172:175]
    v_exp_f32 v163, v163
    v_mfma_f32_16x16x32_bf16 v[172:175], a[164:167], v[104:107], v[172:175]
    ds_read_b64_tr_b16 a[184:185], v210 offset:32768
    v_add_f32 v200, v163, v200
    v_cvt_pk_bf16_f32 v85, v162, v163
    v_mfma_f32_16x16x32_bf16 v[172:175], a[160:163], v[96:99], v[172:175]
    v_exp_f32 v164, v164
    v_mfma_f32_16x16x32_bf16 v[176:179], a[160:163], v[128:131], v[196:199]
    ds_read_b64_tr_b16 a[186:187], v210 offset:36864
    v_add_f32 v201, v164, v201
    v_mfma_f32_16x16x32_bf16 v[176:179], a[164:167], v[136:139], v[176:179]
    v_exp_f32 v165, v165
    v_mfma_f32_16x16x32_bf16 v[176:179], a[168:171], v[144:147], v[176:179]
    ds_read_b64_tr_b16 a[188:189], v210 offset:40960
    v_add_f32 v201, v165, v201
    v_cvt_pk_bf16_f32 v100, v164, v165
    v_mfma_f32_16x16x32_bf16 v[176:179], a[172:175], v[152:155], v[176:179]
    s_waitcnt lgkmcnt(5)
    v_exp_f32 v166, v166
    v_mfma_f32_16x16x32_bf16 a[0:3], a[176:179], v[4:7], a[0:3]
    s_waitcnt lgkmcnt(3)
    ds_read_b64_tr_b16 a[190:191], v210 offset:45056
    v_add_f32 v201, v166, v201
    v_mfma_f32_16x16x32_bf16 a[0:3], a[180:183], v[12:15], a[0:3]
    v_exp_f32 v167, v167
    v_mfma_f32_16x16x32_bf16 a[32:35], a[180:183], v[28:31], a[32:35]
    v_add_f32 v201, v167, v201
    v_cvt_pk_bf16_f32 v101, v166, v167
    v_mfma_f32_16x16x32_bf16 a[32:35], a[176:179], v[20:23], a[32:35]
    v_exp_f32 v168, v168
    v_mfma_f32_16x16x32_bf16 a[64:67], a[176:179], v[36:39], a[64:67]
    ds_read_b128 a[160:163], v205 offset:53248
    v_add_f32 v202, v168, v202
    v_mfma_f32_16x16x32_bf16 a[64:67], a[180:183], v[44:47], a[64:67]
    v_exp_f32 v169, v169
    v_mfma_f32_16x16x32_bf16 a[96:99], a[180:183], v[60:63], a[96:99]
    v_add_f32 v202, v169, v202
    v_cvt_pk_bf16_f32 v116, v168, v169
    v_mfma_f32_16x16x32_bf16 a[96:99], a[176:179], v[52:55], a[96:99]
    v_exp_f32 v170, v170
    v_mfma_f32_16x16x32_bf16 a[128:131], a[176:179], v[68:71], a[128:131]
    ds_read_b128 a[164:167], v206 offset:53248
    v_add_f32 v202, v170, v202
    v_mfma_f32_16x16x32_bf16 a[128:131], a[180:183], v[76:79], a[128:131]
    s_waitcnt lgkmcnt(4)
    v_exp_f32 v171, v171
    v_mfma_f32_16x16x32_bf16 a[4:7], a[184:187], v[4:7], a[4:7]
    s_waitcnt lgkmcnt(2)
    v_add_f32 v202, v171, v202
    v_cvt_pk_bf16_f32 v117, v170, v171
    v_mfma_f32_16x16x32_bf16 a[4:7], a[188:191], v[12:15], a[4:7]
    v_exp_f32 v172, v172
    v_mfma_f32_16x16x32_bf16 a[36:39], a[188:191], v[28:31], a[36:39]
    ds_read_b128 a[168:171], v207 offset:53248
    v_add_f32 v203, v172, v203
    v_mfma_f32_16x16x32_bf16 a[36:39], a[184:187], v[20:23], a[36:39]
    v_exp_f32 v173, v173
    v_mfma_f32_16x16x32_bf16 a[68:71], a[184:187], v[36:39], a[68:71]
    v_add_f32 v203, v173, v203
    v_cvt_pk_bf16_f32 v132, v172, v173
    v_mfma_f32_16x16x32_bf16 a[68:71], a[188:191], v[44:47], a[68:71]
    v_exp_f32 v174, v174
    v_mfma_f32_16x16x32_bf16 a[100:103], a[188:191], v[60:63], a[100:103]
    ds_read_b128 a[172:175], v208 offset:53248
    v_add_f32 v203, v174, v203
    v_mfma_f32_16x16x32_bf16 a[100:103], a[184:187], v[52:55], a[100:103]
    v_exp_f32 v175, v175
    v_mfma_f32_16x16x32_bf16 a[132:135], a[184:187], v[68:71], a[132:135]
    v_add_f32 v203, v175, v203
    v_cvt_pk_bf16_f32 v133, v174, v175
    v_mfma_f32_16x16x32_bf16 a[132:135], a[188:191], v[76:79], a[132:135]
    s_waitcnt lgkmcnt(3)
    v_exp_f32 v176, v176
    v_mfma_f32_16x16x32_bf16 v[160:163], a[160:163], v[0:3], v[180:183]
    s_waitcnt lgkmcnt(2)
    ds_read_b64_tr_b16 a[176:177], v211 offset:32768
    v_add_f32 v204, v176, v204
    v_mfma_f32_16x16x32_bf16 v[160:163], a[164:167], v[8:11], v[160:163]
    s_waitcnt lgkmcnt(2)
    v_exp_f32 v177, v177
    v_mfma_f32_16x16x32_bf16 v[160:163], a[168:171], v[16:19], v[160:163]
    s_waitcnt lgkmcnt(1)
    v_add_f32 v204, v177, v204
    v_cvt_pk_bf16_f32 v148, v176, v177
    v_mfma_f32_16x16x32_bf16 v[160:163], a[172:175], v[24:27], v[160:163]
    v_exp_f32 v178, v178
    v_mfma_f32_16x16x32_bf16 v[164:167], a[172:175], v[56:59], v[184:187]
    ds_read_b64_tr_b16 a[178:179], v211 offset:36864
    v_add_f32 v204, v178, v204
    v_mfma_f32_16x16x32_bf16 v[164:167], a[168:171], v[48:51], v[164:167]
    v_exp_f32 v179, v179
    v_mfma_f32_16x16x32_bf16 v[164:167], a[164:167], v[40:43], v[164:167]
    v_add_f32 v204, v179, v204
    v_cvt_pk_bf16_f32 v149, v178, v179
    v_mfma_f32_16x16x32_bf16 v[164:167], a[160:163], v[32:35], v[164:167]
    v_exp_f32 v160, v160
    v_mfma_f32_16x16x32_bf16 v[168:171], a[160:163], v[64:67], v[188:191]
    ds_read_b64_tr_b16 a[180:181], v211 offset:40960
    v_add_f32 v200, v160, v200
    v_mfma_f32_16x16x32_bf16 v[168:171], a[164:167], v[72:75], v[168:171]
    v_exp_f32 v161, v161
    v_mfma_f32_16x16x32_bf16 v[168:171], a[168:171], v[80:83], v[168:171]
    v_add_f32 v200, v161, v200
    v_cvt_pk_bf16_f32 v86, v160, v161
    v_mfma_f32_16x16x32_bf16 v[168:171], a[172:175], v[88:91], v[168:171]
    v_exp_f32 v162, v162
    v_mfma_f32_16x16x32_bf16 v[172:175], a[172:175], v[120:123], v[192:195]
    ds_read_b64_tr_b16 a[182:183], v211 offset:45056
    v_add_f32 v200, v162, v200
    v_mfma_f32_16x16x32_bf16 v[172:175], a[168:171], v[112:115], v[172:175]
    v_exp_f32 v163, v163
    v_mfma_f32_16x16x32_bf16 v[172:175], a[164:167], v[104:107], v[172:175]
    ds_read_b64_tr_b16 a[184:185], v212 offset:32768
    v_add_f32 v200, v163, v200
    v_cvt_pk_bf16_f32 v87, v162, v163
    v_mfma_f32_16x16x32_bf16 v[172:175], a[160:163], v[96:99], v[172:175]
    v_exp_f32 v164, v164
    v_mfma_f32_16x16x32_bf16 v[176:179], a[160:163], v[128:131], v[196:199]
    ds_read_b64_tr_b16 a[186:187], v212 offset:36864
    v_add_f32 v201, v164, v201
    v_mfma_f32_16x16x32_bf16 v[176:179], a[164:167], v[136:139], v[176:179]
    v_exp_f32 v165, v165
    v_mfma_f32_16x16x32_bf16 v[176:179], a[168:171], v[144:147], v[176:179]
    ds_read_b64_tr_b16 a[188:189], v212 offset:40960
    v_add_f32 v201, v165, v201
    v_cvt_pk_bf16_f32 v102, v164, v165
    v_mfma_f32_16x16x32_bf16 v[176:179], a[172:175], v[152:155], v[176:179]
    s_waitcnt lgkmcnt(5)
    v_exp_f32 v166, v166
    v_mfma_f32_16x16x32_bf16 a[8:11], a[176:179], v[4:7], a[8:11]
    s_waitcnt lgkmcnt(3)
    ds_read_b64_tr_b16 a[190:191], v212 offset:45056
    v_add_f32 v201, v166, v201
    v_mfma_f32_16x16x32_bf16 a[8:11], a[180:183], v[12:15], a[8:11]
    v_exp_f32 v167, v167
    v_mfma_f32_16x16x32_bf16 a[40:43], a[180:183], v[28:31], a[40:43]
    v_add_f32 v201, v167, v201
    v_cvt_pk_bf16_f32 v103, v166, v167
    v_mfma_f32_16x16x32_bf16 a[40:43], a[176:179], v[20:23], a[40:43]
    v_exp_f32 v168, v168
    v_mfma_f32_16x16x32_bf16 a[72:75], a[176:179], v[36:39], a[72:75]
    ds_read_b128 a[160:163], v205 offset:57344
    v_add_f32 v202, v168, v202
    v_mfma_f32_16x16x32_bf16 a[72:75], a[180:183], v[44:47], a[72:75]
    v_exp_f32 v169, v169
    v_mfma_f32_16x16x32_bf16 a[104:107], a[180:183], v[60:63], a[104:107]
    v_add_f32 v202, v169, v202
    v_cvt_pk_bf16_f32 v118, v168, v169
    v_mfma_f32_16x16x32_bf16 a[104:107], a[176:179], v[52:55], a[104:107]
    v_exp_f32 v170, v170
    v_mfma_f32_16x16x32_bf16 a[136:139], a[176:179], v[68:71], a[136:139]
    ds_read_b128 a[164:167], v206 offset:57344
    v_add_f32 v202, v170, v202
    v_mfma_f32_16x16x32_bf16 a[136:139], a[180:183], v[76:79], a[136:139]
    s_waitcnt lgkmcnt(4)
    v_exp_f32 v171, v171
    v_mfma_f32_16x16x32_bf16 a[12:15], a[184:187], v[4:7], a[12:15]
    s_waitcnt lgkmcnt(2)
    v_add_f32 v202, v171, v202
    v_cvt_pk_bf16_f32 v119, v170, v171
    v_mfma_f32_16x16x32_bf16 a[12:15], a[188:191], v[12:15], a[12:15]
    v_exp_f32 v172, v172
    v_mfma_f32_16x16x32_bf16 a[44:47], a[188:191], v[28:31], a[44:47]
    ds_read_b128 a[168:171], v207 offset:57344
    v_add_f32 v203, v172, v203
    v_mfma_f32_16x16x32_bf16 a[44:47], a[184:187], v[20:23], a[44:47]
    v_exp_f32 v173, v173
    v_mfma_f32_16x16x32_bf16 a[76:79], a[184:187], v[36:39], a[76:79]
    v_add_f32 v203, v173, v203
    v_cvt_pk_bf16_f32 v134, v172, v173
    v_mfma_f32_16x16x32_bf16 a[76:79], a[188:191], v[44:47], a[76:79]
    v_exp_f32 v174, v174
    v_mfma_f32_16x16x32_bf16 a[108:111], a[188:191], v[60:63], a[108:111]
    ds_read_b128 a[172:175], v208 offset:57344
    v_add_f32 v203, v174, v203
    v_mfma_f32_16x16x32_bf16 a[108:111], a[184:187], v[52:55], a[108:111]
    v_exp_f32 v175, v175
    v_mfma_f32_16x16x32_bf16 a[140:143], a[184:187], v[68:71], a[140:143]
    v_add_f32 v203, v175, v203
    v_cvt_pk_bf16_f32 v135, v174, v175
    v_mfma_f32_16x16x32_bf16 a[140:143], a[188:191], v[76:79], a[140:143]
    s_waitcnt lgkmcnt(3)
    v_exp_f32 v176, v176
    v_mfma_f32_16x16x32_bf16 v[160:163], a[160:163], v[0:3], v[180:183]
    s_waitcnt lgkmcnt(2)
    ds_read_b64_tr_b16 a[176:177], v213 offset:32768
    v_add_f32 v204, v176, v204
    v_mfma_f32_16x16x32_bf16 v[160:163], a[164:167], v[8:11], v[160:163]
    s_waitcnt lgkmcnt(2)
    v_exp_f32 v177, v177
    v_mfma_f32_16x16x32_bf16 v[160:163], a[168:171], v[16:19], v[160:163]
    s_waitcnt lgkmcnt(1)
    v_add_f32 v204, v177, v204
    v_cvt_pk_bf16_f32 v150, v176, v177
    v_mfma_f32_16x16x32_bf16 v[160:163], a[172:175], v[24:27], v[160:163]
    v_exp_f32 v178, v178
    v_mfma_f32_16x16x32_bf16 v[164:167], a[172:175], v[56:59], v[184:187]
    ds_read_b64_tr_b16 a[178:179], v213 offset:36864
    v_add_f32 v204, v178, v204
    v_mfma_f32_16x16x32_bf16 v[164:167], a[168:171], v[48:51], v[164:167]
    v_exp_f32 v179, v179
    v_mfma_f32_16x16x32_bf16 v[164:167], a[164:167], v[40:43], v[164:167]
    v_add_f32 v204, v179, v204
    v_cvt_pk_bf16_f32 v151, v178, v179
    v_mfma_f32_16x16x32_bf16 v[164:167], a[160:163], v[32:35], v[164:167]
    v_exp_f32 v160, v160
    v_mfma_f32_16x16x32_bf16 v[168:171], a[160:163], v[64:67], v[188:191]
    ds_read_b64_tr_b16 a[180:181], v213 offset:40960
    v_add_f32 v200, v160, v200
    v_mfma_f32_16x16x32_bf16 v[168:171], a[164:167], v[72:75], v[168:171]
    v_exp_f32 v161, v161
    v_mfma_f32_16x16x32_bf16 v[168:171], a[168:171], v[80:83], v[168:171]
    v_add_f32 v200, v161, v200
    v_cvt_pk_bf16_f32 v92, v160, v161
    v_mfma_f32_16x16x32_bf16 v[168:171], a[172:175], v[88:91], v[168:171]
    v_exp_f32 v162, v162
    v_mfma_f32_16x16x32_bf16 v[172:175], a[172:175], v[120:123], v[192:195]
    ds_read_b64_tr_b16 a[182:183], v213 offset:45056
    v_add_f32 v200, v162, v200
    v_mfma_f32_16x16x32_bf16 v[172:175], a[168:171], v[112:115], v[172:175]
    v_exp_f32 v163, v163
    v_mfma_f32_16x16x32_bf16 v[172:175], a[164:167], v[104:107], v[172:175]
    ds_read_b64_tr_b16 a[184:185], v214 offset:32768
    v_add_f32 v200, v163, v200
    v_cvt_pk_bf16_f32 v93, v162, v163
    v_mfma_f32_16x16x32_bf16 v[172:175], a[160:163], v[96:99], v[172:175]
    v_exp_f32 v164, v164
    v_mfma_f32_16x16x32_bf16 v[176:179], a[160:163], v[128:131], v[196:199]
    ds_read_b64_tr_b16 a[186:187], v214 offset:36864
    v_add_f32 v201, v164, v201
    v_mfma_f32_16x16x32_bf16 v[176:179], a[164:167], v[136:139], v[176:179]
    v_exp_f32 v165, v165
    v_mfma_f32_16x16x32_bf16 v[176:179], a[168:171], v[144:147], v[176:179]
    ds_read_b64_tr_b16 a[188:189], v214 offset:40960
    v_add_f32 v201, v165, v201
    v_cvt_pk_bf16_f32 v108, v164, v165
    v_mfma_f32_16x16x32_bf16 v[176:179], a[172:175], v[152:155], v[176:179]
    s_waitcnt lgkmcnt(5)
    v_exp_f32 v166, v166
    v_mfma_f32_16x16x32_bf16 a[16:19], a[176:179], v[4:7], a[16:19]
    s_waitcnt lgkmcnt(3)
    ds_read_b64_tr_b16 a[190:191], v214 offset:45056
    v_add_f32 v201, v166, v201
    v_mfma_f32_16x16x32_bf16 a[16:19], a[180:183], v[12:15], a[16:19]
    v_exp_f32 v167, v167
    v_mfma_f32_16x16x32_bf16 a[48:51], a[180:183], v[28:31], a[48:51]
    v_add_f32 v201, v167, v201
    v_cvt_pk_bf16_f32 v109, v166, v167
    v_mfma_f32_16x16x32_bf16 a[48:51], a[176:179], v[20:23], a[48:51]
    v_exp_f32 v168, v168
    v_mfma_f32_16x16x32_bf16 a[80:83], a[176:179], v[36:39], a[80:83]
    ds_read_b128 a[160:163], v205 offset:61440
    v_add_f32 v202, v168, v202
    v_mfma_f32_16x16x32_bf16 a[80:83], a[180:183], v[44:47], a[80:83]
    v_exp_f32 v169, v169
    v_mfma_f32_16x16x32_bf16 a[112:115], a[180:183], v[60:63], a[112:115]
    v_add_f32 v202, v169, v202
    v_cvt_pk_bf16_f32 v124, v168, v169
    v_mfma_f32_16x16x32_bf16 a[112:115], a[176:179], v[52:55], a[112:115]
    v_exp_f32 v170, v170
    v_mfma_f32_16x16x32_bf16 a[144:147], a[176:179], v[68:71], a[144:147]
    ds_read_b128 a[164:167], v206 offset:61440
    v_add_f32 v202, v170, v202
    v_mfma_f32_16x16x32_bf16 a[144:147], a[180:183], v[76:79], a[144:147]
    s_waitcnt lgkmcnt(4)
    v_exp_f32 v171, v171
    v_mfma_f32_16x16x32_bf16 a[20:23], a[184:187], v[4:7], a[20:23]
    s_waitcnt lgkmcnt(2)
    v_add_f32 v202, v171, v202
    v_cvt_pk_bf16_f32 v125, v170, v171
    v_mfma_f32_16x16x32_bf16 a[20:23], a[188:191], v[12:15], a[20:23]
    v_exp_f32 v172, v172
    v_mfma_f32_16x16x32_bf16 a[52:55], a[188:191], v[28:31], a[52:55]
    ds_read_b128 a[168:171], v207 offset:61440
    v_add_f32 v203, v172, v203
    v_mfma_f32_16x16x32_bf16 a[52:55], a[184:187], v[20:23], a[52:55]
    v_exp_f32 v173, v173
    v_mfma_f32_16x16x32_bf16 a[84:87], a[184:187], v[36:39], a[84:87]
    v_add_f32 v203, v173, v203
    v_cvt_pk_bf16_f32 v140, v172, v173
    v_mfma_f32_16x16x32_bf16 a[84:87], a[188:191], v[44:47], a[84:87]
    v_exp_f32 v174, v174
    v_mfma_f32_16x16x32_bf16 a[116:119], a[188:191], v[60:63], a[116:119]
    ds_read_b128 a[172:175], v208 offset:61440
    v_add_f32 v203, v174, v203
    v_mfma_f32_16x16x32_bf16 a[116:119], a[184:187], v[52:55], a[116:119]
    v_exp_f32 v175, v175
    v_mfma_f32_16x16x32_bf16 a[148:151], a[184:187], v[68:71], a[148:151]
    v_add_f32 v203, v175, v203
    v_cvt_pk_bf16_f32 v141, v174, v175
    v_mfma_f32_16x16x32_bf16 a[148:151], a[188:191], v[76:79], a[148:151]
    s_waitcnt lgkmcnt(3)
    v_exp_f32 v176, v176
    v_mfma_f32_16x16x32_bf16 v[160:163], a[160:163], v[0:3], v[180:183]
    s_waitcnt lgkmcnt(2)
    ds_read_b64_tr_b16 a[176:177], v215 offset:32768
    v_add_f32 v204, v176, v204
    v_mfma_f32_16x16x32_bf16 v[160:163], a[164:167], v[8:11], v[160:163]
    s_waitcnt lgkmcnt(2)
    v_exp_f32 v177, v177
    v_mfma_f32_16x16x32_bf16 v[160:163], a[168:171], v[16:19], v[160:163]
    s_waitcnt lgkmcnt(1)
    v_add_f32 v204, v177, v204
    v_cvt_pk_bf16_f32 v156, v176, v177
    v_mfma_f32_16x16x32_bf16 v[160:163], a[172:175], v[24:27], v[160:163]
    v_exp_f32 v178, v178
    v_mfma_f32_16x16x32_bf16 v[164:167], a[172:175], v[56:59], v[184:187]
    ds_read_b64_tr_b16 a[178:179], v215 offset:36864
    v_add_f32 v204, v178, v204
    v_mfma_f32_16x16x32_bf16 v[164:167], a[168:171], v[48:51], v[164:167]
    v_exp_f32 v179, v179
    v_mfma_f32_16x16x32_bf16 v[164:167], a[164:167], v[40:43], v[164:167]
    v_add_f32 v204, v179, v204
    v_cvt_pk_bf16_f32 v157, v178, v179
    v_mfma_f32_16x16x32_bf16 v[164:167], a[160:163], v[32:35], v[164:167]
    v_exp_f32 v160, v160
    v_mfma_f32_16x16x32_bf16 v[168:171], a[160:163], v[64:67], v[188:191]
    ds_read_b64_tr_b16 a[180:181], v215 offset:40960
    v_add_f32 v200, v160, v200
    v_mfma_f32_16x16x32_bf16 v[168:171], a[164:167], v[72:75], v[168:171]
    v_exp_f32 v161, v161
    v_mfma_f32_16x16x32_bf16 v[168:171], a[168:171], v[80:83], v[168:171]
    v_add_f32 v200, v161, v200
    v_cvt_pk_bf16_f32 v94, v160, v161
    v_mfma_f32_16x16x32_bf16 v[168:171], a[172:175], v[88:91], v[168:171]
    v_exp_f32 v162, v162
    v_mfma_f32_16x16x32_bf16 v[172:175], a[172:175], v[120:123], v[192:195]
    ds_read_b64_tr_b16 a[182:183], v215 offset:45056
    v_add_f32 v200, v162, v200
    v_mfma_f32_16x16x32_bf16 v[172:175], a[168:171], v[112:115], v[172:175]
    v_exp_f32 v163, v163
    v_mfma_f32_16x16x32_bf16 v[172:175], a[164:167], v[104:107], v[172:175]
    ds_read_b64_tr_b16 a[184:185], v216 offset:32768
    v_add_f32 v200, v163, v200
    v_cvt_pk_bf16_f32 v95, v162, v163
    v_mfma_f32_16x16x32_bf16 v[172:175], a[160:163], v[96:99], v[172:175]
    v_exp_f32 v164, v164
    v_mfma_f32_16x16x32_bf16 v[176:179], a[160:163], v[128:131], v[196:199]
    ds_read_b64_tr_b16 a[186:187], v216 offset:36864
    v_add_f32 v201, v164, v201
    v_mfma_f32_16x16x32_bf16 v[176:179], a[164:167], v[136:139], v[176:179]
    v_exp_f32 v165, v165
    v_mfma_f32_16x16x32_bf16 v[176:179], a[168:171], v[144:147], v[176:179]
    ds_read_b64_tr_b16 a[188:189], v216 offset:40960
    v_add_f32 v201, v165, v201
    v_cvt_pk_bf16_f32 v110, v164, v165
    v_mfma_f32_16x16x32_bf16 v[176:179], a[172:175], v[152:155], v[176:179]
    s_waitcnt lgkmcnt(5)
    v_exp_f32 v166, v166
    v_mfma_f32_16x16x32_bf16 a[24:27], a[176:179], v[4:7], a[24:27]
    s_waitcnt lgkmcnt(3)
    ds_read_b64_tr_b16 a[190:191], v216 offset:45056
    v_add_f32 v201, v166, v201
    v_mfma_f32_16x16x32_bf16 a[24:27], a[180:183], v[12:15], a[24:27]
    v_exp_f32 v167, v167
    v_mfma_f32_16x16x32_bf16 a[56:59], a[180:183], v[28:31], a[56:59]
    v_add_f32 v201, v167, v201
    v_cvt_pk_bf16_f32 v111, v166, v167
    v_mfma_f32_16x16x32_bf16 a[56:59], a[176:179], v[20:23], a[56:59]
    v_exp_f32 v168, v168
    v_mfma_f32_16x16x32_bf16 a[88:91], a[176:179], v[36:39], a[88:91]
    v_add_f32 v202, v168, v202
    v_mfma_f32_16x16x32_bf16 a[88:91], a[180:183], v[44:47], a[88:91]
    v_exp_f32 v169, v169
    v_mfma_f32_16x16x32_bf16 a[120:123], a[180:183], v[60:63], a[120:123]
    s_waitcnt vmcnt(1) lgkmcnt(0)
    v_add_f32 v202, v169, v202
    v_cvt_pk_bf16_f32 v126, v168, v169
    v_mfma_f32_16x16x32_bf16 a[120:123], a[176:179], v[52:55], a[120:123]
    s_barrier
    v_exp_f32 v170, v170
    v_mfma_f32_16x16x32_bf16 a[152:155], a[176:179], v[68:71], a[152:155]
    ds_read_b128 a[160:163], v205 offset:0
    v_add_f32 v202, v170, v202
    v_mfma_f32_16x16x32_bf16 a[152:155], a[180:183], v[76:79], a[152:155]
    v_exp_f32 v171, v171
    v_mfma_f32_16x16x32_bf16 a[28:31], a[184:187], v[4:7], a[28:31]
    ds_read_b128 a[164:167], v206 offset:0
    v_add_f32 v202, v171, v202
    v_cvt_pk_bf16_f32 v127, v170, v171
    v_mfma_f32_16x16x32_bf16 a[28:31], a[188:191], v[12:15], a[28:31]
    v_exp_f32 v172, v172
    v_mfma_f32_16x16x32_bf16 a[60:63], a[188:191], v[28:31], a[60:63]
    ds_read_b128 a[168:171], v207 offset:0
    v_add_f32 v203, v172, v203
    v_mfma_f32_16x16x32_bf16 a[60:63], a[184:187], v[20:23], a[60:63]
    v_exp_f32 v173, v173
    v_mfma_f32_16x16x32_bf16 a[92:95], a[184:187], v[36:39], a[92:95]
    v_add_f32 v203, v173, v203
    v_cvt_pk_bf16_f32 v142, v172, v173
    v_mfma_f32_16x16x32_bf16 a[92:95], a[188:191], v[44:47], a[92:95]
    v_exp_f32 v174, v174
    v_mfma_f32_16x16x32_bf16 a[124:127], a[188:191], v[60:63], a[124:127]
    ds_read_b128 a[172:175], v208 offset:0
    v_add_f32 v203, v174, v203
    v_mfma_f32_16x16x32_bf16 a[124:127], a[184:187], v[52:55], a[124:127]
    v_exp_f32 v175, v175
    v_mfma_f32_16x16x32_bf16 a[156:159], a[184:187], v[68:71], a[156:159]
    v_add_f32 v203, v175, v203
    v_cvt_pk_bf16_f32 v143, v174, v175
    v_mfma_f32_16x16x32_bf16 a[156:159], a[188:191], v[76:79], a[156:159]
    s_waitcnt lgkmcnt(3)
    s_mov_b32 s33, 0x1000
    v_exp_f32 v176, v176
    v_mfma_f32_16x16x32_bf16 v[160:163], a[160:163], v[0:3], v[180:183]
    s_waitcnt lgkmcnt(2)
    ds_read_b64_tr_b16 a[176:177], v209 offset:49152
    v_add_f32 v204, v176, v204
    v_mfma_f32_16x16x32_bf16 v[160:163], a[164:167], v[8:11], v[160:163]
    s_waitcnt lgkmcnt(2)
    v_exp_f32 v177, v177
    v_mfma_f32_16x16x32_bf16 v[160:163], a[168:171], v[16:19], v[160:163]
    s_waitcnt lgkmcnt(1)
    v_add_f32 v204, v177, v204
    v_cvt_pk_bf16_f32 v158, v176, v177
    v_mfma_f32_16x16x32_bf16 v[160:163], a[172:175], v[24:27], v[160:163]
    v_exp_f32 v178, v178
    v_mfma_f32_16x16x32_bf16 v[164:167], a[172:175], v[56:59], v[184:187]
    ds_read_b64_tr_b16 a[178:179], v209 offset:53248
    v_add_f32 v204, v178, v204
    v_mfma_f32_16x16x32_bf16 v[164:167], a[168:171], v[48:51], v[164:167]
    v_exp_f32 v179, v179
    v_mfma_f32_16x16x32_bf16 v[164:167], a[164:167], v[40:43], v[164:167]
    v_add_f32 v204, v179, v204
    v_cvt_pk_bf16_f32 v159, v178, v179
    v_mfma_f32_16x16x32_bf16 v[164:167], a[160:163], v[32:35], v[164:167]
    v_exp_f32 v160, v160
    v_mfma_f32_16x16x32_bf16 v[168:171], a[160:163], v[64:67], v[188:191]
    ds_read_b64_tr_b16 a[180:181], v209 offset:57344
    v_add_f32 v200, v160, v200
    v_mfma_f32_16x16x32_bf16 v[168:171], a[164:167], v[72:75], v[168:171]
    v_exp_f32 v161, v161
    v_mfma_f32_16x16x32_bf16 v[168:171], a[168:171], v[80:83], v[168:171]
    v_add_f32 v200, v161, v200
    v_cvt_pk_bf16_f32 v4, v160, v161
    v_mfma_f32_16x16x32_bf16 v[168:171], a[172:175], v[88:91], v[168:171]
    v_exp_f32 v162, v162
    v_mfma_f32_16x16x32_bf16 v[172:175], a[172:175], v[120:123], v[192:195]
    ds_read_b64_tr_b16 a[182:183], v209 offset:61440
    v_add_f32 v200, v162, v200
    v_mfma_f32_16x16x32_bf16 v[172:175], a[168:171], v[112:115], v[172:175]
    v_exp_f32 v163, v163
    v_mfma_f32_16x16x32_bf16 v[172:175], a[164:167], v[104:107], v[172:175]
    ds_read_b64_tr_b16 a[184:185], v210 offset:49152
    v_add_f32 v200, v163, v200
    v_cvt_pk_bf16_f32 v5, v162, v163
    v_mfma_f32_16x16x32_bf16 v[172:175], a[160:163], v[96:99], v[172:175]
    v_exp_f32 v164, v164
    v_mfma_f32_16x16x32_bf16 v[176:179], a[160:163], v[128:131], v[196:199]
    ds_read_b64_tr_b16 a[186:187], v210 offset:53248
    v_add_f32 v201, v164, v201
    v_mfma_f32_16x16x32_bf16 v[176:179], a[164:167], v[136:139], v[176:179]
    v_exp_f32 v165, v165
    v_mfma_f32_16x16x32_bf16 v[176:179], a[168:171], v[144:147], v[176:179]
    ds_read_b64_tr_b16 a[188:189], v210 offset:57344
    v_add_f32 v201, v165, v201
    v_cvt_pk_bf16_f32 v20, v164, v165
    v_mfma_f32_16x16x32_bf16 v[176:179], a[172:175], v[152:155], v[176:179]
    s_waitcnt lgkmcnt(5)
    v_exp_f32 v166, v166
    v_mfma_f32_16x16x32_bf16 a[0:3], a[176:179], v[84:87], a[0:3]
    s_waitcnt lgkmcnt(3)
    ds_read_b64_tr_b16 a[190:191], v210 offset:61440
    v_add_f32 v201, v166, v201
    v_mfma_f32_16x16x32_bf16 a[0:3], a[180:183], v[92:95], a[0:3]
    v_exp_f32 v167, v167
    v_mfma_f32_16x16x32_bf16 a[32:35], a[180:183], v[108:111], a[32:35]
    v_add_f32 v201, v167, v201
    v_cvt_pk_bf16_f32 v21, v166, v167
    v_mfma_f32_16x16x32_bf16 a[32:35], a[176:179], v[100:103], a[32:35]
    v_exp_f32 v168, v168
    v_mfma_f32_16x16x32_bf16 a[64:67], a[176:179], v[116:119], a[64:67]
    ds_read_b128 a[160:163], v205 offset:4096
    v_add_f32 v202, v168, v202
    v_mfma_f32_16x16x32_bf16 a[64:67], a[180:183], v[124:127], a[64:67]
    v_exp_f32 v169, v169
    v_mfma_f32_16x16x32_bf16 a[96:99], a[180:183], v[140:143], a[96:99]
    v_add_f32 v202, v169, v202
    v_cvt_pk_bf16_f32 v36, v168, v169
    v_mfma_f32_16x16x32_bf16 a[96:99], a[176:179], v[132:135], a[96:99]
    v_exp_f32 v170, v170
    v_mfma_f32_16x16x32_bf16 a[128:131], a[176:179], v[148:151], a[128:131]
    ds_read_b128 a[164:167], v206 offset:4096
    v_add_f32 v202, v170, v202
    v_mfma_f32_16x16x32_bf16 a[128:131], a[180:183], v[156:159], a[128:131]
    s_waitcnt lgkmcnt(4)
    v_exp_f32 v171, v171
    v_mfma_f32_16x16x32_bf16 a[4:7], a[184:187], v[84:87], a[4:7]
    s_waitcnt lgkmcnt(2)
    v_add_f32 v202, v171, v202
    v_cvt_pk_bf16_f32 v37, v170, v171
    v_mfma_f32_16x16x32_bf16 a[4:7], a[188:191], v[92:95], a[4:7]
    v_exp_f32 v172, v172
    v_mfma_f32_16x16x32_bf16 a[36:39], a[188:191], v[108:111], a[36:39]
    ds_read_b128 a[168:171], v207 offset:4096
    v_add_f32 v203, v172, v203
    v_mfma_f32_16x16x32_bf16 a[36:39], a[184:187], v[100:103], a[36:39]
    v_exp_f32 v173, v173
    v_mfma_f32_16x16x32_bf16 a[68:71], a[184:187], v[116:119], a[68:71]
    v_add_f32 v203, v173, v203
    v_cvt_pk_bf16_f32 v52, v172, v173
    v_mfma_f32_16x16x32_bf16 a[68:71], a[188:191], v[124:127], a[68:71]
    v_exp_f32 v174, v174
    v_mfma_f32_16x16x32_bf16 a[100:103], a[188:191], v[140:143], a[100:103]
    ds_read_b128 a[172:175], v208 offset:4096
    v_add_f32 v203, v174, v203
    v_mfma_f32_16x16x32_bf16 a[100:103], a[184:187], v[132:135], a[100:103]
    v_exp_f32 v175, v175
    v_mfma_f32_16x16x32_bf16 a[132:135], a[184:187], v[148:151], a[132:135]
    v_add_f32 v203, v175, v203
    v_cvt_pk_bf16_f32 v53, v174, v175
    v_mfma_f32_16x16x32_bf16 a[132:135], a[188:191], v[156:159], a[132:135]
    s_waitcnt lgkmcnt(3)
    v_exp_f32 v176, v176
    v_mfma_f32_16x16x32_bf16 v[160:163], a[160:163], v[0:3], v[180:183]
    s_waitcnt lgkmcnt(2)
    ds_read_b64_tr_b16 a[176:177], v211 offset:49152
    v_add_f32 v204, v176, v204
    v_mfma_f32_16x16x32_bf16 v[160:163], a[164:167], v[8:11], v[160:163]
    s_waitcnt lgkmcnt(2)
    v_exp_f32 v177, v177
    v_mfma_f32_16x16x32_bf16 v[160:163], a[168:171], v[16:19], v[160:163]
    s_waitcnt lgkmcnt(1)
    v_add_f32 v204, v177, v204
    v_cvt_pk_bf16_f32 v68, v176, v177
    v_mfma_f32_16x16x32_bf16 v[160:163], a[172:175], v[24:27], v[160:163]
    v_exp_f32 v178, v178
    v_mfma_f32_16x16x32_bf16 v[164:167], a[172:175], v[56:59], v[184:187]
    ds_read_b64_tr_b16 a[178:179], v211 offset:53248
    v_add_f32 v204, v178, v204
    v_mfma_f32_16x16x32_bf16 v[164:167], a[168:171], v[48:51], v[164:167]
    v_exp_f32 v179, v179
    v_mfma_f32_16x16x32_bf16 v[164:167], a[164:167], v[40:43], v[164:167]
    v_add_f32 v204, v179, v204
    v_cvt_pk_bf16_f32 v69, v178, v179
    v_mfma_f32_16x16x32_bf16 v[164:167], a[160:163], v[32:35], v[164:167]
    v_exp_f32 v160, v160
    v_mfma_f32_16x16x32_bf16 v[168:171], a[160:163], v[64:67], v[188:191]
    ds_read_b64_tr_b16 a[180:181], v211 offset:57344
    v_add_f32 v200, v160, v200
    v_mfma_f32_16x16x32_bf16 v[168:171], a[164:167], v[72:75], v[168:171]
    v_exp_f32 v161, v161
    v_mfma_f32_16x16x32_bf16 v[168:171], a[168:171], v[80:83], v[168:171]
    v_add_f32 v200, v161, v200
    v_cvt_pk_bf16_f32 v6, v160, v161
    v_mfma_f32_16x16x32_bf16 v[168:171], a[172:175], v[88:91], v[168:171]
    v_exp_f32 v162, v162
    v_mfma_f32_16x16x32_bf16 v[172:175], a[172:175], v[120:123], v[192:195]
    ds_read_b64_tr_b16 a[182:183], v211 offset:61440
    v_add_f32 v200, v162, v200
    v_mfma_f32_16x16x32_bf16 v[172:175], a[168:171], v[112:115], v[172:175]
    v_exp_f32 v163, v163
    v_mfma_f32_16x16x32_bf16 v[172:175], a[164:167], v[104:107], v[172:175]
    ds_read_b64_tr_b16 a[184:185], v212 offset:49152
    v_add_f32 v200, v163, v200
    v_cvt_pk_bf16_f32 v7, v162, v163
    v_mfma_f32_16x16x32_bf16 v[172:175], a[160:163], v[96:99], v[172:175]
    v_exp_f32 v164, v164
    v_mfma_f32_16x16x32_bf16 v[176:179], a[160:163], v[128:131], v[196:199]
    ds_read_b64_tr_b16 a[186:187], v212 offset:53248
    v_add_f32 v201, v164, v201
    v_mfma_f32_16x16x32_bf16 v[176:179], a[164:167], v[136:139], v[176:179]
    v_exp_f32 v165, v165
    v_mfma_f32_16x16x32_bf16 v[176:179], a[168:171], v[144:147], v[176:179]
    ds_read_b64_tr_b16 a[188:189], v212 offset:57344
    v_add_f32 v201, v165, v201
    v_cvt_pk_bf16_f32 v22, v164, v165
    v_mfma_f32_16x16x32_bf16 v[176:179], a[172:175], v[152:155], v[176:179]
    s_waitcnt lgkmcnt(5)
    v_exp_f32 v166, v166
    v_mfma_f32_16x16x32_bf16 a[8:11], a[176:179], v[84:87], a[8:11]
    s_waitcnt lgkmcnt(3)
    ds_read_b64_tr_b16 a[190:191], v212 offset:61440
    v_add_f32 v201, v166, v201
    v_mfma_f32_16x16x32_bf16 a[8:11], a[180:183], v[92:95], a[8:11]
    v_exp_f32 v167, v167
    v_mfma_f32_16x16x32_bf16 a[40:43], a[180:183], v[108:111], a[40:43]
    v_add_f32 v201, v167, v201
    v_cvt_pk_bf16_f32 v23, v166, v167
    v_mfma_f32_16x16x32_bf16 a[40:43], a[176:179], v[100:103], a[40:43]
    v_exp_f32 v168, v168
    v_mfma_f32_16x16x32_bf16 a[72:75], a[176:179], v[116:119], a[72:75]
    ds_read_b128 a[160:163], v205 offset:8192
    v_add_f32 v202, v168, v202
    v_mfma_f32_16x16x32_bf16 a[72:75], a[180:183], v[124:127], a[72:75]
    v_exp_f32 v169, v169
    v_mfma_f32_16x16x32_bf16 a[104:107], a[180:183], v[140:143], a[104:107]
    v_add_f32 v202, v169, v202
    v_cvt_pk_bf16_f32 v38, v168, v169
    v_mfma_f32_16x16x32_bf16 a[104:107], a[176:179], v[132:135], a[104:107]
    v_exp_f32 v170, v170
    v_mfma_f32_16x16x32_bf16 a[136:139], a[176:179], v[148:151], a[136:139]
    ds_read_b128 a[164:167], v206 offset:8192
    v_add_f32 v202, v170, v202
    v_mfma_f32_16x16x32_bf16 a[136:139], a[180:183], v[156:159], a[136:139]
    s_waitcnt lgkmcnt(4)
    v_exp_f32 v171, v171
    v_mfma_f32_16x16x32_bf16 a[12:15], a[184:187], v[84:87], a[12:15]
    s_waitcnt lgkmcnt(2)
    v_add_f32 v202, v171, v202
    v_cvt_pk_bf16_f32 v39, v170, v171
    v_mfma_f32_16x16x32_bf16 a[12:15], a[188:191], v[92:95], a[12:15]
    v_exp_f32 v172, v172
    v_mfma_f32_16x16x32_bf16 a[44:47], a[188:191], v[108:111], a[44:47]
    ds_read_b128 a[168:171], v207 offset:8192
    v_add_f32 v203, v172, v203
    v_mfma_f32_16x16x32_bf16 a[44:47], a[184:187], v[100:103], a[44:47]
    v_exp_f32 v173, v173
    v_mfma_f32_16x16x32_bf16 a[76:79], a[184:187], v[116:119], a[76:79]
    v_add_f32 v203, v173, v203
    v_cvt_pk_bf16_f32 v54, v172, v173
    v_mfma_f32_16x16x32_bf16 a[76:79], a[188:191], v[124:127], a[76:79]
    v_exp_f32 v174, v174
    v_mfma_f32_16x16x32_bf16 a[108:111], a[188:191], v[140:143], a[108:111]
    ds_read_b128 a[172:175], v208 offset:8192
    v_add_f32 v203, v174, v203
    v_mfma_f32_16x16x32_bf16 a[108:111], a[184:187], v[132:135], a[108:111]
    v_exp_f32 v175, v175
    v_mfma_f32_16x16x32_bf16 a[140:143], a[184:187], v[148:151], a[140:143]
    v_add_f32 v203, v175, v203
    v_cvt_pk_bf16_f32 v55, v174, v175
    v_mfma_f32_16x16x32_bf16 a[140:143], a[188:191], v[156:159], a[140:143]
    s_waitcnt lgkmcnt(3)
    v_exp_f32 v176, v176
    v_mfma_f32_16x16x32_bf16 v[160:163], a[160:163], v[0:3], v[180:183]
    s_waitcnt lgkmcnt(2)
    ds_read_b64_tr_b16 a[176:177], v213 offset:49152
    v_add_f32 v204, v176, v204
    v_mfma_f32_16x16x32_bf16 v[160:163], a[164:167], v[8:11], v[160:163]
    s_waitcnt lgkmcnt(2)
    v_exp_f32 v177, v177
    v_mfma_f32_16x16x32_bf16 v[160:163], a[168:171], v[16:19], v[160:163]
    s_waitcnt lgkmcnt(1)
    v_add_f32 v204, v177, v204
    v_cvt_pk_bf16_f32 v70, v176, v177
    v_mfma_f32_16x16x32_bf16 v[160:163], a[172:175], v[24:27], v[160:163]
    v_exp_f32 v178, v178
    v_mfma_f32_16x16x32_bf16 v[164:167], a[172:175], v[56:59], v[184:187]
    ds_read_b64_tr_b16 a[178:179], v213 offset:53248
    v_add_f32 v204, v178, v204
    v_mfma_f32_16x16x32_bf16 v[164:167], a[168:171], v[48:51], v[164:167]
    v_exp_f32 v179, v179
    v_mfma_f32_16x16x32_bf16 v[164:167], a[164:167], v[40:43], v[164:167]
    v_add_f32 v204, v179, v204
    v_cvt_pk_bf16_f32 v71, v178, v179
    v_mfma_f32_16x16x32_bf16 v[164:167], a[160:163], v[32:35], v[164:167]
    v_exp_f32 v160, v160
    v_mfma_f32_16x16x32_bf16 v[168:171], a[160:163], v[64:67], v[188:191]
    ds_read_b64_tr_b16 a[180:181], v213 offset:57344
    v_add_f32 v200, v160, v200
    v_mfma_f32_16x16x32_bf16 v[168:171], a[164:167], v[72:75], v[168:171]
    v_exp_f32 v161, v161
    v_mfma_f32_16x16x32_bf16 v[168:171], a[168:171], v[80:83], v[168:171]
    v_add_f32 v200, v161, v200
    v_cvt_pk_bf16_f32 v12, v160, v161
    v_mfma_f32_16x16x32_bf16 v[168:171], a[172:175], v[88:91], v[168:171]
    v_exp_f32 v162, v162
    v_mfma_f32_16x16x32_bf16 v[172:175], a[172:175], v[120:123], v[192:195]
    ds_read_b64_tr_b16 a[182:183], v213 offset:61440
    v_add_f32 v200, v162, v200
    v_mfma_f32_16x16x32_bf16 v[172:175], a[168:171], v[112:115], v[172:175]
    v_exp_f32 v163, v163
    v_mfma_f32_16x16x32_bf16 v[172:175], a[164:167], v[104:107], v[172:175]
    ds_read_b64_tr_b16 a[184:185], v214 offset:49152
    v_add_f32 v200, v163, v200
    v_cvt_pk_bf16_f32 v13, v162, v163
    v_mfma_f32_16x16x32_bf16 v[172:175], a[160:163], v[96:99], v[172:175]
    v_exp_f32 v164, v164
    v_mfma_f32_16x16x32_bf16 v[176:179], a[160:163], v[128:131], v[196:199]
    ds_read_b64_tr_b16 a[186:187], v214 offset:53248
    v_add_f32 v201, v164, v201
    v_mfma_f32_16x16x32_bf16 v[176:179], a[164:167], v[136:139], v[176:179]
    v_exp_f32 v165, v165
    v_mfma_f32_16x16x32_bf16 v[176:179], a[168:171], v[144:147], v[176:179]
    ds_read_b64_tr_b16 a[188:189], v214 offset:57344
    v_add_f32 v201, v165, v201
    v_cvt_pk_bf16_f32 v28, v164, v165
    v_mfma_f32_16x16x32_bf16 v[176:179], a[172:175], v[152:155], v[176:179]
    s_waitcnt lgkmcnt(5)
    v_exp_f32 v166, v166
    v_mfma_f32_16x16x32_bf16 a[16:19], a[176:179], v[84:87], a[16:19]
    s_waitcnt lgkmcnt(3)
    ds_read_b64_tr_b16 a[190:191], v214 offset:61440
    v_add_f32 v201, v166, v201
    v_mfma_f32_16x16x32_bf16 a[16:19], a[180:183], v[92:95], a[16:19]
    v_exp_f32 v167, v167
    v_mfma_f32_16x16x32_bf16 a[48:51], a[180:183], v[108:111], a[48:51]
    v_add_f32 v201, v167, v201
    v_cvt_pk_bf16_f32 v29, v166, v167
    v_mfma_f32_16x16x32_bf16 a[48:51], a[176:179], v[100:103], a[48:51]
    v_exp_f32 v168, v168
    v_mfma_f32_16x16x32_bf16 a[80:83], a[176:179], v[116:119], a[80:83]
    ds_read_b128 a[160:163], v205 offset:12288
    v_add_f32 v202, v168, v202
    v_mfma_f32_16x16x32_bf16 a[80:83], a[180:183], v[124:127], a[80:83]
    v_exp_f32 v169, v169
    v_mfma_f32_16x16x32_bf16 a[112:115], a[180:183], v[140:143], a[112:115]
    v_add_f32 v202, v169, v202
    v_cvt_pk_bf16_f32 v44, v168, v169
    v_mfma_f32_16x16x32_bf16 a[112:115], a[176:179], v[132:135], a[112:115]
    v_exp_f32 v170, v170
    v_mfma_f32_16x16x32_bf16 a[144:147], a[176:179], v[148:151], a[144:147]
    ds_read_b128 a[164:167], v206 offset:12288
    v_add_f32 v202, v170, v202
    v_mfma_f32_16x16x32_bf16 a[144:147], a[180:183], v[156:159], a[144:147]
    s_waitcnt lgkmcnt(4)
    v_exp_f32 v171, v171
    v_mfma_f32_16x16x32_bf16 a[20:23], a[184:187], v[84:87], a[20:23]
    s_waitcnt lgkmcnt(2)
    v_add_f32 v202, v171, v202
    v_cvt_pk_bf16_f32 v45, v170, v171
    v_mfma_f32_16x16x32_bf16 a[20:23], a[188:191], v[92:95], a[20:23]
    v_exp_f32 v172, v172
    v_mfma_f32_16x16x32_bf16 a[52:55], a[188:191], v[108:111], a[52:55]
    ds_read_b128 a[168:171], v207 offset:12288
    v_add_f32 v203, v172, v203
    v_mfma_f32_16x16x32_bf16 a[52:55], a[184:187], v[100:103], a[52:55]
    v_exp_f32 v173, v173
    v_mfma_f32_16x16x32_bf16 a[84:87], a[184:187], v[116:119], a[84:87]
    v_add_f32 v203, v173, v203
    v_cvt_pk_bf16_f32 v60, v172, v173
    v_mfma_f32_16x16x32_bf16 a[84:87], a[188:191], v[124:127], a[84:87]
    v_exp_f32 v174, v174
    v_mfma_f32_16x16x32_bf16 a[116:119], a[188:191], v[140:143], a[116:119]
    ds_read_b128 a[172:175], v208 offset:12288
    v_add_f32 v203, v174, v203
    v_mfma_f32_16x16x32_bf16 a[116:119], a[184:187], v[132:135], a[116:119]
    v_exp_f32 v175, v175
    v_mfma_f32_16x16x32_bf16 a[148:151], a[184:187], v[148:151], a[148:151]
    v_add_f32 v203, v175, v203
    v_cvt_pk_bf16_f32 v61, v174, v175
    v_mfma_f32_16x16x32_bf16 a[148:151], a[188:191], v[156:159], a[148:151]
    s_waitcnt lgkmcnt(3)
    v_exp_f32 v176, v176
    v_mfma_f32_16x16x32_bf16 v[160:163], a[160:163], v[0:3], v[180:183]
    s_waitcnt lgkmcnt(2)
    ds_read_b64_tr_b16 a[176:177], v215 offset:49152
    v_add_f32 v204, v176, v204
    v_mfma_f32_16x16x32_bf16 v[160:163], a[164:167], v[8:11], v[160:163]
    s_waitcnt lgkmcnt(2)
    v_exp_f32 v177, v177
    v_mfma_f32_16x16x32_bf16 v[160:163], a[168:171], v[16:19], v[160:163]
    s_waitcnt lgkmcnt(1)
    v_add_f32 v204, v177, v204
    v_cvt_pk_bf16_f32 v76, v176, v177
    v_mfma_f32_16x16x32_bf16 v[160:163], a[172:175], v[24:27], v[160:163]
    v_exp_f32 v178, v178
    v_mfma_f32_16x16x32_bf16 v[164:167], a[172:175], v[56:59], v[184:187]
    ds_read_b64_tr_b16 a[178:179], v215 offset:53248
    v_add_f32 v204, v178, v204
    v_mfma_f32_16x16x32_bf16 v[164:167], a[168:171], v[48:51], v[164:167]
    v_exp_f32 v179, v179
    v_mfma_f32_16x16x32_bf16 v[164:167], a[164:167], v[40:43], v[164:167]
    v_add_f32 v204, v179, v204
    v_cvt_pk_bf16_f32 v77, v178, v179
    v_mfma_f32_16x16x32_bf16 v[164:167], a[160:163], v[32:35], v[164:167]
    v_exp_f32 v160, v160
    v_mfma_f32_16x16x32_bf16 v[168:171], a[160:163], v[64:67], v[188:191]
    ds_read_b64_tr_b16 a[180:181], v215 offset:57344
    v_add_f32 v200, v160, v200
    v_mfma_f32_16x16x32_bf16 v[168:171], a[164:167], v[72:75], v[168:171]
    v_exp_f32 v161, v161
    v_mfma_f32_16x16x32_bf16 v[168:171], a[168:171], v[80:83], v[168:171]
    v_add_f32 v200, v161, v200
    v_cvt_pk_bf16_f32 v14, v160, v161
    v_mfma_f32_16x16x32_bf16 v[168:171], a[172:175], v[88:91], v[168:171]
    v_exp_f32 v162, v162
    v_mfma_f32_16x16x32_bf16 v[172:175], a[172:175], v[120:123], v[192:195]
    ds_read_b64_tr_b16 a[182:183], v215 offset:61440
    v_add_f32 v200, v162, v200
    v_mfma_f32_16x16x32_bf16 v[172:175], a[168:171], v[112:115], v[172:175]
    v_exp_f32 v163, v163
    v_mfma_f32_16x16x32_bf16 v[172:175], a[164:167], v[104:107], v[172:175]
    ds_read_b64_tr_b16 a[184:185], v216 offset:49152
    v_add_f32 v200, v163, v200
    v_cvt_pk_bf16_f32 v15, v162, v163
    v_mfma_f32_16x16x32_bf16 v[172:175], a[160:163], v[96:99], v[172:175]
    v_exp_f32 v164, v164
    v_mfma_f32_16x16x32_bf16 v[176:179], a[160:163], v[128:131], v[196:199]
    ds_read_b64_tr_b16 a[186:187], v216 offset:53248
    v_add_f32 v201, v164, v201
    v_mfma_f32_16x16x32_bf16 v[176:179], a[164:167], v[136:139], v[176:179]
    v_exp_f32 v165, v165
    v_mfma_f32_16x16x32_bf16 v[176:179], a[168:171], v[144:147], v[176:179]
    ds_read_b64_tr_b16 a[188:189], v216 offset:57344
    v_add_f32 v201, v165, v201
    v_cvt_pk_bf16_f32 v30, v164, v165
    v_mfma_f32_16x16x32_bf16 v[176:179], a[172:175], v[152:155], v[176:179]
    s_waitcnt lgkmcnt(5)
    v_exp_f32 v166, v166
    v_mfma_f32_16x16x32_bf16 a[24:27], a[176:179], v[84:87], a[24:27]
    s_waitcnt lgkmcnt(3)
    ds_read_b64_tr_b16 a[190:191], v216 offset:61440
    v_add_f32 v201, v166, v201
    v_mfma_f32_16x16x32_bf16 a[24:27], a[180:183], v[92:95], a[24:27]
    v_exp_f32 v167, v167
    v_mfma_f32_16x16x32_bf16 a[56:59], a[180:183], v[108:111], a[56:59]
    v_add_f32 v201, v167, v201
    v_cvt_pk_bf16_f32 v31, v166, v167
    v_mfma_f32_16x16x32_bf16 a[56:59], a[176:179], v[100:103], a[56:59]
    v_exp_f32 v168, v168
    v_mfma_f32_16x16x32_bf16 a[88:91], a[176:179], v[116:119], a[88:91]
    v_add_f32 v202, v168, v202
    v_mfma_f32_16x16x32_bf16 a[88:91], a[180:183], v[124:127], a[88:91]
    v_exp_f32 v169, v169
    v_mfma_f32_16x16x32_bf16 a[120:123], a[180:183], v[140:143], a[120:123]
    s_waitcnt vmcnt(0) lgkmcnt(0)
    v_add_f32 v202, v169, v202
    v_cvt_pk_bf16_f32 v46, v168, v169
    v_mfma_f32_16x16x32_bf16 a[120:123], a[176:179], v[132:135], a[120:123]
    s_barrier
    v_exp_f32 v170, v170
    v_mfma_f32_16x16x32_bf16 a[152:155], a[176:179], v[148:151], a[152:155]
    ds_read_b128 a[160:163], v205 offset:16384
    v_add_f32 v202, v170, v202
    v_mfma_f32_16x16x32_bf16 a[152:155], a[180:183], v[156:159], a[152:155]
    v_exp_f32 v171, v171
    v_mfma_f32_16x16x32_bf16 a[28:31], a[184:187], v[84:87], a[28:31]
    ds_read_b128 a[164:167], v206 offset:16384
    v_add_f32 v202, v171, v202
    v_cvt_pk_bf16_f32 v47, v170, v171
    v_mfma_f32_16x16x32_bf16 a[28:31], a[188:191], v[92:95], a[28:31]
    v_exp_f32 v172, v172
    v_mfma_f32_16x16x32_bf16 a[60:63], a[188:191], v[108:111], a[60:63]
    ds_read_b128 a[168:171], v207 offset:16384
    v_add_f32 v203, v172, v203
    v_mfma_f32_16x16x32_bf16 a[60:63], a[184:187], v[100:103], a[60:63]
    v_exp_f32 v173, v173
    v_mfma_f32_16x16x32_bf16 a[92:95], a[184:187], v[116:119], a[92:95]
    v_add_f32 v203, v173, v203
    v_cvt_pk_bf16_f32 v62, v172, v173
    v_mfma_f32_16x16x32_bf16 a[92:95], a[188:191], v[124:127], a[92:95]
    v_exp_f32 v174, v174
    v_mfma_f32_16x16x32_bf16 a[124:127], a[188:191], v[140:143], a[124:127]
    ds_read_b128 a[172:175], v208 offset:16384
    v_add_f32 v203, v174, v203
    v_mfma_f32_16x16x32_bf16 a[124:127], a[184:187], v[132:135], a[124:127]
    v_exp_f32 v175, v175
    v_mfma_f32_16x16x32_bf16 a[156:159], a[184:187], v[148:151], a[156:159]
    v_add_f32 v203, v175, v203
    v_cvt_pk_bf16_f32 v63, v174, v175
    v_mfma_f32_16x16x32_bf16 a[156:159], a[188:191], v[156:159], a[156:159]
    v_exp_f32 v176, v176
    v_cmp_gt_u32 vcc, 32, v254
    s_mov_b32 s32, 0x40000
    s_cmp_eq_u32 s31, 3
    s_cbranch_scc1 L_loopA
    s_nop 1
    s_cbranch_vccz L_loopA
L_spinA:
    s_sleep 8
    buffer_load_dword v254, v255, s[20:23], 0 offen sc0 sc1
    s_waitcnt vmcnt(0)
    v_cmp_gt_u32 vcc, 32, v254
    s_sub_u32 s32, s32, 1
    s_nop 3
    s_cbranch_vccz L_loopA
    s_cmp_eq_u32 s32, 0
    s_cbranch_scc0 L_spinA
    s_branch L_loopA
L_p14A:
    s_waitcnt lgkmcnt(3)
    v_mfma_f32_16x16x32_bf16 v[160:163], a[160:163], v[0:3], v[180:183]
    s_waitcnt lgkmcnt(2)
    ds_read_b64_tr_b16 a[176:177], v209 offset:16384
    v_add_f32 v204, v176, v204
    v_mfma_f32_16x16x32_bf16 v[160:163], a[164:167], v[8:11], v[160:163]
    s_waitcnt lgkmcnt(2)
    v_exp_f32 v177, v177
    v_mfma_f32_16x16x32_bf16 v[160:163], a[168:171], v[16:19], v[160:163]
    s_waitcnt lgkmcnt(1)
    v_add_f32 v204, v177, v204
    v_cvt_pk_bf16_f32 v158, v176, v177
    v_mfma_f32_16x16x32_bf16 v[160:163], a[172:175], v[24:27], v[160:163]
    s_mov_b32 s27, 0
    buffer_load_dwordx4 a[192:195], v238, s[56:59], s27 offen sc1
    v_exp_f32 v178, v178
    v_mfma_f32_16x16x32_bf16 v[164:167], a[172:175], v[56:59], v[184:187]
    ds_read_b64_tr_b16 a[178:179], v209 offset:20480
    v_add_f32 v204, v178, v204
    v_mfma_f32_16x16x32_bf16 v[164:167], a[168:171], v[48:51], v[164:167]
    v_exp_f32 v179, v179
    v_mfma_f32_16x16x32_bf16 v[164:167], a[164:167], v[40:43], v[164:167]
    v_add_f32 v204, v179, v204
    v_cvt_pk_bf16_f32 v159, v178, v179
    v_mfma_f32_16x16x32_bf16 v[164:167], a[160:163], v[32:35], v[164:167]
    v_exp_f32 v160, v160
    v_mfma_f32_16x16x32_bf16 v[168:171], a[160:163], v[64:67], v[188:191]
    ds_read_b64_tr_b16 a[180:181], v209 offset:24576
    v_add_f32 v200, v160, v200
    v_mfma_f32_16x16x32_bf16 v[168:171], a[164:167], v[72:75], v[168:171]
    v_exp_f32 v161, v161
    v_mfma_f32_16x16x32_bf16 v[168:171], a[168:171], v[80:83], v[168:171]
    v_add_f32 v200, v161, v200
    v_cvt_pk_bf16_f32 v4, v160, v161
    v_mfma_f32_16x16x32_bf16 v[168:171], a[172:175], v[88:91], v[168:171]
    v_exp_f32 v162, v162
    v_mfma_f32_16x16x32_bf16 v[172:175], a[172:175], v[120:123], v[192:195]
    ds_read_b64_tr_b16 a[182:183], v209 offset:28672
    v_add_f32 v200, v162, v200
    v_mfma_f32_16x16x32_bf16 v[172:175], a[168:171], v[112:115], v[172:175]
    buffer_load_dwordx4 a[196:199], v238, s[56:59], s27 offen offset:1024 sc1
    v_exp_f32 v163, v163
    v_mfma_f32_16x16x32_bf16 v[172:175], a[164:167], v[104:107], v[172:175]
    ds_read_b64_tr_b16 a[184:185], v210 offset:16384
    v_add_f32 v200, v163, v200
    v_cvt_pk_bf16_f32 v5, v162, v163
    v_mfma_f32_16x16x32_bf16 v[172:175], a[160:163], v[96:99], v[172:175]
    v_exp_f32 v164, v164
    v_mfma_f32_16x16x32_bf16 v[176:179], a[160:163], v[128:131], v[196:199]
    ds_read_b64_tr_b16 a[186:187], v210 offset:20480
    v_add_f32 v201, v164, v201
    v_mfma_f32_16x16x32_bf16 v[176:179], a[164:167], v[136:139], v[176:179]
    v_exp_f32 v165, v165
    v_mfma_f32_16x16x32_bf16 v[176:179], a[168:171], v[144:147], v[176:179]
    ds_read_b64_tr_b16 a[188:189], v210 offset:24576
    v_add_f32 v201, v165, v201
    v_cvt_pk_bf16_f32 v20, v164, v165
    v_mfma_f32_16x16x32_bf16 v[176:179], a[172:175], v[152:155], v[176:179]
    s_waitcnt lgkmcnt(5)
    v_exp_f32 v166, v166
    v_mfma_f32_16x16x32_bf16 a[0:3], a[176:179], v[84:87], a[0:3]
    s_waitcnt lgkmcnt(3)
    ds_read_b64_tr_b16 a[190:191], v210 offset:28672
    v_add_f32 v201, v166, v201
    v_mfma_f32_16x16x32_bf16 a[0:3], a[180:183], v[92:95], a[0:3]
    v_exp_f32 v167, v167
    v_mfma_f32_16x16x32_bf16 a[32:35], a[180:183], v[108:111], a[32:35]
    v_add_f32 v201, v167, v201
    v_cvt_pk_bf16_f32 v21, v166, v167
    v_mfma_f32_16x16x32_bf16 a[32:35], a[176:179], v[100:103], a[32:35]
    buffer_load_dwordx4 a[200:203], v238, s[56:59], s27 offen offset:2048 sc1
    v_exp_f32 v168, v168
    v_mfma_f32_16x16x32_bf16 a[64:67], a[176:179], v[116:119], a[64:67]
    ds_read_b128 a[160:163], v205 offset:36864
    v_add_f32 v202, v168, v202
    v_mfma_f32_16x16x32_bf16 a[64:67], a[180:183], v[124:127], a[64:67]
    v_exp_f32 v169, v169
    v_mfma_f32_16x16x32_bf16 a[96:99], a[180:183], v[140:143], a[96:99]
    v_add_f32 v202, v169, v202
    v_cvt_pk_bf16_f32 v36, v168, v169
    v_mfma_f32_16x16x32_bf16 a[96:99], a[176:179], v[132:135], a[96:99]
    v_exp_f32 v170, v170
    v_mfma_f32_16x16x32_bf16 a[128:131], a[176:179], v[148:151], a[128:131]
    ds_read_b128 a[164:167], v206 offset:36864
    v_add_f32 v202, v170, v202
    v_mfma_f32_16x16x32_bf16 a[128:131], a[180:183], v[156:159], a[128:131]
    s_waitcnt lgkmcnt(4)
    v_exp_f32 v171, v171
    v_mfma_f32_16x16x32_bf16 a[4:7], a[184:187], v[84:87], a[4:7]
    s_waitcnt lgkmcnt(2)
    v_add_f32 v202, v171, v202
    v_cvt_pk_bf16_f32 v37, v170, v171
    v_mfma_f32_16x16x32_bf16 a[4:7], a[188:191], v[92:95], a[4:7]
    v_exp_f32 v172, v172
    v_mfma_f32_16x16x32_bf16 a[36:39], a[188:191], v[108:111], a[36:39]
    ds_read_b128 a[168:171], v207 offset:36864
    v_add_f32 v203, v172, v203
    v_mfma_f32_16x16x32_bf16 a[36:39], a[184:187], v[100:103], a[36:39]
    buffer_load_dwordx4 a[204:207], v238, s[56:59], s27 offen offset:3072 sc1
    v_exp_f32 v173, v173
    v_mfma_f32_16x16x32_bf16 a[68:71], a[184:187], v[116:119], a[68:71]
    v_add_f32 v203, v173, v203
    v_cvt_pk_bf16_f32 v52, v172, v173
    v_mfma_f32_16x16x32_bf16 a[68:71], a[188:191], v[124:127], a[68:71]
    v_exp_f32 v174, v174
    v_mfma_f32_16x16x32_bf16 a[100:103], a[188:191], v[140:143], a[100:103]
    ds_read_b128 a[172:175], v208 offset:36864
    v_add_f32 v203, v174, v203
    v_mfma_f32_16x16x32_bf16 a[100:103], a[184:187], v[132:135], a[100:103]
    v_exp_f32 v175, v175
    v_mfma_f32_16x16x32_bf16 a[132:135], a[184:187], v[148:151], a[132:135]
    v_add_f32 v203, v175, v203
    v_cvt_pk_bf16_f32 v53, v174, v175
    v_mfma_f32_16x16x32_bf16 a[132:135], a[188:191], v[156:159], a[132:135]
    s_waitcnt lgkmcnt(3)
    v_exp_f32 v176, v176
    v_mfma_f32_16x16x32_bf16 v[160:163], a[160:163], v[0:3], v[180:183]
    s_waitcnt lgkmcnt(2)
    ds_read_b64_tr_b16 a[176:177], v211 offset:16384
    v_add_f32 v204, v176, v204
    v_mfma_f32_16x16x32_bf16 v[160:163], a[164:167], v[8:11], v[160:163]
    s_waitcnt lgkmcnt(2)
    v_exp_f32 v177, v177
    v_mfma_f32_16x16x32_bf16 v[160:163], a[168:171], v[16:19], v[160:163]
    s_waitcnt lgkmcnt(1)
    v_add_f32 v204, v177, v204
    v_cvt_pk_bf16_f32 v68, v176, v177
    v_mfma_f32_16x16x32_bf16 v[160:163], a[172:175], v[24:27], v[160:163]
    v_exp_f32 v178, v178
    v_mfma_f32_16x16x32_bf16 v[164:167], a[172:175], v[56:59], v[184:187]
    s_mov_b32 s27, 262144
    ds_read_b64_tr_b16 a[178:179], v211 offset:20480
    buffer_load_dwordx4 a[208:211], v238, s[56:59], s27 offen sc1
    v_add_f32 v204, v178, v204
    v_mfma_f32_16x16x32_bf16 v[164:167], a[168:171], v[48:51], v[164:167]
    v_exp_f32 v179, v179
    v_mfma_f32_16x16x32_bf16 v[164:167], a[164:167], v[40:43], v[164:167]
    v_add_f32 v204, v179, v204
    v_cvt_pk_bf16_f32 v69, v178, v179
    v_mfma_f32_16x16x32_bf16 v[164:167], a[160:163], v[32:35], v[164:167]
    v_exp_f32 v160, v160
    v_mfma_f32_16x16x32_bf16 v[168:171], a[160:163], v[64:67], v[188:191]
    ds_read_b64_tr_b16 a[180:181], v211 offset:24576
    v_add_f32 v200, v160, v200
    v_mfma_f32_16x16x32_bf16 v[168:171], a[164:167], v[72:75], v[168:171]
    v_exp_f32 v161, v161
    v_mfma_f32_16x16x32_bf16 v[168:171], a[168:171], v[80:83], v[168:171]
    v_add_f32 v200, v161, v200
    v_cvt_pk_bf16_f32 v6, v160, v161
    v_mfma_f32_16x16x32_bf16 v[168:171], a[172:175], v[88:91], v[168:171]
    v_exp_f32 v162, v162
    v_mfma_f32_16x16x32_bf16 v[172:175], a[172:175], v[120:123], v[192:195]
    ds_read_b64_tr_b16 a[182:183], v211 offset:28672
    v_add_f32 v200, v162, v200
    v_mfma_f32_16x16x32_bf16 v[172:175], a[168:171], v[112:115], v[172:175]
    v_exp_f32 v163, v163
    v_mfma_f32_16x16x32_bf16 v[172:175], a[164:167], v[104:107], v[172:175]
    ds_read_b64_tr_b16 a[184:185], v212 offset:16384
    buffer_load_dwordx4 a[212:215], v238, s[56:59], s27 offen offset:1024 sc1
    v_add_f32 v200, v163, v200
    v_cvt_pk_bf16_f32 v7, v162, v163
    v_mfma_f32_16x16x32_bf16 v[172:175], a[160:163], v[96:99], v[172:175]
    v_exp_f32 v164, v164
    v_mfma_f32_16x16x32_bf16 v[176:179], a[160:163], v[128:131], v[196:199]
    ds_read_b64_tr_b16 a[186:187], v212 offset:20480
    v_add_f32 v201, v164, v201
    v_mfma_f32_16x16x32_bf16 v[176:179], a[164:167], v[136:139], v[176:179]
    v_exp_f32 v165, v165
    v_mfma_f32_16x16x32_bf16 v[176:179], a[168:171], v[144:147], v[176:179]
    ds_read_b64_tr_b16 a[188:189], v212 offset:24576
    v_add_f32 v201, v165, v201
    v_cvt_pk_bf16_f32 v22, v164, v165
    v_mfma_f32_16x16x32_bf16 v[176:179], a[172:175], v[152:155], v[176:179]
    s_waitcnt lgkmcnt(5)
    v_exp_f32 v166, v166
    v_mfma_f32_16x16x32_bf16 a[8:11], a[176:179], v[84:87], a[8:11]
    s_waitcnt lgkmcnt(3)
    ds_read_b64_tr_b16 a[190:191], v212 offset:28672
    v_add_f32 v201, v166, v201
    v_mfma_f32_16x16x32_bf16 a[8:11], a[180:183], v[92:95], a[8:11]
    v_exp_f32 v167, v167
    v_mfma_f32_16x16x32_bf16 a[40:43], a[180:183], v[108:111], a[40:43]
    v_add_f32 v201, v167, v201
    v_cvt_pk_bf16_f32 v23, v166, v167
    v_mfma_f32_16x16x32_bf16 a[40:43], a[176:179], v[100:103], a[40:43]
    v_exp_f32 v168, v168
    v_mfma_f32_16x16x32_bf16 a[72:75], a[176:179], v[116:119], a[72:75]
    ds_read_b128 a[160:163], v205 offset:40960
    buffer_load_dwordx4 a[216:219], v238, s[56:59], s27 offen offset:2048 sc1
    v_add_f32 v202, v168, v202
    v_mfma_f32_16x16x32_bf16 a[72:75], a[180:183], v[124:127], a[72:75]
    v_exp_f32 v169, v169
    v_mfma_f32_16x16x32_bf16 a[104:107], a[180:183], v[140:143], a[104:107]
    v_add_f32 v202, v169, v202
    v_cvt_pk_bf16_f32 v38, v168, v169
    v_mfma_f32_16x16x32_bf16 a[104:107], a[176:179], v[132:135], a[104:107]
    v_exp_f32 v170, v170
    v_mfma_f32_16x16x32_bf16 a[136:139], a[176:179], v[148:151], a[136:139]
    ds_read_b128 a[164:167], v206 offset:40960
    v_add_f32 v202, v170, v202
    v_mfma_f32_16x16x32_bf16 a[136:139], a[180:183], v[156:159], a[136:139]
    s_waitcnt lgkmcnt(4)
    v_exp_f32 v171, v171
    v_mfma_f32_16x16x32_bf16 a[12:15], a[184:187], v[84:87], a[12:15]
    s_waitcnt lgkmcnt(2)
    v_add_f32 v202, v171, v202
    v_cvt_pk_bf16_f32 v39, v170, v171
    v_mfma_f32_16x16x32_bf16 a[12:15], a[188:191], v[92:95], a[12:15]
    v_exp_f32 v172, v172
    v_mfma_f32_16x16x32_bf16 a[44:47], a[188:191], v[108:111], a[44:47]
    ds_read_b128 a[168:171], v207 offset:40960
    v_add_f32 v203, v172, v203
    v_mfma_f32_16x16x32_bf16 a[44:47], a[184:187], v[100:103], a[44:47]
    v_exp_f32 v173, v173
    v_mfma_f32_16x16x32_bf16 a[76:79], a[184:187], v[116:119], a[76:79]
    buffer_load_dwordx4 a[220:223], v238, s[56:59], s27 offen offset:3072 sc1
    v_add_f32 v203, v173, v203
    v_cvt_pk_bf16_f32 v54, v172, v173
    v_mfma_f32_16x16x32_bf16 a[76:79], a[188:191], v[124:127], a[76:79]
    v_exp_f32 v174, v174
    v_mfma_f32_16x16x32_bf16 a[108:111], a[188:191], v[140:143], a[108:111]
    ds_read_b128 a[172:175], v208 offset:40960
    v_add_f32 v203, v174, v203
    v_mfma_f32_16x16x32_bf16 a[108:111], a[184:187], v[132:135], a[108:111]
    v_exp_f32 v175, v175
    v_mfma_f32_16x16x32_bf16 a[140:143], a[184:187], v[148:151], a[140:143]
    v_add_f32 v203, v175, v203
    v_cvt_pk_bf16_f32 v55, v174, v175
    v_mfma_f32_16x16x32_bf16 a[140:143], a[188:191], v[156:159], a[140:143]
    s_waitcnt lgkmcnt(3)
    v_exp_f32 v176, v176
    v_mfma_f32_16x16x32_bf16 v[160:163], a[160:163], v[0:3], v[180:183]
    s_waitcnt lgkmcnt(2)
    ds_read_b64_tr_b16 a[176:177], v213 offset:16384
    v_add_f32 v204, v176, v204
    v_mfma_f32_16x16x32_bf16 v[160:163], a[164:167], v[8:11], v[160:163]
    s_waitcnt lgkmcnt(2)
    v_exp_f32 v177, v177
    v_mfma_f32_16x16x32_bf16 v[160:163], a[168:171], v[16:19], v[160:163]
    s_waitcnt lgkmcnt(1)
    v_add_f32 v204, v177, v204
    v_cvt_pk_bf16_f32 v70, v176, v177
    v_mfma_f32_16x16x32_bf16 v[160:163], a[172:175], v[24:27], v[160:163]
    v_exp_f32 v178, v178
    v_mfma_f32_16x16x32_bf16 v[164:167], a[172:175], v[56:59], v[184:187]
    ds_read_b64_tr_b16 a[178:179], v213 offset:20480
    v_add_f32 v204, v178, v204
    v_mfma_f32_16x16x32_bf16 v[164:167], a[168:171], v[48:51], v[164:167]
    s_mov_b32 s27, 524288
    buffer_load_dwordx4 a[224:227], v238, s[56:59], s27 offen sc1
    v_exp_f32 v179, v179
    v_mfma_f32_16x16x32_bf16 v[164:167], a[164:167], v[40:43], v[164:167]
    v_add_f32 v204, v179, v204
    v_cvt_pk_bf16_f32 v71, v178, v179
    v_mfma_f32_16x16x32_bf16 v[164:167], a[160:163], v[32:35], v[164:167]
    v_exp_f32 v160, v160
    v_mfma_f32_16x16x32_bf16 v[168:171], a[160:163], v[64:67], v[188:191]
    ds_read_b64_tr_b16 a[180:181], v213 offset:24576
    v_add_f32 v200, v160, v200
    v_mfma_f32_16x16x32_bf16 v[168:171], a[164:167], v[72:75], v[168:171]
    v_exp_f32 v161, v161
    v_mfma_f32_16x16x32_bf16 v[168:171], a[168:171], v[80:83], v[168:171]
    v_add_f32 v200, v161, v200
    v_cvt_pk_bf16_f32 v12, v160, v161
    v_mfma_f32_16x16x32_bf16 v[168:171], a[172:175], v[88:91], v[168:171]
    v_exp_f32 v162, v162
    v_mfma_f32_16x16x32_bf16 v[172:175], a[172:175], v[120:123], v[192:195]
    ds_read_b64_tr_b16 a[182:183], v213 offset:28672
    v_add_f32 v200, v162, v200
    v_mfma_f32_16x16x32_bf16 v[172:175], a[168:171], v[112:115], v[172:175]
    v_exp_f32 v163, v163
    v_mfma_f32_16x16x32_bf16 v[172:175], a[164:167], v[104:107], v[172:175]
    ds_read_b64_tr_b16 a[184:185], v214 offset:16384
    v_add_f32 v200, v163, v200
    v_cvt_pk_bf16_f32 v13, v162, v163
    v_mfma_f32_16x16x32_bf16 v[172:175], a[160:163], v[96:99], v[172:175]
    buffer_load_dwordx4 a[228:231], v238, s[56:59], s27 offen offset:1024 sc1
    v_exp_f32 v164, v164
    v_mfma_f32_16x16x32_bf16 v[176:179], a[160:163], v[128:131], v[196:199]
    ds_read_b64_tr_b16 a[186:187], v214 offset:20480
    v_add_f32 v201, v164, v201
    v_mfma_f32_16x16x32_bf16 v[176:179], a[164:167], v[136:139], v[176:179]
    v_exp_f32 v165, v165
    v_mfma_f32_16x16x32_bf16 v[176:179], a[168:171], v[144:147], v[176:179]
    ds_read_b64_tr_b16 a[188:189], v214 offset:24576
    v_add_f32 v201, v165, v201
    v_cvt_pk_bf16_f32 v28, v164, v165
    v_mfma_f32_16x16x32_bf16 v[176:179], a[172:175], v[152:155], v[176:179]
    s_waitcnt lgkmcnt(5)
    v_exp_f32 v166, v166
    v_mfma_f32_16x16x32_bf16 a[16:19], a[176:179], v[84:87], a[16:19]
    s_waitcnt lgkmcnt(3)
    ds_read_b64_tr_b16 a[190:191], v214 offset:28672
    v_add_f32 v201, v166, v201
    v_mfma_f32_16x16x32_bf16 a[16:19], a[180:183], v[92:95], a[16:19]
    v_exp_f32 v167, v167
    v_mfma_f32_16x16x32_bf16 a[48:51], a[180:183], v[108:111], a[48:51]
    v_add_f32 v201, v167, v201
    v_cvt_pk_bf16_f32 v29, v166, v167
    v_mfma_f32_16x16x32_bf16 a[48:51], a[176:179], v[100:103], a[48:51]
    v_exp_f32 v168, v168
    v_mfma_f32_16x16x32_bf16 a[80:83], a[176:179], v[116:119], a[80:83]
    ds_read_b128 a[160:163], v205 offset:45056
    v_add_f32 v202, v168, v202
    v_mfma_f32_16x16x32_bf16 a[80:83], a[180:183], v[124:127], a[80:83]
    buffer_load_dwordx4 a[232:235], v238, s[56:59], s27 offen offset:2048 sc1
    v_exp_f32 v169, v169
    v_mfma_f32_16x16x32_bf16 a[112:115], a[180:183], v[140:143], a[112:115]
    v_add_f32 v202, v169, v202
    v_cvt_pk_bf16_f32 v44, v168, v169
    v_mfma_f32_16x16x32_bf16 a[112:115], a[176:179], v[132:135], a[112:115]
    v_exp_f32 v170, v170
    v_mfma_f32_16x16x32_bf16 a[144:147], a[176:179], v[148:151], a[144:147]
    ds_read_b128 a[164:167], v206 offset:45056
    v_add_f32 v202, v170, v202
    v_mfma_f32_16x16x32_bf16 a[144:147], a[180:183], v[156:159], a[144:147]
    s_waitcnt lgkmcnt(4)
    v_exp_f32 v171, v171
    v_mfma_f32_16x16x32_bf16 a[20:23], a[184:187], v[84:87], a[20:23]
    s_waitcnt lgkmcnt(2)
    v_add_f32 v202, v171, v202
    v_cvt_pk_bf16_f32 v45, v170, v171
    v_mfma_f32_16x16x32_bf16 a[20:23], a[188:191], v[92:95], a[20:23]
    v_exp_f32 v172, v172
    v_mfma_f32_16x16x32_bf16 a[52:55], a[188:191], v[108:111], a[52:55]
    ds_read_b128 a[168:171], v207 offset:45056
    v_add_f32 v203, v172, v203
    v_mfma_f32_16x16x32_bf16 a[52:55], a[184:187], v[100:103], a[52:55]
    v_exp_f32 v173, v173
    v_mfma_f32_16x16x32_bf16 a[84:87], a[184:187], v[116:119], a[84:87]
    v_add_f32 v203, v173, v203
    v_cvt_pk_bf16_f32 v60, v172, v173
    v_mfma_f32_16x16x32_bf16 a[84:87], a[188:191], v[124:127], a[84:87]
    buffer_load_dwordx4 a[236:239], v238, s[56:59], s27 offen offset:3072 sc1
    v_exp_f32 v174, v174
    v_mfma_f32_16x16x32_bf16 a[116:119], a[188:191], v[140:143], a[116:119]
    ds_read_b128 a[172:175], v208 offset:45056
    v_add_f32 v203, v174, v203
    v_mfma_f32_16x16x32_bf16 a[116:119], a[184:187], v[132:135], a[116:119]
    v_exp_f32 v175, v175
    v_mfma_f32_16x16x32_bf16 a[148:151], a[184:187], v[148:151], a[148:151]
    v_add_f32 v203, v175, v203
    v_cvt_pk_bf16_f32 v61, v174, v175
    v_mfma_f32_16x16x32_bf16 a[148:151], a[188:191], v[156:159], a[148:151]
    s_waitcnt lgkmcnt(3)
    v_exp_f32 v176, v176
    v_mfma_f32_16x16x32_bf16 v[160:163], a[160:163], v[0:3], v[180:183]
    s_waitcnt lgkmcnt(2)
    ds_read_b64_tr_b16 a[176:177], v215 offset:16384
    v_add_f32 v204, v176, v204
    v_mfma_f32_16x16x32_bf16 v[160:163], a[164:167], v[8:11], v[160:163]
    s_waitcnt lgkmcnt(2)
    v_exp_f32 v177, v177
    v_mfma_f32_16x16x32_bf16 v[160:163], a[168:171], v[16:19], v[160:163]
    s_waitcnt lgkmcnt(1)
    v_add_f32 v204, v177, v204
    v_cvt_pk_bf16_f32 v76, v176, v177
    v_mfma_f32_16x16x32_bf16 v[160:163], a[172:175], v[24:27], v[160:163]
    v_exp_f32 v178, v178
    v_mfma_f32_16x16x32_bf16 v[164:167], a[172:175], v[56:59], v[184:187]
    ds_read_b64_tr_b16 a[178:179], v215 offset:20480
    v_add_f32 v204, v178, v204
    v_mfma_f32_16x16x32_bf16 v[164:167], a[168:171], v[48:51], v[164:167]
    s_add_u32 m0, s34, 16384
    v_exp_f32 v179, v179
    v_mfma_f32_16x16x32_bf16 v[164:167], a[164:167], v[40:43], v[164:167]
    s_mov_b32 s27, 2621440
    buffer_load_dwordx4 v238, s[56:59], s27 offen sc1 lds
    v_add_f32 v204, v179, v204
    v_cvt_pk_bf16_f32 v77, v178, v179
    v_mfma_f32_16x16x32_bf16 v[164:167], a[160:163], v[32:35], v[164:167]
    v_exp_f32 v160, v160
    v_mfma_f32_16x16x32_bf16 v[168:171], a[160:163], v[64:67], v[188:191]
    ds_read_b64_tr_b16 a[180:181], v215 offset:24576
    v_add_f32 v200, v160, v200
    v_mfma_f32_16x16x32_bf16 v[168:171], a[164:167], v[72:75], v[168:171]
    v_exp_f32 v161, v161
    v_mfma_f32_16x16x32_bf16 v[168:171], a[168:171], v[80:83], v[168:171]
    v_add_f32 v200, v161, v200
    v_cvt_pk_bf16_f32 v14, v160, v161
    v_mfma_f32_16x16x32_bf16 v[168:171], a[172:175], v[88:91], v[168:171]
    v_exp_f32 v162, v162
    v_mfma_f32_16x16x32_bf16 v[172:175], a[172:175], v[120:123], v[192:195]
    ds_read_b64_tr_b16 a[182:183], v215 offset:28672
    v_add_f32 v200, v162, v200
    v_mfma_f32_16x16x32_bf16 v[172:175], a[168:171], v[112:115], v[172:175]
    v_exp_f32 v163, v163
    v_mfma_f32_16x16x32_bf16 v[172:175], a[164:167], v[104:107], v[172:175]
    ds_read_b64_tr_b16 a[184:185], v216 offset:16384
    v_add_f32 v200, v163, v200
    v_cvt_pk_bf16_f32 v15, v162, v163
    v_mfma_f32_16x16x32_bf16 v[172:175], a[160:163], v[96:99], v[172:175]
    v_exp_f32 v164, v164
    v_mfma_f32_16x16x32_bf16 v[176:179], a[160:163], v[128:131], v[196:199]
    ds_read_b64_tr_b16 a[186:187], v216 offset:20480
    buffer_load_dwordx4 v238, s[56:59], s27 offen offset:1024 sc1 lds
    v_add_f32 v201, v164, v201
    v_mfma_f32_16x16x32_bf16 v[176:179], a[164:167], v[136:139], v[176:179]
    v_exp_f32 v165, v165
    v_mfma_f32_16x16x32_bf16 v[176:179], a[168:171], v[144:147], v[176:179]
    ds_read_b64_tr_b16 a[188:189], v216 offset:24576
    v_add_f32 v201, v165, v201
    v_cvt_pk_bf16_f32 v30, v164, v165
    v_mfma_f32_16x16x32_bf16 v[176:179], a[172:175], v[152:155], v[176:179]
    s_waitcnt lgkmcnt(5)
    v_exp_f32 v166, v166
    v_mfma_f32_16x16x32_bf16 a[24:27], a[176:179], v[84:87], a[24:27]
    s_waitcnt lgkmcnt(3)
    ds_read_b64_tr_b16 a[190:191], v216 offset:28672
    v_add_f32 v201, v166, v201
    v_mfma_f32_16x16x32_bf16 a[24:27], a[180:183], v[92:95], a[24:27]
    v_exp_f32 v167, v167
    v_mfma_f32_16x16x32_bf16 a[56:59], a[180:183], v[108:111], a[56:59]
    v_add_f32 v201, v167, v201
    v_cvt_pk_bf16_f32 v31, v166, v167
    v_mfma_f32_16x16x32_bf16 a[56:59], a[176:179], v[100:103], a[56:59]
    v_exp_f32 v168, v168
    v_mfma_f32_16x16x32_bf16 a[88:91], a[176:179], v[116:119], a[88:91]
    v_add_f32 v202, v168, v202
    v_mfma_f32_16x16x32_bf16 a[88:91], a[180:183], v[124:127], a[88:91]
    v_exp_f32 v169, v169
    v_mfma_f32_16x16x32_bf16 a[120:123], a[180:183], v[140:143], a[120:123]
    s_waitcnt vmcnt(14) lgkmcnt(0)
    v_add_f32 v202, v169, v202
    v_cvt_pk_bf16_f32 v46, v168, v169
    v_mfma_f32_16x16x32_bf16 a[120:123], a[176:179], v[132:135], a[120:123]
    s_barrier
    v_exp_f32 v170, v170
    v_mfma_f32_16x16x32_bf16 a[152:155], a[176:179], v[148:151], a[152:155]
    ds_read_b128 a[160:163], v205 offset:49152
    buffer_load_dwordx4 v238, s[56:59], s27 offen offset:2048 sc1 lds
    v_add_f32 v202, v170, v202
    v_mfma_f32_16x16x32_bf16 a[152:155], a[180:183], v[156:159], a[152:155]
    v_exp_f32 v171, v171
    v_mfma_f32_16x16x32_bf16 a[28:31], a[184:187], v[84:87], a[28:31]
    ds_read_b128 a[164:167], v206 offset:49152
    v_add_f32 v202, v171, v202
    v_cvt_pk_bf16_f32 v47, v170, v171
    v_mfma_f32_16x16x32_bf16 a[28:31], a[188:191], v[92:95], a[28:31]
    v_exp_f32 v172, v172
    v_mfma_f32_16x16x32_bf16 a[60:63], a[188:191], v[108:111], a[60:63]
    ds_read_b128 a[168:171], v207 offset:49152
    v_add_f32 v203, v172, v203
    v_mfma_f32_16x16x32_bf16 a[60:63], a[184:187], v[100:103], a[60:63]
    v_exp_f32 v173, v173
    v_mfma_f32_16x16x32_bf16 a[92:95], a[184:187], v[116:119], a[92:95]
    v_add_f32 v203, v173, v203
    v_cvt_pk_bf16_f32 v62, v172, v173
    v_mfma_f32_16x16x32_bf16 a[92:95], a[188:191], v[124:127], a[92:95]
    v_exp_f32 v174, v174
    v_mfma_f32_16x16x32_bf16 a[124:127], a[188:191], v[140:143], a[124:127]
    ds_read_b128 a[172:175], v208 offset:49152
    v_add_f32 v203, v174, v203
    v_mfma_f32_16x16x32_bf16 a[124:127], a[184:187], v[132:135], a[124:127]
    buffer_load_dwordx4 v238, s[56:59], s27 offen offset:3072 sc1 lds
    v_exp_f32 v175, v175
    v_mfma_f32_16x16x32_bf16 a[156:159], a[184:187], v[148:151], a[156:159]
    v_add_f32 v203, v175, v203
    v_cvt_pk_bf16_f32 v63, v174, v175
    v_mfma_f32_16x16x32_bf16 a[156:159], a[188:191], v[156:159], a[156:159]
    s_waitcnt lgkmcnt(3)
    v_exp_f32 v176, v176
    v_mfma_f32_16x16x32_bf16 v[160:163], a[160:163], v[0:3], v[180:183]
    s_waitcnt lgkmcnt(2)
    v_add_f32 v204, v176, v204
    v_mfma_f32_16x16x32_bf16 v[160:163], a[164:167], v[8:11], v[160:163]
    s_waitcnt lgkmcnt(1)
    ds_read_b64_tr_b16 a[176:177], v209 offset:32768
    v_exp_f32 v177, v177
    v_mfma_f32_16x16x32_bf16 v[160:163], a[168:171], v[16:19], v[160:163]
    s_waitcnt lgkmcnt(1)
    v_add_f32 v204, v177, v204
    v_cvt_pk_bf16_f32 v78, v176, v177
    v_mfma_f32_16x16x32_bf16 v[160:163], a[172:175], v[24:27], v[160:163]
    s_mov_b32 s27, 786432
    buffer_load_dwordx4 a[240:243], v238, s[56:59], s27 offen sc1
    v_exp_f32 v178, v178
    v_mfma_f32_16x16x32_bf16 v[164:167], a[172:175], v[56:59], v[184:187]
    ds_read_b64_tr_b16 a[178:179], v209 offset:36864
    v_add_f32 v204, v178, v204
    v_mfma_f32_16x16x32_bf16 v[164:167], a[168:171], v[48:51], v[164:167]
    v_exp_f32 v179, v179
    v_mfma_f32_16x16x32_bf16 v[164:167], a[164:167], v[40:43], v[164:167]
    v_add_f32 v204, v179, v204
    v_cvt_pk_bf16_f32 v79, v178, v179
    v_mfma_f32_16x16x32_bf16 v[164:167], a[160:163], v[32:35], v[164:167]
    ds_read_b64_tr_b16 a[180:181], v209 offset:40960
    v_exp_f32 v160, v160
    v_mfma_f32_16x16x32_bf16 v[168:171], a[160:163], v[64:67], v[188:191]
    v_add_f32 v200, v160, v200
    v_exp_f32 v161, v161
    v_mfma_f32_16x16x32_bf16 v[168:171], a[164:167], v[72:75], v[168:171]
    v_add_f32 v200, v161, v200
    v_cvt_pk_bf16_f32 v84, v160, v161
    v_mfma_f32_16x16x32_bf16 v[168:171], a[168:171], v[80:83], v[168:171]
    ds_read_b64_tr_b16 a[182:183], v209 offset:45056
    buffer_load_dwordx4 a[244:247], v238, s[56:59], s27 offen offset:1024 sc1
    v_exp_f32 v162, v162
    v_mfma_f32_16x16x32_bf16 v[168:171], a[172:175], v[88:91], v[168:171]
    v_add_f32 v200, v162, v200
    v_exp_f32 v163, v163
    v_mfma_f32_16x16x32_bf16 v[172:175], a[172:175], v[120:123], v[192:195]
    v_add_f32 v200, v163, v200
    v_cvt_pk_bf16_f32 v85, v162, v163
    v_mfma_f32_16x16x32_bf16 v[172:175], a[168:171], v[112:115], v[172:175]
    v_exp_f32 v164, v164
    v_mfma_f32_16x16x32_bf16 v[172:175], a[164:167], v[104:107], v[172:175]
    v_add_f32 v201, v164, v201
    v_exp_f32 v165, v165
    v_mfma_f32_16x16x32_bf16 v[172:175], a[160:163], v[96:99], v[172:175]
    v_add_f32 v201, v165, v201
    v_cvt_pk_bf16_f32 v100, v164, v165
    v_mfma_f32_16x16x32_bf16 v[176:179], a[160:163], v[128:131], v[196:199]
    v_exp_f32 v166, v166
    v_mfma_f32_16x16x32_bf16 v[176:179], a[164:167], v[136:139], v[176:179]
    v_add_f32 v201, v166, v201
    v_exp_f32 v167, v167
    v_mfma_f32_16x16x32_bf16 v[176:179], a[168:171], v[144:147], v[176:179]
    buffer_load_dwordx4 a[248:251], v238, s[56:59], s27 offen offset:2048 sc1
    v_add_f32 v201, v167, v201
    v_cvt_pk_bf16_f32 v101, v166, v167
    v_mfma_f32_16x16x32_bf16 v[176:179], a[172:175], v[152:155], v[176:179]
    s_waitcnt lgkmcnt(2)
    v_exp_f32 v168, v168
    v_mfma_f32_16x16x32_bf16 a[0:3], a[176:179], v[4:7], a[0:3]
    s_waitcnt lgkmcnt(0)
    ds_read_b128 a[160:163], v205 offset:53248
    v_add_f32 v202, v168, v202
    v_exp_f32 v169, v169
    v_mfma_f32_16x16x32_bf16 a[0:3], a[180:183], v[12:15], a[0:3]
    ds_read_b128 a[164:167], v206 offset:53248
    v_add_f32 v202, v169, v202
    v_cvt_pk_bf16_f32 v116, v168, v169
    v_mfma_f32_16x16x32_bf16 a[32:35], a[180:183], v[28:31], a[32:35]
    ds_read_b128 a[168:171], v207 offset:53248
    v_exp_f32 v170, v170
    v_mfma_f32_16x16x32_bf16 a[32:35], a[176:179], v[20:23], a[32:35]
    ds_read_b128 a[172:175], v208 offset:53248
    v_add_f32 v202, v170, v202
    v_exp_f32 v171, v171
    v_mfma_f32_16x16x32_bf16 a[64:67], a[176:179], v[36:39], a[64:67]
    v_add_f32 v202, v171, v202
    v_cvt_pk_bf16_f32 v117, v170, v171
    v_mfma_f32_16x16x32_bf16 a[64:67], a[180:183], v[44:47], a[64:67]
    buffer_load_dwordx4 a[252:255], v238, s[56:59], s27 offen offset:3072 sc1
    v_exp_f32 v172, v172
    v_mfma_f32_16x16x32_bf16 a[96:99], a[180:183], v[60:63], a[96:99]
    v_add_f32 v203, v172, v203
    v_exp_f32 v173, v173
    v_mfma_f32_16x16x32_bf16 a[96:99], a[176:179], v[52:55], a[96:99]
    v_add_f32 v203, v173, v203
    v_cvt_pk_bf16_f32 v132, v172, v173
    v_mfma_f32_16x16x32_bf16 a[128:131], a[176:179], v[68:71], a[128:131]
    v_exp_f32 v174, v174
    v_mfma_f32_16x16x32_bf16 a[128:131], a[180:183], v[76:79], a[128:131]
    s_waitcnt lgkmcnt(3)
    v_add_f32 v203, v174, v203
    v_exp_f32 v175, v175
    v_mfma_f32_16x16x32_bf16 v[160:163], a[160:163], v[0:3], v[180:183]
    s_waitcnt lgkmcnt(2)
    v_add_f32 v203, v175, v203
    v_cvt_pk_bf16_f32 v133, v174, v175
    v_mfma_f32_16x16x32_bf16 v[160:163], a[164:167], v[8:11], v[160:163]
    s_waitcnt lgkmcnt(1)
    ds_read_b64_tr_b16 a[176:177], v210 offset:32768
    v_exp_f32 v176, v176
    v_mfma_f32_16x16x32_bf16 v[160:163], a[168:171], v[16:19], v[160:163]
    s_waitcnt lgkmcnt(1)
    s_add_u32 m0, s34, 65536
    v_add_f32 v204, v176, v204
    v_exp_f32 v177, v177
    v_mfma_f32_16x16x32_bf16 v[160:163], a[172:175], v[24:27], v[160:163]
    s_mov_b32 s27, 2883584
    buffer_load_dwordx4 v238, s[56:59], s27 offen sc1 lds
    v_add_f32 v204, v177, v204
    v_cvt_pk_bf16_f32 v148, v176, v177
    v_mfma_f32_16x16x32_bf16 v[164:167], a[172:175], v[56:59], v[184:187]
    ds_read_b64_tr_b16 a[178:179], v210 offset:36864
    v_exp_f32 v178, v178
    v_mfma_f32_16x16x32_bf16 v[164:167], a[168:171], v[48:51], v[164:167]
    v_add_f32 v204, v178, v204
    v_exp_f32 v179, v179
    v_mfma_f32_16x16x32_bf16 v[164:167], a[164:167], v[40:43], v[164:167]
    v_add_f32 v204, v179, v204
    v_cvt_pk_bf16_f32 v149, v178, v179
    v_mfma_f32_16x16x32_bf16 v[164:167], a[160:163], v[32:35], v[164:167]
    ds_read_b64_tr_b16 a[180:181], v210 offset:40960
    v_exp_f32 v160, v160
    v_mfma_f32_16x16x32_bf16 v[168:171], a[160:163], v[64:67], v[188:191]
    v_add_f32 v200, v160, v200
    v_exp_f32 v161, v161
    v_mfma_f32_16x16x32_bf16 v[168:171], a[164:167], v[72:75], v[168:171]
    v_add_f32 v200, v161, v200
    v_cvt_pk_bf16_f32 v86, v160, v161
    v_mfma_f32_16x16x32_bf16 v[168:171], a[168:171], v[80:83], v[168:171]
    ds_read_b64_tr_b16 a[182:183], v210 offset:45056
    v_exp_f32 v162, v162
    v_mfma_f32_16x16x32_bf16 v[168:171], a[172:175], v[88:91], v[168:171]
    buffer_load_dwordx4 v238, s[56:59], s27 offen offset:1024 sc1 lds
    v_add_f32 v200, v162, v200
    v_exp_f32 v163, v163
    v_mfma_f32_16x16x32_bf16 v[172:175], a[172:175], v[120:123], v[192:195]
    v_add_f32 v200, v163, v200
    v_cvt_pk_bf16_f32 v87, v162, v163
    v_mfma_f32_16x16x32_bf16 v[172:175], a[168:171], v[112:115], v[172:175]
    v_exp_f32 v164, v164
    v_mfma_f32_16x16x32_bf16 v[172:175], a[164:167], v[104:107], v[172:175]
    v_add_f32 v201, v164, v201
    v_exp_f32 v165, v165
    v_mfma_f32_16x16x32_bf16 v[172:175], a[160:163], v[96:99], v[172:175]
    v_add_f32 v201, v165, v201
    v_cvt_pk_bf16_f32 v102, v164, v165
    v_mfma_f32_16x16x32_bf16 v[176:179], a[160:163], v[128:131], v[196:199]
    v_exp_f32 v166, v166
    v_mfma_f32_16x16x32_bf16 v[176:179], a[164:167], v[136:139], v[176:179]
    v_add_f32 v201, v166, v201
    v_exp_f32 v167, v167
    v_mfma_f32_16x16x32_bf16 v[176:179], a[168:171], v[144:147], v[176:179]
    buffer_load_dwordx4 v238, s[56:59], s27 offen offset:2048 sc1 lds
    v_add_f32 v201, v167, v201
    v_cvt_pk_bf16_f32 v103, v166, v167
    v_mfma_f32_16x16x32_bf16 v[176:179], a[172:175], v[152:155], v[176:179]
    s_waitcnt lgkmcnt(2)
    v_exp_f32 v168, v168
    v_mfma_f32_16x16x32_bf16 a[4:7], a[176:179], v[4:7], a[4:7]
    s_waitcnt lgkmcnt(0)
    ds_read_b128 a[160:163], v205 offset:57344
    v_add_f32 v202, v168, v202
    v_exp_f32 v169, v169
    v_mfma_f32_16x16x32_bf16 a[4:7], a[180:183], v[12:15], a[4:7]
    ds_read_b128 a[164:167], v206 offset:57344
    v_add_f32 v202, v169, v202
    v_cvt_pk_bf16_f32 v118, v168, v169
    v_mfma_f32_16x16x32_bf16 a[36:39], a[180:183], v[28:31], a[36:39]
    ds_read_b128 a[168:171], v207 offset:57344
    v_exp_f32 v170, v170
    v_mfma_f32_16x16x32_bf16 a[36:39], a[176:179], v[20:23], a[36:39]
    ds_read_b128 a[172:175], v208 offset:57344
    v_add_f32 v202, v170, v202
    v_exp_f32 v171, v171
    v_mfma_f32_16x16x32_bf16 a[68:71], a[176:179], v[36:39], a[68:71]
    v_add_f32 v202, v171, v202
    v_cvt_pk_bf16_f32 v119, v170, v171
    v_mfma_f32_16x16x32_bf16 a[68:71], a[180:183], v[44:47], a[68:71]
    v_exp_f32 v172, v172
    v_mfma_f32_16x16x32_bf16 a[100:103], a[180:183], v[60:63], a[100:103]
    buffer_load_dwordx4 v238, s[56:59], s27 offen offset:3072 sc1 lds
    v_add_f32 v203, v172, v203
    v_exp_f32 v173, v173
    v_mfma_f32_16x16x32_bf16 a[100:103], a[176:179], v[52:55], a[100:103]
    v_add_f32 v203, v173, v203
    v_cvt_pk_bf16_f32 v134, v172, v173
    v_mfma_f32_16x16x32_bf16 a[132:135], a[176:179], v[68:71], a[132:135]
    v_exp_f32 v174, v174
    v_mfma_f32_16x16x32_bf16 a[132:135], a[180:183], v[76:79], a[132:135]
    s_waitcnt lgkmcnt(3)
    v_add_f32 v203, v174, v203
    v_exp_f32 v175, v175
    v_mfma_f32_16x16x32_bf16 v[160:163], a[160:163], v[0:3], v[180:183]
    s_waitcnt lgkmcnt(2)
    v_add_f32 v203, v175, v203
    v_cvt_pk_bf16_f32 v135, v174, v175
    v_mfma_f32_16x16x32_bf16 v[160:163], a[164:167], v[8:11], v[160:163]
    s_waitcnt lgkmcnt(1)
    ds_read_b64_tr_b16 a[176:177], v211 offset:32768
    v_exp_f32 v176, v176
    v_mfma_f32_16x16x32_bf16 v[160:163], a[168:171], v[16:19], v[160:163]
    s_waitcnt lgkmcnt(1)
    s_add_u32 m0, s34, 32768
    v_add_f32 v204, v176, v204
    v_exp_f32 v177, v177
    v_mfma_f32_16x16x32_bf16 v[160:163], a[172:175], v[24:27], v[160:163]
    s_mov_b32 s27, 3670016
    buffer_load_dwordx4 v238, s[56:59], s27 offen sc1 lds
    v_add_f32 v204, v177, v204
    v_cvt_pk_bf16_f32 v150, v176, v177
    v_mfma_f32_16x16x32_bf16 v[164:167], a[172:175], v[56:59], v[184:187]
    ds_read_b64_tr_b16 a[178:179], v211 offset:36864
    v_exp_f32 v178, v178
    v_mfma_f32_16x16x32_bf16 v[164:167], a[168:171], v[48:51], v[164:167]
    v_add_f32 v204, v178, v204
    v_exp_f32 v179, v179
    v_mfma_f32_16x16x32_bf16 v[164:167], a[164:167], v[40:43], v[164:167]
    v_add_f32 v204, v179, v204
    v_cvt_pk_bf16_f32 v151, v178, v179
    v_mfma_f32_16x16x32_bf16 v[164:167], a[160:163], v[32:35], v[164:167]
    ds_read_b64_tr_b16 a[180:181], v211 offset:40960
    v_exp_f32 v160, v160
    v_mfma_f32_16x16x32_bf16 v[168:171], a[160:163], v[64:67], v[188:191]
    v_add_f32 v200, v160, v200
    v_exp_f32 v161, v161
    v_mfma_f32_16x16x32_bf16 v[168:171], a[164:167], v[72:75], v[168:171]
    v_add_f32 v200, v161, v200
    v_cvt_pk_bf16_f32 v92, v160, v161
    v_mfma_f32_16x16x32_bf16 v[168:171], a[168:171], v[80:83], v[168:171]
    ds_read_b64_tr_b16 a[182:183], v211 offset:45056
    v_exp_f32 v162, v162
    v_mfma_f32_16x16x32_bf16 v[168:171], a[172:175], v[88:91], v[168:171]
    buffer_load_dwordx4 v238, s[56:59], s27 offen offset:1024 sc1 lds
    v_add_f32 v200, v162, v200
    v_exp_f32 v163, v163
    v_mfma_f32_16x16x32_bf16 v[172:175], a[172:175], v[120:123], v[192:195]
    v_add_f32 v200, v163, v200
    v_cvt_pk_bf16_f32 v93, v162, v163
    v_mfma_f32_16x16x32_bf16 v[172:175], a[168:171], v[112:115], v[172:175]
    v_exp_f32 v164, v164
    v_mfma_f32_16x16x32_bf16 v[172:175], a[164:167], v[104:107], v[172:175]
    v_add_f32 v201, v164, v201
    v_exp_f32 v165, v165
    v_mfma_f32_16x16x32_bf16 v[172:175], a[160:163], v[96:99], v[172:175]
    v_add_f32 v201, v165, v201
    v_cvt_pk_bf16_f32 v108, v164, v165
    v_mfma_f32_16x16x32_bf16 v[176:179], a[160:163], v[128:131], v[196:199]
    v_exp_f32 v166, v166
    v_mfma_f32_16x16x32_bf16 v[176:179], a[164:167], v[136:139], v[176:179]
    v_add_f32 v201, v166, v201
    v_exp_f32 v167, v167
    v_mfma_f32_16x16x32_bf16 v[176:179], a[168:171], v[144:147], v[176:179]
    v_add_f32 v201, v167, v201
    v_cvt_pk_bf16_f32 v109, v166, v167
    v_mfma_f32_16x16x32_bf16 v[176:179], a[172:175], v[152:155], v[176:179]
    s_waitcnt lgkmcnt(2)
    buffer_load_dwordx4 v238, s[56:59], s27 offen offset:2048 sc1 lds
    v_exp_f32 v168, v168
    v_mfma_f32_16x16x32_bf16 a[8:11], a[176:179], v[4:7], a[8:11]
    s_waitcnt lgkmcnt(0)
    ds_read_b128 a[160:163], v205 offset:61440
    v_add_f32 v202, v168, v202
    v_exp_f32 v169, v169
    v_mfma_f32_16x16x32_bf16 a[8:11], a[180:183], v[12:15], a[8:11]
    ds_read_b128 a[164:167], v206 offset:61440
    v_add_f32 v202, v169, v202
    v_cvt_pk_bf16_f32 v124, v168, v169
    v_mfma_f32_16x16x32_bf16 a[40:43], a[180:183], v[28:31], a[40:43]
    ds_read_b128 a[168:171], v207 offset:61440
    v_exp_f32 v170, v170
    v_mfma_f32_16x16x32_bf16 a[40:43], a[176:179], v[20:23], a[40:43]
    ds_read_b128 a[172:175], v208 offset:61440
    v_add_f32 v202, v170, v202
    v_exp_f32 v171, v171
    v_mfma_f32_16x16x32_bf16 a[72:75], a[176:179], v[36:39], a[72:75]
    v_add_f32 v202, v171, v202
    v_cvt_pk_bf16_f32 v125, v170, v171
    v_mfma_f32_16x16x32_bf16 a[72:75], a[180:183], v[44:47], a[72:75]
    v_exp_f32 v172, v172
    v_mfma_f32_16x16x32_bf16 a[104:107], a[180:183], v[60:63], a[104:107]
    buffer_load_dwordx4 v238, s[56:59], s27 offen offset:3072 sc1 lds
    v_add_f32 v203, v172, v203
    v_exp_f32 v173, v173
    v_mfma_f32_16x16x32_bf16 a[104:107], a[176:179], v[52:55], a[104:107]
    v_add_f32 v203, v173, v203
    v_cvt_pk_bf16_f32 v140, v172, v173
    v_mfma_f32_16x16x32_bf16 a[136:139], a[176:179], v[68:71], a[136:139]
    v_exp_f32 v174, v174
    v_mfma_f32_16x16x32_bf16 a[136:139], a[180:183], v[76:79], a[136:139]
    s_waitcnt lgkmcnt(3)
    v_add_f32 v203, v174, v203
    v_exp_f32 v175, v175
    v_mfma_f32_16x16x32_bf16 v[160:163], a[160:163], v[0:3], v[180:183]
    s_waitcnt lgkmcnt(2)
    v_add_f32 v203, v175, v203
    v_cvt_pk_bf16_f32 v141, v174, v175
    v_mfma_f32_16x16x32_bf16 v[160:163], a[164:167], v[8:11], v[160:163]
    s_waitcnt lgkmcnt(1)
    ds_read_b64_tr_b16 a[176:177], v212 offset:32768
    v_exp_f32 v176, v176
    v_mfma_f32_16x16x32_bf16 v[160:163], a[168:171], v[16:19], v[160:163]
    s_waitcnt lgkmcnt(1)
    v_add_f32 v204, v176, v204
    v_exp_f32 v177, v177
    v_mfma_f32_16x16x32_bf16 v[160:163], a[172:175], v[24:27], v[160:163]
    s_add_u32 m0, s34, 81920
    v_add_f32 v204, v177, v204
    v_cvt_pk_bf16_f32 v156, v176, v177
    v_mfma_f32_16x16x32_bf16 v[164:167], a[172:175], v[56:59], v[184:187]
    s_mov_b32 s27, 3932160
    ds_read_b64_tr_b16 a[178:179], v212 offset:36864
    buffer_load_dwordx4 v238, s[56:59], s27 offen sc1 lds
    v_exp_f32 v178, v178
    v_mfma_f32_16x16x32_bf16 v[164:167], a[168:171], v[48:51], v[164:167]
    v_add_f32 v204, v178, v204
    v_exp_f32 v179, v179
    v_mfma_f32_16x16x32_bf16 v[164:167], a[164:167], v[40:43], v[164:167]
    v_add_f32 v204, v179, v204
    v_cvt_pk_bf16_f32 v157, v178, v179
    v_mfma_f32_16x16x32_bf16 v[164:167], a[160:163], v[32:35], v[164:167]
    ds_read_b64_tr_b16 a[180:181], v212 offset:40960
    v_exp_f32 v160, v160
    v_mfma_f32_16x16x32_bf16 v[168:171], a[160:163], v[64:67], v[188:191]
    v_add_f32 v200, v160, v200
    v_exp_f32 v161, v161
    v_mfma_f32_16x16x32_bf16 v[168:171], a[164:167], v[72:75], v[168:171]
    v_add_f32 v200, v161, v200
    v_cvt_pk_bf16_f32 v94, v160, v161
    v_mfma_f32_16x16x32_bf16 v[168:171], a[168:171], v[80:83], v[168:171]
    ds_read_b64_tr_b16 a[182:183], v212 offset:45056
    v_exp_f32 v162, v162
    v_mfma_f32_16x16x32_bf16 v[168:171], a[172:175], v[88:91], v[168:171]
    buffer_load_dwordx4 v238, s[56:59], s27 offen offset:1024 sc1 lds
    v_add_f32 v200, v162, v200
    v_exp_f32 v163, v163
    v_mfma_f32_16x16x32_bf16 v[172:175], a[172:175], v[120:123], v[192:195]
    v_add_f32 v200, v163, v200
    v_cvt_pk_bf16_f32 v95, v162, v163
    v_mfma_f32_16x16x32_bf16 v[172:175], a[168:171], v[112:115], v[172:175]
    v_exp_f32 v164, v164
    v_mfma_f32_16x16x32_bf16 v[172:175], a[164:167], v[104:107], v[172:175]
    v_add_f32 v201, v164, v201
    v_exp_f32 v165, v165
    v_mfma_f32_16x16x32_bf16 v[172:175], a[160:163], v[96:99], v[172:175]
    v_add_f32 v201, v165, v201
    v_cvt_pk_bf16_f32 v110, v164, v165
    v_mfma_f32_16x16x32_bf16 v[176:179], a[160:163], v[128:131], v[196:199]
    v_exp_f32 v166, v166
    v_mfma_f32_16x16x32_bf16 v[176:179], a[164:167], v[136:139], v[176:179]
    s_waitcnt vmcnt(30) lgkmcnt(0)
    v_add_f32 v201, v166, v201
    v_exp_f32 v167, v167
    v_mfma_f32_16x16x32_bf16 v[176:179], a[168:171], v[144:147], v[176:179]
    s_barrier
    v_add_f32 v201, v167, v201
    v_cvt_pk_bf16_f32 v111, v166, v167
    v_mfma_f32_16x16x32_bf16 v[176:179], a[172:175], v[152:155], v[176:179]
    buffer_load_dwordx4 v238, s[56:59], s27 offen offset:2048 sc1 lds
    v_exp_f32 v168, v168
    v_mfma_f32_16x16x32_bf16 a[12:15], a[176:179], v[4:7], a[12:15]
    ds_read_b64_tr_b16 a[160:161], v209 offset:49152
    v_add_f32 v202, v168, v202
    v_exp_f32 v169, v169
    v_mfma_f32_16x16x32_bf16 a[12:15], a[180:183], v[12:15], a[12:15]
    ds_read_b64_tr_b16 a[162:163], v209 offset:53248
    v_add_f32 v202, v169, v202
    v_cvt_pk_bf16_f32 v126, v168, v169
    v_mfma_f32_16x16x32_bf16 a[44:47], a[180:183], v[28:31], a[44:47]
    ds_read_b64_tr_b16 a[164:165], v209 offset:57344
    v_exp_f32 v170, v170
    v_mfma_f32_16x16x32_bf16 a[44:47], a[176:179], v[20:23], a[44:47]
    ds_read_b64_tr_b16 a[166:167], v209 offset:61440
    v_add_f32 v202, v170, v202
    v_exp_f32 v171, v171
    v_mfma_f32_16x16x32_bf16 a[76:79], a[176:179], v[36:39], a[76:79]
    ds_read_b64_tr_b16 a[168:169], v210 offset:49152
    v_add_f32 v202, v171, v202
    v_cvt_pk_bf16_f32 v127, v170, v171
    v_mfma_f32_16x16x32_bf16 a[76:79], a[180:183], v[44:47], a[76:79]
    ds_read_b64_tr_b16 a[170:171], v210 offset:53248
    v_exp_f32 v172, v172
    v_mfma_f32_16x16x32_bf16 a[108:111], a[180:183], v[60:63], a[108:111]
    ds_read_b64_tr_b16 a[172:173], v210 offset:57344
    v_add_f32 v203, v172, v203
    v_exp_f32 v173, v173
    v_mfma_f32_16x16x32_bf16 a[108:111], a[176:179], v[52:55], a[108:111]
    ds_read_b64_tr_b16 a[174:175], v210 offset:61440
    buffer_load_dwordx4 v238, s[56:59], s27 offen offset:3072 sc1 lds
    v_add_f32 v203, v173, v203
    v_cvt_pk_bf16_f32 v142, v172, v173
    v_mfma_f32_16x16x32_bf16 a[140:143], a[176:179], v[68:71], a[140:143]
    v_exp_f32 v174, v174
    v_mfma_f32_16x16x32_bf16 a[140:143], a[180:183], v[76:79], a[140:143]
    s_waitcnt lgkmcnt(6)
    v_add_f32 v203, v174, v203
    v_exp_f32 v175, v175
    s_mul_i32 s27, s25, 20
    v_add_f32 v203, v175, v203
    v_cvt_pk_bf16_f32 v143, v174, v175
    v_exp_f32 v176, v176
    s_mul_i32 s32, s24, 5
    v_add_f32 v204, v176, v204
    v_exp_f32 v177, v177
    s_add_u32 s27, s27, s32
    v_add_f32 v204, v177, v204
    v_cvt_pk_bf16_f32 v158, v176, v177
    v_exp_f32 v178, v178
    s_lshl_b32 s27, s27, 5
    v_add_f32 v204, v178, v204
    v_exp_f32 v179, v179
    s_add_u32 s27, s27, s26
    v_add_f32 v204, v179, v204
    v_cvt_pk_bf16_f32 v159, v178, v179
    s_lshl_b32 s27, s27, 12
    s_add_u32 s8, s50, s27
    s_addc_u32 s9, s51, 0
    s_mov_b32 s10, 528384
    s_mov_b32 s11, 0x20000
    s_and_b32 s98, s26, 3
    s_lshl_b32 s98, s98, 10
    s_mov_b32 s33, 0x58800000
    v_mfma_f32_16x16x32_bf16 a[0:3], a[160:163], v[84:87], a[0:3]
    s_waitcnt lgkmcnt(4)
    ds_read_b64_tr_b16 a[176:177], v211 offset:49152
    v_mov_b32 v239, v200
    v_mfma_f32_16x16x32_bf16 a[0:3], a[164:167], v[92:95], a[0:3]
    ds_read_b64_tr_b16 a[178:179], v211 offset:53248
    v_mov_b32 v240, v201
    v_mfma_f32_16x16x32_bf16 a[32:35], a[164:167], v[108:111], a[32:35]
    s_mov_b32 s27, 1048576
    ds_read_b64_tr_b16 a[180:181], v211 offset:57344
    buffer_load_dwordx4 v[0:3], v238, s[56:59], s27 offen sc1
    v_mfma_f32_16x16x32_bf16 a[32:35], a[160:163], v[100:103], a[32:35]
    ds_read_b64_tr_b16 a[182:183], v211 offset:61440
    v_mov_b32 v241, v202
    v_mfma_f32_16x16x32_bf16 a[64:67], a[160:163], v[116:119], a[64:67]
    v_mov_b32 v242, v203
    v_mov_b32 v243, v204
    v_mfma_f32_16x16x32_bf16 a[64:67], a[164:167], v[124:127], a[64:67]
    s_nop 0
    v_permlane16_swap_b32 v200, v239
    v_mfma_f32_16x16x32_bf16 a[96:99], a[164:167], v[140:143], a[96:99]
    v_permlane16_swap_b32 v201, v240
    v_permlane16_swap_b32 v202, v241
    v_mfma_f32_16x16x32_bf16 a[96:99], a[160:163], v[132:135], a[96:99]
    buffer_load_dwordx4 v[8:11], v238, s[56:59], s27 offen offset:1024 sc1
    v_permlane16_swap_b32 v203, v242
    v_mfma_f32_16x16x32_bf16 a[128:131], a[160:163], v[148:151], a[128:131]
    v_permlane16_swap_b32 v204, v243
    v_add_f32 v200, v200, v239
    v_mfma_f32_16x16x32_bf16 a[128:131], a[164:167], v[156:159], a[128:131]
    s_waitcnt lgkmcnt(6)
    v_mov_b32 v239, v200
    v_add_f32 v201, v201, v240
    v_mfma_f32_16x16x32_bf16 a[4:7], a[168:171], v[84:87], a[4:7]
    s_waitcnt lgkmcnt(4)
    ds_read_b64_tr_b16 a[184:185], v212 offset:49152
    v_mov_b32 v240, v201
    v_mfma_f32_16x16x32_bf16 a[4:7], a[172:175], v[92:95], a[4:7]
    ds_read_b64_tr_b16 a[186:187], v212 offset:53248
    v_add_f32 v202, v202, v241
    v_mfma_f32_16x16x32_bf16 a[36:39], a[172:175], v[108:111], a[36:39]
    ds_read_b64_tr_b16 a[188:189], v212 offset:57344
    buffer_load_dwordx4 v[16:19], v238, s[56:59], s27 offen offset:2048 sc1
    v_mfma_f32_16x16x32_bf16 a[36:39], a[168:171], v[100:103], a[36:39]
    ds_read_b64_tr_b16 a[190:191], v212 offset:61440
    v_mov_b32 v241, v202
    v_mfma_f32_16x16x32_bf16 a[68:71], a[168:171], v[116:119], a[68:71]
    v_add_f32 v203, v203, v242
    v_mov_b32 v242, v203
    v_mfma_f32_16x16x32_bf16 a[68:71], a[172:175], v[124:127], a[68:71]
    v_add_f32 v204, v204, v243
    v_mov_b32 v243, v204
    v_mfma_f32_16x16x32_bf16 a[100:103], a[172:175], v[140:143], a[100:103]
    s_nop 0
    v_permlane32_swap_b32 v200, v239
    v_mfma_f32_16x16x32_bf16 a[100:103], a[168:171], v[132:135], a[100:103]
    buffer_load_dwordx4 v[24:27], v238, s[56:59], s27 offen offset:3072 sc1
    v_permlane32_swap_b32 v201, v240
    v_mfma_f32_16x16x32_bf16 a[132:135], a[168:171], v[148:151], a[132:135]
    v_permlane32_swap_b32 v202, v241
    v_permlane32_swap_b32 v203, v242
    v_mfma_f32_16x16x32_bf16 a[132:135], a[172:175], v[156:159], a[132:135]
    s_waitcnt lgkmcnt(6)
    v_permlane32_swap_b32 v204, v243
    v_add_f32 v200, v200, v239
    v_mfma_f32_16x16x32_bf16 a[8:11], a[176:179], v[84:87], a[8:11]
    s_waitcnt lgkmcnt(4)
    ds_read_b64_tr_b16 a[160:161], v213 offset:32768
    v_add_f32 v201, v201, v240
    v_mfma_f32_16x16x32_bf16 a[8:11], a[180:183], v[92:95], a[8:11]
    ds_read_b64_tr_b16 a[162:163], v213 offset:36864
    v_add_f32 v202, v202, v241
    v_mfma_f32_16x16x32_bf16 a[40:43], a[180:183], v[108:111], a[40:43]
    s_mov_b32 s27, 1310720
    ds_read_b64_tr_b16 a[164:165], v213 offset:40960
    buffer_load_dwordx4 v[32:35], v238, s[56:59], s27 offen sc1
    v_mfma_f32_16x16x32_bf16 a[40:43], a[176:179], v[100:103], a[40:43]
    ds_read_b64_tr_b16 a[166:167], v213 offset:45056
    v_add_f32 v203, v203, v242
    v_mfma_f32_16x16x32_bf16 a[72:75], a[176:179], v[116:119], a[72:75]
    v_add_f32 v204, v204, v243
    v_cmp_nlt_f32 s[86:87], v200, s33
    v_mfma_f32_16x16x32_bf16 a[72:75], a[180:183], v[124:127], a[72:75]
    v_cmp_nlt_f32 s[88:89], v201, s33
    v_cmp_nlt_f32 s[90:91], v202, s33
    v_mfma_f32_16x16x32_bf16 a[104:107], a[180:183], v[140:143], a[104:107]
    v_cmp_nlt_f32 s[92:93], v203, s33
    v_cmp_nlt_f32 s[94:95], v204, s33
    v_mfma_f32_16x16x32_bf16 a[104:107], a[176:179], v[132:135], a[104:107]
    buffer_load_dwordx4 v[40:43], v238, s[56:59], s27 offen offset:1024 sc1
    v_rcp_f32 v200, v200
    v_mfma_f32_16x16x32_bf16 a[136:139], a[176:179], v[148:151], a[136:139]
    v_rcp_f32 v201, v201
    v_mfma_f32_16x16x32_bf16 a[136:139], a[180:183], v[156:159], a[136:139]
    s_waitcnt lgkmcnt(6)
    v_rcp_f32 v202, v202
    v_mfma_f32_16x16x32_bf16 a[12:15], a[184:187], v[84:87], a[12:15]
    s_waitcnt lgkmcnt(4)
    ds_read_b64_tr_b16 a[168:169], v214 offset:32768
    v_rcp_f32 v203, v203
    v_mfma_f32_16x16x32_bf16 a[12:15], a[188:191], v[92:95], a[12:15]
    ds_read_b64_tr_b16 a[170:171], v214 offset:36864
    v_rcp_f32 v204, v204
    v_mfma_f32_16x16x32_bf16 a[44:47], a[188:191], v[108:111], a[44:47]
    ds_read_b64_tr_b16 a[172:173], v214 offset:40960
    buffer_load_dwordx4 v[48:51], v238, s[56:59], s27 offen offset:2048 sc1
    v_mfma_f32_16x16x32_bf16 a[44:47], a[184:187], v[100:103], a[44:47]
    ds_read_b64_tr_b16 a[174:175], v214 offset:45056
    s_or_b64 s[86:87], s[86:87], s[88:89]
    s_or_b64 s[86:87], s[86:87], s[90:91]
    s_or_b64 s[86:87], s[86:87], s[92:93]
    s_or_b64 s[86:87], s[86:87], s[94:95]
    s_or_b32 s86, s86, s87
    v_and_b32 v245, 3, v237
    v_mfma_f32_16x16x32_bf16 a[76:79], a[184:187], v[116:119], a[76:79]
    v_lshlrev_b32 v245, 12, v245
    v_lshl_add_u32 v245, s24, 2, v245
    v_mfma_f32_16x16x32_bf16 a[76:79], a[188:191], v[124:127], a[76:79]
    v_add_u32 v245, 0x10000, v245
    v_mov_b32 v228, 0
    v_mfma_f32_16x16x32_bf16 a[108:111], a[188:191], v[140:143], a[108:111]
    v_mov_b32 v229, 0
    v_mov_b32 v230, 0
    v_mfma_f32_16x16x32_bf16 a[108:111], a[184:187], v[132:135], a[108:111]
    buffer_load_dwordx4 v[56:59], v238, s[56:59], s27 offen offset:3072 sc1
    v_mov_b32 v231, 0
    v_mfma_f32_16x16x32_bf16 a[140:143], a[184:187], v[148:151], a[140:143]
    v_mov_b32 v232, 0
    v_mov_b32 v233, 0
    v_mfma_f32_16x16x32_bf16 a[140:143], a[188:191], v[156:159], a[140:143]
    s_waitcnt lgkmcnt(6)
    v_mov_b32 v234, 0
    v_mov_b32 v235, 0
    v_mfma_f32_16x16x32_bf16 a[16:19], a[160:163], v[4:7], a[16:19]
    s_waitcnt lgkmcnt(4)
    ds_read_b64_tr_b16 a[176:177], v215 offset:32768
    v_add_u32 v223, s34, v238
    v_mfma_f32_16x16x32_bf16 a[16:19], a[164:167], v[12:15], a[16:19]
    ds_read_b64_tr_b16 a[178:179], v215 offset:36864
    v_add_u32 v224, 0x10000, v223
    v_mfma_f32_16x16x32_bf16 a[48:51], a[164:167], v[28:31], a[48:51]
    s_mov_b32 s27, 1572864
    ds_read_b64_tr_b16 a[180:181], v215 offset:40960
    buffer_load_dwordx4 v[64:67], v238, s[56:59], s27 offen sc1
    v_mfma_f32_16x16x32_bf16 a[48:51], a[160:163], v[20:23], a[48:51]
    ds_read_b64_tr_b16 a[182:183], v215 offset:45056
    v_add_u32 v225, 0x20000, v223
    v_mfma_f32_16x16x32_bf16 a[80:83], a[160:163], v[36:39], a[80:83]
    v_accvgpr_read_b32 v160, a0
    v_accvgpr_read_b32 v161, a1
    v_mfma_f32_16x16x32_bf16 a[80:83], a[164:167], v[44:47], a[80:83]
    v_accvgpr_read_b32 v162, a2
    v_accvgpr_read_b32 v163, a3
    v_mfma_f32_16x16x32_bf16 a[112:115], a[164:167], v[60:63], a[112:115]
    v_accvgpr_read_b32 v164, a4
    v_accvgpr_read_b32 v165, a5
    v_mfma_f32_16x16x32_bf16 a[112:115], a[160:163], v[52:55], a[112:115]
    buffer_load_dwordx4 v[72:75], v238, s[56:59], s27 offen offset:1024 sc1
    v_accvgpr_read_b32 v166, a6
    v_mfma_f32_16x16x32_bf16 a[144:147], a[160:163], v[68:71], a[144:147]
    v_accvgpr_read_b32 v167, a7
    v_mul_f32 v160, v160, v200
    v_mfma_f32_16x16x32_bf16 a[144:147], a[164:167], v[76:79], a[144:147]
    s_waitcnt lgkmcnt(6)
    v_mul_f32 v161, v161, v200
    v_mul_f32 v162, v162, v200
    v_mfma_f32_16x16x32_bf16 a[20:23], a[168:171], v[4:7], a[20:23]
    s_waitcnt lgkmcnt(4)
    ds_read_b64_tr_b16 a[184:185], v216 offset:32768
    v_mul_f32 v163, v163, v200
    v_mfma_f32_16x16x32_bf16 a[20:23], a[172:175], v[12:15], a[20:23]
    ds_read_b64_tr_b16 a[186:187], v216 offset:36864
    v_mul_f32 v164, v164, v200
    v_mfma_f32_16x16x32_bf16 a[52:55], a[172:175], v[28:31], a[52:55]
    ds_read_b64_tr_b16 a[188:189], v216 offset:40960
    buffer_load_dwordx4 v[80:83], v238, s[56:59], s27 offen offset:2048 sc1
    v_mfma_f32_16x16x32_bf16 a[52:55], a[168:171], v[20:23], a[52:55]
    ds_read_b64_tr_b16 a[190:191], v216 offset:45056
    v_mul_f32 v165, v165, v200
    v_mfma_f32_16x16x32_bf16 a[84:87], a[168:171], v[36:39], a[84:87]
    v_mul_f32 v166, v166, v200
    v_mul_f32 v167, v167, v200
    v_mfma_f32_16x16x32_bf16 a[84:87], a[172:175], v[44:47], a[84:87]
    v_cvt_pk_bf16_f32 v160, v160, v161
    v_cvt_pk_bf16_f32 v161, v162, v163
    v_mfma_f32_16x16x32_bf16 a[116:119], a[172:175], v[60:63], a[116:119]
    v_cvt_pk_bf16_f32 v162, v164, v165
    v_cvt_pk_bf16_f32 v163, v166, v167
    v_mfma_f32_16x16x32_bf16 a[116:119], a[168:171], v[52:55], a[116:119]
    buffer_load_dwordx4 v[88:91], v238, s[56:59], s27 offen offset:3072 sc1
    s_xor_b32 s29, s98, 0
    buffer_store_dwordx4 v[160:163], v238, s[8:11], s29 offen sc0 sc1
    v_mfma_f32_16x16x32_bf16 a[148:151], a[168:171], v[68:71], a[148:151]
    v_mfma_f32_16x16x32_bf16 v[232:235], v[228:231], v[160:163], v[232:235]
    v_accvgpr_read_b32 v168, a32
    v_mfma_f32_16x16x32_bf16 a[148:151], a[172:175], v[76:79], a[148:151]
    s_waitcnt lgkmcnt(6)
    v_accvgpr_read_b32 v169, a33
    v_accvgpr_read_b32 v170, a34
    v_mfma_f32_16x16x32_bf16 a[24:27], a[176:179], v[4:7], a[24:27]
    s_waitcnt lgkmcnt(4)
    ds_read_b64_tr_b16 a[160:161], v213 offset:49152
    v_accvgpr_read_b32 v171, a35
    v_mfma_f32_16x16x32_bf16 a[24:27], a[180:183], v[12:15], a[24:27]
    ds_read_b64_tr_b16 a[162:163], v213 offset:53248
    v_accvgpr_read_b32 v172, a36
    v_mfma_f32_16x16x32_bf16 a[56:59], a[180:183], v[28:31], a[56:59]
    s_mov_b32 s27, 1835008
    ds_read_b64_tr_b16 a[164:165], v213 offset:57344
    buffer_load_dwordx4 v[96:99], v238, s[56:59], s27 offen sc1
    v_mfma_f32_16x16x32_bf16 a[56:59], a[176:179], v[20:23], a[56:59]
    ds_read_b64_tr_b16 a[166:167], v213 offset:61440
    v_accvgpr_read_b32 v173, a37
    v_mfma_f32_16x16x32_bf16 a[88:91], a[176:179], v[36:39], a[88:91]
    v_accvgpr_read_b32 v174, a38
    v_accvgpr_read_b32 v175, a39
    v_mfma_f32_16x16x32_bf16 a[88:91], a[180:183], v[44:47], a[88:91]
    v_mul_f32 v168, v168, v201
    v_mul_f32 v169, v169, v201
    v_mfma_f32_16x16x32_bf16 a[120:123], a[180:183], v[60:63], a[120:123]
    v_mul_f32 v170, v170, v201
    v_mul_f32 v171, v171, v201
    v_mfma_f32_16x16x32_bf16 a[120:123], a[176:179], v[52:55], a[120:123]
    buffer_load_dwordx4 v[104:107], v238, s[56:59], s27 offen offset:1024 sc1
    v_mul_f32 v172, v172, v201
    v_mfma_f32_16x16x32_bf16 a[152:155], a[176:179], v[68:71], a[152:155]
    v_mul_f32 v173, v173, v201
    v_mul_f32 v174, v174, v201
    v_mfma_f32_16x16x32_bf16 a[152:155], a[180:183], v[76:79], a[152:155]
    s_waitcnt lgkmcnt(6)
    v_mul_f32 v175, v175, v201
    v_cvt_pk_bf16_f32 v168, v168, v169
    v_mfma_f32_16x16x32_bf16 a[28:31], a[184:187], v[4:7], a[28:31]
    s_waitcnt lgkmcnt(4)
    ds_read_b64_tr_b16 a[168:169], v214 offset:49152
    v_cvt_pk_bf16_f32 v169, v170, v171
    v_mfma_f32_16x16x32_bf16 a[28:31], a[188:191], v[12:15], a[28:31]
    ds_read_b64_tr_b16 a[170:171], v214 offset:53248
    v_cvt_pk_bf16_f32 v170, v172, v173
    v_mfma_f32_16x16x32_bf16 a[60:63], a[188:191], v[28:31], a[60:63]
    ds_read_b64_tr_b16 a[172:173], v214 offset:57344
    buffer_load_dwordx4 v[112:115], v238, s[56:59], s27 offen offset:2048 sc1
    v_mfma_f32_16x16x32_bf16 a[60:63], a[184:187], v[20:23], a[60:63]
    ds_read_b64_tr_b16 a[174:175], v214 offset:61440
    v_cvt_pk_bf16_f32 v171, v174, v175
    v_mfma_f32_16x16x32_bf16 a[92:95], a[184:187], v[36:39], a[92:95]
    s_xor_b32 s29, s98, 131072
    buffer_store_dwordx4 v[168:171], v238, s[8:11], s29 offen sc0 sc1
    v_mfma_f32_16x16x32_bf16 a[92:95], a[188:191], v[44:47], a[92:95]
    v_mfma_f32_16x16x32_bf16 v[232:235], v[228:231], v[168:171], v[232:235]
    v_accvgpr_read_b32 v176, a64
    v_mfma_f32_16x16x32_bf16 a[124:127], a[188:191], v[60:63], a[124:127]
    v_accvgpr_read_b32 v177, a65
    v_accvgpr_read_b32 v178, a66
    v_mfma_f32_16x16x32_bf16 a[124:127], a[184:187], v[52:55], a[124:127]
    v_accvgpr_read_b32 v179, a67
    v_accvgpr_read_b32 v180, a68
    v_mfma_f32_16x16x32_bf16 a[156:159], a[184:187], v[68:71], a[156:159]
    buffer_load_dwordx4 v[120:123], v238, s[56:59], s27 offen offset:3072 sc1
    v_accvgpr_read_b32 v181, a69
    v_mfma_f32_16x16x32_bf16 a[156:159], a[188:191], v[76:79], a[156:159]
    s_waitcnt lgkmcnt(6)
    v_accvgpr_read_b32 v182, a70
    v_accvgpr_read_b32 v183, a71
    v_mfma_f32_16x16x32_bf16 a[16:19], a[160:163], v[84:87], a[16:19]
    s_waitcnt lgkmcnt(4)
    ds_read_b64_tr_b16 a[176:177], v215 offset:49152
    v_mul_f32 v176, v176, v202
    v_mfma_f32_16x16x32_bf16 a[16:19], a[164:167], v[92:95], a[16:19]
    ds_read_b64_tr_b16 a[178:179], v215 offset:53248
    v_mul_f32 v177, v177, v202
    v_mfma_f32_16x16x32_bf16 a[48:51], a[164:167], v[108:111], a[48:51]
    ds_read_b64_tr_b16 a[180:181], v215 offset:57344
    v_mul_f32 v178, v178, v202
    v_mfma_f32_16x16x32_bf16 a[48:51], a[160:163], v[100:103], a[48:51]
    ds_read_b64_tr_b16 a[182:183], v215 offset:61440
    v_mul_f32 v179, v179, v202
    v_mfma_f32_16x16x32_bf16 a[80:83], a[160:163], v[116:119], a[80:83]
    v_mul_f32 v180, v180, v202
    v_mul_f32 v181, v181, v202
    v_mfma_f32_16x16x32_bf16 a[80:83], a[164:167], v[124:127], a[80:83]
    v_mul_f32 v182, v182, v202
    v_mul_f32 v183, v183, v202
    v_mfma_f32_16x16x32_bf16 a[112:115], a[164:167], v[140:143], a[112:115]
    v_cvt_pk_bf16_f32 v176, v176, v177
    v_cvt_pk_bf16_f32 v177, v178, v179
    v_mfma_f32_16x16x32_bf16 a[112:115], a[160:163], v[132:135], a[112:115]
    v_cvt_pk_bf16_f32 v178, v180, v181
    v_cvt_pk_bf16_f32 v179, v182, v183
    v_mfma_f32_16x16x32_bf16 a[144:147], a[160:163], v[148:151], a[144:147]
    s_xor_b32 s29, s98, 262144
    buffer_store_dwordx4 v[176:179], v238, s[8:11], s29 offen sc0 sc1
    v_mfma_f32_16x16x32_bf16 a[144:147], a[164:167], v[156:159], a[144:147]
    v_mfma_f32_16x16x32_bf16 v[232:235], v[228:231], v[176:179], v[232:235]
    s_waitcnt lgkmcnt(6)
    v_accvgpr_read_b32 v184, a96
    v_mfma_f32_16x16x32_bf16 a[20:23], a[168:171], v[84:87], a[20:23]
    s_waitcnt lgkmcnt(4)
    ds_read_b64_tr_b16 a[184:185], v216 offset:49152
    v_accvgpr_read_b32 v185, a97
    v_mfma_f32_16x16x32_bf16 a[20:23], a[172:175], v[92:95], a[20:23]
    ds_read_b64_tr_b16 a[186:187], v216 offset:53248
    v_accvgpr_read_b32 v186, a98
    v_mfma_f32_16x16x32_bf16 a[52:55], a[172:175], v[108:111], a[52:55]
    ds_read_b64_tr_b16 a[188:189], v216 offset:57344
    v_accvgpr_read_b32 v187, a99
    v_mfma_f32_16x16x32_bf16 a[52:55], a[168:171], v[100:103], a[52:55]
    ds_read_b64_tr_b16 a[190:191], v216 offset:61440
    v_accvgpr_read_b32 v188, a100
    v_mfma_f32_16x16x32_bf16 a[84:87], a[168:171], v[116:119], a[84:87]
    v_accvgpr_read_b32 v189, a101
    v_accvgpr_read_b32 v190, a102
    v_mfma_f32_16x16x32_bf16 a[84:87], a[172:175], v[124:127], a[84:87]
    v_accvgpr_read_b32 v191, a103
    v_mul_f32 v184, v184, v203
    v_mfma_f32_16x16x32_bf16 a[116:119], a[172:175], v[140:143], a[116:119]
    v_mul_f32 v185, v185, v203
    v_mul_f32 v186, v186, v203
    v_mfma_f32_16x16x32_bf16 a[116:119], a[168:171], v[132:135], a[116:119]
    v_mul_f32 v187, v187, v203
    v_mul_f32 v188, v188, v203
    v_mfma_f32_16x16x32_bf16 a[148:151], a[168:171], v[148:151], a[148:151]
    v_mul_f32 v189, v189, v203
    v_mul_f32 v190, v190, v203
    v_mfma_f32_16x16x32_bf16 a[148:151], a[172:175], v[156:159], a[148:151]
    s_waitcnt lgkmcnt(6)
    v_mul_f32 v191, v191, v203
    v_cvt_pk_bf16_f32 v184, v184, v185
    v_mfma_f32_16x16x32_bf16 a[24:27], a[176:179], v[84:87], a[24:27]
    s_waitcnt lgkmcnt(4)
    v_cvt_pk_bf16_f32 v185, v186, v187
    v_cvt_pk_bf16_f32 v186, v188, v189
    v_mfma_f32_16x16x32_bf16 a[24:27], a[180:183], v[92:95], a[24:27]
    v_cvt_pk_bf16_f32 v187, v190, v191
    s_xor_b32 s29, s98, 393216
    buffer_store_dwordx4 v[184:187], v238, s[8:11], s29 offen sc0 sc1
    v_mfma_f32_16x16x32_bf16 a[56:59], a[180:183], v[108:111], a[56:59]
    v_mfma_f32_16x16x32_bf16 v[232:235], v[228:231], v[184:187], v[232:235]
    v_accvgpr_read_b32 v192, a128
    v_mfma_f32_16x16x32_bf16 a[56:59], a[176:179], v[100:103], a[56:59]
    v_accvgpr_read_b32 v193, a129
    v_accvgpr_read_b32 v194, a130
    v_mfma_f32_16x16x32_bf16 a[88:91], a[176:179], v[116:119], a[88:91]
    v_accvgpr_read_b32 v195, a131
    v_accvgpr_read_b32 v196, a132
    v_mfma_f32_16x16x32_bf16 a[88:91], a[180:183], v[124:127], a[88:91]
    v_accvgpr_read_b32 v197, a133
    v_accvgpr_read_b32 v198, a134
    v_mfma_f32_16x16x32_bf16 a[120:123], a[180:183], v[140:143], a[120:123]
    v_accvgpr_read_b32 v199, a135
    v_mul_f32 v192, v192, v204
    v_mfma_f32_16x16x32_bf16 a[120:123], a[176:179], v[132:135], a[120:123]
    v_mul_f32 v193, v193, v204
    v_mul_f32 v194, v194, v204
    v_mfma_f32_16x16x32_bf16 a[152:155], a[176:179], v[148:151], a[152:155]
    v_mul_f32 v195, v195, v204
    v_mul_f32 v196, v196, v204
    v_mfma_f32_16x16x32_bf16 a[152:155], a[180:183], v[156:159], a[152:155]
    s_waitcnt lgkmcnt(2)
    v_mul_f32 v197, v197, v204
    v_mul_f32 v198, v198, v204
    v_mfma_f32_16x16x32_bf16 a[28:31], a[184:187], v[84:87], a[28:31]
    s_waitcnt lgkmcnt(0)
    v_mul_f32 v199, v199, v204
    v_cvt_pk_bf16_f32 v192, v192, v193
    v_mfma_f32_16x16x32_bf16 a[28:31], a[188:191], v[92:95], a[28:31]
    v_cvt_pk_bf16_f32 v193, v194, v195
    v_cvt_pk_bf16_f32 v194, v196, v197
    v_mfma_f32_16x16x32_bf16 a[60:63], a[188:191], v[108:111], a[60:63]
    v_cvt_pk_bf16_f32 v195, v198, v199
    s_xor_b32 s29, s98, 524288
    buffer_store_dwordx4 v[192:195], v238, s[8:11], s29 offen sc0 sc1
    v_mfma_f32_16x16x32_bf16 a[60:63], a[184:187], v[100:103], a[60:63]
    v_mfma_f32_16x16x32_bf16 v[232:235], v[228:231], v[192:195], v[232:235]
    v_accvgpr_read_b32 v160, a8
    v_mfma_f32_16x16x32_bf16 a[92:95], a[184:187], v[116:119], a[92:95]
    v_accvgpr_read_b32 v161, a9
    v_accvgpr_read_b32 v162, a10
    v_mfma_f32_16x16x32_bf16 a[92:95], a[188:191], v[124:127], a[92:95]
    v_accvgpr_read_b32 v163, a11
    v_accvgpr_read_b32 v164, a12
    v_mfma_f32_16x16x32_bf16 a[124:127], a[188:191], v[140:143], a[124:127]
    v_accvgpr_read_b32 v165, a13
    v_accvgpr_read_b32 v166, a14
    v_mfma_f32_16x16x32_bf16 a[124:127], a[184:187], v[132:135], a[124:127]
    v_accvgpr_read_b32 v167, a15
    v_mul_f32 v160, v160, v200
    v_mfma_f32_16x16x32_bf16 a[156:159], a[184:187], v[148:151], a[156:159]
    v_mul_f32 v161, v161, v200
    v_mul_f32 v162, v162, v200
    v_mfma_f32_16x16x32_bf16 a[156:159], a[188:191], v[156:159], a[156:159]
    v_mul_f32 v163, v163, v200
    v_mul_f32 v164, v164, v200
    v_mul_f32 v165, v165, v200
    v_mul_f32 v166, v166, v200
    v_mul_f32 v167, v167, v200
    v_cvt_pk_bf16_f32 v160, v160, v161
    v_cvt_pk_bf16_f32 v161, v162, v163
    v_cvt_pk_bf16_f32 v162, v164, v165
    v_cvt_pk_bf16_f32 v163, v166, v167
    s_xor_b32 s29, s98, 1024
    buffer_store_dwordx4 v[160:163], v238, s[8:11], s29 offen sc0 sc1
    v_mfma_f32_16x16x32_bf16 v[232:235], v[228:231], v[160:163], v[232:235]
    v_accvgpr_read_b32 v168, a40
    v_accvgpr_read_b32 v169, a41
    v_accvgpr_read_b32 v170, a42
    v_accvgpr_read_b32 v171, a43
    v_accvgpr_read_b32 v172, a44
    v_accvgpr_read_b32 v173, a45
    v_accvgpr_read_b32 v174, a46
    v_accvgpr_read_b32 v175, a47
    v_mul_f32 v168, v168, v201
    v_mul_f32 v169, v169, v201
    v_mul_f32 v170, v170, v201
    v_mul_f32 v171, v171, v201
    v_mul_f32 v172, v172, v201
    v_mul_f32 v173, v173, v201
    v_mul_f32 v174, v174, v201
    v_mul_f32 v175, v175, v201
    v_cvt_pk_bf16_f32 v168, v168, v169
    v_cvt_pk_bf16_f32 v169, v170, v171
    v_cvt_pk_bf16_f32 v170, v172, v173
    v_cvt_pk_bf16_f32 v171, v174, v175
    s_xor_b32 s29, s98, 132096
    buffer_store_dwordx4 v[168:171], v238, s[8:11], s29 offen sc0 sc1
    v_mfma_f32_16x16x32_bf16 v[232:235], v[228:231], v[168:171], v[232:235]
    v_accvgpr_read_b32 v176, a72
    v_accvgpr_read_b32 v177, a73
    v_accvgpr_read_b32 v178, a74
    v_accvgpr_read_b32 v179, a75
    v_accvgpr_read_b32 v180, a76
    v_accvgpr_read_b32 v181, a77
    v_accvgpr_read_b32 v182, a78
    v_accvgpr_read_b32 v183, a79
    v_mul_f32 v176, v176, v202
    v_mul_f32 v177, v177, v202
    v_mul_f32 v178, v178, v202
    v_mul_f32 v179, v179, v202
    v_mul_f32 v180, v180, v202
    v_mul_f32 v181, v181, v202
    v_mul_f32 v182, v182, v202
    v_mul_f32 v183, v183, v202
    v_cvt_pk_bf16_f32 v176, v176, v177
    v_cvt_pk_bf16_f32 v177, v178, v179
    v_cvt_pk_bf16_f32 v178, v180, v181
    v_cvt_pk_bf16_f32 v179, v182, v183
    s_xor_b32 s29, s98, 263168
    buffer_store_dwordx4 v[176:179], v238, s[8:11], s29 offen sc0 sc1
    v_mfma_f32_16x16x32_bf16 v[232:235], v[228:231], v[176:179], v[232:235]
    v_accvgpr_read_b32 v184, a104
    v_accvgpr_read_b32 v185, a105
    v_accvgpr_read_b32 v186, a106
    v_accvgpr_read_b32 v187, a107
    v_accvgpr_read_b32 v188, a108
    v_accvgpr_read_b32 v189, a109
    v_accvgpr_read_b32 v190, a110
    v_accvgpr_read_b32 v191, a111
    v_mul_f32 v184, v184, v203
    v_mul_f32 v185, v185, v203
    v_mul_f32 v186, v186, v203
    v_mul_f32 v187, v187, v203
    v_mul_f32 v188, v188, v203
    v_mul_f32 v189, v189, v203
    v_mul_f32 v190, v190, v203
    v_mul_f32 v191, v191, v203
    v_cvt_pk_bf16_f32 v184, v184, v185
    v_cvt_pk_bf16_f32 v185, v186, v187
    v_cvt_pk_bf16_f32 v186, v188, v189
    v_cvt_pk_bf16_f32 v187, v190, v191
    s_xor_b32 s29, s98, 394240
    buffer_store_dwordx4 v[184:187], v238, s[8:11], s29 offen sc0 sc1
    v_mfma_f32_16x16x32_bf16 v[232:235], v[228:231], v[184:187], v[232:235]
    v_accvgpr_read_b32 v192, a136
    v_accvgpr_read_b32 v193, a137
    v_accvgpr_read_b32 v194, a138
    v_accvgpr_read_b32 v195, a139
    v_accvgpr_read_b32 v196, a140
    v_accvgpr_read_b32 v197, a141
    v_accvgpr_read_b32 v198, a142
    v_accvgpr_read_b32 v199, a143
    v_mul_f32 v192, v192, v204
    v_mul_f32 v193, v193, v204
    v_mul_f32 v194, v194, v204
    v_mul_f32 v195, v195, v204
    v_mul_f32 v196, v196, v204
    v_mul_f32 v197, v197, v204
    v_mul_f32 v198, v198, v204
    v_mul_f32 v199, v199, v204
    v_cvt_pk_bf16_f32 v192, v192, v193
    v_cvt_pk_bf16_f32 v193, v194, v195
    v_cvt_pk_bf16_f32 v194, v196, v197
    v_cvt_pk_bf16_f32 v195, v198, v199
    s_xor_b32 s29, s98, 525312
    buffer_store_dwordx4 v[192:195], v238, s[8:11], s29 offen sc0 sc1
    v_mfma_f32_16x16x32_bf16 v[232:235], v[228:231], v[192:195], v[232:235]
    s_barrier
    s_nop 7
    v_accvgpr_read_b32 v160, a16
    v_accvgpr_read_b32 v161, a17
    v_accvgpr_read_b32 v162, a18
    v_accvgpr_read_b32 v163, a19
    v_accvgpr_read_b32 v164, a20
    v_accvgpr_read_b32 v165, a21
    v_accvgpr_read_b32 v166, a22
    v_accvgpr_read_b32 v167, a23
    v_mul_f32 v160, v160, v200
    v_mul_f32 v161, v161, v200
    v_mul_f32 v162, v162, v200
    v_mul_f32 v163, v163, v200
    v_mul_f32 v164, v164, v200
    v_mul_f32 v165, v165, v200
    v_mul_f32 v166, v166, v200
    v_mul_f32 v167, v167, v200
    v_cvt_pk_bf16_f32 v128, v160, v161
    v_cvt_pk_bf16_f32 v129, v162, v163
    v_cvt_pk_bf16_f32 v130, v164, v165
    v_cvt_pk_bf16_f32 v131, v166, v167
    v_accvgpr_read_b32 v168, a48
    v_accvgpr_read_b32 v169, a49
    v_mfma_f32_16x16x32_bf16 v[232:235], v[228:231], v[128:131], v[232:235]
    v_accvgpr_read_b32 v170, a50
    v_accvgpr_read_b32 v171, a51
    v_accvgpr_read_b32 v172, a52
    v_accvgpr_read_b32 v173, a53
    v_accvgpr_read_b32 v174, a54
    v_accvgpr_read_b32 v175, a55
    v_mul_f32 v168, v168, v201
    v_mul_f32 v169, v169, v201
    v_mul_f32 v170, v170, v201
    v_mul_f32 v171, v171, v201
    v_mul_f32 v172, v172, v201
    v_mul_f32 v173, v173, v201
    v_mul_f32 v174, v174, v201
    v_mul_f32 v175, v175, v201
    v_cvt_pk_bf16_f32 v136, v168, v169
    v_cvt_pk_bf16_f32 v137, v170, v171
    v_cvt_pk_bf16_f32 v138, v172, v173
    v_cvt_pk_bf16_f32 v139, v174, v175
    v_accvgpr_read_b32 v176, a80
    v_accvgpr_read_b32 v177, a81
    v_mfma_f32_16x16x32_bf16 v[232:235], v[228:231], v[136:139], v[232:235]
    v_accvgpr_read_b32 v178, a82
    v_accvgpr_read_b32 v179, a83
    v_accvgpr_read_b32 v180, a84
    v_accvgpr_read_b32 v181, a85
    v_accvgpr_read_b32 v182, a86
    v_accvgpr_read_b32 v183, a87
    v_mul_f32 v176, v176, v202
    v_mul_f32 v177, v177, v202
    v_mul_f32 v178, v178, v202
    v_mul_f32 v179, v179, v202
    v_mul_f32 v180, v180, v202
    v_mul_f32 v181, v181, v202
    v_mul_f32 v182, v182, v202
    v_mul_f32 v183, v183, v202
    v_cvt_pk_bf16_f32 v144, v176, v177
    v_cvt_pk_bf16_f32 v145, v178, v179
    v_cvt_pk_bf16_f32 v146, v180, v181
    v_cvt_pk_bf16_f32 v147, v182, v183
    v_accvgpr_read_b32 v184, a112
    v_accvgpr_read_b32 v185, a113
    v_mfma_f32_16x16x32_bf16 v[232:235], v[228:231], v[144:147], v[232:235]
    v_accvgpr_read_b32 v186, a114
    v_accvgpr_read_b32 v187, a115
    v_accvgpr_read_b32 v188, a116
    v_accvgpr_read_b32 v189, a117
    v_accvgpr_read_b32 v190, a118
    v_accvgpr_read_b32 v191, a119
    v_mul_f32 v184, v184, v203
    v_mul_f32 v185, v185, v203
    v_mul_f32 v186, v186, v203
    v_mul_f32 v187, v187, v203
    v_mul_f32 v188, v188, v203
    v_mul_f32 v189, v189, v203
    v_mul_f32 v190, v190, v203
    v_mul_f32 v191, v191, v203
    v_cvt_pk_bf16_f32 v152, v184, v185
    v_cvt_pk_bf16_f32 v153, v186, v187
    v_cvt_pk_bf16_f32 v154, v188, v189
    v_cvt_pk_bf16_f32 v155, v190, v191
    v_accvgpr_read_b32 v192, a144
    v_accvgpr_read_b32 v193, a145
    v_mfma_f32_16x16x32_bf16 v[232:235], v[228:231], v[152:155], v[232:235]
    v_accvgpr_read_b32 v194, a146
    v_accvgpr_read_b32 v195, a147
    v_accvgpr_read_b32 v196, a148
    v_accvgpr_read_b32 v197, a149
    v_accvgpr_read_b32 v198, a150
    v_accvgpr_read_b32 v199, a151
    v_mul_f32 v192, v192, v204
    v_mul_f32 v193, v193, v204
    v_mul_f32 v194, v194, v204
    v_mul_f32 v195, v195, v204
    v_mul_f32 v196, v196, v204
    v_mul_f32 v197, v197, v204
    v_mul_f32 v198, v198, v204
    v_mul_f32 v199, v199, v204
    v_cvt_pk_bf16_f32 v208, v192, v193
    v_cvt_pk_bf16_f32 v209, v194, v195
    v_cvt_pk_bf16_f32 v210, v196, v197
    v_cvt_pk_bf16_f32 v211, v198, v199
    v_accvgpr_read_b32 v160, a24
    v_accvgpr_read_b32 v161, a25
    v_mfma_f32_16x16x32_bf16 v[232:235], v[228:231], v[208:211], v[232:235]
    v_accvgpr_read_b32 v162, a26
    v_accvgpr_read_b32 v163, a27
    v_accvgpr_read_b32 v164, a28
    v_accvgpr_read_b32 v165, a29
    v_accvgpr_read_b32 v166, a30
    v_accvgpr_read_b32 v167, a31
    v_mul_f32 v160, v160, v200
    v_mul_f32 v161, v161, v200
    v_mul_f32 v162, v162, v200
    v_mul_f32 v163, v163, v200
    v_mul_f32 v164, v164, v200
    v_mul_f32 v165, v165, v200
    v_mul_f32 v166, v166, v200
    v_mul_f32 v167, v167, v200
    v_cvt_pk_bf16_f32 v132, v160, v161
    v_cvt_pk_bf16_f32 v133, v162, v163
    v_cvt_pk_bf16_f32 v134, v164, v165
    v_cvt_pk_bf16_f32 v135, v166, v167
    v_cmp_u_f32 vcc, v232, v232
    v_mov_b32 v254, 1
    s_or_b32 s86, s86, vcc_lo
    s_or_b32 s86, s86, vcc_hi
    s_cmp_eq_u32 s86, 0
    s_cselect_b32 s32, s53, 0x7ff00000
    s_waitcnt vmcnt(0)
    buffer_store_dword v254, v253, s[60:63], s32 offen sc0 sc1
    s_xor_b32 s29, s98, 2048
    buffer_store_dwordx4 v[128:131], v238, s[8:11], s29 offen sc0 sc1
    s_xor_b32 s29, s98, 133120
    buffer_store_dwordx4 v[136:139], v238, s[8:11], s29 offen sc0 sc1
    s_xor_b32 s29, s98, 264192
    buffer_store_dwordx4 v[144:147], v238, s[8:11], s29 offen sc0 sc1
    s_xor_b32 s29, s98, 395264
    buffer_store_dwordx4 v[152:155], v238, s[8:11], s29 offen sc0 sc1
    s_xor_b32 s29, s98, 526336
    buffer_store_dwordx4 v[208:211], v238, s[8:11], s29 offen sc0 sc1
    s_xor_b32 s29, s98, 3072
    buffer_store_dwordx4 v[132:135], v238, s[8:11], s29 offen sc0 sc1
    v_accvgpr_read_b32 v168, a56
    v_accvgpr_read_b32 v169, a57
    v_mfma_f32_16x16x32_bf16 v[232:235], v[228:231], v[132:135], v[232:235]
    v_accvgpr_read_b32 v170, a58
    v_accvgpr_read_b32 v171, a59
    v_accvgpr_read_b32 v172, a60
    v_accvgpr_read_b32 v173, a61
    v_accvgpr_read_b32 v174, a62
    v_accvgpr_read_b32 v175, a63
    v_mul_f32 v168, v168, v201
    v_mul_f32 v169, v169, v201
    v_mul_f32 v170, v170, v201
    v_mul_f32 v171, v171, v201
    v_mul_f32 v172, v172, v201
    v_mul_f32 v173, v173, v201
    v_mul_f32 v174, v174, v201
    v_mul_f32 v175, v175, v201
    v_cvt_pk_bf16_f32 v140, v168, v169
    v_cvt_pk_bf16_f32 v141, v170, v171
    v_cvt_pk_bf16_f32 v142, v172, v173
    v_cvt_pk_bf16_f32 v143, v174, v175
    s_xor_b32 s29, s98, 134144
    buffer_store_dwordx4 v[140:143], v238, s[8:11], s29 offen sc0 sc1
    v_accvgpr_read_b32 v176, a88
    v_accvgpr_read_b32 v177, a89
    v_mfma_f32_16x16x32_bf16 v[232:235], v[228:231], v[140:143], v[232:235]
    v_accvgpr_read_b32 v178, a90
    v_accvgpr_read_b32 v179, a91
    v_accvgpr_read_b32 v180, a92
    v_accvgpr_read_b32 v181, a93
    v_accvgpr_read_b32 v182, a94
    v_accvgpr_read_b32 v183, a95
    v_mul_f32 v176, v176, v202
    v_mul_f32 v177, v177, v202
    v_mul_f32 v178, v178, v202
    v_mul_f32 v179, v179, v202
    v_mul_f32 v180, v180, v202
    v_mul_f32 v181, v181, v202
    v_mul_f32 v182, v182, v202
    v_mul_f32 v183, v183, v202
    v_cvt_pk_bf16_f32 v148, v176, v177
    v_cvt_pk_bf16_f32 v149, v178, v179
    v_cvt_pk_bf16_f32 v150, v180, v181
    v_cvt_pk_bf16_f32 v151, v182, v183
    s_xor_b32 s29, s98, 265216
    buffer_store_dwordx4 v[148:151], v238, s[8:11], s29 offen sc0 sc1
    v_accvgpr_read_b32 v184, a120
    v_accvgpr_read_b32 v185, a121
    v_mfma_f32_16x16x32_bf16 v[232:235], v[228:231], v[148:151], v[232:235]
    v_accvgpr_read_b32 v186, a122
    v_accvgpr_read_b32 v187, a123
    v_accvgpr_read_b32 v188, a124
    v_accvgpr_read_b32 v189, a125
    v_accvgpr_read_b32 v190, a126
    v_accvgpr_read_b32 v191, a127
    v_mul_f32 v184, v184, v203
    v_mul_f32 v185, v185, v203
    v_mul_f32 v186, v186, v203
    v_mul_f32 v187, v187, v203
    v_mul_f32 v188, v188, v203
    v_mul_f32 v189, v189, v203
    v_mul_f32 v190, v190, v203
    v_mul_f32 v191, v191, v203
    v_cvt_pk_bf16_f32 v156, v184, v185
    v_cvt_pk_bf16_f32 v157, v186, v187
    v_cvt_pk_bf16_f32 v158, v188, v189
    v_cvt_pk_bf16_f32 v159, v190, v191
    v_accvgpr_read_b32 v192, a152
    v_accvgpr_read_b32 v193, a153
    v_mfma_f32_16x16x32_bf16 v[232:235], v[228:231], v[156:159], v[232:235]
    v_accvgpr_read_b32 v194, a154
    v_accvgpr_read_b32 v195, a155
    v_accvgpr_read_b32 v196, a156
    v_accvgpr_read_b32 v197, a157
    v_accvgpr_read_b32 v198, a158
    v_accvgpr_read_b32 v199, a159
    v_mul_f32 v192, v192, v204
    v_mul_f32 v193, v193, v204
    v_mul_f32 v194, v194, v204
    v_mul_f32 v195, v195, v204
    v_mul_f32 v196, v196, v204
    v_mul_f32 v197, v197, v204
    v_mul_f32 v198, v198, v204
    v_mul_f32 v199, v199, v204
    v_cvt_pk_bf16_f32 v212, v192, v193
    v_cvt_pk_bf16_f32 v213, v194, v195
    v_cvt_pk_bf16_f32 v214, v196, v197
    v_cvt_pk_bf16_f32 v215, v198, v199
    s_and_b32 s0, s2, 3
    s_lshl_b32 s0, s0, 1
    v_mfma_f32_16x16x32_bf16 v[232:235], v[228:231], v[212:215], v[232:235]
    s_lshr_b32 s27, s1, 4
    s_add_u32 s0, s0, s27
    s_and_b32 s28, s55, 1
    s_lshl_b32 s28, s28, 2
    s_add_u32 s28, s28, s24
    s_xor_b32 s29, s55, 1
    s_mul_i32 s27, s0, 20
    s_mul_i32 s32, s29, 5
    s_add_u32 s27, s27, s32
    s_lshl_b32 s27, s27, 17
    s_lshl_b32 s32, s28, 14
    s_add_u32 s27, s27, s32
    s_add_u32 s12, s50, s27
    s_addc_u32 s13, s51, 0
    s_mov_b32 s14, 655360
    s_mov_b32 s15, 0x20000
    s_cmp_eq_u32 s29, 3
    s_cselect_b32 s14, 524288, s14
    s_xor_b32 s29, s55, 0
    s_mul_i32 s27, s0, 20
    s_mul_i32 s32, s29, 5
    s_add_u32 s27, s27, s32
    s_lshl_b32 s27, s27, 17
    s_lshl_b32 s32, s28, 14
    s_add_u32 s27, s27, s32
    s_add_u32 s20, s50, s27
    s_addc_u32 s21, s51, 0
    s_mov_b32 s22, 655360
    s_mov_b32 s23, 0x20000
    s_cmp_eq_u32 s29, 3
    s_cselect_b32 s22, 524288, s22
    s_lshr_b32 s27, s55, 1
    s_lshl_b32 s30, s0, 1
    s_add_u32 s30, s30, s27
    s_lshl_b32 s30, s30, 3
    s_add_u32 s30, s30, s28
    s_lshl_b32 s30, s30, 7
    v_and_b32 v255, 7, v237
    v_lshlrev_b32 v255, 2, v255
    s_mov_b32 s31, 0x40000
    s_mov_b32 s27, 3145728
    buffer_load_dwordx4 v[4:7], v238, s[56:59], s27 offen sc1
    buffer_load_dwordx4 v[12:15], v238, s[56:59], s27 offen offset:1024 sc1
    buffer_load_dwordx4 v[20:23], v238, s[56:59], s27 offen offset:2048 sc1
    buffer_load_dwordx4 v[28:31], v238, s[56:59], s27 offen offset:3072 sc1
    s_mov_b32 s27, 3407872
    buffer_load_dwordx4 v[36:39], v238, s[56:59], s27 offen sc1
    buffer_load_dwordx4 v[44:47], v238, s[56:59], s27 offen offset:1024 sc1
    buffer_load_dwordx4 v[52:55], v238, s[56:59], s27 offen offset:2048 sc1
    buffer_load_dwordx4 v[60:63], v238, s[56:59], s27 offen offset:3072 sc1
    v_cmp_u_f32 vcc, v232, v232
    v_mov_b32 v244, s34
    v_add_u32 v244, 0x10000, v244
    s_or_b32 s86, s86, vcc_lo
    s_or_b32 s86, s86, vcc_hi
    v_mov_b32 v246, s86
    ds_write_b32 v245, v246 offset:32768
    s_waitcnt lgkmcnt(0)
    s_barrier
    ds_read_b128 v[240:243], v244 offset:32768
    s_waitcnt lgkmcnt(0)
    v_or3_b32 v240, v240, v241, v242
    v_or_b32 v240, v240, v243
    s_nop 0
    v_readfirstlane_b32 s33, v240
    s_cmp_lg_u32 s33, 0
    s_cbranch_scc1 L_fail
L_merge:
L_poll:
    buffer_load_dword v254, v255, s[60:63], s30 offen sc0 sc1
    s_waitcnt vmcnt(0) lgkmcnt(0)
    v_cmp_eq_u32 vcc, 0, v254
    s_sub_u32 s31, s31, 1
    s_nop 3
    s_cbranch_vccz L_go
    s_cmp_eq_u32 s31, 0
    s_cbranch_scc0 L_poll
L_go:
    s_mov_b32 s32, 0
    buffer_load_dwordx4 a[160:163], v238, s[12:15], s32 offen sc1
    buffer_load_dwordx4 a[164:167], v238, s[12:15], s32 offen offset:1024 sc1
    s_mov_b32 s32, 131072
    buffer_load_dwordx4 a[168:171], v238, s[12:15], s32 offen sc1
    buffer_load_dwordx4 a[172:175], v238, s[12:15], s32 offen offset:1024 sc1
    s_mov_b32 s32, 262144
    buffer_load_dwordx4 a[176:179], v238, s[12:15], s32 offen sc1
    buffer_load_dwordx4 a[180:183], v238, s[12:15], s32 offen offset:1024 sc1
    s_mov_b32 s32, 393216
    buffer_load_dwordx4 a[184:187], v238, s[12:15], s32 offen sc1
    buffer_load_dwordx4 a[188:191], v238, s[12:15], s32 offen offset:1024 sc1
    s_mov_b32 s32, 524288
    buffer_load_dwordx4 v[160:163], v238, s[12:15], s32 offen sc1
    buffer_load_dwordx4 v[164:167], v238, s[12:15], s32 offen offset:1024 sc1
    s_mov_b32 s32, 4096
    buffer_load_dwordx4 v[168:171], v238, s[12:15], s32 offen offset:1024 sc1
    buffer_load_dwordx4 v[172:175], v238, s[12:15], s32 offen sc1
    s_mov_b32 s32, 135168
    buffer_load_dwordx4 v[176:179], v238, s[12:15], s32 offen offset:1024 sc1
    buffer_load_dwordx4 v[180:183], v238, s[12:15], s32 offen sc1
    s_mov_b32 s32, 266240
    buffer_load_dwordx4 v[184:187], v238, s[12:15], s32 offen offset:1024 sc1
    buffer_load_dwordx4 v[188:191], v238, s[12:15], s32 offen sc1
    s_mov_b32 s32, 397312
    buffer_load_dwordx4 v[192:195], v238, s[12:15], s32 offen offset:1024 sc1
    buffer_load_dwordx4 v[196:199], v238, s[12:15], s32 offen sc1
    s_mov_b32 s32, 528384
    buffer_load_dwordx4 v[216:219], v238, s[12:15], s32 offen offset:1024 sc1
    buffer_load_dwordx4 v[228:231], v238, s[12:15], s32 offen sc1
    ds_read_b128 v[68:71], v223 offset:32768
    ds_read_b128 v[76:79], v223 offset:33792
    ds_read_b128 v[84:87], v223 offset:34816
    ds_read_b128 v[92:95], v223 offset:35840
    ds_read_b128 v[100:103], v224 offset:16384
    ds_read_b128 v[108:111], v224 offset:17408
    ds_read_b128 v[116:119], v224 offset:18432
    ds_read_b128 v[124:127], v224 offset:19456
    s_mul_i32 s27, s0, 311296
    s_add_u32 s16, s46, s27
    s_addc_u32 s17, s47, 0
    s_mov_b32 s18, 311296
    s_mov_b32 s19, 0x20000
    s_xor_b32 s27, s2, 0
    s_lshl_b32 s27, s27, 2
    s_add_u32 s27, s27, s24
    s_lshl_b32 s52, s27, 6
    s_add_u32 s52, s52, 16384
    s_lshl_b32 s27, s27, 13
    s_add_u32 s27, s27, 0x3000000
    s_add_u32 s56, s50, s27
    s_addc_u32 s57, s51, 0
    s_mov_b32 s58, 6144
    s_mov_b32 s59, 0x20000
    s_cmp_ge_u32 s24, 2
    s_cselect_b32 s58, 4096, s58
    s_xor_b32 s27, s2, 4
    s_lshl_b32 s27, s27, 2
    s_add_u32 s27, s27, s24
    s_lshl_b32 s33, s27, 6
    s_add_u32 s33, s33, 16384
    s_lshl_b32 s27, s27, 13
    s_add_u32 s27, s27, 0x3000000
    s_add_u32 s4, s50, s27
    s_addc_u32 s5, s51, 0
    s_mov_b32 s6, 6144
    s_mov_b32 s7, 0x20000
    s_cmp_ge_u32 s24, 2
    s_cselect_b32 s6, 4096, s6
    v_lshrrev_b32 v239, 4, v237
    v_and_b32 v240, 15, v237
    v_lshrrev_b32 v241, 2, v240
    v_and_b32 v242, 3, v237
    v_xor_b32 v243, v239, v240
    v_lshlrev_b32 v244, 8, v240
    v_lshl_add_u32 v245, v243, 4, v244
    v_add_u32 v245, s34, v245
    v_xor_b32 v232, 0x0, v245
    v_xor_b32 v233, 0x40, v245
    v_xor_b32 v234, 0x80, v245
    v_xor_b32 v235, 0xc0, v245
    s_and_b32 s27, s24, 1
    s_lshl_b32 s27, s27, 3
    v_lshrrev_b32 v243, 3, v237
    v_add_u32 v243, s27, v243
    v_and_b32 v244, 7, v237
    v_lshlrev_b32 v248, 10, v243
    v_lshl_add_u32 v248, v244, 4, v248
    v_lshlrev_b32 v244, 1, v244
    v_xor_b32 v244, v244, v243
    v_lshlrev_b32 v243, 8, v243
    v_lshl_add_u32 v246, v244, 4, v243
    s_lshr_b32 s27, s24, 1
    s_lshl_b32 s35, s27, 14
    v_add_u32 v246, s35, v246
    v_xor_b32 v247, 16, v246
    s_mul_i32 s28, s55, 81920
    s_add_u32 s28, s28, s35
    s_lshl_b32 s27, s54, 7
    s_add_u32 s28, s28, s27
    v_mov_b32 v239, 0
    s_waitcnt vmcnt(18)
    v_mfma_f32_16x16x32_bf16 a[0:3], a[192:195], a[160:163], 0
    v_mfma_f32_16x16x32_bf16 a[0:3], a[208:211], a[164:167], a[0:3]
    v_mfma_f32_16x16x32_bf16 a[4:7], a[212:215], a[164:167], 0
    v_mfma_f32_16x16x32_bf16 a[4:7], a[196:199], a[160:163], a[4:7]
    v_mfma_f32_16x16x32_bf16 a[8:11], a[200:203], a[160:163], 0
    v_mfma_f32_16x16x32_bf16 a[8:11], a[216:219], a[164:167], a[8:11]
    s_xor_b32 s29, s98, 396288
    buffer_store_dwordx4 v[156:159], v238, s[8:11], s29 offen sc0 sc1
    v_mfma_f32_16x16x32_bf16 a[12:15], a[220:223], a[164:167], 0
    v_mfma_f32_16x16x32_bf16 a[12:15], a[204:207], a[160:163], a[12:15]
    s_waitcnt vmcnt(17)
    v_mfma_f32_16x16x32_bf16 a[16:19], a[192:195], a[168:171], 0
    s_mov_b32 s32, 8192
    buffer_load_dwordx4 a[160:163], v238, s[12:15], s32 offen offset:2048 sc1
    v_mfma_f32_16x16x32_bf16 a[16:19], a[208:211], a[172:175], a[16:19]
    v_mfma_f32_16x16x32_bf16 a[20:23], a[212:215], a[172:175], 0
    buffer_load_dwordx4 a[164:167], v238, s[12:15], s32 offen offset:3072 sc1
    v_mfma_f32_16x16x32_bf16 a[20:23], a[196:199], a[168:171], a[20:23]
    v_mfma_f32_16x16x32_bf16 a[24:27], a[200:203], a[168:171], 0
    v_mfma_f32_16x16x32_bf16 a[24:27], a[216:219], a[172:175], a[24:27]
    s_xor_b32 s29, s98, 527360
    buffer_store_dwordx4 v[212:215], v238, s[8:11], s29 offen sc0 sc1
    v_mfma_f32_16x16x32_bf16 a[28:31], a[220:223], a[172:175], 0
    v_mfma_f32_16x16x32_bf16 a[28:31], a[204:207], a[168:171], a[28:31]
    s_waitcnt vmcnt(18)
    v_mfma_f32_16x16x32_bf16 a[32:35], a[192:195], a[176:179], 0
    s_mov_b32 s32, 139264
    buffer_load_dwordx4 a[168:171], v238, s[12:15], s32 offen offset:2048 sc1
    v_mfma_f32_16x16x32_bf16 a[32:35], a[208:211], a[180:183], a[32:35]
    v_mfma_f32_16x16x32_bf16 a[36:39], a[212:215], a[180:183], 0
    buffer_load_dwordx4 a[172:175], v238, s[12:15], s32 offen offset:3072 sc1
    v_mfma_f32_16x16x32_bf16 a[36:39], a[196:199], a[176:179], a[36:39]
    v_mfma_f32_16x16x32_bf16 a[40:43], a[200:203], a[176:179], 0
    v_mfma_f32_16x16x32_bf16 a[40:43], a[216:219], a[180:183], a[40:43]
    v_mfma_f32_16x16x32_bf16 a[44:47], a[220:223], a[180:183], 0
    v_mfma_f32_16x16x32_bf16 a[44:47], a[204:207], a[176:179], a[44:47]
    s_waitcnt vmcnt(18)
    v_mfma_f32_16x16x32_bf16 a[48:51], a[192:195], a[184:187], 0
    s_mov_b32 s32, 270336
    buffer_load_dwordx4 a[176:179], v238, s[12:15], s32 offen offset:2048 sc1
    v_mfma_f32_16x16x32_bf16 a[48:51], a[208:211], a[188:191], a[48:51]
    v_mfma_f32_16x16x32_bf16 a[52:55], a[212:215], a[188:191], 0
    buffer_load_dwordx4 a[180:183], v238, s[12:15], s32 offen offset:3072 sc1
    v_mfma_f32_16x16x32_bf16 a[52:55], a[196:199], a[184:187], a[52:55]
    v_mfma_f32_16x16x32_bf16 a[56:59], a[200:203], a[184:187], 0
    v_mfma_f32_16x16x32_bf16 a[56:59], a[216:219], a[188:191], a[56:59]
    v_mfma_f32_16x16x32_bf16 a[60:63], a[220:223], a[188:191], 0
    v_mfma_f32_16x16x32_bf16 a[60:63], a[204:207], a[184:187], a[60:63]
    s_waitcnt vmcnt(18)
    v_mfma_f32_16x16x32_bf16 a[64:67], a[192:195], v[160:163], 0
    s_mov_b32 s32, 401408
    buffer_load_dwordx4 a[184:187], v238, s[12:15], s32 offen offset:2048 sc1
    v_mfma_f32_16x16x32_bf16 a[64:67], a[208:211], v[164:167], a[64:67]
    v_mfma_f32_16x16x32_bf16 a[68:71], a[212:215], v[164:167], 0
    buffer_load_dwordx4 a[188:191], v238, s[12:15], s32 offen offset:3072 sc1
    v_mfma_f32_16x16x32_bf16 a[68:71], a[196:199], v[160:163], a[68:71]
    v_mfma_f32_16x16x32_bf16 a[72:75], a[200:203], v[160:163], 0
    v_mfma_f32_16x16x32_bf16 a[72:75], a[216:219], v[164:167], a[72:75]
    v_mfma_f32_16x16x32_bf16 a[76:79], a[220:223], v[164:167], 0
    v_mfma_f32_16x16x32_bf16 a[76:79], a[204:207], v[160:163], a[76:79]
    s_waitcnt vmcnt(18)
    v_mfma_f32_16x16x32_bf16 a[0:3], a[224:227], v[168:171], a[0:3]
    s_mov_b32 s32, 532480
    buffer_load_dwordx4 v[160:163], v238, s[12:15], s32 offen offset:2048 sc1
    v_mfma_f32_16x16x32_bf16 a[0:3], a[240:243], v[172:175], a[0:3]
    v_mfma_f32_16x16x32_bf16 a[4:7], a[244:247], v[172:175], a[4:7]
    buffer_load_dwordx4 v[164:167], v238, s[12:15], s32 offen offset:3072 sc1
    v_mfma_f32_16x16x32_bf16 a[4:7], a[228:231], v[168:171], a[4:7]
    v_mfma_f32_16x16x32_bf16 a[8:11], a[232:235], v[168:171], a[8:11]
    v_mfma_f32_16x16x32_bf16 a[8:11], a[248:251], v[172:175], a[8:11]
    v_mfma_f32_16x16x32_bf16 a[12:15], a[252:255], v[172:175], a[12:15]
    v_mfma_f32_16x16x32_bf16 a[12:15], a[236:239], v[168:171], a[12:15]
    s_waitcnt vmcnt(18)
    v_mfma_f32_16x16x32_bf16 a[16:19], a[224:227], v[176:179], a[16:19]
    s_mov_b32 s32, 12288
    buffer_load_dwordx4 v[168:171], v238, s[12:15], s32 offen offset:3072 sc1
    v_mfma_f32_16x16x32_bf16 a[16:19], a[240:243], v[180:183], a[16:19]
    v_mfma_f32_16x16x32_bf16 a[20:23], a[244:247], v[180:183], a[20:23]
    buffer_load_dwordx4 v[172:175], v238, s[12:15], s32 offen offset:2048 sc1
    v_mfma_f32_16x16x32_bf16 a[20:23], a[228:231], v[176:179], a[20:23]
    v_mfma_f32_16x16x32_bf16 a[24:27], a[232:235], v[176:179], a[24:27]
    v_mfma_f32_16x16x32_bf16 a[24:27], a[248:251], v[180:183], a[24:27]
    v_mfma_f32_16x16x32_bf16 a[28:31], a[252:255], v[180:183], a[28:31]
    v_mfma_f32_16x16x32_bf16 a[28:31], a[236:239], v[176:179], a[28:31]
    s_waitcnt vmcnt(18)
    v_mfma_f32_16x16x32_bf16 a[32:35], a[224:227], v[184:187], a[32:35]
    s_mov_b32 s32, 143360
    buffer_load_dwordx4 v[176:179], v238, s[12:15], s32 offen offset:3072 sc1
    v_mfma_f32_16x16x32_bf16 a[32:35], a[240:243], v[188:191], a[32:35]
    v_mfma_f32_16x16x32_bf16 a[36:39], a[244:247], v[188:191], a[36:39]
    buffer_load_dwordx4 v[180:183], v238, s[12:15], s32 offen offset:2048 sc1
    v_mfma_f32_16x16x32_bf16 a[36:39], a[228:231], v[184:187], a[36:39]
    v_mfma_f32_16x16x32_bf16 a[40:43], a[232:235], v[184:187], a[40:43]
    v_mfma_f32_16x16x32_bf16 a[40:43], a[248:251], v[188:191], a[40:43]
    v_mfma_f32_16x16x32_bf16 a[44:47], a[252:255], v[188:191], a[44:47]
    v_mfma_f32_16x16x32_bf16 a[44:47], a[236:239], v[184:187], a[44:47]
    s_waitcnt vmcnt(18)
    v_mfma_f32_16x16x32_bf16 a[48:51], a[224:227], v[192:195], a[48:51]
    s_mov_b32 s32, 274432
    buffer_load_dwordx4 v[184:187], v238, s[12:15], s32 offen offset:3072 sc1
    v_mfma_f32_16x16x32_bf16 a[48:51], a[240:243], v[196:199], a[48:51]
    v_mfma_f32_16x16x32_bf16 a[52:55], a[244:247], v[196:199], a[52:55]
    buffer_load_dwordx4 v[188:191], v238, s[12:15], s32 offen offset:2048 sc1
    v_mfma_f32_16x16x32_bf16 a[52:55], a[228:231], v[192:195], a[52:55]
    v_mfma_f32_16x16x32_bf16 a[56:59], a[232:235], v[192:195], a[56:59]
    v_mfma_f32_16x16x32_bf16 a[56:59], a[248:251], v[196:199], a[56:59]
    v_mov_b32 v254, 2
    v_mfma_f32_16x16x32_bf16 a[60:63], a[252:255], v[196:199], a[60:63]
    s_waitcnt vmcnt(14)
    buffer_store_dword v254, v253, s[60:63], s53 offen sc0 sc1
    v_mfma_f32_16x16x32_bf16 a[60:63], a[236:239], v[192:195], a[60:63]
    s_waitcnt vmcnt(15)
    v_mfma_f32_16x16x32_bf16 a[64:67], a[224:227], v[216:219], a[64:67]
    s_mov_b32 s32, 405504
    buffer_load_dwordx4 v[192:195], v238, s[12:15], s32 offen offset:3072 sc1
    v_mfma_f32_16x16x32_bf16 a[64:67], a[240:243], v[228:231], a[64:67]
    v_mfma_f32_16x16x32_bf16 a[68:71], a[244:247], v[228:231], a[68:71]
    buffer_load_dwordx4 v[196:199], v238, s[12:15], s32 offen offset:2048 sc1
    v_mfma_f32_16x16x32_bf16 a[68:71], a[228:231], v[216:219], a[68:71]
    v_mfma_f32_16x16x32_bf16 a[72:75], a[232:235], v[216:219], a[72:75]
    v_mfma_f32_16x16x32_bf16 a[72:75], a[248:251], v[228:231], a[72:75]
    v_mfma_f32_16x16x32_bf16 a[76:79], a[252:255], v[228:231], a[76:79]
    v_mfma_f32_16x16x32_bf16 a[76:79], a[236:239], v[216:219], a[76:79]
    s_waitcnt vmcnt(17)
    v_mfma_f32_16x16x32_bf16 a[0:3], v[0:3], a[160:163], a[0:3]
    s_mov_b32 s32, 536576
    buffer_load_dwordx4 v[216:219], v238, s[12:15], s32 offen offset:3072 sc1
    v_mfma_f32_16x16x32_bf16 a[0:3], v[32:35], a[164:167], a[0:3]
    v_mfma_f32_16x16x32_bf16 a[4:7], v[40:43], a[164:167], a[4:7]
    buffer_load_dwordx4 v[228:231], v238, s[12:15], s32 offen offset:2048 sc1
    v_mfma_f32_16x16x32_bf16 a[4:7], v[8:11], a[160:163], a[4:7]
    v_mfma_f32_16x16x32_bf16 a[8:11], v[16:19], a[160:163], a[8:11]
    v_mfma_f32_16x16x32_bf16 a[8:11], v[48:51], a[164:167], a[8:11]
    v_mfma_f32_16x16x32_bf16 a[12:15], v[56:59], a[164:167], a[12:15]
    v_mfma_f32_16x16x32_bf16 a[12:15], v[24:27], a[160:163], a[12:15]
    s_waitcnt vmcnt(17)
    v_mfma_f32_16x16x32_bf16 a[16:19], v[0:3], a[168:171], a[16:19]
    s_mov_b32 s32, 0
    buffer_load_dwordx4 a[160:163], v238, s[20:23], s32 offen sc1
    v_mfma_f32_16x16x32_bf16 a[16:19], v[32:35], a[172:175], a[16:19]
    v_mfma_f32_16x16x32_bf16 a[20:23], v[40:43], a[172:175], a[20:23]
    buffer_load_dwordx4 a[164:167], v238, s[20:23], s32 offen offset:1024 sc1
    v_mfma_f32_16x16x32_bf16 a[20:23], v[8:11], a[168:171], a[20:23]
    v_mfma_f32_16x16x32_bf16 a[24:27], v[16:19], a[168:171], a[24:27]
    v_mfma_f32_16x16x32_bf16 a[24:27], v[48:51], a[172:175], a[24:27]
    v_mfma_f32_16x16x32_bf16 a[28:31], v[56:59], a[172:175], a[28:31]
    v_mfma_f32_16x16x32_bf16 a[28:31], v[24:27], a[168:171], a[28:31]
    s_waitcnt vmcnt(17)
    v_mfma_f32_16x16x32_bf16 a[32:35], v[0:3], a[176:179], a[32:35]
    s_mov_b32 s32, 131072
    buffer_load_dwordx4 a[168:171], v238, s[20:23], s32 offen sc1
    v_mfma_f32_16x16x32_bf16 a[32:35], v[32:35], a[180:183], a[32:35]
    v_mfma_f32_16x16x32_bf16 a[36:39], v[40:43], a[180:183], a[36:39]
    buffer_load_dwordx4 a[172:175], v238, s[20:23], s32 offen offset:1024 sc1
    v_mfma_f32_16x16x32_bf16 a[36:39], v[8:11], a[176:179], a[36:39]
    v_mfma_f32_16x16x32_bf16 a[40:43], v[16:19], a[176:179], a[40:43]
    v_mfma_f32_16x16x32_bf16 a[40:43], v[48:51], a[180:183], a[40:43]
    v_mfma_f32_16x16x32_bf16 a[44:47], v[56:59], a[180:183], a[44:47]
    v_mfma_f32_16x16x32_bf16 a[44:47], v[24:27], a[176:179], a[44:47]
    s_waitcnt vmcnt(17)
    v_mfma_f32_16x16x32_bf16 a[48:51], v[0:3], a[184:187], a[48:51]
    s_mov_b32 s32, 262144
    buffer_load_dwordx4 a[176:179], v238, s[20:23], s32 offen sc1
    v_mfma_f32_16x16x32_bf16 a[48:51], v[32:35], a[188:191], a[48:51]
    v_mfma_f32_16x16x32_bf16 a[52:55], v[40:43], a[188:191], a[52:55]
    buffer_load_dwordx4 a[180:183], v238, s[20:23], s32 offen offset:1024 sc1
    v_mfma_f32_16x16x32_bf16 a[52:55], v[8:11], a[184:187], a[52:55]
    v_mfma_f32_16x16x32_bf16 a[56:59], v[16:19], a[184:187], a[56:59]
    v_mfma_f32_16x16x32_bf16 a[56:59], v[48:51], a[188:191], a[56:59]
    v_mfma_f32_16x16x32_bf16 a[60:63], v[56:59], a[188:191], a[60:63]
    v_mfma_f32_16x16x32_bf16 a[60:63], v[24:27], a[184:187], a[60:63]
    s_waitcnt vmcnt(17)
    v_mfma_f32_16x16x32_bf16 a[64:67], v[0:3], v[160:163], a[64:67]
    s_mov_b32 s32, 393216
    buffer_load_dwordx4 a[184:187], v238, s[20:23], s32 offen sc1
    v_mfma_f32_16x16x32_bf16 a[64:67], v[32:35], v[164:167], a[64:67]
    v_mfma_f32_16x16x32_bf16 a[68:71], v[40:43], v[164:167], a[68:71]
    buffer_load_dwordx4 a[188:191], v238, s[20:23], s32 offen offset:1024 sc1
    v_mfma_f32_16x16x32_bf16 a[68:71], v[8:11], v[160:163], a[68:71]
    v_mfma_f32_16x16x32_bf16 a[72:75], v[16:19], v[160:163], a[72:75]
    v_mfma_f32_16x16x32_bf16 a[72:75], v[48:51], v[164:167], a[72:75]
    v_mfma_f32_16x16x32_bf16 a[76:79], v[56:59], v[164:167], a[76:79]
    v_mfma_f32_16x16x32_bf16 a[76:79], v[24:27], v[160:163], a[76:79]
    s_waitcnt vmcnt(17)
    v_mfma_f32_16x16x32_bf16 a[0:3], v[64:67], v[168:171], a[0:3]
    s_mov_b32 s32, 524288
    buffer_load_dwordx4 v[160:163], v238, s[20:23], s32 offen sc1
    v_mfma_f32_16x16x32_bf16 a[0:3], v[96:99], v[172:175], a[0:3]
    v_mfma_f32_16x16x32_bf16 a[4:7], v[104:107], v[172:175], a[4:7]
    buffer_load_dwordx4 v[164:167], v238, s[20:23], s32 offen offset:1024 sc1
    v_mfma_f32_16x16x32_bf16 a[4:7], v[72:75], v[168:171], a[4:7]
    v_mfma_f32_16x16x32_bf16 a[8:11], v[80:83], v[168:171], a[8:11]
    v_mfma_f32_16x16x32_bf16 a[8:11], v[112:115], v[172:175], a[8:11]
    v_mfma_f32_16x16x32_bf16 a[12:15], v[120:123], v[172:175], a[12:15]
    v_mfma_f32_16x16x32_bf16 a[12:15], v[88:91], v[168:171], a[12:15]
    s_waitcnt vmcnt(17)
    v_mfma_f32_16x16x32_bf16 a[16:19], v[64:67], v[176:179], a[16:19]
    s_mov_b32 s32, 4096
    buffer_load_dwordx4 v[168:171], v238, s[20:23], s32 offen offset:1024 sc1
    v_mfma_f32_16x16x32_bf16 a[16:19], v[96:99], v[180:183], a[16:19]
    v_mfma_f32_16x16x32_bf16 a[20:23], v[104:107], v[180:183], a[20:23]
    buffer_load_dwordx4 v[172:175], v238, s[20:23], s32 offen sc1
    v_mfma_f32_16x16x32_bf16 a[20:23], v[72:75], v[176:179], a[20:23]
    v_mfma_f32_16x16x32_bf16 a[24:27], v[80:83], v[176:179], a[24:27]
    v_mfma_f32_16x16x32_bf16 a[24:27], v[112:115], v[180:183], a[24:27]
    v_mfma_f32_16x16x32_bf16 a[28:31], v[120:123], v[180:183], a[28:31]
    v_mfma_f32_16x16x32_bf16 a[28:31], v[88:91], v[176:179], a[28:31]
    s_waitcnt vmcnt(17)
    v_mfma_f32_16x16x32_bf16 a[32:35], v[64:67], v[184:187], a[32:35]
    s_mov_b32 s32, 135168
    buffer_load_dwordx4 v[176:179], v238, s[20:23], s32 offen offset:1024 sc1
    v_mfma_f32_16x16x32_bf16 a[32:35], v[96:99], v[188:191], a[32:35]
    v_mfma_f32_16x16x32_bf16 a[36:39], v[104:107], v[188:191], a[36:39]
    buffer_load_dwordx4 v[180:183], v238, s[20:23], s32 offen sc1
    v_mfma_f32_16x16x32_bf16 a[36:39], v[72:75], v[184:187], a[36:39]
    v_mfma_f32_16x16x32_bf16 a[40:43], v[80:83], v[184:187], a[40:43]
    v_mfma_f32_16x16x32_bf16 a[40:43], v[112:115], v[188:191], a[40:43]
    v_mfma_f32_16x16x32_bf16 a[44:47], v[120:123], v[188:191], a[44:47]
    v_mfma_f32_16x16x32_bf16 a[44:47], v[88:91], v[184:187], a[44:47]
    s_waitcnt vmcnt(16)
    v_mfma_f32_16x16x32_bf16 a[48:51], v[64:67], v[192:195], a[48:51]
    s_mov_b32 s32, 266240
    buffer_load_dwordx4 v[184:187], v238, s[20:23], s32 offen offset:1024 sc1
    v_mfma_f32_16x16x32_bf16 a[48:51], v[96:99], v[196:199], a[48:51]
    v_mfma_f32_16x16x32_bf16 a[52:55], v[104:107], v[196:199], a[52:55]
    buffer_load_dwordx4 v[188:191], v238, s[20:23], s32 offen sc1
    v_mfma_f32_16x16x32_bf16 a[52:55], v[72:75], v[192:195], a[52:55]
    v_mfma_f32_16x16x32_bf16 a[56:59], v[80:83], v[192:195], a[56:59]
    v_mfma_f32_16x16x32_bf16 a[56:59], v[112:115], v[196:199], a[56:59]
    v_mfma_f32_16x16x32_bf16 a[60:63], v[120:123], v[196:199], a[60:63]
    v_mfma_f32_16x16x32_bf16 a[60:63], v[88:91], v[192:195], a[60:63]
    s_waitcnt vmcnt(16)
    v_mfma_f32_16x16x32_bf16 a[64:67], v[64:67], v[216:219], a[64:67]
    s_mov_b32 s32, 397312
    buffer_load_dwordx4 v[192:195], v238, s[20:23], s32 offen offset:1024 sc1
    v_mfma_f32_16x16x32_bf16 a[64:67], v[96:99], v[228:231], a[64:67]
    v_mfma_f32_16x16x32_bf16 a[68:71], v[104:107], v[228:231], a[68:71]
    buffer_load_dwordx4 v[196:199], v238, s[20:23], s32 offen sc1
    v_mfma_f32_16x16x32_bf16 a[68:71], v[72:75], v[216:219], a[68:71]
    v_mfma_f32_16x16x32_bf16 a[72:75], v[80:83], v[216:219], a[72:75]
    v_mfma_f32_16x16x32_bf16 a[72:75], v[112:115], v[228:231], a[72:75]
    v_mfma_f32_16x16x32_bf16 a[76:79], v[120:123], v[228:231], a[76:79]
    v_mfma_f32_16x16x32_bf16 a[76:79], v[88:91], v[216:219], a[76:79]
    s_waitcnt vmcnt(16)
    v_mfma_f32_16x16x32_bf16 a[80:83], a[192:195], a[160:163], 0
    s_mov_b32 s32, 528384
    buffer_load_dwordx4 v[216:219], v238, s[20:23], s32 offen offset:1024 sc1
    v_mfma_f32_16x16x32_bf16 a[80:83], a[208:211], a[164:167], a[80:83]
    v_mfma_f32_16x16x32_bf16 a[84:87], a[212:215], a[164:167], 0
    buffer_load_dwordx4 v[228:231], v238, s[20:23], s32 offen sc1
    v_mfma_f32_16x16x32_bf16 a[84:87], a[196:199], a[160:163], a[84:87]
    v_mfma_f32_16x16x32_bf16 a[88:91], a[200:203], a[160:163], 0
    v_mfma_f32_16x16x32_bf16 a[88:91], a[216:219], a[164:167], a[88:91]
    v_mfma_f32_16x16x32_bf16 a[92:95], a[220:223], a[164:167], 0
    v_mfma_f32_16x16x32_bf16 a[92:95], a[204:207], a[160:163], a[92:95]
    s_waitcnt vmcnt(16)
    v_mfma_f32_16x16x32_bf16 a[96:99], a[192:195], a[168:171], 0
    s_mov_b32 s32, 8192
    buffer_load_dwordx4 a[160:163], v238, s[20:23], s32 offen offset:2048 sc1
    v_mfma_f32_16x16x32_bf16 a[96:99], a[208:211], a[172:175], a[96:99]
    v_mfma_f32_16x16x32_bf16 a[100:103], a[212:215], a[172:175], 0
    buffer_load_dwordx4 a[164:167], v238, s[20:23], s32 offen offset:3072 sc1
    v_mfma_f32_16x16x32_bf16 a[100:103], a[196:199], a[168:171], a[100:103]
    v_mfma_f32_16x16x32_bf16 a[104:107], a[200:203], a[168:171], 0
    v_mfma_f32_16x16x32_bf16 a[104:107], a[216:219], a[172:175], a[104:107]
    buffer_load_dword v252, v255, s[60:63], s30 offen sc0 sc1
    v_mfma_f32_16x16x32_bf16 a[108:111], a[220:223], a[172:175], 0
    v_mfma_f32_16x16x32_bf16 a[108:111], a[204:207], a[168:171], a[108:111]
    s_waitcnt vmcnt(17)
    v_mfma_f32_16x16x32_bf16 a[112:115], a[192:195], a[176:179], 0
    s_mov_b32 s32, 139264
    buffer_load_dwordx4 a[168:171], v238, s[20:23], s32 offen offset:2048 sc1
    v_mfma_f32_16x16x32_bf16 a[112:115], a[208:211], a[180:183], a[112:115]
    v_mfma_f32_16x16x32_bf16 a[116:119], a[212:215], a[180:183], 0
    buffer_load_dwordx4 a[172:175], v238, s[20:23], s32 offen offset:3072 sc1
    v_mfma_f32_16x16x32_bf16 a[116:119], a[196:199], a[176:179], a[116:119]
    v_mfma_f32_16x16x32_bf16 a[120:123], a[200:203], a[176:179], 0
    v_mfma_f32_16x16x32_bf16 a[120:123], a[216:219], a[180:183], a[120:123]
    v_mfma_f32_16x16x32_bf16 a[124:127], a[220:223], a[180:183], 0
    v_mfma_f32_16x16x32_bf16 a[124:127], a[204:207], a[176:179], a[124:127]
    s_waitcnt vmcnt(17)
    v_mfma_f32_16x16x32_bf16 a[128:131], a[192:195], a[184:187], 0
    s_mov_b32 s32, 270336
    buffer_load_dwordx4 a[176:179], v238, s[20:23], s32 offen offset:2048 sc1
    v_mfma_f32_16x16x32_bf16 a[128:131], a[208:211], a[188:191], a[128:131]
    v_mfma_f32_16x16x32_bf16 a[132:135], a[212:215], a[188:191], 0
    buffer_load_dwordx4 a[180:183], v238, s[20:23], s32 offen offset:3072 sc1
    v_mfma_f32_16x16x32_bf16 a[132:135], a[196:199], a[184:187], a[132:135]
    v_mfma_f32_16x16x32_bf16 a[136:139], a[200:203], a[184:187], 0
    v_mfma_f32_16x16x32_bf16 a[136:139], a[216:219], a[188:191], a[136:139]
    v_mfma_f32_16x16x32_bf16 a[140:143], a[220:223], a[188:191], 0
    v_mfma_f32_16x16x32_bf16 a[140:143], a[204:207], a[184:187], a[140:143]
    s_waitcnt vmcnt(17)
    v_mfma_f32_16x16x32_bf16 a[144:147], a[192:195], v[160:163], 0
    s_mov_b32 s32, 401408
    buffer_load_dwordx4 a[184:187], v238, s[20:23], s32 offen offset:2048 sc1
    v_mfma_f32_16x16x32_bf16 a[144:147], a[208:211], v[164:167], a[144:147]
    v_mfma_f32_16x16x32_bf16 a[148:151], a[212:215], v[164:167], 0
    buffer_load_dwordx4 a[188:191], v238, s[20:23], s32 offen offset:3072 sc1
    v_mfma_f32_16x16x32_bf16 a[148:151], a[196:199], v[160:163], a[148:151]
    v_mfma_f32_16x16x32_bf16 a[152:155], a[200:203], v[160:163], 0
    v_mfma_f32_16x16x32_bf16 a[152:155], a[216:219], v[164:167], a[152:155]
    v_mfma_f32_16x16x32_bf16 a[156:159], a[220:223], v[164:167], 0
    v_mfma_f32_16x16x32_bf16 a[156:159], a[204:207], v[160:163], a[156:159]
    s_waitcnt vmcnt(17)
    v_mfma_f32_16x16x32_bf16 a[80:83], a[224:227], v[168:171], a[80:83]
    s_mov_b32 s32, 532480
    buffer_load_dwordx4 v[160:163], v238, s[20:23], s32 offen offset:2048 sc1
    v_mfma_f32_16x16x32_bf16 a[80:83], a[240:243], v[172:175], a[80:83]
    ds_read_b128 a[192:195], v225 offset:0
    v_mfma_f32_16x16x32_bf16 a[84:87], a[244:247], v[172:175], a[84:87]
    buffer_load_dwordx4 v[164:167], v238, s[20:23], s32 offen offset:3072 sc1
    v_mfma_f32_16x16x32_bf16 a[84:87], a[228:231], v[168:171], a[84:87]
    v_mfma_f32_16x16x32_bf16 a[88:91], a[232:235], v[168:171], a[88:91]
    v_mfma_f32_16x16x32_bf16 a[88:91], a[248:251], v[172:175], a[88:91]
    ds_read_b128 a[196:199], v225 offset:1024
    v_mfma_f32_16x16x32_bf16 a[92:95], a[252:255], v[172:175], a[92:95]
    v_mfma_f32_16x16x32_bf16 a[92:95], a[236:239], v[168:171], a[92:95]
    s_waitcnt vmcnt(17)
    v_mfma_f32_16x16x32_bf16 a[96:99], a[224:227], v[176:179], a[96:99]
    s_mov_b32 s32, 12288
    buffer_load_dwordx4 v[168:171], v238, s[20:23], s32 offen offset:3072 sc1
    v_mfma_f32_16x16x32_bf16 a[96:99], a[240:243], v[180:183], a[96:99]
    ds_read_b128 a[200:203], v225 offset:2048
    v_mfma_f32_16x16x32_bf16 a[100:103], a[244:247], v[180:183], a[100:103]
    buffer_load_dwordx4 v[172:175], v238, s[20:23], s32 offen offset:2048 sc1
    v_mfma_f32_16x16x32_bf16 a[100:103], a[228:231], v[176:179], a[100:103]
    v_mfma_f32_16x16x32_bf16 a[104:107], a[232:235], v[176:179], a[104:107]
    v_mfma_f32_16x16x32_bf16 a[104:107], a[248:251], v[180:183], a[104:107]
    ds_read_b128 a[204:207], v225 offset:3072
    v_mfma_f32_16x16x32_bf16 a[108:111], a[252:255], v[180:183], a[108:111]
    v_mfma_f32_16x16x32_bf16 a[108:111], a[236:239], v[176:179], a[108:111]
    s_waitcnt vmcnt(17)
    v_mfma_f32_16x16x32_bf16 a[112:115], a[224:227], v[184:187], a[112:115]
    s_mov_b32 s32, 143360
    buffer_load_dwordx4 v[176:179], v238, s[20:23], s32 offen offset:3072 sc1
    v_mfma_f32_16x16x32_bf16 a[112:115], a[240:243], v[188:191], a[112:115]
    ds_read_b128 a[208:211], v225 offset:16384
    v_mfma_f32_16x16x32_bf16 a[116:119], a[244:247], v[188:191], a[116:119]
    buffer_load_dwordx4 v[180:183], v238, s[20:23], s32 offen offset:2048 sc1
    v_mfma_f32_16x16x32_bf16 a[116:119], a[228:231], v[184:187], a[116:119]
    v_mfma_f32_16x16x32_bf16 a[120:123], a[232:235], v[184:187], a[120:123]
    v_mfma_f32_16x16x32_bf16 a[120:123], a[248:251], v[188:191], a[120:123]
    ds_read_b128 a[212:215], v225 offset:17408
    v_mfma_f32_16x16x32_bf16 a[124:127], a[252:255], v[188:191], a[124:127]
    v_mfma_f32_16x16x32_bf16 a[124:127], a[236:239], v[184:187], a[124:127]
    s_waitcnt vmcnt(17)
    v_mfma_f32_16x16x32_bf16 a[128:131], a[224:227], v[192:195], a[128:131]
    s_mov_b32 s32, 274432
    buffer_load_dwordx4 v[184:187], v238, s[20:23], s32 offen offset:3072 sc1
    v_mfma_f32_16x16x32_bf16 a[128:131], a[240:243], v[196:199], a[128:131]
    ds_read_b128 a[216:219], v225 offset:18432
    v_mfma_f32_16x16x32_bf16 a[132:135], a[244:247], v[196:199], a[132:135]
    buffer_load_dwordx4 v[188:191], v238, s[20:23], s32 offen offset:2048 sc1
    v_mfma_f32_16x16x32_bf16 a[132:135], a[228:231], v[192:195], a[132:135]
    v_mfma_f32_16x16x32_bf16 a[136:139], a[232:235], v[192:195], a[136:139]
    v_mfma_f32_16x16x32_bf16 a[136:139], a[248:251], v[196:199], a[136:139]
    ds_read_b128 a[220:223], v225 offset:19456
    v_mfma_f32_16x16x32_bf16 a[140:143], a[252:255], v[196:199], a[140:143]
    v_mfma_f32_16x16x32_bf16 a[140:143], a[236:239], v[192:195], a[140:143]
    s_waitcnt vmcnt(17)
    v_mfma_f32_16x16x32_bf16 a[144:147], a[224:227], v[216:219], a[144:147]
    s_mov_b32 s32, 405504
    buffer_load_dwordx4 v[192:195], v238, s[20:23], s32 offen offset:3072 sc1
    v_mfma_f32_16x16x32_bf16 a[144:147], a[240:243], v[228:231], a[144:147]
    v_mfma_f32_16x16x32_bf16 a[148:151], a[244:247], v[228:231], a[148:151]
    buffer_load_dwordx4 v[196:199], v238, s[20:23], s32 offen offset:2048 sc1
    v_mfma_f32_16x16x32_bf16 a[148:151], a[228:231], v[216:219], a[148:151]
    v_mfma_f32_16x16x32_bf16 a[152:155], a[232:235], v[216:219], a[152:155]
    v_mfma_f32_16x16x32_bf16 a[152:155], a[248:251], v[228:231], a[152:155]
    v_mfma_f32_16x16x32_bf16 a[156:159], a[252:255], v[228:231], a[156:159]
    v_mfma_f32_16x16x32_bf16 a[156:159], a[236:239], v[216:219], a[156:159]
    s_waitcnt vmcnt(17)
    v_mfma_f32_16x16x32_bf16 a[80:83], v[0:3], a[160:163], a[80:83]
    s_mov_b32 s32, 536576
    buffer_load_dwordx4 v[216:219], v238, s[20:23], s32 offen offset:3072 sc1
    v_mfma_f32_16x16x32_bf16 a[80:83], v[32:35], a[164:167], a[80:83]
    ds_read_b128 a[224:227], v223 offset:16384
    v_mfma_f32_16x16x32_bf16 a[84:87], v[40:43], a[164:167], a[84:87]
    buffer_load_dwordx4 v[228:231], v238, s[20:23], s32 offen offset:2048 sc1
    v_mfma_f32_16x16x32_bf16 a[84:87], v[8:11], a[160:163], a[84:87]
    s_waitcnt vmcnt(18)
    v_cmp_gt_u32 vcc, 2, v252
    v_mfma_f32_16x16x32_bf16 a[88:91], v[16:19], a[160:163], a[88:91]
    v_mfma_f32_16x16x32_bf16 a[88:91], v[48:51], a[164:167], a[88:91]
    ds_read_b128 a[228:231], v223 offset:17408
    v_mfma_f32_16x16x32_bf16 a[92:95], v[56:59], a[164:167], a[92:95]
    v_mfma_f32_16x16x32_bf16 a[92:95], v[24:27], a[160:163], a[92:95]
    s_waitcnt vmcnt(16)
    s_cbranch_vccnz L_poll2
L_go2:
    v_mfma_f32_16x16x32_bf16 a[96:99], v[0:3], a[168:171], a[96:99]
    s_mov_b32 s32, 0
    buffer_load_dwordx4 a[160:163], v238, s[12:15], s32 offen offset:2048 sc1
    v_mfma_f32_16x16x32_bf16 a[96:99], v[32:35], a[172:175], a[96:99]
    ds_read_b128 a[232:235], v223 offset:18432
    v_mfma_f32_16x16x32_bf16 a[100:103], v[40:43], a[172:175], a[100:103]
    buffer_load_dwordx4 a[164:167], v238, s[12:15], s32 offen offset:3072 sc1
    v_mfma_f32_16x16x32_bf16 a[100:103], v[8:11], a[168:171], a[100:103]
    v_mfma_f32_16x16x32_bf16 a[104:107], v[16:19], a[168:171], a[104:107]
    v_mfma_f32_16x16x32_bf16 a[104:107], v[48:51], a[172:175], a[104:107]
    ds_read_b128 a[236:239], v223 offset:19456
    v_mfma_f32_16x16x32_bf16 a[108:111], v[56:59], a[172:175], a[108:111]
    v_mfma_f32_16x16x32_bf16 a[108:111], v[24:27], a[168:171], a[108:111]
    s_waitcnt vmcnt(16)
    v_mfma_f32_16x16x32_bf16 a[112:115], v[0:3], a[176:179], a[112:115]
    s_mov_b32 s32, 131072
    buffer_load_dwordx4 a[168:171], v238, s[12:15], s32 offen offset:2048 sc1
    v_mfma_f32_16x16x32_bf16 a[112:115], v[32:35], a[180:183], a[112:115]
    ds_read_b128 a[240:243], v224 offset:0
    v_mfma_f32_16x16x32_bf16 a[116:119], v[40:43], a[180:183], a[116:119]
    buffer_load_dwordx4 a[172:175], v238, s[12:15], s32 offen offset:3072 sc1
    v_mfma_f32_16x16x32_bf16 a[116:119], v[8:11], a[176:179], a[116:119]
    v_mfma_f32_16x16x32_bf16 a[120:123], v[16:19], a[176:179], a[120:123]
    v_mfma_f32_16x16x32_bf16 a[120:123], v[48:51], a[180:183], a[120:123]
    ds_read_b128 a[244:247], v224 offset:1024
    v_mfma_f32_16x16x32_bf16 a[124:127], v[56:59], a[180:183], a[124:127]
    v_mfma_f32_16x16x32_bf16 a[124:127], v[24:27], a[176:179], a[124:127]
    s_waitcnt vmcnt(16)
    v_mfma_f32_16x16x32_bf16 a[128:131], v[0:3], a[184:187], a[128:131]
    s_mov_b32 s32, 262144
    buffer_load_dwordx4 a[176:179], v238, s[12:15], s32 offen offset:2048 sc1
    v_mfma_f32_16x16x32_bf16 a[128:131], v[32:35], a[188:191], a[128:131]
    ds_read_b128 a[248:251], v224 offset:2048
    v_mfma_f32_16x16x32_bf16 a[132:135], v[40:43], a[188:191], a[132:135]
    buffer_load_dwordx4 a[180:183], v238, s[12:15], s32 offen offset:3072 sc1
    v_mfma_f32_16x16x32_bf16 a[132:135], v[8:11], a[184:187], a[132:135]
    v_mfma_f32_16x16x32_bf16 a[136:139], v[16:19], a[184:187], a[136:139]
    v_mfma_f32_16x16x32_bf16 a[136:139], v[48:51], a[188:191], a[136:139]
    ds_read_b128 a[252:255], v224 offset:3072
    v_mfma_f32_16x16x32_bf16 a[140:143], v[56:59], a[188:191], a[140:143]
    v_mfma_f32_16x16x32_bf16 a[140:143], v[24:27], a[184:187], a[140:143]
    s_waitcnt vmcnt(16)
    v_mfma_f32_16x16x32_bf16 a[144:147], v[0:3], v[160:163], a[144:147]
    s_mov_b32 s32, 393216
    buffer_load_dwordx4 a[184:187], v238, s[12:15], s32 offen offset:2048 sc1
    v_mfma_f32_16x16x32_bf16 a[144:147], v[32:35], v[164:167], a[144:147]
    v_mfma_f32_16x16x32_bf16 a[148:151], v[40:43], v[164:167], a[148:151]
    buffer_load_dwordx4 a[188:191], v238, s[12:15], s32 offen offset:3072 sc1
    v_mfma_f32_16x16x32_bf16 a[148:151], v[8:11], v[160:163], a[148:151]
    v_mfma_f32_16x16x32_bf16 a[152:155], v[16:19], v[160:163], a[152:155]
    v_mfma_f32_16x16x32_bf16 a[152:155], v[48:51], v[164:167], a[152:155]
    v_mfma_f32_16x16x32_bf16 a[156:159], v[56:59], v[164:167], a[156:159]
    v_mfma_f32_16x16x32_bf16 a[156:159], v[24:27], v[160:163], a[156:159]
    s_waitcnt vmcnt(16)
    v_mfma_f32_16x16x32_bf16 a[80:83], v[64:67], v[168:171], a[80:83]
    s_mov_b32 s32, 524288
    buffer_load_dwordx4 v[160:163], v238, s[12:15], s32 offen offset:2048 sc1
    v_mfma_f32_16x16x32_bf16 a[80:83], v[96:99], v[172:175], a[80:83]
    v_mfma_f32_16x16x32_bf16 a[84:87], v[104:107], v[172:175], a[84:87]
    buffer_load_dwordx4 v[164:167], v238, s[12:15], s32 offen offset:3072 sc1
    v_mfma_f32_16x16x32_bf16 a[84:87], v[72:75], v[168:171], a[84:87]
    v_mfma_f32_16x16x32_bf16 a[88:91], v[80:83], v[168:171], a[88:91]
    v_mfma_f32_16x16x32_bf16 a[88:91], v[112:115], v[172:175], a[88:91]
    v_mfma_f32_16x16x32_bf16 a[92:95], v[120:123], v[172:175], a[92:95]
    v_mfma_f32_16x16x32_bf16 a[92:95], v[88:91], v[168:171], a[92:95]
    s_waitcnt vmcnt(16)
    v_mfma_f32_16x16x32_bf16 a[96:99], v[64:67], v[176:179], a[96:99]
    s_mov_b32 s32, 4096
    buffer_load_dwordx4 v[168:171], v238, s[12:15], s32 offen offset:3072 sc1
    v_mfma_f32_16x16x32_bf16 a[96:99], v[96:99], v[180:183], a[96:99]
    v_mfma_f32_16x16x32_bf16 a[100:103], v[104:107], v[180:183], a[100:103]
    buffer_load_dwordx4 v[172:175], v238, s[12:15], s32 offen offset:2048 sc1
    v_mfma_f32_16x16x32_bf16 a[100:103], v[72:75], v[176:179], a[100:103]
    v_mfma_f32_16x16x32_bf16 a[104:107], v[80:83], v[176:179], a[104:107]
    v_mfma_f32_16x16x32_bf16 a[104:107], v[112:115], v[180:183], a[104:107]
    v_mfma_f32_16x16x32_bf16 a[108:111], v[120:123], v[180:183], a[108:111]
    v_mfma_f32_16x16x32_bf16 a[108:111], v[88:91], v[176:179], a[108:111]
    s_waitcnt vmcnt(16)
    v_mfma_f32_16x16x32_bf16 a[112:115], v[64:67], v[184:187], a[112:115]
    s_mov_b32 s32, 135168
    buffer_load_dwordx4 v[176:179], v238, s[12:15], s32 offen offset:3072 sc1
    v_mfma_f32_16x16x32_bf16 a[112:115], v[96:99], v[188:191], a[112:115]
    v_mfma_f32_16x16x32_bf16 a[116:119], v[104:107], v[188:191], a[116:119]
    buffer_load_dwordx4 v[180:183], v238, s[12:15], s32 offen offset:2048 sc1
    v_mfma_f32_16x16x32_bf16 a[116:119], v[72:75], v[184:187], a[116:119]
    v_mfma_f32_16x16x32_bf16 a[120:123], v[80:83], v[184:187], a[120:123]
    v_mfma_f32_16x16x32_bf16 a[120:123], v[112:115], v[188:191], a[120:123]
    v_mfma_f32_16x16x32_bf16 a[124:127], v[120:123], v[188:191], a[124:127]
    v_mfma_f32_16x16x32_bf16 a[124:127], v[88:91], v[184:187], a[124:127]
    s_waitcnt vmcnt(16)
    v_mfma_f32_16x16x32_bf16 a[128:131], v[64:67], v[192:195], a[128:131]
    s_mov_b32 s32, 266240
    buffer_load_dwordx4 v[184:187], v238, s[12:15], s32 offen offset:3072 sc1
    v_mfma_f32_16x16x32_bf16 a[128:131], v[96:99], v[196:199], a[128:131]
    v_mfma_f32_16x16x32_bf16 a[132:135], v[104:107], v[196:199], a[132:135]
    buffer_load_dwordx4 v[188:191], v238, s[12:15], s32 offen offset:2048 sc1
    v_mfma_f32_16x16x32_bf16 a[132:135], v[72:75], v[192:195], a[132:135]
    v_mfma_f32_16x16x32_bf16 a[136:139], v[80:83], v[192:195], a[136:139]
    v_mfma_f32_16x16x32_bf16 a[136:139], v[112:115], v[196:199], a[136:139]
    v_mfma_f32_16x16x32_bf16 a[140:143], v[120:123], v[196:199], a[140:143]
    v_mfma_f32_16x16x32_bf16 a[140:143], v[88:91], v[192:195], a[140:143]
    s_waitcnt vmcnt(16)
    v_mfma_f32_16x16x32_bf16 a[144:147], v[64:67], v[216:219], a[144:147]
    s_mov_b32 s32, 397312
    buffer_load_dwordx4 v[192:195], v238, s[12:15], s32 offen offset:3072 sc1
    v_mfma_f32_16x16x32_bf16 a[144:147], v[96:99], v[228:231], a[144:147]
    v_mfma_f32_16x16x32_bf16 a[148:151], v[104:107], v[228:231], a[148:151]
    buffer_load_dwordx4 v[196:199], v238, s[12:15], s32 offen offset:2048 sc1
    v_mfma_f32_16x16x32_bf16 a[148:151], v[72:75], v[216:219], a[148:151]
    v_mfma_f32_16x16x32_bf16 a[152:155], v[80:83], v[216:219], a[152:155]
    v_mfma_f32_16x16x32_bf16 a[152:155], v[112:115], v[228:231], a[152:155]
    v_mfma_f32_16x16x32_bf16 a[156:159], v[120:123], v[228:231], a[156:159]
    v_mfma_f32_16x16x32_bf16 a[156:159], v[88:91], v[216:219], a[156:159]
    s_waitcnt lgkmcnt(15)
    s_waitcnt vmcnt(16)
    v_mfma_f32_16x16x32_bf16 a[0:3], a[192:195], a[160:163], a[0:3]
    s_waitcnt lgkmcnt(11)
    s_mov_b32 s32, 528384
    buffer_load_dwordx4 v[216:219], v238, s[12:15], s32 offen offset:3072 sc1
    v_mfma_f32_16x16x32_bf16 a[0:3], a[208:211], a[164:167], a[0:3]
    s_waitcnt lgkmcnt(10)
    v_mfma_f32_16x16x32_bf16 a[4:7], a[212:215], a[164:167], a[4:7]
    buffer_load_dwordx4 v[228:231], v238, s[12:15], s32 offen offset:2048 sc1
    v_mfma_f32_16x16x32_bf16 a[4:7], a[196:199], a[160:163], a[4:7]
    v_mfma_f32_16x16x32_bf16 a[8:11], a[200:203], a[160:163], a[8:11]
    s_waitcnt lgkmcnt(9)
    v_mfma_f32_16x16x32_bf16 a[8:11], a[216:219], a[164:167], a[8:11]
    s_waitcnt lgkmcnt(8)
    v_mfma_f32_16x16x32_bf16 a[12:15], a[220:223], a[164:167], a[12:15]
    v_mfma_f32_16x16x32_bf16 a[12:15], a[204:207], a[160:163], a[12:15]
    s_waitcnt vmcnt(16)
    v_mfma_f32_16x16x32_bf16 a[16:19], a[192:195], a[168:171], a[16:19]
    s_mov_b32 s32, 8192
    buffer_load_dwordx4 a[160:163], v238, s[12:15], s32 offen sc1
    v_mfma_f32_16x16x32_bf16 a[16:19], a[208:211], a[172:175], a[16:19]
    v_mfma_f32_16x16x32_bf16 a[20:23], a[212:215], a[172:175], a[20:23]
    buffer_load_dwordx4 a[164:167], v238, s[12:15], s32 offen offset:1024 sc1
    v_mfma_f32_16x16x32_bf16 a[20:23], a[196:199], a[168:171], a[20:23]
    v_mfma_f32_16x16x32_bf16 a[24:27], a[200:203], a[168:171], a[24:27]
    v_mfma_f32_16x16x32_bf16 a[24:27], a[216:219], a[172:175], a[24:27]
    v_mfma_f32_16x16x32_bf16 a[28:31], a[220:223], a[172:175], a[28:31]
    v_mfma_f32_16x16x32_bf16 a[28:31], a[204:207], a[168:171], a[28:31]
    s_waitcnt vmcnt(16)
    v_mfma_f32_16x16x32_bf16 a[32:35], a[192:195], a[176:179], a[32:35]
    s_mov_b32 s32, 139264
    buffer_load_dwordx4 a[168:171], v238, s[12:15], s32 offen sc1
    v_mfma_f32_16x16x32_bf16 a[32:35], a[208:211], a[180:183], a[32:35]
    v_mfma_f32_16x16x32_bf16 a[36:39], a[212:215], a[180:183], a[36:39]
    buffer_load_dwordx4 a[172:175], v238, s[12:15], s32 offen offset:1024 sc1
    v_mfma_f32_16x16x32_bf16 a[36:39], a[196:199], a[176:179], a[36:39]
    v_mfma_f32_16x16x32_bf16 a[40:43], a[200:203], a[176:179], a[40:43]
    v_mfma_f32_16x16x32_bf16 a[40:43], a[216:219], a[180:183], a[40:43]
    v_mfma_f32_16x16x32_bf16 a[44:47], a[220:223], a[180:183], a[44:47]
    v_mfma_f32_16x16x32_bf16 a[44:47], a[204:207], a[176:179], a[44:47]
    s_waitcnt vmcnt(16)
    v_mfma_f32_16x16x32_bf16 a[48:51], a[192:195], a[184:187], a[48:51]
    s_mov_b32 s32, 270336
    buffer_load_dwordx4 a[176:179], v238, s[12:15], s32 offen sc1
    v_mfma_f32_16x16x32_bf16 a[48:51], a[208:211], a[188:191], a[48:51]
    v_mfma_f32_16x16x32_bf16 a[52:55], a[212:215], a[188:191], a[52:55]
    buffer_load_dwordx4 a[180:183], v238, s[12:15], s32 offen offset:1024 sc1
    v_mfma_f32_16x16x32_bf16 a[52:55], a[196:199], a[184:187], a[52:55]
    v_mfma_f32_16x16x32_bf16 a[56:59], a[200:203], a[184:187], a[56:59]
    v_mfma_f32_16x16x32_bf16 a[56:59], a[216:219], a[188:191], a[56:59]
    v_mfma_f32_16x16x32_bf16 a[60:63], a[220:223], a[188:191], a[60:63]
    v_mfma_f32_16x16x32_bf16 a[60:63], a[204:207], a[184:187], a[60:63]
    s_waitcnt vmcnt(16)
    v_mfma_f32_16x16x32_bf16 a[64:67], a[192:195], v[160:163], a[64:67]
    s_mov_b32 s32, 401408
    buffer_load_dwordx4 a[184:187], v238, s[12:15], s32 offen sc1
    v_mfma_f32_16x16x32_bf16 a[64:67], a[208:211], v[164:167], a[64:67]
    v_mfma_f32_16x16x32_bf16 a[68:71], a[212:215], v[164:167], a[68:71]
    buffer_load_dwordx4 a[188:191], v238, s[12:15], s32 offen offset:1024 sc1
    v_mfma_f32_16x16x32_bf16 a[68:71], a[196:199], v[160:163], a[68:71]
    v_mfma_f32_16x16x32_bf16 a[72:75], a[200:203], v[160:163], a[72:75]
    v_mfma_f32_16x16x32_bf16 a[72:75], a[216:219], v[164:167], a[72:75]
    v_mfma_f32_16x16x32_bf16 a[76:79], a[220:223], v[164:167], a[76:79]
    v_mfma_f32_16x16x32_bf16 a[76:79], a[204:207], v[160:163], a[76:79]
    s_waitcnt lgkmcnt(7)
    s_waitcnt vmcnt(16)
    v_mfma_f32_16x16x32_bf16 a[0:3], a[224:227], v[168:171], a[0:3]
    s_waitcnt lgkmcnt(3)
    s_mov_b32 s32, 532480
    buffer_load_dwordx4 v[160:163], v238, s[12:15], s32 offen sc1
    v_mfma_f32_16x16x32_bf16 a[0:3], a[240:243], v[172:175], a[0:3]
    s_waitcnt lgkmcnt(2)
    v_mfma_f32_16x16x32_bf16 a[4:7], a[244:247], v[172:175], a[4:7]
    buffer_load_dwordx4 v[164:167], v238, s[12:15], s32 offen offset:1024 sc1
    v_mfma_f32_16x16x32_bf16 a[4:7], a[228:231], v[168:171], a[4:7]
    v_mfma_f32_16x16x32_bf16 a[8:11], a[232:235], v[168:171], a[8:11]
    s_waitcnt lgkmcnt(1)
    v_mfma_f32_16x16x32_bf16 a[8:11], a[248:251], v[172:175], a[8:11]
    s_waitcnt lgkmcnt(0)
    v_mfma_f32_16x16x32_bf16 a[12:15], a[252:255], v[172:175], a[12:15]
    v_mfma_f32_16x16x32_bf16 a[12:15], a[236:239], v[168:171], a[12:15]
    s_waitcnt vmcnt(16)
    v_mfma_f32_16x16x32_bf16 a[16:19], a[224:227], v[176:179], a[16:19]
    s_mov_b32 s32, 12288
    buffer_load_dwordx4 v[168:171], v238, s[12:15], s32 offen offset:1024 sc1
    v_mfma_f32_16x16x32_bf16 a[16:19], a[240:243], v[180:183], a[16:19]
    v_mfma_f32_16x16x32_bf16 a[20:23], a[244:247], v[180:183], a[20:23]
    buffer_load_dwordx4 v[172:175], v238, s[12:15], s32 offen sc1
    v_mfma_f32_16x16x32_bf16 a[20:23], a[228:231], v[176:179], a[20:23]
    v_mfma_f32_16x16x32_bf16 a[24:27], a[232:235], v[176:179], a[24:27]
    v_mfma_f32_16x16x32_bf16 a[24:27], a[248:251], v[180:183], a[24:27]
    v_mfma_f32_16x16x32_bf16 a[28:31], a[252:255], v[180:183], a[28:31]
    v_mfma_f32_16x16x32_bf16 a[28:31], a[236:239], v[176:179], a[28:31]
    s_waitcnt vmcnt(16)
    v_mfma_f32_16x16x32_bf16 a[32:35], a[224:227], v[184:187], a[32:35]
    s_mov_b32 s32, 143360
    buffer_load_dwordx4 v[176:179], v238, s[12:15], s32 offen offset:1024 sc1
    v_mfma_f32_16x16x32_bf16 a[32:35], a[240:243], v[188:191], a[32:35]
    v_mfma_f32_16x16x32_bf16 a[36:39], a[244:247], v[188:191], a[36:39]
    buffer_load_dwordx4 v[180:183], v238, s[12:15], s32 offen sc1
    v_mfma_f32_16x16x32_bf16 a[36:39], a[228:231], v[184:187], a[36:39]
    v_mfma_f32_16x16x32_bf16 a[40:43], a[232:235], v[184:187], a[40:43]
    v_mfma_f32_16x16x32_bf16 a[40:43], a[248:251], v[188:191], a[40:43]
    v_mfma_f32_16x16x32_bf16 a[44:47], a[252:255], v[188:191], a[44:47]
    v_mfma_f32_16x16x32_bf16 a[44:47], a[236:239], v[184:187], a[44:47]
    s_waitcnt vmcnt(16)
    v_mfma_f32_16x16x32_bf16 a[48:51], a[224:227], v[192:195], a[48:51]
    s_mov_b32 s32, 274432
    buffer_load_dwordx4 v[184:187], v238, s[12:15], s32 offen offset:1024 sc1
    v_mfma_f32_16x16x32_bf16 a[48:51], a[240:243], v[196:199], a[48:51]
    v_mfma_f32_16x16x32_bf16 a[52:55], a[244:247], v[196:199], a[52:55]
    buffer_load_dwordx4 v[188:191], v238, s[12:15], s32 offen sc1
    v_mfma_f32_16x16x32_bf16 a[52:55], a[228:231], v[192:195], a[52:55]
    v_mfma_f32_16x16x32_bf16 a[56:59], a[232:235], v[192:195], a[56:59]
    v_mfma_f32_16x16x32_bf16 a[56:59], a[248:251], v[196:199], a[56:59]
    v_mfma_f32_16x16x32_bf16 a[60:63], a[252:255], v[196:199], a[60:63]
    v_mfma_f32_16x16x32_bf16 a[60:63], a[236:239], v[192:195], a[60:63]
    s_waitcnt vmcnt(16)
    v_mfma_f32_16x16x32_bf16 a[64:67], a[224:227], v[216:219], a[64:67]
    s_mov_b32 s32, 405504
    buffer_load_dwordx4 v[192:195], v238, s[12:15], s32 offen offset:1024 sc1
    v_mfma_f32_16x16x32_bf16 a[64:67], a[240:243], v[228:231], a[64:67]
    v_mfma_f32_16x16x32_bf16 a[68:71], a[244:247], v[228:231], a[68:71]
    buffer_load_dwordx4 v[196:199], v238, s[12:15], s32 offen sc1
    v_mfma_f32_16x16x32_bf16 a[68:71], a[228:231], v[216:219], a[68:71]
    v_mfma_f32_16x16x32_bf16 a[72:75], a[232:235], v[216:219], a[72:75]
    v_mfma_f32_16x16x32_bf16 a[72:75], a[248:251], v[228:231], a[72:75]
    v_mfma_f32_16x16x32_bf16 a[76:79], a[252:255], v[228:231], a[76:79]
    v_mfma_f32_16x16x32_bf16 a[76:79], a[236:239], v[216:219], a[76:79]
    s_waitcnt vmcnt(16)
    v_mfma_f32_16x16x32_bf16 a[0:3], v[4:7], a[160:163], a[0:3]
    s_mov_b32 s32, 536576
    buffer_load_dwordx4 v[216:219], v238, s[12:15], s32 offen offset:1024 sc1
    v_mfma_f32_16x16x32_bf16 a[0:3], v[36:39], a[164:167], a[0:3]
    v_mfma_f32_16x16x32_bf16 a[4:7], v[44:47], a[164:167], a[4:7]
    buffer_load_dwordx4 v[228:231], v238, s[12:15], s32 offen sc1
    v_mfma_f32_16x16x32_bf16 a[4:7], v[12:15], a[160:163], a[4:7]
    v_mfma_f32_16x16x32_bf16 a[8:11], v[20:23], a[160:163], a[8:11]
    v_mfma_f32_16x16x32_bf16 a[8:11], v[52:55], a[164:167], a[8:11]
    v_mfma_f32_16x16x32_bf16 a[12:15], v[60:63], a[164:167], a[12:15]
    v_mfma_f32_16x16x32_bf16 a[12:15], v[28:31], a[160:163], a[12:15]
    s_waitcnt vmcnt(16)
    v_mfma_f32_16x16x32_bf16 a[16:19], v[4:7], a[168:171], a[16:19]
    s_mov_b32 s32, 0
    buffer_load_dwordx4 a[160:163], v238, s[20:23], s32 offen offset:2048 sc1
    v_mfma_f32_16x16x32_bf16 a[16:19], v[36:39], a[172:175], a[16:19]
    v_mfma_f32_16x16x32_bf16 a[20:23], v[44:47], a[172:175], a[20:23]
    buffer_load_dwordx4 a[164:167], v238, s[20:23], s32 offen offset:3072 sc1
    v_mfma_f32_16x16x32_bf16 a[20:23], v[12:15], a[168:171], a[20:23]
    v_mfma_f32_16x16x32_bf16 a[24:27], v[20:23], a[168:171], a[24:27]
    v_mfma_f32_16x16x32_bf16 a[24:27], v[52:55], a[172:175], a[24:27]
    v_mfma_f32_16x16x32_bf16 a[28:31], v[60:63], a[172:175], a[28:31]
    v_mfma_f32_16x16x32_bf16 a[28:31], v[28:31], a[168:171], a[28:31]
    s_waitcnt vmcnt(16)
    v_mfma_f32_16x16x32_bf16 a[32:35], v[4:7], a[176:179], a[32:35]
    s_mov_b32 s32, 131072
    buffer_load_dwordx4 a[168:171], v238, s[20:23], s32 offen offset:2048 sc1
    v_mfma_f32_16x16x32_bf16 a[32:35], v[36:39], a[180:183], a[32:35]
    v_mfma_f32_16x16x32_bf16 a[36:39], v[44:47], a[180:183], a[36:39]
    buffer_load_dwordx4 a[172:175], v238, s[20:23], s32 offen offset:3072 sc1
    v_mfma_f32_16x16x32_bf16 a[36:39], v[12:15], a[176:179], a[36:39]
    v_mfma_f32_16x16x32_bf16 a[40:43], v[20:23], a[176:179], a[40:43]
    v_mfma_f32_16x16x32_bf16 a[40:43], v[52:55], a[180:183], a[40:43]
    v_mfma_f32_16x16x32_bf16 a[44:47], v[60:63], a[180:183], a[44:47]
    v_mfma_f32_16x16x32_bf16 a[44:47], v[28:31], a[176:179], a[44:47]
    s_waitcnt vmcnt(16)
    v_mfma_f32_16x16x32_bf16 a[48:51], v[4:7], a[184:187], a[48:51]
    s_mov_b32 s32, 262144
    buffer_load_dwordx4 a[176:179], v238, s[20:23], s32 offen offset:2048 sc1
    v_mfma_f32_16x16x32_bf16 a[48:51], v[36:39], a[188:191], a[48:51]
    v_mfma_f32_16x16x32_bf16 a[52:55], v[44:47], a[188:191], a[52:55]
    buffer_load_dwordx4 a[180:183], v238, s[20:23], s32 offen offset:3072 sc1
    v_mfma_f32_16x16x32_bf16 a[52:55], v[12:15], a[184:187], a[52:55]
    v_mfma_f32_16x16x32_bf16 a[56:59], v[20:23], a[184:187], a[56:59]
    v_mfma_f32_16x16x32_bf16 a[56:59], v[52:55], a[188:191], a[56:59]
    v_mfma_f32_16x16x32_bf16 a[60:63], v[60:63], a[188:191], a[60:63]
    v_mfma_f32_16x16x32_bf16 a[60:63], v[28:31], a[184:187], a[60:63]
    s_waitcnt vmcnt(16)
    v_mfma_f32_16x16x32_bf16 a[64:67], v[4:7], v[160:163], a[64:67]
    s_mov_b32 s32, 393216
    buffer_load_dwordx4 a[184:187], v238, s[20:23], s32 offen offset:2048 sc1
    v_mfma_f32_16x16x32_bf16 a[64:67], v[36:39], v[164:167], a[64:67]
    v_mfma_f32_16x16x32_bf16 a[68:71], v[44:47], v[164:167], a[68:71]
    buffer_load_dwordx4 a[188:191], v238, s[20:23], s32 offen offset:3072 sc1
    v_mfma_f32_16x16x32_bf16 a[68:71], v[12:15], v[160:163], a[68:71]
    v_mfma_f32_16x16x32_bf16 a[72:75], v[20:23], v[160:163], a[72:75]
    v_mfma_f32_16x16x32_bf16 a[72:75], v[52:55], v[164:167], a[72:75]
    v_mfma_f32_16x16x32_bf16 a[76:79], v[60:63], v[164:167], a[76:79]
    v_mfma_f32_16x16x32_bf16 a[76:79], v[28:31], v[160:163], a[76:79]
    s_waitcnt vmcnt(16)
    v_mfma_f32_16x16x32_bf16 a[0:3], v[68:71], v[168:171], a[0:3]
    s_mov_b32 s32, 524288
    buffer_load_dwordx4 v[160:163], v238, s[20:23], s32 offen offset:2048 sc1
    v_mfma_f32_16x16x32_bf16 a[0:3], v[100:103], v[172:175], a[0:3]
    v_mfma_f32_16x16x32_bf16 a[4:7], v[108:111], v[172:175], a[4:7]
    buffer_load_dwordx4 v[164:167], v238, s[20:23], s32 offen offset:3072 sc1
    v_mfma_f32_16x16x32_bf16 a[4:7], v[76:79], v[168:171], a[4:7]
    v_mfma_f32_16x16x32_bf16 a[8:11], v[84:87], v[168:171], a[8:11]
    v_mfma_f32_16x16x32_bf16 a[8:11], v[116:119], v[172:175], a[8:11]
    v_mfma_f32_16x16x32_bf16 a[12:15], v[124:127], v[172:175], a[12:15]
    v_mfma_f32_16x16x32_bf16 a[12:15], v[92:95], v[168:171], a[12:15]
    s_waitcnt vmcnt(16)
    v_mfma_f32_16x16x32_bf16 a[16:19], v[68:71], v[176:179], a[16:19]
    s_mov_b32 s32, 4096
    buffer_load_dwordx4 v[168:171], v238, s[20:23], s32 offen offset:3072 sc1
    v_mfma_f32_16x16x32_bf16 a[16:19], v[100:103], v[180:183], a[16:19]
    ds_write_b128 v232, a[0:3] offset:0
    v_mfma_f32_16x16x32_bf16 a[20:23], v[108:111], v[180:183], a[20:23]
    buffer_load_dwordx4 v[172:175], v238, s[20:23], s32 offen offset:2048 sc1
    v_mfma_f32_16x16x32_bf16 a[20:23], v[76:79], v[176:179], a[20:23]
    ds_write_b128 v233, a[4:7] offset:0
    v_mfma_f32_16x16x32_bf16 a[24:27], v[84:87], v[176:179], a[24:27]
    v_mfma_f32_16x16x32_bf16 a[24:27], v[116:119], v[180:183], a[24:27]
    ds_write_b128 v234, a[8:11] offset:0
    v_mfma_f32_16x16x32_bf16 a[28:31], v[124:127], v[180:183], a[28:31]
    v_mfma_f32_16x16x32_bf16 a[28:31], v[92:95], v[176:179], a[28:31]
    s_waitcnt vmcnt(16)
    ds_write_b128 v235, a[12:15] offset:0
    v_mfma_f32_16x16x32_bf16 a[32:35], v[68:71], v[184:187], a[32:35]
    s_mov_b32 s32, 135168
    buffer_load_dwordx4 v[176:179], v238, s[20:23], s32 offen offset:3072 sc1
    v_mfma_f32_16x16x32_bf16 a[32:35], v[100:103], v[188:191], a[32:35]
    ds_write_b128 v232, a[16:19] offset:16384
    v_mfma_f32_16x16x32_bf16 a[36:39], v[108:111], v[188:191], a[36:39]
    buffer_load_dwordx4 v[180:183], v238, s[20:23], s32 offen offset:2048 sc1
    v_mfma_f32_16x16x32_bf16 a[36:39], v[76:79], v[184:187], a[36:39]
    ds_write_b128 v233, a[20:23] offset:16384
    v_mfma_f32_16x16x32_bf16 a[40:43], v[84:87], v[184:187], a[40:43]
    v_mfma_f32_16x16x32_bf16 a[40:43], v[116:119], v[188:191], a[40:43]
    ds_write_b128 v234, a[24:27] offset:16384
    v_mfma_f32_16x16x32_bf16 a[44:47], v[124:127], v[188:191], a[44:47]
    v_mfma_f32_16x16x32_bf16 a[44:47], v[92:95], v[184:187], a[44:47]
    s_waitcnt vmcnt(16)
    ds_write_b128 v235, a[28:31] offset:16384
    v_mfma_f32_16x16x32_bf16 a[48:51], v[68:71], v[192:195], a[48:51]
    s_mov_b32 s32, 266240
    buffer_load_dwordx4 v[184:187], v238, s[20:23], s32 offen offset:3072 sc1
    v_mfma_f32_16x16x32_bf16 a[48:51], v[100:103], v[196:199], a[48:51]
    ds_write_b128 v232, a[32:35] offset:32768
    v_mfma_f32_16x16x32_bf16 a[52:55], v[108:111], v[196:199], a[52:55]
    buffer_load_dwordx4 v[188:191], v238, s[20:23], s32 offen offset:2048 sc1
    v_mfma_f32_16x16x32_bf16 a[52:55], v[76:79], v[192:195], a[52:55]
    ds_write_b128 v233, a[36:39] offset:32768
    v_mfma_f32_16x16x32_bf16 a[56:59], v[84:87], v[192:195], a[56:59]
    v_mfma_f32_16x16x32_bf16 a[56:59], v[116:119], v[196:199], a[56:59]
    ds_write_b128 v234, a[40:43] offset:32768
    v_mfma_f32_16x16x32_bf16 a[60:63], v[124:127], v[196:199], a[60:63]
    v_mfma_f32_16x16x32_bf16 a[60:63], v[92:95], v[192:195], a[60:63]
    s_waitcnt vmcnt(16)
    ds_write_b128 v235, a[44:47] offset:32768
    v_mfma_f32_16x16x32_bf16 a[64:67], v[68:71], v[216:219], a[64:67]
    s_mov_b32 s32, 397312
    buffer_load_dwordx4 v[192:195], v238, s[20:23], s32 offen offset:3072 sc1
    v_mfma_f32_16x16x32_bf16 a[64:67], v[100:103], v[228:231], a[64:67]
    ds_write_b128 v232, a[48:51] offset:49152
    v_mfma_f32_16x16x32_bf16 a[68:71], v[108:111], v[228:231], a[68:71]
    buffer_load_dwordx4 v[196:199], v238, s[20:23], s32 offen offset:2048 sc1
    v_mfma_f32_16x16x32_bf16 a[68:71], v[76:79], v[216:219], a[68:71]
    ds_write_b128 v233, a[52:55] offset:49152
    v_mfma_f32_16x16x32_bf16 a[72:75], v[84:87], v[216:219], a[72:75]
    v_mfma_f32_16x16x32_bf16 a[72:75], v[116:119], v[228:231], a[72:75]
    ds_write_b128 v234, a[56:59] offset:49152
    v_mfma_f32_16x16x32_bf16 a[76:79], v[124:127], v[228:231], a[76:79]
    v_mfma_f32_16x16x32_bf16 a[76:79], v[92:95], v[216:219], a[76:79]
    s_waitcnt vmcnt(16)
    ds_write_b128 v235, a[60:63] offset:49152
    v_mfma_f32_16x16x32_bf16 a[80:83], a[192:195], a[160:163], a[80:83]
    s_mov_b32 s32, 528384
    buffer_load_dwordx4 v[216:219], v238, s[20:23], s32 offen offset:3072 sc1
    v_add_u32 v232, 0x10000, v232
    v_mfma_f32_16x16x32_bf16 a[80:83], a[208:211], a[164:167], a[80:83]
    ds_write_b128 v232, a[64:67] offset:0
    v_mfma_f32_16x16x32_bf16 a[84:87], a[212:215], a[164:167], a[84:87]
    buffer_load_dwordx4 v[228:231], v238, s[20:23], s32 offen offset:2048 sc1
    v_add_u32 v233, 0x10000, v233
    v_mfma_f32_16x16x32_bf16 a[84:87], a[196:199], a[160:163], a[84:87]
    ds_write_b128 v233, a[68:71] offset:0
    v_mfma_f32_16x16x32_bf16 a[88:91], a[200:203], a[160:163], a[88:91]
    v_add_u32 v234, 0x10000, v234
    v_mfma_f32_16x16x32_bf16 a[88:91], a[216:219], a[164:167], a[88:91]
    ds_write_b128 v234, a[72:75] offset:0
    v_mfma_f32_16x16x32_bf16 a[92:95], a[220:223], a[164:167], a[92:95]
    v_add_u32 v235, 0x10000, v235
    v_mfma_f32_16x16x32_bf16 a[92:95], a[204:207], a[160:163], a[92:95]
    s_waitcnt vmcnt(16)
    ds_write_b128 v235, a[76:79] offset:0
    v_mfma_f32_16x16x32_bf16 a[96:99], a[192:195], a[168:171], a[96:99]
    s_mov_b32 s32, 8192
    buffer_load_dwordx4 a[160:163], v238, s[20:23], s32 offen sc1
    v_mfma_f32_16x16x32_bf16 a[96:99], a[208:211], a[172:175], a[96:99]
    v_mfma_f32_16x16x32_bf16 a[100:103], a[212:215], a[172:175], a[100:103]
    buffer_load_dwordx4 a[164:167], v238, s[20:23], s32 offen offset:1024 sc1
    v_mfma_f32_16x16x32_bf16 a[100:103], a[196:199], a[168:171], a[100:103]
    v_mfma_f32_16x16x32_bf16 a[104:107], a[200:203], a[168:171], a[104:107]
    v_mfma_f32_16x16x32_bf16 a[104:107], a[216:219], a[172:175], a[104:107]
    v_mfma_f32_16x16x32_bf16 a[108:111], a[220:223], a[172:175], a[108:111]
    s_waitcnt lgkmcnt(0)
    v_mfma_f32_16x16x32_bf16 a[108:111], a[204:207], a[168:171], a[108:111]
    s_waitcnt vmcnt(16)
    s_barrier
    v_mfma_f32_16x16x32_bf16 a[112:115], a[192:195], a[176:179], a[112:115]
    s_mov_b32 s32, 139264
    buffer_load_dwordx4 a[168:171], v238, s[20:23], s32 offen sc1
    ds_read_b128 v[128:131], v246 offset:0
    v_mfma_f32_16x16x32_bf16 a[112:115], a[208:211], a[180:183], a[112:115]
    ds_read_b128 v[132:135], v247 offset:0
    v_mfma_f32_16x16x32_bf16 a[116:119], a[212:215], a[180:183], a[116:119]
    buffer_load_dwordx4 a[172:175], v238, s[20:23], s32 offen offset:1024 sc1
    ds_read_b128 v[136:139], v246 offset:4096
    v_mfma_f32_16x16x32_bf16 a[116:119], a[196:199], a[176:179], a[116:119]
    ds_read_b128 v[140:143], v247 offset:4096
    v_mfma_f32_16x16x32_bf16 a[120:123], a[200:203], a[176:179], a[120:123]
    ds_read_b128 v[144:147], v246 offset:8192
    v_mfma_f32_16x16x32_bf16 a[120:123], a[216:219], a[180:183], a[120:123]
    ds_read_b128 v[148:151], v247 offset:8192
    v_mfma_f32_16x16x32_bf16 a[124:127], a[220:223], a[180:183], a[124:127]
    ds_read_b128 v[152:155], v246 offset:12288
    v_mfma_f32_16x16x32_bf16 a[124:127], a[204:207], a[176:179], a[124:127]
    s_waitcnt vmcnt(16)
    ds_read_b128 v[156:159], v247 offset:12288
    v_mfma_f32_16x16x32_bf16 a[128:131], a[192:195], a[184:187], a[128:131]
    s_mov_b32 s32, 270336
    buffer_load_dwordx4 a[176:179], v238, s[20:23], s32 offen sc1
    ds_read_b128 v[0:3], v246 offset:32768
    v_mfma_f32_16x16x32_bf16 a[128:131], a[208:211], a[188:191], a[128:131]
    ds_read_b128 v[8:11], v247 offset:32768
    v_mfma_f32_16x16x32_bf16 a[132:135], a[212:215], a[188:191], a[132:135]
    buffer_load_dwordx4 a[180:183], v238, s[20:23], s32 offen offset:1024 sc1
    ds_read_b128 v[16:19], v246 offset:36864
    s_waitcnt lgkmcnt(8)
    v_add_f32 v128, v128, v136
    s_waitcnt lgkmcnt(4)
    v_add_f32 v144, v144, v152
    v_mfma_f32_16x16x32_bf16 a[132:135], a[196:199], a[184:187], a[132:135]
    ds_read_b128 v[24:27], v247 offset:36864
    v_add_f32 v129, v129, v137
    v_add_f32 v145, v145, v153
    v_mfma_f32_16x16x32_bf16 a[136:139], a[200:203], a[184:187], a[136:139]
    ds_read_b128 v[32:35], v246 offset:40960
    v_add_f32 v130, v130, v138
    v_add_f32 v146, v146, v154
    v_mfma_f32_16x16x32_bf16 a[136:139], a[216:219], a[188:191], a[136:139]
    ds_read_b128 v[40:43], v247 offset:40960
    v_add_f32 v131, v131, v139
    v_add_f32 v147, v147, v155
    v_mfma_f32_16x16x32_bf16 a[140:143], a[220:223], a[188:191], a[140:143]
    ds_read_b128 v[48:51], v246 offset:45056
    v_add_f32 v132, v132, v140
    s_waitcnt lgkmcnt(7)
    v_add_f32 v148, v148, v156
    v_mfma_f32_16x16x32_bf16 a[140:143], a[204:207], a[184:187], a[140:143]
    s_waitcnt vmcnt(16)
    ds_read_b128 v[56:59], v247 offset:45056
    v_add_f32 v133, v133, v141
    v_add_f32 v149, v149, v157
    v_mfma_f32_16x16x32_bf16 a[144:147], a[192:195], v[160:163], a[144:147]
    s_mov_b32 s32, 401408
    buffer_load_dwordx4 a[184:187], v238, s[20:23], s32 offen sc1
    v_add_u32 v246, 0x10000, v246
    v_add_f32 v134, v134, v142
    v_add_f32 v150, v150, v158
    v_mfma_f32_16x16x32_bf16 a[144:147], a[208:211], v[164:167], a[144:147]
    v_add_u32 v247, 0x10000, v247
    v_add_f32 v135, v135, v143
    v_add_f32 v151, v151, v159
    v_mfma_f32_16x16x32_bf16 a[148:151], a[212:215], v[164:167], a[148:151]
    buffer_load_dwordx4 a[188:191], v238, s[20:23], s32 offen offset:1024 sc1
    ds_read_b128 v[64:67], v246 offset:0
    v_add_f32 v128, v128, v144
    v_add_f32 v129, v129, v145
    v_mfma_f32_16x16x32_bf16 a[148:151], a[196:199], v[160:163], a[148:151]
    ds_read_b128 v[72:75], v247 offset:0
    v_add_f32 v130, v130, v146
    v_add_f32 v131, v131, v147
    v_mfma_f32_16x16x32_bf16 a[152:155], a[200:203], v[160:163], a[152:155]
    ds_read_b128 v[80:83], v246 offset:4096
    v_add_f32 v132, v132, v148
    v_add_f32 v133, v133, v149
    v_mfma_f32_16x16x32_bf16 a[152:155], a[216:219], v[164:167], a[152:155]
    ds_read_b128 v[88:91], v247 offset:4096
    v_add_f32 v134, v134, v150
    v_add_f32 v135, v135, v151
    v_mfma_f32_16x16x32_bf16 a[156:159], a[220:223], v[164:167], a[156:159]
    ds_read_b128 v[96:99], v246 offset:8192
    v_mfma_f32_16x16x32_bf16 a[156:159], a[204:207], v[160:163], a[156:159]
    s_waitcnt vmcnt(16)
    s_mov_b32 s29, 0
    ds_read_b128 v[104:107], v247 offset:8192
    buffer_store_dwordx4 v[128:131], v238, s[56:59], s29 offen sc0 sc1
    s_waitcnt lgkmcnt(11)
    v_add_f32 v0, v0, v16
    s_waitcnt lgkmcnt(7)
    v_add_f32 v32, v32, v48
    v_mfma_f32_16x16x32_bf16 a[80:83], a[224:227], v[168:171], a[80:83]
    s_mov_b32 s32, 532480
    buffer_load_dwordx4 v[160:163], v238, s[20:23], s32 offen sc1
    ds_read_b128 v[112:115], v246 offset:12288
    v_add_f32 v1, v1, v17
    v_add_f32 v33, v33, v49
    v_mfma_f32_16x16x32_bf16 a[80:83], a[240:243], v[172:175], a[80:83]
    ds_read_b128 v[120:123], v247 offset:12288
    buffer_store_dwordx4 v[132:135], v238, s[56:59], s29 offen offset:1024 sc0 sc1
    v_add_f32 v2, v2, v18
    v_add_f32 v34, v34, v50
    v_mfma_f32_16x16x32_bf16 a[84:87], a[244:247], v[172:175], a[84:87]
    buffer_load_dwordx4 v[164:167], v238, s[20:23], s32 offen offset:1024 sc1
    v_add_f32 v3, v3, v19
    v_add_f32 v35, v35, v51
    v_mfma_f32_16x16x32_bf16 a[84:87], a[228:231], v[168:171], a[84:87]
    v_add_f32 v8, v8, v24
    s_waitcnt lgkmcnt(8)
    v_add_f32 v40, v40, v56
    v_mfma_f32_16x16x32_bf16 a[88:91], a[232:235], v[168:171], a[88:91]
    v_add_f32 v9, v9, v25
    v_add_f32 v41, v41, v57
    v_mfma_f32_16x16x32_bf16 a[88:91], a[248:251], v[172:175], a[88:91]
    v_add_f32 v10, v10, v26
    v_add_f32 v42, v42, v58
    v_mfma_f32_16x16x32_bf16 a[92:95], a[252:255], v[172:175], a[92:95]
    v_add_f32 v11, v11, v27
    v_add_f32 v43, v43, v59
    v_mfma_f32_16x16x32_bf16 a[92:95], a[236:239], v[168:171], a[92:95]
    s_waitcnt vmcnt(18)
    v_add_f32 v0, v0, v32
    v_add_f32 v1, v1, v33
    v_mfma_f32_16x16x32_bf16 a[96:99], a[224:227], v[176:179], a[96:99]
    s_mov_b32 s32, 12288
    buffer_load_dwordx4 v[168:171], v238, s[20:23], s32 offen offset:1024 sc1
    v_add_f32 v2, v2, v34
    v_add_f32 v3, v3, v35
    v_mfma_f32_16x16x32_bf16 a[96:99], a[240:243], v[180:183], a[96:99]
    v_add_f32 v8, v8, v40
    v_add_f32 v9, v9, v41
    v_mfma_f32_16x16x32_bf16 a[100:103], a[244:247], v[180:183], a[100:103]
    buffer_load_dwordx4 v[172:175], v238, s[20:23], s32 offen sc1
    v_add_f32 v10, v10, v42
    v_add_f32 v11, v11, v43
    v_mfma_f32_16x16x32_bf16 a[100:103], a[228:231], v[176:179], a[100:103]
    v_mfma_f32_16x16x32_bf16 a[104:107], a[232:235], v[176:179], a[104:107]
    s_waitcnt lgkmcnt(5)
    v_add_f32 v64, v64, v80
    s_waitcnt lgkmcnt(1)
    v_add_f32 v96, v96, v112
    v_mfma_f32_16x16x32_bf16 a[104:107], a[248:251], v[180:183], a[104:107]
    s_mov_b32 s29, 2048
    buffer_store_dwordx4 v[0:3], v238, s[56:59], s29 offen sc0 sc1
    v_add_f32 v65, v65, v81
    v_add_f32 v97, v97, v113
    v_mfma_f32_16x16x32_bf16 a[108:111], a[252:255], v[180:183], a[108:111]
    v_add_f32 v66, v66, v82
    v_add_f32 v98, v98, v114
    v_mfma_f32_16x16x32_bf16 a[108:111], a[236:239], v[176:179], a[108:111]
    s_waitcnt vmcnt(19)
    buffer_store_dwordx4 v[8:11], v238, s[56:59], s29 offen offset:1024 sc0 sc1
    v_add_f32 v67, v67, v83
    v_add_f32 v99, v99, v115
    v_mfma_f32_16x16x32_bf16 a[112:115], a[224:227], v[184:187], a[112:115]
    s_mov_b32 s32, 143360
    buffer_load_dwordx4 v[176:179], v238, s[20:23], s32 offen offset:1024 sc1
    v_add_f32 v72, v72, v88
    s_waitcnt lgkmcnt(0)
    v_add_f32 v104, v104, v120
    v_mfma_f32_16x16x32_bf16 a[112:115], a[240:243], v[188:191], a[112:115]
    v_add_f32 v73, v73, v89
    v_add_f32 v105, v105, v121
    v_mfma_f32_16x16x32_bf16 a[116:119], a[244:247], v[188:191], a[116:119]
    buffer_load_dwordx4 v[180:183], v238, s[20:23], s32 offen sc1
    v_add_f32 v74, v74, v90
    v_add_f32 v106, v106, v122
    v_mfma_f32_16x16x32_bf16 a[116:119], a[228:231], v[184:187], a[116:119]
    v_add_f32 v75, v75, v91
    v_add_f32 v107, v107, v123
    v_mfma_f32_16x16x32_bf16 a[120:123], a[232:235], v[184:187], a[120:123]
    v_add_f32 v64, v64, v96
    v_add_f32 v65, v65, v97
    v_mfma_f32_16x16x32_bf16 a[120:123], a[248:251], v[188:191], a[120:123]
    v_add_f32 v66, v66, v98
    v_add_f32 v67, v67, v99
    v_mfma_f32_16x16x32_bf16 a[124:127], a[252:255], v[188:191], a[124:127]
    v_add_f32 v72, v72, v104
    v_add_f32 v73, v73, v105
    v_mfma_f32_16x16x32_bf16 a[124:127], a[236:239], v[184:187], a[124:127]
    s_waitcnt vmcnt(20)
    v_add_f32 v74, v74, v106
    v_add_f32 v75, v75, v107
    v_mfma_f32_16x16x32_bf16 a[128:131], a[224:227], v[192:195], a[128:131]
    s_mov_b32 s32, 274432
    buffer_load_dwordx4 v[184:187], v238, s[20:23], s32 offen offset:1024 sc1
    v_mfma_f32_16x16x32_bf16 a[128:131], a[240:243], v[196:199], a[128:131]
    s_mov_b32 s29, 4096
    buffer_store_dwordx4 v[64:67], v238, s[56:59], s29 offen sc0 sc1
    v_mfma_f32_16x16x32_bf16 a[132:135], a[244:247], v[196:199], a[132:135]
    buffer_load_dwordx4 v[188:191], v238, s[20:23], s32 offen sc1
    v_mfma_f32_16x16x32_bf16 a[132:135], a[228:231], v[192:195], a[132:135]
    buffer_store_dwordx4 v[72:75], v238, s[56:59], s29 offen offset:1024 sc0 sc1
    v_mfma_f32_16x16x32_bf16 a[136:139], a[232:235], v[192:195], a[136:139]
    v_mfma_f32_16x16x32_bf16 a[136:139], a[248:251], v[196:199], a[136:139]
    v_mfma_f32_16x16x32_bf16 a[140:143], a[252:255], v[196:199], a[140:143]
    v_mfma_f32_16x16x32_bf16 a[140:143], a[236:239], v[192:195], a[140:143]
    s_waitcnt vmcnt(22)
    v_mfma_f32_16x16x32_bf16 a[144:147], a[224:227], v[216:219], a[144:147]
    s_mov_b32 s32, 405504
    buffer_load_dwordx4 v[192:195], v238, s[20:23], s32 offen offset:1024 sc1
    v_mfma_f32_16x16x32_bf16 a[144:147], a[240:243], v[228:231], a[144:147]
    v_mfma_f32_16x16x32_bf16 a[148:151], a[244:247], v[228:231], a[148:151]
    buffer_load_dwordx4 v[196:199], v238, s[20:23], s32 offen sc1
    v_mfma_f32_16x16x32_bf16 a[148:151], a[228:231], v[216:219], a[148:151]
    v_mfma_f32_16x16x32_bf16 a[152:155], a[232:235], v[216:219], a[152:155]
    v_mfma_f32_16x16x32_bf16 a[152:155], a[248:251], v[228:231], a[152:155]
    v_mfma_f32_16x16x32_bf16 a[156:159], a[252:255], v[228:231], a[156:159]
    v_mfma_f32_16x16x32_bf16 a[156:159], a[236:239], v[216:219], a[156:159]
    s_waitcnt vmcnt(22)
    v_mfma_f32_16x16x32_bf16 a[80:83], v[4:7], a[160:163], a[80:83]
    s_mov_b32 s32, 536576
    buffer_load_dwordx4 v[216:219], v238, s[20:23], s32 offen offset:1024 sc1
    v_mfma_f32_16x16x32_bf16 a[80:83], v[36:39], a[164:167], a[80:83]
    v_mfma_f32_16x16x32_bf16 a[84:87], v[44:47], a[164:167], a[84:87]
    buffer_load_dwordx4 v[228:231], v238, s[20:23], s32 offen sc1
    v_mfma_f32_16x16x32_bf16 a[84:87], v[12:15], a[160:163], a[84:87]
    v_mfma_f32_16x16x32_bf16 a[88:91], v[20:23], a[160:163], a[88:91]
    v_mfma_f32_16x16x32_bf16 a[88:91], v[52:55], a[164:167], a[88:91]
    v_mfma_f32_16x16x32_bf16 a[92:95], v[60:63], a[164:167], a[92:95]
    v_mfma_f32_16x16x32_bf16 a[92:95], v[28:31], a[160:163], a[92:95]
    s_waitcnt vmcnt(22)
    v_mfma_f32_16x16x32_bf16 a[96:99], v[4:7], a[168:171], a[96:99]
    v_mfma_f32_16x16x32_bf16 a[96:99], v[36:39], a[172:175], a[96:99]
    v_mfma_f32_16x16x32_bf16 a[100:103], v[44:47], a[172:175], a[100:103]
    v_mfma_f32_16x16x32_bf16 a[100:103], v[12:15], a[168:171], a[100:103]
    v_mfma_f32_16x16x32_bf16 a[104:107], v[20:23], a[168:171], a[104:107]
    v_mfma_f32_16x16x32_bf16 a[104:107], v[52:55], a[172:175], a[104:107]
    v_mfma_f32_16x16x32_bf16 a[108:111], v[60:63], a[172:175], a[108:111]
    v_mfma_f32_16x16x32_bf16 a[108:111], v[28:31], a[168:171], a[108:111]
    s_waitcnt vmcnt(20)
    v_mfma_f32_16x16x32_bf16 a[112:115], v[4:7], a[176:179], a[112:115]
    v_mfma_f32_16x16x32_bf16 a[112:115], v[36:39], a[180:183], a[112:115]
    v_mfma_f32_16x16x32_bf16 a[116:119], v[44:47], a[180:183], a[116:119]
    v_mfma_f32_16x16x32_bf16 a[116:119], v[12:15], a[176:179], a[116:119]
    v_mfma_f32_16x16x32_bf16 a[120:123], v[20:23], a[176:179], a[120:123]
    v_mfma_f32_16x16x32_bf16 a[120:123], v[52:55], a[180:183], a[120:123]
    v_mfma_f32_16x16x32_bf16 a[124:127], v[60:63], a[180:183], a[124:127]
    v_mfma_f32_16x16x32_bf16 a[124:127], v[28:31], a[176:179], a[124:127]
    s_waitcnt vmcnt(18)
    v_mfma_f32_16x16x32_bf16 a[128:131], v[4:7], a[184:187], a[128:131]
    v_mfma_f32_16x16x32_bf16 a[128:131], v[36:39], a[188:191], a[128:131]
    v_mfma_f32_16x16x32_bf16 a[132:135], v[44:47], a[188:191], a[132:135]
    v_mfma_f32_16x16x32_bf16 a[132:135], v[12:15], a[184:187], a[132:135]
    v_mfma_f32_16x16x32_bf16 a[136:139], v[20:23], a[184:187], a[136:139]
    v_mfma_f32_16x16x32_bf16 a[136:139], v[52:55], a[188:191], a[136:139]
    v_mfma_f32_16x16x32_bf16 a[140:143], v[60:63], a[188:191], a[140:143]
    v_mfma_f32_16x16x32_bf16 a[140:143], v[28:31], a[184:187], a[140:143]
    s_waitcnt vmcnt(14)
    v_mfma_f32_16x16x32_bf16 a[144:147], v[4:7], v[160:163], a[144:147]
    v_mfma_f32_16x16x32_bf16 a[144:147], v[36:39], v[164:167], a[144:147]
    v_mfma_f32_16x16x32_bf16 a[148:151], v[44:47], v[164:167], a[148:151]
    v_mfma_f32_16x16x32_bf16 a[148:151], v[12:15], v[160:163], a[148:151]
    v_mfma_f32_16x16x32_bf16 a[152:155], v[20:23], v[160:163], a[152:155]
    v_mfma_f32_16x16x32_bf16 a[152:155], v[52:55], v[164:167], a[152:155]
    v_mfma_f32_16x16x32_bf16 a[156:159], v[60:63], v[164:167], a[156:159]
    v_mfma_f32_16x16x32_bf16 a[156:159], v[28:31], v[160:163], a[156:159]
    s_waitcnt vmcnt(12)
    v_mfma_f32_16x16x32_bf16 a[80:83], v[68:71], v[168:171], a[80:83]
    v_mfma_f32_16x16x32_bf16 a[80:83], v[100:103], v[172:175], a[80:83]
    v_mfma_f32_16x16x32_bf16 a[84:87], v[108:111], v[172:175], a[84:87]
    v_mfma_f32_16x16x32_bf16 a[84:87], v[76:79], v[168:171], a[84:87]
    v_mfma_f32_16x16x32_bf16 a[88:91], v[84:87], v[168:171], a[88:91]
    v_mfma_f32_16x16x32_bf16 a[88:91], v[116:119], v[172:175], a[88:91]
    v_mfma_f32_16x16x32_bf16 a[92:95], v[124:127], v[172:175], a[92:95]
    v_mfma_f32_16x16x32_bf16 a[92:95], v[92:95], v[168:171], a[92:95]
    s_waitcnt vmcnt(8)
    v_mfma_f32_16x16x32_bf16 a[96:99], v[68:71], v[176:179], a[96:99]
    v_mfma_f32_16x16x32_bf16 a[96:99], v[100:103], v[180:183], a[96:99]
    ds_write_b128 v232, a[80:83] offset:16384
    v_mfma_f32_16x16x32_bf16 a[100:103], v[108:111], v[180:183], a[100:103]
    v_mfma_f32_16x16x32_bf16 a[100:103], v[76:79], v[176:179], a[100:103]
    ds_write_b128 v233, a[84:87] offset:16384
    v_mfma_f32_16x16x32_bf16 a[104:107], v[84:87], v[176:179], a[104:107]
    v_mfma_f32_16x16x32_bf16 a[104:107], v[116:119], v[180:183], a[104:107]
    ds_write_b128 v234, a[88:91] offset:16384
    v_mfma_f32_16x16x32_bf16 a[108:111], v[124:127], v[180:183], a[108:111]
    v_mov_b32 v254, 1
    v_mfma_f32_16x16x32_bf16 a[108:111], v[92:95], v[176:179], a[108:111]
    s_waitcnt vmcnt(5)
    s_waitcnt vmcnt(4)
    ds_write_b128 v235, a[92:95] offset:16384
    buffer_store_dword v254, v253, s[60:63], s52 offen sc0 sc1
    v_mfma_f32_16x16x32_bf16 a[112:115], v[68:71], v[184:187], a[112:115]
    v_mfma_f32_16x16x32_bf16 a[112:115], v[100:103], v[188:191], a[112:115]
    ds_write_b128 v232, a[96:99] offset:32768
    v_mfma_f32_16x16x32_bf16 a[116:119], v[108:111], v[188:191], a[116:119]
    v_mfma_f32_16x16x32_bf16 a[116:119], v[76:79], v[184:187], a[116:119]
    ds_write_b128 v233, a[100:103] offset:32768
    v_mfma_f32_16x16x32_bf16 a[120:123], v[84:87], v[184:187], a[120:123]
    v_mfma_f32_16x16x32_bf16 a[120:123], v[116:119], v[188:191], a[120:123]
    ds_write_b128 v234, a[104:107] offset:32768
    v_mfma_f32_16x16x32_bf16 a[124:127], v[124:127], v[188:191], a[124:127]
    v_mfma_f32_16x16x32_bf16 a[124:127], v[92:95], v[184:187], a[124:127]
    s_waitcnt vmcnt(3)
    ds_write_b128 v235, a[108:111] offset:32768
    v_mfma_f32_16x16x32_bf16 a[128:131], v[68:71], v[192:195], a[128:131]
    v_mfma_f32_16x16x32_bf16 a[128:131], v[100:103], v[196:199], a[128:131]
    ds_write_b128 v232, a[112:115] offset:49152
    v_mfma_f32_16x16x32_bf16 a[132:135], v[108:111], v[196:199], a[132:135]
    v_mfma_f32_16x16x32_bf16 a[132:135], v[76:79], v[192:195], a[132:135]
    ds_write_b128 v233, a[116:119] offset:49152
    v_mfma_f32_16x16x32_bf16 a[136:139], v[84:87], v[192:195], a[136:139]
    v_mfma_f32_16x16x32_bf16 a[136:139], v[116:119], v[196:199], a[136:139]
    ds_write_b128 v234, a[120:123] offset:49152
    v_mfma_f32_16x16x32_bf16 a[140:143], v[124:127], v[196:199], a[140:143]
    v_mfma_f32_16x16x32_bf16 a[140:143], v[92:95], v[192:195], a[140:143]
    s_waitcnt vmcnt(1)
    ds_write_b128 v235, a[124:127] offset:49152
    v_mfma_f32_16x16x32_bf16 a[144:147], v[68:71], v[216:219], a[144:147]
    v_add_u32 v232, 0x10000, v232
    v_mfma_f32_16x16x32_bf16 a[144:147], v[100:103], v[228:231], a[144:147]
    ds_write_b128 v232, a[128:131] offset:0
    v_mfma_f32_16x16x32_bf16 a[148:151], v[108:111], v[228:231], a[148:151]
    v_add_u32 v233, 0x10000, v233
    v_mfma_f32_16x16x32_bf16 a[148:151], v[76:79], v[216:219], a[148:151]
    ds_write_b128 v233, a[132:135] offset:0
    v_mfma_f32_16x16x32_bf16 a[152:155], v[84:87], v[216:219], a[152:155]
    v_add_u32 v234, 0x10000, v234
    v_mfma_f32_16x16x32_bf16 a[152:155], v[116:119], v[228:231], a[152:155]
    ds_write_b128 v234, a[136:139] offset:0
    v_mfma_f32_16x16x32_bf16 a[156:159], v[124:127], v[228:231], a[156:159]
    v_add_u32 v235, 0x10000, v235
    v_mfma_f32_16x16x32_bf16 a[156:159], v[92:95], v[216:219], a[156:159]
    ds_write_b128 v235, a[140:143] offset:0
    buffer_load_dword v252, v239, s[60:63], s33 offen sc0 sc1
    s_nop 1
    ds_write_b128 v232, a[144:147] offset:16384
    s_nop 1
    ds_write_b128 v233, a[148:151] offset:16384
    s_nop 1
    ds_write_b128 v234, a[152:155] offset:16384
    s_nop 1
    ds_write_b128 v235, a[156:159] offset:16384
    s_waitcnt vmcnt(0)
    v_cmp_gt_u32 vcc, 1, v252
    s_waitcnt lgkmcnt(0)
    s_nop 3
    s_cbranch_vccnz L_poll3
L_go3:
    s_mov_b32 s29, 0
    buffer_load_dwordx4 v[4:7], v238, s[4:7], s29 offen sc1
    buffer_load_dwordx4 v[12:15], v238, s[4:7], s29 offen offset:1024 sc1
    s_mov_b32 s29, 2048
    buffer_load_dwordx4 v[20:23], v238, s[4:7], s29 offen sc1
    buffer_load_dwordx4 v[28:31], v238, s[4:7], s29 offen offset:1024 sc1
    s_mov_b32 s29, 4096
    buffer_load_dwordx4 v[36:39], v238, s[4:7], s29 offen sc1
    buffer_load_dwordx4 v[44:47], v238, s[4:7], s29 offen offset:1024 sc1
    s_barrier
    ds_read_b128 v[128:131], v246 offset:16384
    ds_read_b128 v[132:135], v247 offset:16384
    ds_read_b128 v[136:139], v246 offset:20480
    ds_read_b128 v[140:143], v247 offset:20480
    ds_read_b128 v[144:147], v246 offset:24576
    ds_read_b128 v[148:151], v247 offset:24576
    ds_read_b128 v[152:155], v246 offset:28672
    ds_read_b128 v[156:159], v247 offset:28672
    ds_read_b128 v[0:3], v246 offset:49152
    ds_read_b128 v[8:11], v247 offset:49152
    ds_read_b128 v[16:19], v246 offset:53248
    ds_read_b128 v[24:27], v247 offset:53248
    ds_read_b128 v[32:35], v246 offset:57344
    ds_read_b128 v[40:43], v247 offset:57344
    ds_read_b128 v[48:51], v246 offset:61440
    ds_read_b128 v[56:59], v247 offset:61440
    s_waitcnt lgkmcnt(13)
    v_add_f32 v128, v128, v136
    s_waitcnt lgkmcnt(9)
    v_add_f32 v144, v144, v152
    v_add_f32 v129, v129, v137
    v_add_f32 v145, v145, v153
    v_add_f32 v130, v130, v138
    v_add_f32 v146, v146, v154
    v_add_f32 v131, v131, v139
    v_add_f32 v147, v147, v155
    v_add_f32 v132, v132, v140
    s_waitcnt lgkmcnt(8)
    v_add_f32 v148, v148, v156
    v_add_f32 v133, v133, v141
    v_add_f32 v149, v149, v157
    v_add_f32 v134, v134, v142
    v_add_f32 v150, v150, v158
    v_add_f32 v135, v135, v143
    v_add_f32 v151, v151, v159
    v_add_f32 v128, v128, v144
    v_add_f32 v129, v129, v145
    v_add_f32 v130, v130, v146
    v_add_f32 v131, v131, v147
    v_add_f32 v132, v132, v148
    v_add_f32 v133, v133, v149
    v_add_f32 v134, v134, v150
    v_add_f32 v135, v135, v151
    s_waitcnt vmcnt(4)
    v_add_f32 v128, v128, v4
    v_add_f32 v129, v129, v5
    v_add_f32 v130, v130, v6
    v_add_f32 v131, v131, v7
    v_add_f32 v132, v132, v12
    v_add_f32 v133, v133, v13
    v_add_f32 v134, v134, v14
    v_add_f32 v135, v135, v15
    v_cvt_pk_bf16_f32 v128, v128, v129
    v_cvt_pk_bf16_f32 v129, v130, v131
    v_cvt_pk_bf16_f32 v130, v132, v133
    v_cvt_pk_bf16_f32 v131, v134, v135
    buffer_store_dwordx4 v[128:131], v248, s[16:19], s28 offen
    s_add_u32 s28, s28, 32768
    s_waitcnt lgkmcnt(5)
    v_add_f32 v0, v0, v16
    s_waitcnt lgkmcnt(1)
    v_add_f32 v32, v32, v48
    v_add_f32 v1, v1, v17
    v_add_f32 v33, v33, v49
    v_add_f32 v2, v2, v18
    v_add_f32 v34, v34, v50
    v_add_f32 v3, v3, v19
    v_add_f32 v35, v35, v51
    v_add_f32 v8, v8, v24
    s_waitcnt lgkmcnt(0)
    v_add_f32 v40, v40, v56
    v_add_f32 v9, v9, v25
    v_add_f32 v41, v41, v57
    v_add_f32 v10, v10, v26
    v_add_f32 v42, v42, v58
    v_add_f32 v11, v11, v27
    v_add_f32 v43, v43, v59
    v_add_f32 v0, v0, v32
    v_add_f32 v1, v1, v33
    v_add_f32 v2, v2, v34
    v_add_f32 v3, v3, v35
    v_add_f32 v8, v8, v40
    v_add_f32 v9, v9, v41
    v_add_f32 v10, v10, v42
    v_add_f32 v11, v11, v43
    s_waitcnt vmcnt(3)
    v_add_f32 v0, v0, v20
    v_add_f32 v1, v1, v21
    v_add_f32 v2, v2, v22
    v_add_f32 v3, v3, v23
    v_add_f32 v8, v8, v28
    v_add_f32 v9, v9, v29
    v_add_f32 v10, v10, v30
    v_add_f32 v11, v11, v31
    v_cvt_pk_bf16_f32 v0, v0, v1
    v_cvt_pk_bf16_f32 v1, v2, v3
    v_cvt_pk_bf16_f32 v2, v8, v9
    v_cvt_pk_bf16_f32 v3, v10, v11
    buffer_store_dwordx4 v[0:3], v248, s[16:19], s28 offen
    s_add_u32 s28, s28, 32768
    s_cmp_ge_u32 s24, 2
    s_cbranch_scc1 L_end
    s_cmp_ge_u32 s55, 3
    s_cbranch_scc1 L_end
    v_add_u32 v246, 0x10000, v246
    v_add_u32 v247, 0x10000, v247
    ds_read_b128 v[64:67], v246 offset:16384
    ds_read_b128 v[72:75], v247 offset:16384
    ds_read_b128 v[80:83], v246 offset:20480
    ds_read_b128 v[88:91], v247 offset:20480
    ds_read_b128 v[96:99], v246 offset:24576
    ds_read_b128 v[104:107], v247 offset:24576
    ds_read_b128 v[112:115], v246 offset:28672
    ds_read_b128 v[120:123], v247 offset:28672
    s_waitcnt lgkmcnt(5)
    v_add_f32 v64, v64, v80
    s_waitcnt lgkmcnt(1)
    v_add_f32 v96, v96, v112
    v_add_f32 v65, v65, v81
    v_add_f32 v97, v97, v113
    v_add_f32 v66, v66, v82
    v_add_f32 v98, v98, v114
    v_add_f32 v67, v67, v83
    v_add_f32 v99, v99, v115
    v_add_f32 v72, v72, v88
    s_waitcnt lgkmcnt(0)
    v_add_f32 v104, v104, v120
    v_add_f32 v73, v73, v89
    v_add_f32 v105, v105, v121
    v_add_f32 v74, v74, v90
    v_add_f32 v106, v106, v122
    v_add_f32 v75, v75, v91
    v_add_f32 v107, v107, v123
    v_add_f32 v64, v64, v96
    v_add_f32 v65, v65, v97
    v_add_f32 v66, v66, v98
    v_add_f32 v67, v67, v99
    v_add_f32 v72, v72, v104
    v_add_f32 v73, v73, v105
    v_add_f32 v74, v74, v106
    v_add_f32 v75, v75, v107
    s_waitcnt vmcnt(2)
    v_add_f32 v64, v64, v36
    v_add_f32 v65, v65, v37
    v_add_f32 v66, v66, v38
    v_add_f32 v67, v67, v39
    v_add_f32 v72, v72, v44
    v_add_f32 v73, v73, v45
    v_add_f32 v74, v74, v46
    v_add_f32 v75, v75, v47
    v_cvt_pk_bf16_f32 v64, v64, v65
    v_cvt_pk_bf16_f32 v65, v66, v67
    v_cvt_pk_bf16_f32 v66, v72, v73
    v_cvt_pk_bf16_f32 v67, v74, v75
    buffer_store_dwordx4 v[64:67], v248, s[16:19], s28 offen
    s_add_u32 s28, s28, 32768
L_end:
    s_endpgm
L_poll2:
    buffer_load_dword v252, v255, s[60:63], s30 offen sc0 sc1
    s_waitcnt vmcnt(0)
    v_cmp_gt_u32 vcc, 2, v252
    s_sub_u32 s31, s31, 1
    s_nop 3
    s_cbranch_vccz L_go2
    s_cmp_gt_i32 s31, 0
    s_cbranch_scc1 L_poll2
    s_branch L_go2
L_poll3:
    buffer_load_dword v252, v239, s[60:63], s33 offen sc0 sc1
    s_waitcnt vmcnt(0)
    v_cmp_gt_u32 vcc, 1, v252
    s_sub_u32 s31, s31, 1
    s_nop 3
    s_cbranch_vccz L_go3
    s_cmp_gt_i32 s31, 0
    s_cbranch_scc1 L_poll3
    s_branch L_go3
L_varB:
    v_and_b32 v255, 7, v237
    v_lshlrev_b32 v255, 5, v255
    v_mov_b32 v254, 1
    s_and_b32 s28, s1, 16
    s_lshl_b32 s32, s24, 2
    s_add_u32 s28, s28, s32
    s_bfe_u32 s32, s1, 0x20001
    s_add_u32 s28, s28, s32
    s_lshl_b32 s28, s28, 1
    s_bfe_u32 s32, s1, 0x10003
    s_add_u32 s28, s28, s32
    s_lshl_b32 s28, s28, 1
    s_and_b32 s32, s1, 1
    s_add_u32 s28, s28, s32
    s_lshl_b32 s28, s28, 15
    s_add_u32 m0, s35, 40960
    s_add_u32 s27, s87, 0
    buffer_load_dwordx4 v223, s[4:7], s27 offen lds
    s_add_u32 s27, s87, 7168
    buffer_load_dwordx4 v224, s[4:7], s27 offen offset:1024 lds
    s_add_u32 s27, s87, 14336
    buffer_load_dwordx4 v223, s[4:7], s27 offen offset:2048 lds
    s_add_u32 s27, s87, 21504
    buffer_load_dwordx4 v224, s[4:7], s27 offen offset:3072 lds
    s_add_u32 m0, s35, 45056
    s_add_u32 s27, s87, 32768
    buffer_load_dwordx4 v223, s[4:7], s27 offen lds
    s_add_u32 s27, s87, 39936
    buffer_load_dwordx4 v224, s[4:7], s27 offen offset:1024 lds
    s_add_u32 s27, s87, 47104
    buffer_load_dwordx4 v223, s[4:7], s27 offen offset:2048 lds
    s_add_u32 s27, s87, 54272
    buffer_load_dwordx4 v224, s[4:7], s27 offen offset:3072 lds
    s_waitcnt vmcnt(14)
    s_barrier
    ds_read_b64_tr_b16 a[240:241], v229 offset:0
    ds_read_b64_tr_b16 a[242:243], v229 offset:1024
    ds_read_b64_tr_b16 a[244:245], v229 offset:8192
    ds_read_b64_tr_b16 a[246:247], v229 offset:9216
    ds_read_b128 a[160:163], v227 offset:0
    ds_read_b128 a[164:167], v228 offset:0
    ds_read_b128 a[168:171], v227 offset:2048
    ds_read_b128 a[172:175], v228 offset:2048
    ds_read_b128 a[176:179], v227 offset:4096
    ds_read_b128 a[180:183], v228 offset:4096
    ds_read_b128 a[184:187], v227 offset:6144
    ds_read_b128 a[188:191], v228 offset:6144
    s_waitcnt lgkmcnt(7)
    v_mfma_f32_16x16x32_bf16 v[0:3], a[240:243], a[160:163], 0
    s_waitcnt lgkmcnt(6)
    ds_read_b64_tr_b16 a[248:249], v230 offset:0
    v_mfma_f32_16x16x32_bf16 v[0:3], a[244:247], a[164:167], v[0:3]
    s_waitcnt lgkmcnt(5)
    s_mov_b32 m0, 147456
    ds_read_b64_tr_b16 a[250:251], v230 offset:1024
    v_mfma_f32_16x16x32_bf16 v[32:35], a[244:247], a[172:175], 0
    s_add_u32 s27, s96, 0
    ds_read_b64_tr_b16 a[252:253], v230 offset:8192
    buffer_load_dwordx4 v225, s[8:11], s27 offen lds
    v_mfma_f32_16x16x32_bf16 v[32:35], a[240:243], a[168:171], v[32:35]
    s_waitcnt lgkmcnt(6)
    ds_read_b64_tr_b16 a[254:255], v230 offset:9216
    v_mfma_f32_16x16x32_bf16 v[64:67], a[240:243], a[176:179], 0
    s_waitcnt lgkmcnt(6)
    s_add_u32 s27, s96, 31744
    buffer_load_dwordx4 v225, s[8:11], s27 offen offset:1024 lds
    v_mfma_f32_16x16x32_bf16 v[64:67], a[244:247], a[180:183], v[64:67]
    s_waitcnt lgkmcnt(4)
    v_mfma_f32_16x16x32_bf16 v[96:99], a[244:247], a[188:191], 0
    s_add_u32 s27, s96, 63488
    buffer_load_dwordx4 v226, s[8:11], s27 offen offset:2048 lds
    v_mfma_f32_16x16x32_bf16 v[96:99], a[240:243], a[184:187], v[96:99]
    s_waitcnt lgkmcnt(2)
    v_mfma_f32_16x16x32_bf16 v[4:7], a[248:251], a[160:163], 0
    s_waitcnt lgkmcnt(0)
    ds_read_b64_tr_b16 a[240:241], v231 offset:0
    v_mfma_f32_16x16x32_bf16 v[4:7], a[252:255], a[164:167], v[4:7]
    s_add_u32 s27, s96, 95232
    ds_read_b64_tr_b16 a[242:243], v231 offset:1024
    buffer_load_dwordx4 v226, s[8:11], s27 offen offset:3072 lds
    v_mfma_f32_16x16x32_bf16 v[36:39], a[252:255], a[172:175], 0
    s_add_u32 m0, s35, 0
    ds_read_b64_tr_b16 a[244:245], v231 offset:8192
    v_mfma_f32_16x16x32_bf16 v[36:39], a[248:251], a[168:171], v[36:39]
    s_add_u32 s27, s88, 0
    ds_read_b64_tr_b16 a[246:247], v231 offset:9216
    buffer_load_dwordx4 v223, s[4:7], s27 offen lds
    v_mfma_f32_16x16x32_bf16 v[68:71], a[248:251], a[176:179], 0
    v_mfma_f32_16x16x32_bf16 v[68:71], a[252:255], a[180:183], v[68:71]
    s_add_u32 s27, s88, 7168
    buffer_load_dwordx4 v224, s[4:7], s27 offen offset:1024 lds
    v_mfma_f32_16x16x32_bf16 v[100:103], a[252:255], a[188:191], 0
    v_mfma_f32_16x16x32_bf16 v[100:103], a[248:251], a[184:187], v[100:103]
    s_waitcnt lgkmcnt(2)
    v_mfma_f32_16x16x32_bf16 v[8:11], a[240:243], a[160:163], 0
    s_waitcnt lgkmcnt(0)
    s_add_u32 s27, s88, 14336
    ds_read_b64_tr_b16 a[248:249], v232 offset:0
    buffer_load_dwordx4 v223, s[4:7], s27 offen offset:2048 lds
    v_mfma_f32_16x16x32_bf16 v[8:11], a[244:247], a[164:167], v[8:11]
    ds_read_b64_tr_b16 a[250:251], v232 offset:1024
    v_mfma_f32_16x16x32_bf16 v[40:43], a[244:247], a[172:175], 0
    ds_read_b64_tr_b16 a[252:253], v232 offset:8192
    v_mfma_f32_16x16x32_bf16 v[40:43], a[240:243], a[168:171], v[40:43]
    s_add_u32 s27, s88, 21504
    ds_read_b64_tr_b16 a[254:255], v232 offset:9216
    buffer_load_dwordx4 v224, s[4:7], s27 offen offset:3072 lds
    v_mfma_f32_16x16x32_bf16 v[72:75], a[240:243], a[176:179], 0
    s_mov_b32 m0, 151552
    v_mfma_f32_16x16x32_bf16 v[72:75], a[244:247], a[180:183], v[72:75]
    s_add_u32 s27, s96, 131072
    buffer_load_dwordx4 v225, s[8:11], s27 offen lds
    v_mfma_f32_16x16x32_bf16 v[104:107], a[244:247], a[188:191], 0
    v_mfma_f32_16x16x32_bf16 v[104:107], a[240:243], a[184:187], v[104:107]
    s_waitcnt lgkmcnt(2)
    v_mfma_f32_16x16x32_bf16 v[12:15], a[248:251], a[160:163], 0
    s_waitcnt lgkmcnt(0)
    s_add_u32 s27, s96, 162816
    ds_read_b64_tr_b16 a[240:241], v233 offset:0
    buffer_load_dwordx4 v225, s[8:11], s27 offen offset:1024 lds
    v_mfma_f32_16x16x32_bf16 v[12:15], a[252:255], a[164:167], v[12:15]
    ds_read_b64_tr_b16 a[242:243], v233 offset:1024
    v_mfma_f32_16x16x32_bf16 v[44:47], a[252:255], a[172:175], 0
    ds_read_b64_tr_b16 a[244:245], v233 offset:8192
    v_mfma_f32_16x16x32_bf16 v[44:47], a[248:251], a[168:171], v[44:47]
    s_add_u32 s27, s96, 194560
    ds_read_b64_tr_b16 a[246:247], v233 offset:9216
    buffer_load_dwordx4 v226, s[8:11], s27 offen offset:2048 lds
    v_mfma_f32_16x16x32_bf16 v[76:79], a[248:251], a[176:179], 0
    v_mfma_f32_16x16x32_bf16 v[76:79], a[252:255], a[180:183], v[76:79]
    s_add_u32 s27, s96, 226304
    buffer_load_dwordx4 v226, s[8:11], s27 offen offset:3072 lds
    v_mfma_f32_16x16x32_bf16 v[108:111], a[252:255], a[188:191], 0
    v_mfma_f32_16x16x32_bf16 v[108:111], a[248:251], a[184:187], v[108:111]
    s_waitcnt lgkmcnt(2)
    s_add_u32 m0, s35, 4096
    v_mfma_f32_16x16x32_bf16 v[16:19], a[240:243], a[160:163], 0
    s_waitcnt lgkmcnt(0)
    s_add_u32 s27, s88, 32768
    ds_read_b64_tr_b16 a[248:249], v234 offset:0
    buffer_load_dwordx4 v223, s[4:7], s27 offen lds
    v_mfma_f32_16x16x32_bf16 v[16:19], a[244:247], a[164:167], v[16:19]
    ds_read_b64_tr_b16 a[250:251], v234 offset:1024
    v_mfma_f32_16x16x32_bf16 v[48:51], a[244:247], a[172:175], 0
    ds_read_b64_tr_b16 a[252:253], v234 offset:8192
    v_mfma_f32_16x16x32_bf16 v[48:51], a[240:243], a[168:171], v[48:51]
    s_add_u32 s27, s88, 39936
    s_waitcnt vmcnt(13)
    ds_read_b64_tr_b16 a[254:255], v234 offset:9216
    buffer_load_dwordx4 v224, s[4:7], s27 offen offset:1024 lds
    v_mfma_f32_16x16x32_bf16 v[80:83], a[240:243], a[176:179], 0
    ds_read_b128 a[200:203], v227 offset:40960
    v_mfma_f32_16x16x32_bf16 v[80:83], a[244:247], a[180:183], v[80:83]
    s_add_u32 s27, s88, 47104
    buffer_load_dwordx4 v223, s[4:7], s27 offen offset:2048 lds
    ds_read_b128 a[204:207], v228 offset:40960
    v_mfma_f32_16x16x32_bf16 v[112:115], a[244:247], a[188:191], 0
    ds_read_b128 a[208:211], v227 offset:43008
    v_mfma_f32_16x16x32_bf16 v[112:115], a[240:243], a[184:187], v[112:115]
    s_waitcnt lgkmcnt(5)
    ds_read_b128 a[212:215], v228 offset:43008
    v_mfma_f32_16x16x32_bf16 v[20:23], a[248:251], a[160:163], 0
    s_waitcnt lgkmcnt(4)
    s_add_u32 s27, s88, 54272
    ds_read_b64_tr_b16 a[240:241], v235 offset:0
    buffer_load_dwordx4 v224, s[4:7], s27 offen offset:3072 lds
    v_mfma_f32_16x16x32_bf16 v[20:23], a[252:255], a[164:167], v[20:23]
    ds_read_b64_tr_b16 a[242:243], v235 offset:1024
    v_mfma_f32_16x16x32_bf16 v[52:55], a[252:255], a[172:175], 0
    s_mov_b32 m0, 155648
    ds_read_b64_tr_b16 a[244:245], v235 offset:8192
    v_mfma_f32_16x16x32_bf16 v[52:55], a[248:251], a[168:171], v[52:55]
    s_add_u32 s27, s96, 262144
    ds_read_b64_tr_b16 a[246:247], v235 offset:9216
    buffer_load_dwordx4 v225, s[8:11], s27 offen lds
    v_mfma_f32_16x16x32_bf16 v[84:87], a[248:251], a[176:179], 0
    ds_read_b128 a[216:219], v227 offset:45056
    v_mfma_f32_16x16x32_bf16 v[84:87], a[252:255], a[180:183], v[84:87]
    s_add_u32 s27, s96, 293888
    buffer_load_dwordx4 v225, s[8:11], s27 offen offset:1024 lds
    ds_read_b128 a[220:223], v228 offset:45056
    v_mfma_f32_16x16x32_bf16 v[116:119], a[252:255], a[188:191], 0
    ds_read_b128 a[224:227], v227 offset:47104
    v_mfma_f32_16x16x32_bf16 v[116:119], a[248:251], a[184:187], v[116:119]
    s_waitcnt lgkmcnt(5)
    ds_read_b128 a[228:231], v228 offset:47104
    v_mfma_f32_16x16x32_bf16 v[24:27], a[240:243], a[160:163], 0
    s_waitcnt lgkmcnt(4)
    s_add_u32 s27, s96, 325632
    ds_read_b64_tr_b16 a[248:249], v236 offset:0
    buffer_load_dwordx4 v226, s[8:11], s27 offen offset:2048 lds
    v_mfma_f32_16x16x32_bf16 v[24:27], a[244:247], a[164:167], v[24:27]
    ds_read_b64_tr_b16 a[250:251], v236 offset:1024
    v_mfma_f32_16x16x32_bf16 v[56:59], a[244:247], a[172:175], 0
    ds_read_b64_tr_b16 a[252:253], v236 offset:8192
    v_mfma_f32_16x16x32_bf16 v[56:59], a[240:243], a[168:171], v[56:59]
    s_add_u32 s27, s96, 357376
    ds_read_b64_tr_b16 a[254:255], v236 offset:9216
    buffer_load_dwordx4 v226, s[8:11], s27 offen offset:3072 lds
    v_mfma_f32_16x16x32_bf16 v[88:91], a[240:243], a[176:179], 0
    s_mov_b32 m0, 159744
    v_mfma_f32_16x16x32_bf16 v[88:91], a[244:247], a[180:183], v[88:91]
    s_add_u32 s27, s96, 393216
    buffer_load_dwordx4 v225, s[8:11], s27 offen lds
    v_mfma_f32_16x16x32_bf16 v[120:123], a[244:247], a[188:191], 0
    v_mfma_f32_16x16x32_bf16 v[120:123], a[240:243], a[184:187], v[120:123]
    s_waitcnt vmcnt(21) lgkmcnt(0)
    s_barrier
    v_mfma_f32_16x16x32_bf16 v[28:31], a[248:251], a[160:163], 0
    s_add_u32 s27, s96, 424960
    buffer_load_dwordx4 v225, s[8:11], s27 offen offset:1024 lds
    ds_read_b64_tr_b16 a[240:241], v229 offset:16384
    v_mfma_f32_16x16x32_bf16 v[28:31], a[252:255], a[164:167], v[28:31]
    ds_read_b64_tr_b16 a[242:243], v229 offset:17408
    v_mfma_f32_16x16x32_bf16 v[60:63], a[252:255], a[172:175], 0
    ds_read_b64_tr_b16 a[244:245], v229 offset:24576
    v_mfma_f32_16x16x32_bf16 v[60:63], a[248:251], a[168:171], v[60:63]
    s_add_u32 s27, s96, 456704
    buffer_load_dwordx4 v226, s[8:11], s27 offen offset:2048 lds
    ds_read_b64_tr_b16 a[246:247], v229 offset:25600
    v_mfma_f32_16x16x32_bf16 v[92:95], a[248:251], a[176:179], 0
    v_mfma_f32_16x16x32_bf16 v[92:95], a[252:255], a[180:183], v[92:95]
    v_mfma_f32_16x16x32_bf16 v[124:127], a[252:255], a[188:191], 0
    s_add_u32 s27, s96, 488448
    buffer_load_dwordx4 v226, s[8:11], s27 offen offset:3072 lds
    v_mfma_f32_16x16x32_bf16 v[124:127], a[248:251], a[184:187], v[124:127]
    s_waitcnt lgkmcnt(2)
    v_mfma_f32_16x16x32_bf16 v[0:3], a[240:243], a[200:203], v[0:3]
    s_waitcnt lgkmcnt(0)
    ds_read_b64_tr_b16 a[248:249], v230 offset:16384
    v_mfma_f32_16x16x32_bf16 v[0:3], a[244:247], a[204:207], v[0:3]
    ds_read_b64_tr_b16 a[250:251], v230 offset:17408
    v_mfma_f32_16x16x32_bf16 v[32:35], a[244:247], a[212:215], v[32:35]
    s_mov_b32 m0, 114688
    ds_read_b64_tr_b16 a[252:253], v230 offset:24576
    v_mfma_f32_16x16x32_bf16 v[32:35], a[240:243], a[208:211], v[32:35]
    s_add_u32 s27, s97, 0
    ds_read_b64_tr_b16 a[254:255], v230 offset:25600
    buffer_load_dwordx4 v225, s[8:11], s27 offen lds
    v_mfma_f32_16x16x32_bf16 v[64:67], a[240:243], a[216:219], v[64:67]
    s_add_u32 s27, s97, 31744
    buffer_load_dwordx4 v225, s[8:11], s27 offen offset:1024 lds
    v_mfma_f32_16x16x32_bf16 v[64:67], a[244:247], a[220:223], v[64:67]
    v_mfma_f32_16x16x32_bf16 v[96:99], a[244:247], a[228:231], v[96:99]
    s_add_u32 s27, s97, 63488
    buffer_load_dwordx4 v226, s[8:11], s27 offen offset:2048 lds
    v_mfma_f32_16x16x32_bf16 v[96:99], a[240:243], a[224:227], v[96:99]
    s_waitcnt lgkmcnt(2)
    v_mfma_f32_16x16x32_bf16 v[4:7], a[248:251], a[200:203], v[4:7]
    s_waitcnt lgkmcnt(0)
    s_add_u32 s27, s97, 95232
    ds_read_b64_tr_b16 a[240:241], v231 offset:16384
    buffer_load_dwordx4 v226, s[8:11], s27 offen offset:3072 lds
    v_mfma_f32_16x16x32_bf16 v[4:7], a[252:255], a[204:207], v[4:7]
    ds_read_b64_tr_b16 a[242:243], v231 offset:17408
    v_mfma_f32_16x16x32_bf16 v[36:39], a[252:255], a[212:215], v[36:39]
    s_add_u32 m0, s35, 40960
    ds_read_b64_tr_b16 a[244:245], v231 offset:24576
    v_mfma_f32_16x16x32_bf16 v[36:39], a[248:251], a[208:211], v[36:39]
    s_add_u32 s27, s89, 0
    ds_read_b64_tr_b16 a[246:247], v231 offset:25600
    buffer_load_dwordx4 v223, s[4:7], s27 offen lds
    v_mfma_f32_16x16x32_bf16 v[68:71], a[248:251], a[216:219], v[68:71]
    v_mfma_f32_16x16x32_bf16 v[68:71], a[252:255], a[220:223], v[68:71]
    s_add_u32 s27, s89, 7168
    buffer_load_dwordx4 v224, s[4:7], s27 offen offset:1024 lds
    v_mfma_f32_16x16x32_bf16 v[100:103], a[252:255], a[228:231], v[100:103]
    v_mfma_f32_16x16x32_bf16 v[100:103], a[248:251], a[224:227], v[100:103]
    s_waitcnt lgkmcnt(2)
    v_mfma_f32_16x16x32_bf16 v[8:11], a[240:243], a[200:203], v[8:11]
    s_waitcnt lgkmcnt(0)
    s_add_u32 s27, s89, 14336
    ds_read_b64_tr_b16 a[248:249], v232 offset:16384
    buffer_load_dwordx4 v223, s[4:7], s27 offen offset:2048 lds
    v_mfma_f32_16x16x32_bf16 v[8:11], a[244:247], a[204:207], v[8:11]
    ds_read_b64_tr_b16 a[250:251], v232 offset:17408
    v_mfma_f32_16x16x32_bf16 v[40:43], a[244:247], a[212:215], v[40:43]
    ds_read_b64_tr_b16 a[252:253], v232 offset:24576
    v_mfma_f32_16x16x32_bf16 v[40:43], a[240:243], a[208:211], v[40:43]
    s_add_u32 s27, s89, 21504
    ds_read_b64_tr_b16 a[254:255], v232 offset:25600
    buffer_load_dwordx4 v224, s[4:7], s27 offen offset:3072 lds
    v_mfma_f32_16x16x32_bf16 v[72:75], a[240:243], a[216:219], v[72:75]
    s_mov_b32 m0, 118784
    v_mfma_f32_16x16x32_bf16 v[72:75], a[244:247], a[220:223], v[72:75]
    s_add_u32 s27, s97, 131072
    buffer_load_dwordx4 v225, s[8:11], s27 offen lds
    v_mfma_f32_16x16x32_bf16 v[104:107], a[244:247], a[228:231], v[104:107]
    v_mfma_f32_16x16x32_bf16 v[104:107], a[240:243], a[224:227], v[104:107]
    s_waitcnt lgkmcnt(2)
    v_mfma_f32_16x16x32_bf16 v[12:15], a[248:251], a[200:203], v[12:15]
    s_waitcnt lgkmcnt(0)
    s_add_u32 s27, s97, 162816
    ds_read_b64_tr_b16 a[240:241], v233 offset:16384
    buffer_load_dwordx4 v225, s[8:11], s27 offen offset:1024 lds
    v_mfma_f32_16x16x32_bf16 v[12:15], a[252:255], a[204:207], v[12:15]
    ds_read_b64_tr_b16 a[242:243], v233 offset:17408
    v_mfma_f32_16x16x32_bf16 v[44:47], a[252:255], a[212:215], v[44:47]
    ds_read_b64_tr_b16 a[244:245], v233 offset:24576
    v_mfma_f32_16x16x32_bf16 v[44:47], a[248:251], a[208:211], v[44:47]
    s_add_u32 s27, s97, 194560
    ds_read_b64_tr_b16 a[246:247], v233 offset:25600
    buffer_load_dwordx4 v226, s[8:11], s27 offen offset:2048 lds
    v_mfma_f32_16x16x32_bf16 v[76:79], a[248:251], a[216:219], v[76:79]
    v_mfma_f32_16x16x32_bf16 v[76:79], a[252:255], a[220:223], v[76:79]
    s_add_u32 s27, s97, 226304
    buffer_load_dwordx4 v226, s[8:11], s27 offen offset:3072 lds
    v_mfma_f32_16x16x32_bf16 v[108:111], a[252:255], a[228:231], v[108:111]
    v_mfma_f32_16x16x32_bf16 v[108:111], a[248:251], a[224:227], v[108:111]
    s_waitcnt lgkmcnt(2)
    s_add_u32 m0, s35, 45056
    v_mfma_f32_16x16x32_bf16 v[16:19], a[240:243], a[200:203], v[16:19]
    s_waitcnt lgkmcnt(0)
    s_add_u32 s27, s89, 32768
    ds_read_b64_tr_b16 a[248:249], v234 offset:16384
    buffer_load_dwordx4 v223, s[4:7], s27 offen lds
    v_mfma_f32_16x16x32_bf16 v[16:19], a[244:247], a[204:207], v[16:19]
    ds_read_b64_tr_b16 a[250:251], v234 offset:17408
    v_mfma_f32_16x16x32_bf16 v[48:51], a[244:247], a[212:215], v[48:51]
    ds_read_b64_tr_b16 a[252:253], v234 offset:24576
    v_mfma_f32_16x16x32_bf16 v[48:51], a[240:243], a[208:211], v[48:51]
    s_add_u32 s27, s89, 39936
    s_waitcnt vmcnt(21)
    ds_read_b64_tr_b16 a[254:255], v234 offset:25600
    buffer_load_dwordx4 v224, s[4:7], s27 offen offset:1024 lds
    v_mfma_f32_16x16x32_bf16 v[80:83], a[240:243], a[216:219], v[80:83]
    ds_read_b128 a[160:163], v227 offset:0
    v_mfma_f32_16x16x32_bf16 v[80:83], a[244:247], a[220:223], v[80:83]
    s_add_u32 s27, s89, 47104
    buffer_load_dwordx4 v223, s[4:7], s27 offen offset:2048 lds
    ds_read_b128 a[164:167], v228 offset:0
    v_mfma_f32_16x16x32_bf16 v[112:115], a[244:247], a[228:231], v[112:115]
    ds_read_b128 a[168:171], v227 offset:2048
    v_mfma_f32_16x16x32_bf16 v[112:115], a[240:243], a[224:227], v[112:115]
    s_waitcnt lgkmcnt(5)
    ds_read_b128 a[172:175], v228 offset:2048
    v_mfma_f32_16x16x32_bf16 v[20:23], a[248:251], a[200:203], v[20:23]
    s_waitcnt lgkmcnt(4)
    s_add_u32 s27, s89, 54272
    ds_read_b64_tr_b16 a[240:241], v235 offset:16384
    buffer_load_dwordx4 v224, s[4:7], s27 offen offset:3072 lds
    v_mfma_f32_16x16x32_bf16 v[20:23], a[252:255], a[204:207], v[20:23]
    ds_read_b64_tr_b16 a[242:243], v235 offset:17408
    v_mfma_f32_16x16x32_bf16 v[52:55], a[252:255], a[212:215], v[52:55]
    s_mov_b32 m0, 122880
    ds_read_b64_tr_b16 a[244:245], v235 offset:24576
    v_mfma_f32_16x16x32_bf16 v[52:55], a[248:251], a[208:211], v[52:55]
    s_add_u32 s27, s97, 262144
    ds_read_b64_tr_b16 a[246:247], v235 offset:25600
    buffer_load_dwordx4 v225, s[8:11], s27 offen lds
    v_mfma_f32_16x16x32_bf16 v[84:87], a[248:251], a[216:219], v[84:87]
    ds_read_b128 a[176:179], v227 offset:4096
    v_mfma_f32_16x16x32_bf16 v[84:87], a[252:255], a[220:223], v[84:87]
    s_add_u32 s27, s97, 293888
    buffer_load_dwordx4 v225, s[8:11], s27 offen offset:1024 lds
    ds_read_b128 a[180:183], v228 offset:4096
    v_mfma_f32_16x16x32_bf16 v[116:119], a[252:255], a[228:231], v[116:119]
    ds_read_b128 a[184:187], v227 offset:6144
    v_mfma_f32_16x16x32_bf16 v[116:119], a[248:251], a[224:227], v[116:119]
    s_waitcnt lgkmcnt(5)
    ds_read_b128 a[188:191], v228 offset:6144
    v_mfma_f32_16x16x32_bf16 v[24:27], a[240:243], a[200:203], v[24:27]
    s_waitcnt lgkmcnt(4)
    s_add_u32 s27, s97, 325632
    ds_read_b64_tr_b16 a[248:249], v236 offset:16384
    buffer_load_dwordx4 v226, s[8:11], s27 offen offset:2048 lds
    v_mfma_f32_16x16x32_bf16 v[24:27], a[244:247], a[204:207], v[24:27]
    ds_read_b64_tr_b16 a[250:251], v236 offset:17408
    v_mfma_f32_16x16x32_bf16 v[56:59], a[244:247], a[212:215], v[56:59]
    ds_read_b64_tr_b16 a[252:253], v236 offset:24576
    v_mfma_f32_16x16x32_bf16 v[56:59], a[240:243], a[208:211], v[56:59]
    s_add_u32 s27, s97, 357376
    ds_read_b64_tr_b16 a[254:255], v236 offset:25600
    buffer_load_dwordx4 v226, s[8:11], s27 offen offset:3072 lds
    v_mfma_f32_16x16x32_bf16 v[88:91], a[240:243], a[216:219], v[88:91]
    s_mov_b32 m0, 126976
    v_mfma_f32_16x16x32_bf16 v[88:91], a[244:247], a[220:223], v[88:91]
    s_add_u32 s27, s97, 393216
    buffer_load_dwordx4 v225, s[8:11], s27 offen lds
    v_mfma_f32_16x16x32_bf16 v[120:123], a[244:247], a[228:231], v[120:123]
    v_mfma_f32_16x16x32_bf16 v[120:123], a[240:243], a[224:227], v[120:123]
    s_waitcnt vmcnt(21) lgkmcnt(0)
    s_barrier
    v_mfma_f32_16x16x32_bf16 v[28:31], a[248:251], a[200:203], v[28:31]
    s_add_u32 s27, s97, 424960
    buffer_load_dwordx4 v225, s[8:11], s27 offen offset:1024 lds
    ds_read_b64_tr_b16 a[240:241], v229 offset:32768
    v_mfma_f32_16x16x32_bf16 v[28:31], a[252:255], a[204:207], v[28:31]
    ds_read_b64_tr_b16 a[242:243], v229 offset:33792
    v_mfma_f32_16x16x32_bf16 v[60:63], a[252:255], a[212:215], v[60:63]
    ds_read_b64_tr_b16 a[244:245], v229 offset:40960
    v_mfma_f32_16x16x32_bf16 v[60:63], a[248:251], a[208:211], v[60:63]
    s_add_u32 s27, s97, 456704
    buffer_load_dwordx4 v226, s[8:11], s27 offen offset:2048 lds
    ds_read_b64_tr_b16 a[246:247], v229 offset:41984
    v_mfma_f32_16x16x32_bf16 v[92:95], a[248:251], a[216:219], v[92:95]
    v_mfma_f32_16x16x32_bf16 v[92:95], a[252:255], a[220:223], v[92:95]
    v_mfma_f32_16x16x32_bf16 v[124:127], a[252:255], a[228:231], v[124:127]
    s_add_u32 s27, s97, 488448
    buffer_load_dwordx4 v226, s[8:11], s27 offen offset:3072 lds
    v_mfma_f32_16x16x32_bf16 v[124:127], a[248:251], a[224:227], v[124:127]
    s_waitcnt lgkmcnt(2)
    v_mfma_f32_16x16x32_bf16 v[0:3], a[240:243], a[160:163], v[0:3]
    s_waitcnt lgkmcnt(0)
    ds_read_b64_tr_b16 a[248:249], v230 offset:32768
    v_mfma_f32_16x16x32_bf16 v[0:3], a[244:247], a[164:167], v[0:3]
    ds_read_b64_tr_b16 a[250:251], v230 offset:33792
    v_mfma_f32_16x16x32_bf16 v[32:35], a[244:247], a[172:175], v[32:35]
    s_mov_b32 m0, 131072
    ds_read_b64_tr_b16 a[252:253], v230 offset:40960
    v_mfma_f32_16x16x32_bf16 v[32:35], a[240:243], a[168:171], v[32:35]
    s_add_u32 s27, s98, 0
    ds_read_b64_tr_b16 a[254:255], v230 offset:41984
    buffer_load_dwordx4 v225, s[8:11], s27 offen lds
    v_mfma_f32_16x16x32_bf16 v[64:67], a[240:243], a[176:179], v[64:67]
    s_add_u32 s27, s98, 31744
    buffer_load_dwordx4 v225, s[8:11], s27 offen offset:1024 lds
    v_accvgpr_write_b32 a0, 0
    v_mfma_f32_16x16x32_bf16 v[64:67], a[244:247], a[180:183], v[64:67]
    v_accvgpr_write_b32 a1, 0
    v_mfma_f32_16x16x32_bf16 v[96:99], a[244:247], a[188:191], v[96:99]
    s_add_u32 s27, s98, 63488
    buffer_load_dwordx4 v226, s[8:11], s27 offen offset:2048 lds
    v_accvgpr_write_b32 a2, 0
    v_mfma_f32_16x16x32_bf16 v[96:99], a[240:243], a[184:187], v[96:99]
    s_waitcnt lgkmcnt(2)
    v_accvgpr_write_b32 a3, 0
    v_mfma_f32_16x16x32_bf16 v[4:7], a[248:251], a[160:163], v[4:7]
    s_waitcnt lgkmcnt(0)
    s_add_u32 s27, s98, 95232
    ds_read_b64_tr_b16 a[240:241], v231 offset:32768
    buffer_load_dwordx4 v226, s[8:11], s27 offen offset:3072 lds
    v_accvgpr_write_b32 a4, 0
    v_mfma_f32_16x16x32_bf16 v[4:7], a[252:255], a[164:167], v[4:7]
    ds_read_b64_tr_b16 a[242:243], v231 offset:33792
    v_accvgpr_write_b32 a5, 0
    v_mfma_f32_16x16x32_bf16 v[36:39], a[252:255], a[172:175], v[36:39]
    s_add_u32 m0, s35, 0
    ds_read_b64_tr_b16 a[244:245], v231 offset:40960
    v_accvgpr_write_b32 a6, 0
    v_mfma_f32_16x16x32_bf16 v[36:39], a[248:251], a[168:171], v[36:39]
    s_add_u32 s27, s90, 0
    ds_read_b64_tr_b16 a[246:247], v231 offset:41984
    buffer_load_dwordx4 v223, s[4:7], s27 offen lds
    v_accvgpr_write_b32 a7, 0
    v_mfma_f32_16x16x32_bf16 v[68:71], a[248:251], a[176:179], v[68:71]
    v_accvgpr_write_b32 a8, 0
    v_mfma_f32_16x16x32_bf16 v[68:71], a[252:255], a[180:183], v[68:71]
    s_add_u32 s27, s90, 7168
    buffer_load_dwordx4 v224, s[4:7], s27 offen offset:1024 lds
    v_accvgpr_write_b32 a9, 0
    v_mfma_f32_16x16x32_bf16 v[100:103], a[252:255], a[188:191], v[100:103]
    v_accvgpr_write_b32 a10, 0
    v_mfma_f32_16x16x32_bf16 v[100:103], a[248:251], a[184:187], v[100:103]
    s_waitcnt lgkmcnt(2)
    v_accvgpr_write_b32 a11, 0
    v_mfma_f32_16x16x32_bf16 v[8:11], a[240:243], a[160:163], v[8:11]
    s_waitcnt lgkmcnt(0)
    s_add_u32 s27, s90, 14336
    ds_read_b64_tr_b16 a[248:249], v232 offset:32768
    buffer_load_dwordx4 v223, s[4:7], s27 offen offset:2048 lds
    v_accvgpr_write_b32 a12, 0
    v_mfma_f32_16x16x32_bf16 v[8:11], a[244:247], a[164:167], v[8:11]
    ds_read_b64_tr_b16 a[250:251], v232 offset:33792
    v_accvgpr_write_b32 a13, 0
    v_mfma_f32_16x16x32_bf16 v[40:43], a[244:247], a[172:175], v[40:43]
    ds_read_b64_tr_b16 a[252:253], v232 offset:40960
    v_accvgpr_write_b32 a14, 0
    v_mfma_f32_16x16x32_bf16 v[40:43], a[240:243], a[168:171], v[40:43]
    s_add_u32 s27, s90, 21504
    ds_read_b64_tr_b16 a[254:255], v232 offset:41984
    buffer_load_dwordx4 v224, s[4:7], s27 offen offset:3072 lds
    v_accvgpr_write_b32 a15, 0
    v_mfma_f32_16x16x32_bf16 v[72:75], a[240:243], a[176:179], v[72:75]
    s_mov_b32 m0, 135168
    v_accvgpr_write_b32 a16, 0
    v_mfma_f32_16x16x32_bf16 v[72:75], a[244:247], a[180:183], v[72:75]
    s_add_u32 s27, s98, 131072
    buffer_load_dwordx4 v225, s[8:11], s27 offen lds
    v_accvgpr_write_b32 a17, 0
    v_mfma_f32_16x16x32_bf16 v[104:107], a[244:247], a[188:191], v[104:107]
    v_accvgpr_write_b32 a18, 0
    v_mfma_f32_16x16x32_bf16 v[104:107], a[240:243], a[184:187], v[104:107]
    s_waitcnt lgkmcnt(2)
    v_accvgpr_write_b32 a19, 0
    v_mfma_f32_16x16x32_bf16 v[12:15], a[248:251], a[160:163], v[12:15]
    s_waitcnt lgkmcnt(0)
    s_add_u32 s27, s98, 162816
    ds_read_b64_tr_b16 a[240:241], v233 offset:32768
    buffer_load_dwordx4 v225, s[8:11], s27 offen offset:1024 lds
    v_accvgpr_write_b32 a20, 0
    v_mfma_f32_16x16x32_bf16 v[12:15], a[252:255], a[164:167], v[12:15]
    ds_read_b64_tr_b16 a[242:243], v233 offset:33792
    v_accvgpr_write_b32 a21, 0
    v_mfma_f32_16x16x32_bf16 v[44:47], a[252:255], a[172:175], v[44:47]
    ds_read_b64_tr_b16 a[244:245], v233 offset:40960
    v_accvgpr_write_b32 a22, 0
    v_mfma_f32_16x16x32_bf16 v[44:47], a[248:251], a[168:171], v[44:47]
    s_add_u32 s27, s98, 194560
    ds_read_b64_tr_b16 a[246:247], v233 offset:41984
    buffer_load_dwordx4 v226, s[8:11], s27 offen offset:2048 lds
    v_accvgpr_write_b32 a23, 0
    v_mfma_f32_16x16x32_bf16 v[76:79], a[248:251], a[176:179], v[76:79]
    v_accvgpr_write_b32 a24, 0
    v_mfma_f32_16x16x32_bf16 v[76:79], a[252:255], a[180:183], v[76:79]
    s_add_u32 s27, s98, 226304
    buffer_load_dwordx4 v226, s[8:11], s27 offen offset:3072 lds
    v_accvgpr_write_b32 a25, 0
    v_mfma_f32_16x16x32_bf16 v[108:111], a[252:255], a[188:191], v[108:111]
    v_accvgpr_write_b32 a26, 0
    v_mfma_f32_16x16x32_bf16 v[108:111], a[248:251], a[184:187], v[108:111]
    s_waitcnt lgkmcnt(2)
    s_add_u32 m0, s35, 4096
    v_accvgpr_write_b32 a27, 0
    v_mfma_f32_16x16x32_bf16 v[16:19], a[240:243], a[160:163], v[16:19]
    s_waitcnt lgkmcnt(0)
    s_add_u32 s27, s90, 32768
    ds_read_b64_tr_b16 a[248:249], v234 offset:32768
    buffer_load_dwordx4 v223, s[4:7], s27 offen lds
    v_accvgpr_write_b32 a28, 0
    v_mfma_f32_16x16x32_bf16 v[16:19], a[244:247], a[164:167], v[16:19]
    ds_read_b64_tr_b16 a[250:251], v234 offset:33792
    v_accvgpr_write_b32 a29, 0
    v_mfma_f32_16x16x32_bf16 v[48:51], a[244:247], a[172:175], v[48:51]
    ds_read_b64_tr_b16 a[252:253], v234 offset:40960
    v_accvgpr_write_b32 a30, 0
    v_mfma_f32_16x16x32_bf16 v[48:51], a[240:243], a[168:171], v[48:51]
    s_add_u32 s27, s90, 39936
    s_waitcnt vmcnt(21)
    ds_read_b64_tr_b16 a[254:255], v234 offset:41984
    buffer_load_dwordx4 v224, s[4:7], s27 offen offset:1024 lds
    v_accvgpr_write_b32 a31, 0
    v_mfma_f32_16x16x32_bf16 v[80:83], a[240:243], a[176:179], v[80:83]
    ds_read_b128 a[200:203], v227 offset:40960
    v_accvgpr_write_b32 a32, 0
    v_mfma_f32_16x16x32_bf16 v[80:83], a[244:247], a[180:183], v[80:83]
    s_add_u32 s27, s90, 47104
    buffer_load_dwordx4 v223, s[4:7], s27 offen offset:2048 lds
    ds_read_b128 a[204:207], v228 offset:40960
    v_accvgpr_write_b32 a33, 0
    v_mfma_f32_16x16x32_bf16 v[112:115], a[244:247], a[188:191], v[112:115]
    ds_read_b128 a[208:211], v227 offset:43008
    v_accvgpr_write_b32 a34, 0
    v_mfma_f32_16x16x32_bf16 v[112:115], a[240:243], a[184:187], v[112:115]
    s_waitcnt lgkmcnt(5)
    ds_read_b128 a[212:215], v228 offset:43008
    v_accvgpr_write_b32 a35, 0
    v_mfma_f32_16x16x32_bf16 v[20:23], a[248:251], a[160:163], v[20:23]
    s_waitcnt lgkmcnt(4)
    s_add_u32 s27, s90, 54272
    ds_read_b64_tr_b16 a[240:241], v235 offset:32768
    buffer_load_dwordx4 v224, s[4:7], s27 offen offset:3072 lds
    v_accvgpr_write_b32 a36, 0
    v_mfma_f32_16x16x32_bf16 v[20:23], a[252:255], a[164:167], v[20:23]
    ds_read_b64_tr_b16 a[242:243], v235 offset:33792
    v_accvgpr_write_b32 a37, 0
    v_mfma_f32_16x16x32_bf16 v[52:55], a[252:255], a[172:175], v[52:55]
    s_mov_b32 m0, 139264
    ds_read_b64_tr_b16 a[244:245], v235 offset:40960
    v_accvgpr_write_b32 a38, 0
    v_mfma_f32_16x16x32_bf16 v[52:55], a[248:251], a[168:171], v[52:55]
    s_add_u32 s27, s98, 262144
    ds_read_b64_tr_b16 a[246:247], v235 offset:41984
    buffer_load_dwordx4 v225, s[8:11], s27 offen lds
    v_accvgpr_write_b32 a39, 0
    v_mfma_f32_16x16x32_bf16 v[84:87], a[248:251], a[176:179], v[84:87]
    ds_read_b128 a[216:219], v227 offset:45056
    v_accvgpr_write_b32 a40, 0
    v_mfma_f32_16x16x32_bf16 v[84:87], a[252:255], a[180:183], v[84:87]
    s_add_u32 s27, s98, 293888
    buffer_load_dwordx4 v225, s[8:11], s27 offen offset:1024 lds
    ds_read_b128 a[220:223], v228 offset:45056
    v_accvgpr_write_b32 a41, 0
    v_mfma_f32_16x16x32_bf16 v[116:119], a[252:255], a[188:191], v[116:119]
    ds_read_b128 a[224:227], v227 offset:47104
    v_accvgpr_write_b32 a42, 0
    v_mfma_f32_16x16x32_bf16 v[116:119], a[248:251], a[184:187], v[116:119]
    s_waitcnt lgkmcnt(5)
    ds_read_b128 a[228:231], v228 offset:47104
    v_accvgpr_write_b32 a43, 0
    v_mfma_f32_16x16x32_bf16 v[24:27], a[240:243], a[160:163], v[24:27]
    s_waitcnt lgkmcnt(4)
    s_add_u32 s27, s98, 325632
    ds_read_b64_tr_b16 a[248:249], v236 offset:32768
    buffer_load_dwordx4 v226, s[8:11], s27 offen offset:2048 lds
    v_mfma_f32_16x16x32_bf16 v[24:27], a[244:247], a[164:167], v[24:27]
    ds_read_b64_tr_b16 a[250:251], v236 offset:33792
    v_mfma_f32_16x16x32_bf16 v[56:59], a[244:247], a[172:175], v[56:59]
    ds_read_b64_tr_b16 a[252:253], v236 offset:40960
    v_mfma_f32_16x16x32_bf16 v[56:59], a[240:243], a[168:171], v[56:59]
    s_add_u32 s27, s98, 357376
    ds_read_b64_tr_b16 a[254:255], v236 offset:41984
    buffer_load_dwordx4 v226, s[8:11], s27 offen offset:3072 lds
    v_mfma_f32_16x16x32_bf16 v[88:91], a[240:243], a[176:179], v[88:91]
    s_mov_b32 m0, 143360
    v_mfma_f32_16x16x32_bf16 v[88:91], a[244:247], a[180:183], v[88:91]
    s_add_u32 s27, s98, 393216
    buffer_load_dwordx4 v225, s[8:11], s27 offen lds
    v_mfma_f32_16x16x32_bf16 v[120:123], a[244:247], a[188:191], v[120:123]
    v_mfma_f32_16x16x32_bf16 v[120:123], a[240:243], a[184:187], v[120:123]
    s_waitcnt vmcnt(21) lgkmcnt(0)
    s_barrier
    v_mfma_f32_16x16x32_bf16 v[28:31], a[248:251], a[160:163], v[28:31]
    s_add_u32 s27, s98, 424960
    buffer_load_dwordx4 v225, s[8:11], s27 offen offset:1024 lds
    ds_read_b64_tr_b16 a[240:241], v229 offset:0
    v_mfma_f32_16x16x32_bf16 v[28:31], a[252:255], a[164:167], v[28:31]
    ds_read_b64_tr_b16 a[242:243], v229 offset:1024
    v_mfma_f32_16x16x32_bf16 v[60:63], a[252:255], a[172:175], v[60:63]
    ds_read_b64_tr_b16 a[244:245], v229 offset:8192
    v_mfma_f32_16x16x32_bf16 v[60:63], a[248:251], a[168:171], v[60:63]
    s_add_u32 s27, s98, 456704
    buffer_load_dwordx4 v226, s[8:11], s27 offen offset:2048 lds
    ds_read_b64_tr_b16 a[246:247], v229 offset:9216
    v_mfma_f32_16x16x32_bf16 v[92:95], a[248:251], a[176:179], v[92:95]
    v_mfma_f32_16x16x32_bf16 v[92:95], a[252:255], a[180:183], v[92:95]
    v_mfma_f32_16x16x32_bf16 v[124:127], a[252:255], a[188:191], v[124:127]
    s_add_u32 s27, s98, 488448
    buffer_load_dwordx4 v226, s[8:11], s27 offen offset:3072 lds
    v_mfma_f32_16x16x32_bf16 v[124:127], a[248:251], a[184:187], v[124:127]
    s_waitcnt lgkmcnt(2)
    v_mfma_f32_16x16x32_bf16 v[0:3], a[240:243], a[200:203], v[0:3]
    s_waitcnt lgkmcnt(0)
    ds_read_b64_tr_b16 a[248:249], v230 offset:0
    v_mfma_f32_16x16x32_bf16 v[0:3], a[244:247], a[204:207], v[0:3]
    ds_read_b64_tr_b16 a[250:251], v230 offset:1024
    v_mfma_f32_16x16x32_bf16 v[32:35], a[244:247], a[212:215], v[32:35]
    s_mov_b32 m0, 147456
    ds_read_b64_tr_b16 a[252:253], v230 offset:8192
    v_mfma_f32_16x16x32_bf16 v[32:35], a[240:243], a[208:211], v[32:35]
    s_add_u32 s27, s99, 0
    ds_read_b64_tr_b16 a[254:255], v230 offset:9216
    buffer_load_dwordx4 v225, s[8:11], s27 offen lds
    v_mfma_f32_16x16x32_bf16 v[64:67], a[240:243], a[216:219], v[64:67]
    s_add_u32 s27, s99, 31744
    buffer_load_dwordx4 v225, s[8:11], s27 offen offset:1024 lds
    v_accvgpr_write_b32 a44, 0
    v_mfma_f32_16x16x32_bf16 v[64:67], a[244:247], a[220:223], v[64:67]
    v_accvgpr_write_b32 a45, 0
    v_mfma_f32_16x16x32_bf16 v[96:99], a[244:247], a[228:231], v[96:99]
    s_add_u32 s27, s99, 63488
    buffer_load_dwordx4 v226, s[8:11], s27 offen offset:2048 lds
    v_accvgpr_write_b32 a46, 0
    v_mfma_f32_16x16x32_bf16 v[96:99], a[240:243], a[224:227], v[96:99]
    s_waitcnt lgkmcnt(2)
    v_accvgpr_write_b32 a47, 0
    v_mfma_f32_16x16x32_bf16 v[4:7], a[248:251], a[200:203], v[4:7]
    s_waitcnt lgkmcnt(0)
    s_add_u32 s27, s99, 95232
    ds_read_b64_tr_b16 a[240:241], v231 offset:0
    buffer_load_dwordx4 v226, s[8:11], s27 offen offset:3072 lds
    v_accvgpr_write_b32 a48, 0
    v_mfma_f32_16x16x32_bf16 v[4:7], a[252:255], a[204:207], v[4:7]
    ds_read_b64_tr_b16 a[242:243], v231 offset:1024
    v_accvgpr_write_b32 a49, 0
    v_mfma_f32_16x16x32_bf16 v[36:39], a[252:255], a[212:215], v[36:39]
    s_add_u32 m0, s35, 40960
    ds_read_b64_tr_b16 a[244:245], v231 offset:8192
    v_accvgpr_write_b32 a50, 0
    v_mfma_f32_16x16x32_bf16 v[36:39], a[248:251], a[208:211], v[36:39]
    s_add_u32 s27, s91, 0
    ds_read_b64_tr_b16 a[246:247], v231 offset:9216
    buffer_load_dwordx4 v223, s[4:7], s27 offen lds
    v_accvgpr_write_b32 a51, 0
    v_mfma_f32_16x16x32_bf16 v[68:71], a[248:251], a[216:219], v[68:71]
    v_accvgpr_write_b32 a52, 0
    v_mfma_f32_16x16x32_bf16 v[68:71], a[252:255], a[220:223], v[68:71]
    s_add_u32 s27, s91, 7168
    buffer_load_dwordx4 v224, s[4:7], s27 offen offset:1024 lds
    v_accvgpr_write_b32 a53, 0
    v_mfma_f32_16x16x32_bf16 v[100:103], a[252:255], a[228:231], v[100:103]
    v_accvgpr_write_b32 a54, 0
    v_mfma_f32_16x16x32_bf16 v[100:103], a[248:251], a[224:227], v[100:103]
    s_waitcnt lgkmcnt(2)
    v_accvgpr_write_b32 a55, 0
    v_mfma_f32_16x16x32_bf16 v[8:11], a[240:243], a[200:203], v[8:11]
    s_waitcnt lgkmcnt(0)
    s_add_u32 s27, s91, 14336
    ds_read_b64_tr_b16 a[248:249], v232 offset:0
    buffer_load_dwordx4 v223, s[4:7], s27 offen offset:2048 lds
    v_accvgpr_write_b32 a56, 0
    v_mfma_f32_16x16x32_bf16 v[8:11], a[244:247], a[204:207], v[8:11]
    ds_read_b64_tr_b16 a[250:251], v232 offset:1024
    v_accvgpr_write_b32 a57, 0
    v_mfma_f32_16x16x32_bf16 v[40:43], a[244:247], a[212:215], v[40:43]
    ds_read_b64_tr_b16 a[252:253], v232 offset:8192
    v_accvgpr_write_b32 a58, 0
    v_mfma_f32_16x16x32_bf16 v[40:43], a[240:243], a[208:211], v[40:43]
    s_add_u32 s27, s91, 21504
    ds_read_b64_tr_b16 a[254:255], v232 offset:9216
    buffer_load_dwordx4 v224, s[4:7], s27 offen offset:3072 lds
    v_accvgpr_write_b32 a59, 0
    v_mfma_f32_16x16x32_bf16 v[72:75], a[240:243], a[216:219], v[72:75]
    s_mov_b32 m0, 151552
    v_accvgpr_write_b32 a60, 0
    v_mfma_f32_16x16x32_bf16 v[72:75], a[244:247], a[220:223], v[72:75]
    s_add_u32 s27, s99, 131072
    buffer_load_dwordx4 v225, s[8:11], s27 offen lds
    v_accvgpr_write_b32 a61, 0
    v_mfma_f32_16x16x32_bf16 v[104:107], a[244:247], a[228:231], v[104:107]
    v_accvgpr_write_b32 a62, 0
    v_mfma_f32_16x16x32_bf16 v[104:107], a[240:243], a[224:227], v[104:107]
    s_waitcnt lgkmcnt(2)
    v_accvgpr_write_b32 a63, 0
    v_mfma_f32_16x16x32_bf16 v[12:15], a[248:251], a[200:203], v[12:15]
    s_waitcnt lgkmcnt(0)
    s_add_u32 s27, s99, 162816
    ds_read_b64_tr_b16 a[240:241], v233 offset:0
    buffer_load_dwordx4 v225, s[8:11], s27 offen offset:1024 lds
    v_accvgpr_write_b32 a64, 0
    v_mfma_f32_16x16x32_bf16 v[12:15], a[252:255], a[204:207], v[12:15]
    ds_read_b64_tr_b16 a[242:243], v233 offset:1024
    v_accvgpr_write_b32 a65, 0
    v_mfma_f32_16x16x32_bf16 v[44:47], a[252:255], a[212:215], v[44:47]
    ds_read_b64_tr_b16 a[244:245], v233 offset:8192
    v_accvgpr_write_b32 a66, 0
    v_mfma_f32_16x16x32_bf16 v[44:47], a[248:251], a[208:211], v[44:47]
    s_add_u32 s27, s99, 194560
    ds_read_b64_tr_b16 a[246:247], v233 offset:9216
    buffer_load_dwordx4 v226, s[8:11], s27 offen offset:2048 lds
    v_accvgpr_write_b32 a67, 0
    v_mfma_f32_16x16x32_bf16 v[76:79], a[248:251], a[216:219], v[76:79]
    v_accvgpr_write_b32 a68, 0
    v_mfma_f32_16x16x32_bf16 v[76:79], a[252:255], a[220:223], v[76:79]
    s_add_u32 s27, s99, 226304
    buffer_load_dwordx4 v226, s[8:11], s27 offen offset:3072 lds
    v_accvgpr_write_b32 a69, 0
    v_mfma_f32_16x16x32_bf16 v[108:111], a[252:255], a[228:231], v[108:111]
    v_accvgpr_write_b32 a70, 0
    v_mfma_f32_16x16x32_bf16 v[108:111], a[248:251], a[224:227], v[108:111]
    s_waitcnt lgkmcnt(2)
    s_add_u32 m0, s35, 45056
    v_accvgpr_write_b32 a71, 0
    v_mfma_f32_16x16x32_bf16 v[16:19], a[240:243], a[200:203], v[16:19]
    s_waitcnt lgkmcnt(0)
    s_add_u32 s27, s91, 32768
    ds_read_b64_tr_b16 a[248:249], v234 offset:0
    buffer_load_dwordx4 v223, s[4:7], s27 offen lds
    v_accvgpr_write_b32 a72, 0
    v_mfma_f32_16x16x32_bf16 v[16:19], a[244:247], a[204:207], v[16:19]
    ds_read_b64_tr_b16 a[250:251], v234 offset:1024
    v_accvgpr_write_b32 a73, 0
    v_mfma_f32_16x16x32_bf16 v[48:51], a[244:247], a[212:215], v[48:51]
    ds_read_b64_tr_b16 a[252:253], v234 offset:8192
    v_accvgpr_write_b32 a74, 0
    v_mfma_f32_16x16x32_bf16 v[48:51], a[240:243], a[208:211], v[48:51]
    s_add_u32 s27, s91, 39936
    s_waitcnt vmcnt(21)
    ds_read_b64_tr_b16 a[254:255], v234 offset:9216
    buffer_load_dwordx4 v224, s[4:7], s27 offen offset:1024 lds
    v_accvgpr_write_b32 a75, 0
    v_mfma_f32_16x16x32_bf16 v[80:83], a[240:243], a[216:219], v[80:83]
    ds_read_b128 a[160:163], v227 offset:0
    v_accvgpr_write_b32 a76, 0
    v_mfma_f32_16x16x32_bf16 v[80:83], a[244:247], a[220:223], v[80:83]
    s_add_u32 s27, s91, 47104
    buffer_load_dwordx4 v223, s[4:7], s27 offen offset:2048 lds
    ds_read_b128 a[164:167], v228 offset:0
    v_accvgpr_write_b32 a77, 0
    v_mfma_f32_16x16x32_bf16 v[112:115], a[244:247], a[228:231], v[112:115]
    ds_read_b128 a[168:171], v227 offset:2048
    v_accvgpr_write_b32 a78, 0
    v_mfma_f32_16x16x32_bf16 v[112:115], a[240:243], a[224:227], v[112:115]
    s_waitcnt lgkmcnt(5)
    ds_read_b128 a[172:175], v228 offset:2048
    v_accvgpr_write_b32 a79, 0
    v_mfma_f32_16x16x32_bf16 v[20:23], a[248:251], a[200:203], v[20:23]
    s_waitcnt lgkmcnt(4)
    s_add_u32 s27, s91, 54272
    ds_read_b64_tr_b16 a[240:241], v235 offset:0
    buffer_load_dwordx4 v224, s[4:7], s27 offen offset:3072 lds
    v_accvgpr_write_b32 a80, 0
    v_mfma_f32_16x16x32_bf16 v[20:23], a[252:255], a[204:207], v[20:23]
    ds_read_b64_tr_b16 a[242:243], v235 offset:1024
    v_accvgpr_write_b32 a81, 0
    v_mfma_f32_16x16x32_bf16 v[52:55], a[252:255], a[212:215], v[52:55]
    s_mov_b32 m0, 155648
    ds_read_b64_tr_b16 a[244:245], v235 offset:8192
    v_accvgpr_write_b32 a82, 0
    v_mfma_f32_16x16x32_bf16 v[52:55], a[248:251], a[208:211], v[52:55]
    s_add_u32 s27, s99, 262144
    ds_read_b64_tr_b16 a[246:247], v235 offset:9216
    buffer_load_dwordx4 v225, s[8:11], s27 offen lds
    v_accvgpr_write_b32 a83, 0
    v_mfma_f32_16x16x32_bf16 v[84:87], a[248:251], a[216:219], v[84:87]
    ds_read_b128 a[176:179], v227 offset:4096
    v_accvgpr_write_b32 a84, 0
    v_mfma_f32_16x16x32_bf16 v[84:87], a[252:255], a[220:223], v[84:87]
    s_add_u32 s27, s99, 293888
    buffer_load_dwordx4 v225, s[8:11], s27 offen offset:1024 lds
    ds_read_b128 a[180:183], v228 offset:4096
    v_accvgpr_write_b32 a85, 0
    v_mfma_f32_16x16x32_bf16 v[116:119], a[252:255], a[228:231], v[116:119]
    ds_read_b128 a[184:187], v227 offset:6144
    v_accvgpr_write_b32 a86, 0
    v_mfma_f32_16x16x32_bf16 v[116:119], a[248:251], a[224:227], v[116:119]
    s_waitcnt lgkmcnt(5)
    ds_read_b128 a[188:191], v228 offset:6144
    v_accvgpr_write_b32 a87, 0
    v_mfma_f32_16x16x32_bf16 v[24:27], a[240:243], a[200:203], v[24:27]
    s_waitcnt lgkmcnt(4)
    s_add_u32 s27, s99, 325632
    ds_read_b64_tr_b16 a[248:249], v236 offset:0
    buffer_load_dwordx4 v226, s[8:11], s27 offen offset:2048 lds
    v_mfma_f32_16x16x32_bf16 v[24:27], a[244:247], a[204:207], v[24:27]
    ds_read_b64_tr_b16 a[250:251], v236 offset:1024
    v_mfma_f32_16x16x32_bf16 v[56:59], a[244:247], a[212:215], v[56:59]
    ds_read_b64_tr_b16 a[252:253], v236 offset:8192
    v_mfma_f32_16x16x32_bf16 v[56:59], a[240:243], a[208:211], v[56:59]
    s_add_u32 s27, s99, 357376
    ds_read_b64_tr_b16 a[254:255], v236 offset:9216
    buffer_load_dwordx4 v226, s[8:11], s27 offen offset:3072 lds
    v_mfma_f32_16x16x32_bf16 v[88:91], a[240:243], a[216:219], v[88:91]
    s_mov_b32 m0, 159744
    v_mfma_f32_16x16x32_bf16 v[88:91], a[244:247], a[220:223], v[88:91]
    s_add_u32 s27, s99, 393216
    buffer_load_dwordx4 v225, s[8:11], s27 offen lds
    v_mfma_f32_16x16x32_bf16 v[120:123], a[244:247], a[228:231], v[120:123]
    v_mfma_f32_16x16x32_bf16 v[120:123], a[240:243], a[224:227], v[120:123]
    s_waitcnt vmcnt(21) lgkmcnt(0)
    s_barrier
    v_mfma_f32_16x16x32_bf16 v[28:31], a[248:251], a[200:203], v[28:31]
    s_add_u32 s27, s99, 424960
    buffer_load_dwordx4 v225, s[8:11], s27 offen offset:1024 lds
    ds_read_b64_tr_b16 a[240:241], v229 offset:16384
    v_mfma_f32_16x16x32_bf16 v[28:31], a[252:255], a[204:207], v[28:31]
    ds_read_b64_tr_b16 a[242:243], v229 offset:17408
    v_mfma_f32_16x16x32_bf16 v[60:63], a[252:255], a[212:215], v[60:63]
    ds_read_b64_tr_b16 a[244:245], v229 offset:24576
    v_mfma_f32_16x16x32_bf16 v[60:63], a[248:251], a[208:211], v[60:63]
    s_add_u32 s27, s99, 456704
    buffer_load_dwordx4 v226, s[8:11], s27 offen offset:2048 lds
    ds_read_b64_tr_b16 a[246:247], v229 offset:25600
    v_mfma_f32_16x16x32_bf16 v[92:95], a[248:251], a[216:219], v[92:95]
    v_mfma_f32_16x16x32_bf16 v[92:95], a[252:255], a[220:223], v[92:95]
    v_mfma_f32_16x16x32_bf16 v[124:127], a[252:255], a[228:231], v[124:127]
    s_add_u32 s27, s99, 488448
    buffer_load_dwordx4 v226, s[8:11], s27 offen offset:3072 lds
    v_mfma_f32_16x16x32_bf16 v[124:127], a[248:251], a[224:227], v[124:127]
    s_waitcnt lgkmcnt(2)
    v_mfma_f32_16x16x32_bf16 v[0:3], a[240:243], a[160:163], v[0:3]
    s_waitcnt lgkmcnt(0)
    ds_read_b64_tr_b16 a[248:249], v230 offset:16384
    v_mfma_f32_16x16x32_bf16 v[0:3], a[244:247], a[164:167], v[0:3]
    ds_read_b64_tr_b16 a[250:251], v230 offset:17408
    v_mfma_f32_16x16x32_bf16 v[32:35], a[244:247], a[172:175], v[32:35]
    s_mov_b32 m0, 114688
    ds_read_b64_tr_b16 a[252:253], v230 offset:24576
    v_mfma_f32_16x16x32_bf16 v[32:35], a[240:243], a[168:171], v[32:35]
    s_add_u32 s27, s100, 0
    ds_read_b64_tr_b16 a[254:255], v230 offset:25600
    buffer_load_dwordx4 v225, s[8:11], s27 offen lds
    v_mfma_f32_16x16x32_bf16 v[64:67], a[240:243], a[176:179], v[64:67]
    s_add_u32 s27, s100, 31744
    buffer_load_dwordx4 v225, s[8:11], s27 offen offset:1024 lds
    v_mfma_f32_16x16x32_bf16 v[64:67], a[244:247], a[180:183], v[64:67]
    v_mfma_f32_16x16x32_bf16 v[96:99], a[244:247], a[188:191], v[96:99]
    s_add_u32 s27, s100, 63488
    buffer_load_dwordx4 v226, s[8:11], s27 offen offset:2048 lds
    v_mfma_f32_16x16x32_bf16 v[96:99], a[240:243], a[184:187], v[96:99]
    s_waitcnt lgkmcnt(2)
    v_mfma_f32_16x16x32_bf16 v[4:7], a[248:251], a[160:163], v[4:7]
    s_waitcnt lgkmcnt(0)
    s_add_u32 s27, s100, 95232
    ds_read_b64_tr_b16 a[240:241], v231 offset:16384
    buffer_load_dwordx4 v226, s[8:11], s27 offen offset:3072 lds
    v_mfma_f32_16x16x32_bf16 v[4:7], a[252:255], a[164:167], v[4:7]
    ds_read_b64_tr_b16 a[242:243], v231 offset:17408
    v_mfma_f32_16x16x32_bf16 v[36:39], a[252:255], a[172:175], v[36:39]
    s_add_u32 m0, s35, 0
    ds_read_b64_tr_b16 a[244:245], v231 offset:24576
    v_mfma_f32_16x16x32_bf16 v[36:39], a[248:251], a[168:171], v[36:39]
    s_add_u32 s27, s92, 0
    ds_read_b64_tr_b16 a[246:247], v231 offset:25600
    buffer_load_dwordx4 v223, s[4:7], s27 offen lds
    v_mfma_f32_16x16x32_bf16 v[68:71], a[248:251], a[176:179], v[68:71]
    v_mfma_f32_16x16x32_bf16 v[68:71], a[252:255], a[180:183], v[68:71]
    s_add_u32 s27, s92, 7168
    buffer_load_dwordx4 v224, s[4:7], s27 offen offset:1024 lds
    v_mfma_f32_16x16x32_bf16 v[100:103], a[252:255], a[188:191], v[100:103]
    v_mfma_f32_16x16x32_bf16 v[100:103], a[248:251], a[184:187], v[100:103]
    s_waitcnt lgkmcnt(2)
    v_mfma_f32_16x16x32_bf16 v[8:11], a[240:243], a[160:163], v[8:11]
    s_waitcnt lgkmcnt(0)
    s_add_u32 s27, s92, 14336
    ds_read_b64_tr_b16 a[248:249], v232 offset:16384
    buffer_load_dwordx4 v223, s[4:7], s27 offen offset:2048 lds
    v_mfma_f32_16x16x32_bf16 v[8:11], a[244:247], a[164:167], v[8:11]
    ds_read_b64_tr_b16 a[250:251], v232 offset:17408
    v_mfma_f32_16x16x32_bf16 v[40:43], a[244:247], a[172:175], v[40:43]
    ds_read_b64_tr_b16 a[252:253], v232 offset:24576
    v_mfma_f32_16x16x32_bf16 v[40:43], a[240:243], a[168:171], v[40:43]
    s_add_u32 s27, s92, 21504
    ds_read_b64_tr_b16 a[254:255], v232 offset:25600
    buffer_load_dwordx4 v224, s[4:7], s27 offen offset:3072 lds
    v_mfma_f32_16x16x32_bf16 v[72:75], a[240:243], a[176:179], v[72:75]
    s_mov_b32 m0, 118784
    v_mfma_f32_16x16x32_bf16 v[72:75], a[244:247], a[180:183], v[72:75]
    s_add_u32 s27, s100, 131072
    buffer_load_dwordx4 v225, s[8:11], s27 offen lds
    v_mfma_f32_16x16x32_bf16 v[104:107], a[244:247], a[188:191], v[104:107]
    v_mfma_f32_16x16x32_bf16 v[104:107], a[240:243], a[184:187], v[104:107]
    s_waitcnt lgkmcnt(2)
    v_mfma_f32_16x16x32_bf16 v[12:15], a[248:251], a[160:163], v[12:15]
    s_waitcnt lgkmcnt(0)
    s_add_u32 s27, s100, 162816
    ds_read_b64_tr_b16 a[240:241], v233 offset:16384
    buffer_load_dwordx4 v225, s[8:11], s27 offen offset:1024 lds
    v_mfma_f32_16x16x32_bf16 v[12:15], a[252:255], a[164:167], v[12:15]
    ds_read_b64_tr_b16 a[242:243], v233 offset:17408
    v_mfma_f32_16x16x32_bf16 v[44:47], a[252:255], a[172:175], v[44:47]
    ds_read_b64_tr_b16 a[244:245], v233 offset:24576
    v_mfma_f32_16x16x32_bf16 v[44:47], a[248:251], a[168:171], v[44:47]
    s_add_u32 s27, s100, 194560
    ds_read_b64_tr_b16 a[246:247], v233 offset:25600
    buffer_load_dwordx4 v226, s[8:11], s27 offen offset:2048 lds
    v_mfma_f32_16x16x32_bf16 v[76:79], a[248:251], a[176:179], v[76:79]
    v_mfma_f32_16x16x32_bf16 v[76:79], a[252:255], a[180:183], v[76:79]
    s_add_u32 s27, s100, 226304
    buffer_load_dwordx4 v226, s[8:11], s27 offen offset:3072 lds
    v_mfma_f32_16x16x32_bf16 v[108:111], a[252:255], a[188:191], v[108:111]
    v_mfma_f32_16x16x32_bf16 v[108:111], a[248:251], a[184:187], v[108:111]
    s_waitcnt lgkmcnt(2)
    s_add_u32 m0, s35, 4096
    v_mfma_f32_16x16x32_bf16 v[16:19], a[240:243], a[160:163], v[16:19]
    s_waitcnt lgkmcnt(0)
    s_add_u32 s27, s92, 32768
    ds_read_b64_tr_b16 a[248:249], v234 offset:16384
    buffer_load_dwordx4 v223, s[4:7], s27 offen lds
    v_mfma_f32_16x16x32_bf16 v[16:19], a[244:247], a[164:167], v[16:19]
    ds_read_b64_tr_b16 a[250:251], v234 offset:17408
    v_mfma_f32_16x16x32_bf16 v[48:51], a[244:247], a[172:175], v[48:51]
    ds_read_b64_tr_b16 a[252:253], v234 offset:24576
    v_mfma_f32_16x16x32_bf16 v[48:51], a[240:243], a[168:171], v[48:51]
    s_add_u32 s27, s92, 39936
    s_waitcnt vmcnt(21)
    ds_read_b64_tr_b16 a[254:255], v234 offset:25600
    buffer_load_dwordx4 v224, s[4:7], s27 offen offset:1024 lds
    v_mfma_f32_16x16x32_bf16 v[80:83], a[240:243], a[176:179], v[80:83]
    ds_read_b128 a[200:203], v227 offset:40960
    v_mfma_f32_16x16x32_bf16 v[80:83], a[244:247], a[180:183], v[80:83]
    s_add_u32 s27, s92, 47104
    buffer_load_dwordx4 v223, s[4:7], s27 offen offset:2048 lds
    ds_read_b128 a[204:207], v228 offset:40960
    v_mfma_f32_16x16x32_bf16 v[112:115], a[244:247], a[188:191], v[112:115]
    ds_read_b128 a[208:211], v227 offset:43008
    v_mfma_f32_16x16x32_bf16 v[112:115], a[240:243], a[184:187], v[112:115]
    s_waitcnt lgkmcnt(5)
    ds_read_b128 a[212:215], v228 offset:43008
    v_mfma_f32_16x16x32_bf16 v[20:23], a[248:251], a[160:163], v[20:23]
    s_waitcnt lgkmcnt(4)
    s_add_u32 s27, s92, 54272
    ds_read_b64_tr_b16 a[240:241], v235 offset:16384
    buffer_load_dwordx4 v224, s[4:7], s27 offen offset:3072 lds
    v_mfma_f32_16x16x32_bf16 v[20:23], a[252:255], a[164:167], v[20:23]
    ds_read_b64_tr_b16 a[242:243], v235 offset:17408
    v_mfma_f32_16x16x32_bf16 v[52:55], a[252:255], a[172:175], v[52:55]
    s_mov_b32 m0, 122880
    ds_read_b64_tr_b16 a[244:245], v235 offset:24576
    v_mfma_f32_16x16x32_bf16 v[52:55], a[248:251], a[168:171], v[52:55]
    s_add_u32 s27, s100, 262144
    ds_read_b64_tr_b16 a[246:247], v235 offset:25600
    buffer_load_dwordx4 v225, s[8:11], s27 offen lds
    v_mfma_f32_16x16x32_bf16 v[84:87], a[248:251], a[176:179], v[84:87]
    ds_read_b128 a[216:219], v227 offset:45056
    v_mfma_f32_16x16x32_bf16 v[84:87], a[252:255], a[180:183], v[84:87]
    s_add_u32 s27, s100, 293888
    buffer_load_dwordx4 v225, s[8:11], s27 offen offset:1024 lds
    ds_read_b128 a[220:223], v228 offset:45056
    v_mfma_f32_16x16x32_bf16 v[116:119], a[252:255], a[188:191], v[116:119]
    ds_read_b128 a[224:227], v227 offset:47104
    v_mfma_f32_16x16x32_bf16 v[116:119], a[248:251], a[184:187], v[116:119]
    s_waitcnt lgkmcnt(5)
    ds_read_b128 a[228:231], v228 offset:47104
    v_mfma_f32_16x16x32_bf16 v[24:27], a[240:243], a[160:163], v[24:27]
    s_waitcnt lgkmcnt(4)
    s_add_u32 s27, s100, 325632
    ds_read_b64_tr_b16 a[248:249], v236 offset:16384
    buffer_load_dwordx4 v226, s[8:11], s27 offen offset:2048 lds
    v_mfma_f32_16x16x32_bf16 v[24:27], a[244:247], a[164:167], v[24:27]
    ds_read_b64_tr_b16 a[250:251], v236 offset:17408
    v_mfma_f32_16x16x32_bf16 v[56:59], a[244:247], a[172:175], v[56:59]
    ds_read_b64_tr_b16 a[252:253], v236 offset:24576
    v_mfma_f32_16x16x32_bf16 v[56:59], a[240:243], a[168:171], v[56:59]
    s_add_u32 s27, s100, 357376
    ds_read_b64_tr_b16 a[254:255], v236 offset:25600
    buffer_load_dwordx4 v226, s[8:11], s27 offen offset:3072 lds
    v_mfma_f32_16x16x32_bf16 v[88:91], a[240:243], a[176:179], v[88:91]
    s_mov_b32 m0, 126976
    v_mfma_f32_16x16x32_bf16 v[88:91], a[244:247], a[180:183], v[88:91]
    s_add_u32 s27, s100, 393216
    buffer_load_dwordx4 v225, s[8:11], s27 offen lds
    v_mfma_f32_16x16x32_bf16 v[120:123], a[244:247], a[188:191], v[120:123]
    v_mfma_f32_16x16x32_bf16 v[120:123], a[240:243], a[184:187], v[120:123]
    s_waitcnt vmcnt(21) lgkmcnt(0)
    s_barrier
    v_mfma_f32_16x16x32_bf16 v[28:31], a[248:251], a[160:163], v[28:31]
    s_add_u32 s27, s100, 424960
    buffer_load_dwordx4 v225, s[8:11], s27 offen offset:1024 lds
    ds_read_b64_tr_b16 a[240:241], v229 offset:32768
    v_mfma_f32_16x16x32_bf16 v[28:31], a[252:255], a[164:167], v[28:31]
    ds_read_b64_tr_b16 a[242:243], v229 offset:33792
    v_mfma_f32_16x16x32_bf16 v[60:63], a[252:255], a[172:175], v[60:63]
    ds_read_b64_tr_b16 a[244:245], v229 offset:40960
    v_mfma_f32_16x16x32_bf16 v[60:63], a[248:251], a[168:171], v[60:63]
    s_add_u32 s27, s100, 456704
    buffer_load_dwordx4 v226, s[8:11], s27 offen offset:2048 lds
    ds_read_b64_tr_b16 a[246:247], v229 offset:41984
    v_mfma_f32_16x16x32_bf16 v[92:95], a[248:251], a[176:179], v[92:95]
    v_mfma_f32_16x16x32_bf16 v[92:95], a[252:255], a[180:183], v[92:95]
    v_mfma_f32_16x16x32_bf16 v[124:127], a[252:255], a[188:191], v[124:127]
    s_add_u32 s27, s100, 488448
    buffer_load_dwordx4 v226, s[8:11], s27 offen offset:3072 lds
    v_mfma_f32_16x16x32_bf16 v[124:127], a[248:251], a[184:187], v[124:127]
    s_waitcnt lgkmcnt(2)
    v_mfma_f32_16x16x32_bf16 v[0:3], a[240:243], a[200:203], v[0:3]
    s_waitcnt lgkmcnt(0)
    ds_read_b64_tr_b16 a[248:249], v230 offset:32768
    v_mfma_f32_16x16x32_bf16 v[0:3], a[244:247], a[204:207], v[0:3]
    ds_read_b64_tr_b16 a[250:251], v230 offset:33792
    v_mfma_f32_16x16x32_bf16 v[32:35], a[244:247], a[212:215], v[32:35]
    s_mov_b32 m0, 131072
    ds_read_b64_tr_b16 a[252:253], v230 offset:40960
    v_mfma_f32_16x16x32_bf16 v[32:35], a[240:243], a[208:211], v[32:35]
    s_add_u32 s27, s101, 0
    ds_read_b64_tr_b16 a[254:255], v230 offset:41984
    buffer_load_dwordx4 v225, s[8:11], s27 offen lds
    v_mfma_f32_16x16x32_bf16 v[64:67], a[240:243], a[216:219], v[64:67]
    s_add_u32 s27, s101, 31744
    buffer_load_dwordx4 v225, s[8:11], s27 offen offset:1024 lds
    v_accvgpr_write_b32 a88, 0
    v_mfma_f32_16x16x32_bf16 v[64:67], a[244:247], a[220:223], v[64:67]
    v_accvgpr_write_b32 a89, 0
    v_mfma_f32_16x16x32_bf16 v[96:99], a[244:247], a[228:231], v[96:99]
    s_add_u32 s27, s101, 63488
    buffer_load_dwordx4 v226, s[8:11], s27 offen offset:2048 lds
    v_accvgpr_write_b32 a90, 0
    v_mfma_f32_16x16x32_bf16 v[96:99], a[240:243], a[224:227], v[96:99]
    s_waitcnt lgkmcnt(2)
    v_accvgpr_write_b32 a91, 0
    v_mfma_f32_16x16x32_bf16 v[4:7], a[248:251], a[200:203], v[4:7]
    s_waitcnt lgkmcnt(0)
    s_add_u32 s27, s101, 95232
    ds_read_b64_tr_b16 a[240:241], v231 offset:32768
    buffer_load_dwordx4 v226, s[8:11], s27 offen offset:3072 lds
    v_accvgpr_write_b32 a92, 0
    v_mfma_f32_16x16x32_bf16 v[4:7], a[252:255], a[204:207], v[4:7]
    ds_read_b64_tr_b16 a[242:243], v231 offset:33792
    v_accvgpr_write_b32 a93, 0
    v_mfma_f32_16x16x32_bf16 v[36:39], a[252:255], a[212:215], v[36:39]
    s_add_u32 m0, s35, 40960
    ds_read_b64_tr_b16 a[244:245], v231 offset:40960
    v_accvgpr_write_b32 a94, 0
    v_mfma_f32_16x16x32_bf16 v[36:39], a[248:251], a[208:211], v[36:39]
    s_add_u32 s27, s93, 0
    ds_read_b64_tr_b16 a[246:247], v231 offset:41984
    buffer_load_dwordx4 v223, s[4:7], s27 offen lds
    v_accvgpr_write_b32 a95, 0
    v_mfma_f32_16x16x32_bf16 v[68:71], a[248:251], a[216:219], v[68:71]
    v_accvgpr_write_b32 a96, 0
    v_mfma_f32_16x16x32_bf16 v[68:71], a[252:255], a[220:223], v[68:71]
    s_add_u32 s27, s93, 7168
    buffer_load_dwordx4 v224, s[4:7], s27 offen offset:1024 lds
    v_accvgpr_write_b32 a97, 0
    v_mfma_f32_16x16x32_bf16 v[100:103], a[252:255], a[228:231], v[100:103]
    v_accvgpr_write_b32 a98, 0
    v_mfma_f32_16x16x32_bf16 v[100:103], a[248:251], a[224:227], v[100:103]
    s_waitcnt lgkmcnt(2)
    v_accvgpr_write_b32 a99, 0
    v_mfma_f32_16x16x32_bf16 v[8:11], a[240:243], a[200:203], v[8:11]
    s_waitcnt lgkmcnt(0)
    s_add_u32 s27, s93, 14336
    ds_read_b64_tr_b16 a[248:249], v232 offset:32768
    buffer_load_dwordx4 v223, s[4:7], s27 offen offset:2048 lds
    v_accvgpr_write_b32 a100, 0
    v_mfma_f32_16x16x32_bf16 v[8:11], a[244:247], a[204:207], v[8:11]
    ds_read_b64_tr_b16 a[250:251], v232 offset:33792
    v_accvgpr_write_b32 a101, 0
    v_mfma_f32_16x16x32_bf16 v[40:43], a[244:247], a[212:215], v[40:43]
    ds_read_b64_tr_b16 a[252:253], v232 offset:40960
    v_accvgpr_write_b32 a102, 0
    v_mfma_f32_16x16x32_bf16 v[40:43], a[240:243], a[208:211], v[40:43]
    s_add_u32 s27, s93, 21504
    ds_read_b64_tr_b16 a[254:255], v232 offset:41984
    buffer_load_dwordx4 v224, s[4:7], s27 offen offset:3072 lds
    v_accvgpr_write_b32 a103, 0
    v_mfma_f32_16x16x32_bf16 v[72:75], a[240:243], a[216:219], v[72:75]
    s_mov_b32 m0, 135168
    v_accvgpr_write_b32 a104, 0
    v_mfma_f32_16x16x32_bf16 v[72:75], a[244:247], a[220:223], v[72:75]
    s_add_u32 s27, s101, 131072
    buffer_load_dwordx4 v225, s[8:11], s27 offen lds
    v_accvgpr_write_b32 a105, 0
    v_mfma_f32_16x16x32_bf16 v[104:107], a[244:247], a[228:231], v[104:107]
    v_accvgpr_write_b32 a106, 0
    v_mfma_f32_16x16x32_bf16 v[104:107], a[240:243], a[224:227], v[104:107]
    s_waitcnt lgkmcnt(2)
    v_accvgpr_write_b32 a107, 0
    v_mfma_f32_16x16x32_bf16 v[12:15], a[248:251], a[200:203], v[12:15]
    s_waitcnt lgkmcnt(0)
    s_add_u32 s27, s101, 162816
    ds_read_b64_tr_b16 a[240:241], v233 offset:32768
    buffer_load_dwordx4 v225, s[8:11], s27 offen offset:1024 lds
    v_accvgpr_write_b32 a108, 0
    v_mfma_f32_16x16x32_bf16 v[12:15], a[252:255], a[204:207], v[12:15]
    ds_read_b64_tr_b16 a[242:243], v233 offset:33792
    v_accvgpr_write_b32 a109, 0
    v_mfma_f32_16x16x32_bf16 v[44:47], a[252:255], a[212:215], v[44:47]
    ds_read_b64_tr_b16 a[244:245], v233 offset:40960
    v_accvgpr_write_b32 a110, 0
    v_mfma_f32_16x16x32_bf16 v[44:47], a[248:251], a[208:211], v[44:47]
    s_add_u32 s27, s101, 194560
    ds_read_b64_tr_b16 a[246:247], v233 offset:41984
    buffer_load_dwordx4 v226, s[8:11], s27 offen offset:2048 lds
    v_accvgpr_write_b32 a111, 0
    v_mfma_f32_16x16x32_bf16 v[76:79], a[248:251], a[216:219], v[76:79]
    v_accvgpr_write_b32 a112, 0
    v_mfma_f32_16x16x32_bf16 v[76:79], a[252:255], a[220:223], v[76:79]
    s_add_u32 s27, s101, 226304
    buffer_load_dwordx4 v226, s[8:11], s27 offen offset:3072 lds
    v_accvgpr_write_b32 a113, 0
    v_mfma_f32_16x16x32_bf16 v[108:111], a[252:255], a[228:231], v[108:111]
    v_accvgpr_write_b32 a114, 0
    v_mfma_f32_16x16x32_bf16 v[108:111], a[248:251], a[224:227], v[108:111]
    s_waitcnt lgkmcnt(2)
    s_add_u32 m0, s35, 45056
    v_accvgpr_write_b32 a115, 0
    v_mfma_f32_16x16x32_bf16 v[16:19], a[240:243], a[200:203], v[16:19]
    s_waitcnt lgkmcnt(0)
    s_add_u32 s27, s93, 32768
    ds_read_b64_tr_b16 a[248:249], v234 offset:32768
    buffer_load_dwordx4 v223, s[4:7], s27 offen lds
    v_accvgpr_write_b32 a116, 0
    v_mfma_f32_16x16x32_bf16 v[16:19], a[244:247], a[204:207], v[16:19]
    ds_read_b64_tr_b16 a[250:251], v234 offset:33792
    v_accvgpr_write_b32 a117, 0
    v_mfma_f32_16x16x32_bf16 v[48:51], a[244:247], a[212:215], v[48:51]
    ds_read_b64_tr_b16 a[252:253], v234 offset:40960
    v_accvgpr_write_b32 a118, 0
    v_mfma_f32_16x16x32_bf16 v[48:51], a[240:243], a[208:211], v[48:51]
    s_add_u32 s27, s93, 39936
    s_waitcnt vmcnt(21)
    ds_read_b64_tr_b16 a[254:255], v234 offset:41984
    buffer_load_dwordx4 v224, s[4:7], s27 offen offset:1024 lds
    v_accvgpr_write_b32 a119, 0
    v_mfma_f32_16x16x32_bf16 v[80:83], a[240:243], a[216:219], v[80:83]
    ds_read_b128 a[160:163], v227 offset:0
    v_accvgpr_write_b32 a120, 0
    v_mfma_f32_16x16x32_bf16 v[80:83], a[244:247], a[220:223], v[80:83]
    s_add_u32 s27, s93, 47104
    buffer_load_dwordx4 v223, s[4:7], s27 offen offset:2048 lds
    ds_read_b128 a[164:167], v228 offset:0
    v_accvgpr_write_b32 a121, 0
    v_mfma_f32_16x16x32_bf16 v[112:115], a[244:247], a[228:231], v[112:115]
    ds_read_b128 a[168:171], v227 offset:2048
    v_accvgpr_write_b32 a122, 0
    v_mfma_f32_16x16x32_bf16 v[112:115], a[240:243], a[224:227], v[112:115]
    s_waitcnt lgkmcnt(5)
    ds_read_b128 a[172:175], v228 offset:2048
    v_accvgpr_write_b32 a123, 0
    v_mfma_f32_16x16x32_bf16 v[20:23], a[248:251], a[200:203], v[20:23]
    s_waitcnt lgkmcnt(4)
    s_add_u32 s27, s93, 54272
    ds_read_b64_tr_b16 a[240:241], v235 offset:32768
    buffer_load_dwordx4 v224, s[4:7], s27 offen offset:3072 lds
    v_accvgpr_write_b32 a124, 0
    v_mfma_f32_16x16x32_bf16 v[20:23], a[252:255], a[204:207], v[20:23]
    ds_read_b64_tr_b16 a[242:243], v235 offset:33792
    v_accvgpr_write_b32 a125, 0
    v_mfma_f32_16x16x32_bf16 v[52:55], a[252:255], a[212:215], v[52:55]
    s_mov_b32 m0, 139264
    ds_read_b64_tr_b16 a[244:245], v235 offset:40960
    v_accvgpr_write_b32 a126, 0
    v_mfma_f32_16x16x32_bf16 v[52:55], a[248:251], a[208:211], v[52:55]
    s_add_u32 s27, s101, 262144
    ds_read_b64_tr_b16 a[246:247], v235 offset:41984
    buffer_load_dwordx4 v225, s[8:11], s27 offen lds
    v_accvgpr_write_b32 a127, 0
    v_mfma_f32_16x16x32_bf16 v[84:87], a[248:251], a[216:219], v[84:87]
    ds_read_b128 a[176:179], v227 offset:4096
    v_mov_b32 v200, 0
    v_mfma_f32_16x16x32_bf16 v[84:87], a[252:255], a[220:223], v[84:87]
    s_add_u32 s27, s101, 293888
    buffer_load_dwordx4 v225, s[8:11], s27 offen offset:1024 lds
    ds_read_b128 a[180:183], v228 offset:4096
    v_mov_b32 v201, 0
    v_mfma_f32_16x16x32_bf16 v[116:119], a[252:255], a[228:231], v[116:119]
    ds_read_b128 a[184:187], v227 offset:6144
    v_mov_b32 v202, 0
    v_mfma_f32_16x16x32_bf16 v[116:119], a[248:251], a[224:227], v[116:119]
    s_waitcnt lgkmcnt(5)
    ds_read_b128 a[188:191], v228 offset:6144
    v_mov_b32 v203, 0
    v_mfma_f32_16x16x32_bf16 v[24:27], a[240:243], a[200:203], v[24:27]
    s_waitcnt lgkmcnt(4)
    s_add_u32 s27, s101, 325632
    ds_read_b64_tr_b16 a[248:249], v236 offset:32768
    buffer_load_dwordx4 v226, s[8:11], s27 offen offset:2048 lds
    v_mfma_f32_16x16x32_bf16 v[24:27], a[244:247], a[204:207], v[24:27]
    ds_read_b64_tr_b16 a[250:251], v236 offset:33792
    v_mfma_f32_16x16x32_bf16 v[56:59], a[244:247], a[212:215], v[56:59]
    ds_read_b64_tr_b16 a[252:253], v236 offset:40960
    v_mfma_f32_16x16x32_bf16 v[56:59], a[240:243], a[208:211], v[56:59]
    s_add_u32 s27, s101, 357376
    ds_read_b64_tr_b16 a[254:255], v236 offset:41984
    buffer_load_dwordx4 v226, s[8:11], s27 offen offset:3072 lds
    v_mfma_f32_16x16x32_bf16 v[88:91], a[240:243], a[216:219], v[88:91]
    s_mov_b32 m0, 143360
    v_mfma_f32_16x16x32_bf16 v[88:91], a[244:247], a[220:223], v[88:91]
    s_add_u32 s27, s101, 393216
    buffer_load_dwordx4 v225, s[8:11], s27 offen lds
    v_mfma_f32_16x16x32_bf16 v[120:123], a[244:247], a[228:231], v[120:123]
    v_mfma_f32_16x16x32_bf16 v[120:123], a[240:243], a[224:227], v[120:123]
    s_waitcnt vmcnt(21) lgkmcnt(0)
    s_barrier
    v_mfma_f32_16x16x32_bf16 v[28:31], a[248:251], a[200:203], v[28:31]
    s_add_u32 s27, s101, 424960
    buffer_load_dwordx4 v225, s[8:11], s27 offen offset:1024 lds
    ds_read_b64_tr_b16 a[240:241], v229 offset:0
    v_mfma_f32_16x16x32_bf16 v[28:31], a[252:255], a[204:207], v[28:31]
    ds_read_b64_tr_b16 a[242:243], v229 offset:1024
    v_mfma_f32_16x16x32_bf16 v[60:63], a[252:255], a[212:215], v[60:63]
    ds_read_b64_tr_b16 a[244:245], v229 offset:8192
    v_mfma_f32_16x16x32_bf16 v[60:63], a[248:251], a[208:211], v[60:63]
    s_add_u32 s27, s101, 456704
    buffer_load_dwordx4 v226, s[8:11], s27 offen offset:2048 lds
    ds_read_b64_tr_b16 a[246:247], v229 offset:9216
    v_mfma_f32_16x16x32_bf16 v[92:95], a[248:251], a[216:219], v[92:95]
    v_mfma_f32_16x16x32_bf16 v[92:95], a[252:255], a[220:223], v[92:95]
    v_mfma_f32_16x16x32_bf16 v[124:127], a[252:255], a[228:231], v[124:127]
    s_add_u32 s27, s101, 488448
    buffer_load_dwordx4 v226, s[8:11], s27 offen offset:3072 lds
    v_mfma_f32_16x16x32_bf16 v[124:127], a[248:251], a[224:227], v[124:127]
    s_waitcnt lgkmcnt(2)
    v_mfma_f32_16x16x32_bf16 v[0:3], a[240:243], a[160:163], v[0:3]
    s_waitcnt lgkmcnt(0)
    ds_read_b64_tr_b16 a[248:249], v230 offset:0
    v_mfma_f32_16x16x32_bf16 v[0:3], a[244:247], a[164:167], v[0:3]
    s_mov_b32 m0, 0
    ds_read_b64_tr_b16 a[250:251], v230 offset:1024
    v_mfma_f32_16x16x32_bf16 v[32:35], a[244:247], a[172:175], v[32:35]
    s_and_b32 s27, s30, 0x3ffff
    ds_read_b64_tr_b16 a[252:253], v230 offset:8192
    buffer_load_dwordx4 v217, s[12:15], s27 offen nt lds
    v_mfma_f32_16x16x32_bf16 v[32:35], a[240:243], a[168:171], v[32:35]
    ds_read_b64_tr_b16 a[254:255], v230 offset:9216
    v_mfma_f32_16x16x32_bf16 v[64:67], a[240:243], a[176:179], v[64:67]
    s_add_u32 s30, s30, 4096
    buffer_load_dwordx4 v218, s[12:15], s27 offen offset:1024 nt lds
    v_and_b32 v243, 1, v239
    v_mfma_f32_16x16x32_bf16 v[64:67], a[244:247], a[180:183], v[64:67]
    v_lshrrev_b32 v244, 1, v241
    v_mfma_f32_16x16x32_bf16 v[96:99], a[244:247], a[188:191], v[96:99]
    v_lshl_add_u32 v243, v243, 1, v244
    v_mfma_f32_16x16x32_bf16 v[96:99], a[240:243], a[184:187], v[96:99]
    s_waitcnt lgkmcnt(2)
    buffer_load_dwordx4 v219, s[12:15], s27 offen offset:2048 nt lds
    v_lshl_add_u32 v244, v239, 2, v241
    v_mfma_f32_16x16x32_bf16 v[4:7], a[248:251], a[160:163], v[4:7]
    s_waitcnt lgkmcnt(0)
    ds_read_b64_tr_b16 a[240:241], v231 offset:0
    v_lshlrev_b32 v244, 7, v244
    v_mfma_f32_16x16x32_bf16 v[4:7], a[252:255], a[164:167], v[4:7]
    ds_read_b64_tr_b16 a[242:243], v231 offset:1024
    buffer_load_dwordx4 v220, s[12:15], s27 offen offset:3072 nt lds
    v_lshl_add_u32 v244, v242, 3, v244
    v_mfma_f32_16x16x32_bf16 v[36:39], a[252:255], a[172:175], v[36:39]
    ds_read_b64_tr_b16 a[244:245], v231 offset:8192
    v_lshl_add_u32 v244, v243, 5, v244
    v_mfma_f32_16x16x32_bf16 v[36:39], a[248:251], a[168:171], v[36:39]
    s_mov_b32 m0, 4096
    ds_read_b64_tr_b16 a[246:247], v231 offset:9216
    v_add_u32 v244, s34, v244
    v_mfma_f32_16x16x32_bf16 v[68:71], a[248:251], a[176:179], v[68:71]
    s_and_b32 s27, s30, 0x3ffff
    buffer_load_dwordx4 v217, s[12:15], s27 offen nt lds
    v_add_u32 v223, 0x24000, v244
    v_mfma_f32_16x16x32_bf16 v[68:71], a[252:255], a[180:183], v[68:71]
    v_xor_b32 v224, 0x20, v223
    v_mfma_f32_16x16x32_bf16 v[100:103], a[252:255], a[188:191], v[100:103]
    v_xor_b32 v225, 0x40, v223
    v_mfma_f32_16x16x32_bf16 v[100:103], a[248:251], a[184:187], v[100:103]
    s_waitcnt lgkmcnt(2)
    s_add_u32 s30, s30, 4096
    buffer_load_dwordx4 v218, s[12:15], s27 offen offset:1024 nt lds
    v_xor_b32 v226, 0x60, v223
    v_mfma_f32_16x16x32_bf16 v[8:11], a[240:243], a[160:163], v[8:11]
    s_waitcnt lgkmcnt(0)
    ds_read_b64_tr_b16 a[248:249], v232 offset:0
    v_mfma_f32_16x16x32_bf16 v[8:11], a[244:247], a[164:167], v[8:11]
    ds_read_b64_tr_b16 a[250:251], v232 offset:1024
    buffer_load_dwordx4 v219, s[12:15], s27 offen offset:2048 nt lds
    v_mfma_f32_16x16x32_bf16 v[40:43], a[244:247], a[172:175], v[40:43]
    ds_read_b64_tr_b16 a[252:253], v232 offset:8192
    v_mfma_f32_16x16x32_bf16 v[40:43], a[240:243], a[168:171], v[40:43]
    ds_read_b64_tr_b16 a[254:255], v232 offset:9216
    v_mfma_f32_16x16x32_bf16 v[72:75], a[240:243], a[176:179], v[72:75]
    buffer_load_dwordx4 v220, s[12:15], s27 offen offset:3072 nt lds
    v_mfma_f32_16x16x32_bf16 v[72:75], a[244:247], a[180:183], v[72:75]
    s_mov_b32 m0, 8192
    v_mfma_f32_16x16x32_bf16 v[104:107], a[244:247], a[188:191], v[104:107]
    s_and_b32 s27, s30, 0x3ffff
    buffer_load_dwordx4 v217, s[12:15], s27 offen nt lds
    v_mfma_f32_16x16x32_bf16 v[104:107], a[240:243], a[184:187], v[104:107]
    s_waitcnt lgkmcnt(2)
    v_mfma_f32_16x16x32_bf16 v[12:15], a[248:251], a[160:163], v[12:15]
    s_waitcnt lgkmcnt(0)
    ds_read_b64_tr_b16 a[240:241], v233 offset:0
    v_mfma_f32_16x16x32_bf16 v[12:15], a[252:255], a[164:167], v[12:15]
    s_add_u32 s30, s30, 4096
    ds_read_b64_tr_b16 a[242:243], v233 offset:1024
    buffer_load_dwordx4 v218, s[12:15], s27 offen offset:1024 nt lds
    v_mfma_f32_16x16x32_bf16 v[44:47], a[252:255], a[172:175], v[44:47]
    ds_read_b64_tr_b16 a[244:245], v233 offset:8192
    v_mfma_f32_16x16x32_bf16 v[44:47], a[248:251], a[168:171], v[44:47]
    ds_read_b64_tr_b16 a[246:247], v233 offset:9216
    v_mfma_f32_16x16x32_bf16 v[76:79], a[248:251], a[176:179], v[76:79]
    buffer_load_dwordx4 v219, s[12:15], s27 offen offset:2048 nt lds
    v_mfma_f32_16x16x32_bf16 v[76:79], a[252:255], a[180:183], v[76:79]
    v_mfma_f32_16x16x32_bf16 v[108:111], a[252:255], a[188:191], v[108:111]
    buffer_load_dwordx4 v220, s[12:15], s27 offen offset:3072 nt lds
    v_mfma_f32_16x16x32_bf16 v[108:111], a[248:251], a[184:187], v[108:111]
    s_waitcnt lgkmcnt(2)
    v_mfma_f32_16x16x32_bf16 v[16:19], a[240:243], a[160:163], v[16:19]
    s_waitcnt lgkmcnt(0)
    s_mov_b32 m0, 12288
    ds_read_b64_tr_b16 a[248:249], v234 offset:0
    v_mfma_f32_16x16x32_bf16 v[16:19], a[244:247], a[164:167], v[16:19]
    s_and_b32 s27, s30, 0x3ffff
    ds_read_b64_tr_b16 a[250:251], v234 offset:1024
    buffer_load_dwordx4 v217, s[12:15], s27 offen nt lds
    v_mfma_f32_16x16x32_bf16 v[48:51], a[244:247], a[172:175], v[48:51]
    ds_read_b64_tr_b16 a[252:253], v234 offset:8192
    v_mfma_f32_16x16x32_bf16 v[48:51], a[240:243], a[168:171], v[48:51]
    s_add_u32 s30, s30, 4096
    s_waitcnt vmcnt(21)
    ds_read_b64_tr_b16 a[254:255], v234 offset:9216
    buffer_load_dwordx4 v218, s[12:15], s27 offen offset:1024 nt lds
    v_mfma_f32_16x16x32_bf16 v[80:83], a[240:243], a[176:179], v[80:83]
    ds_read_b128 a[200:203], v227 offset:40960
    v_mfma_f32_16x16x32_bf16 v[80:83], a[244:247], a[180:183], v[80:83]
    ds_read_b128 a[204:207], v228 offset:40960
    v_mfma_f32_16x16x32_bf16 v[112:115], a[244:247], a[188:191], v[112:115]
    buffer_load_dwordx4 v219, s[12:15], s27 offen offset:2048 nt lds
    ds_read_b128 a[208:211], v227 offset:43008
    v_mfma_f32_16x16x32_bf16 v[112:115], a[240:243], a[184:187], v[112:115]
    s_waitcnt lgkmcnt(5)
    ds_read_b128 a[212:215], v228 offset:43008
    v_mfma_f32_16x16x32_bf16 v[20:23], a[248:251], a[160:163], v[20:23]
    s_waitcnt lgkmcnt(4)
    ds_read_b64_tr_b16 a[240:241], v235 offset:0
    v_mfma_f32_16x16x32_bf16 v[20:23], a[252:255], a[164:167], v[20:23]
    ds_read_b64_tr_b16 a[242:243], v235 offset:1024
    buffer_load_dwordx4 v220, s[12:15], s27 offen offset:3072 nt lds
    v_mfma_f32_16x16x32_bf16 v[52:55], a[252:255], a[172:175], v[52:55]
    s_mov_b32 m0, 16384
    ds_read_b64_tr_b16 a[244:245], v235 offset:8192
    v_mfma_f32_16x16x32_bf16 v[52:55], a[248:251], a[168:171], v[52:55]
    s_and_b32 s27, s30, 0x3ffff
    ds_read_b64_tr_b16 a[246:247], v235 offset:9216
    buffer_load_dwordx4 v217, s[12:15], s27 offen nt lds
    v_mfma_f32_16x16x32_bf16 v[84:87], a[248:251], a[176:179], v[84:87]
    ds_read_b128 a[216:219], v227 offset:45056
    v_mfma_f32_16x16x32_bf16 v[84:87], a[252:255], a[180:183], v[84:87]
    ds_read_b128 a[220:223], v228 offset:45056
    v_mfma_f32_16x16x32_bf16 v[116:119], a[252:255], a[188:191], v[116:119]
    s_add_u32 s30, s30, 4096
    buffer_load_dwordx4 v218, s[12:15], s27 offen offset:1024 nt lds
    ds_read_b128 a[224:227], v227 offset:47104
    v_mfma_f32_16x16x32_bf16 v[116:119], a[248:251], a[184:187], v[116:119]
    s_waitcnt lgkmcnt(5)
    ds_read_b128 a[228:231], v228 offset:47104
    v_mfma_f32_16x16x32_bf16 v[24:27], a[240:243], a[160:163], v[24:27]
    s_waitcnt lgkmcnt(4)
    ds_read_b64_tr_b16 a[248:249], v236 offset:0
    buffer_load_dwordx4 v219, s[12:15], s27 offen offset:2048 nt lds
    v_mfma_f32_16x16x32_bf16 v[24:27], a[244:247], a[164:167], v[24:27]
    ds_read_b64_tr_b16 a[250:251], v236 offset:1024
    v_mfma_f32_16x16x32_bf16 v[56:59], a[244:247], a[172:175], v[56:59]
    ds_read_b64_tr_b16 a[252:253], v236 offset:8192
    v_mfma_f32_16x16x32_bf16 v[56:59], a[240:243], a[168:171], v[56:59]
    ds_read_b64_tr_b16 a[254:255], v236 offset:9216
    buffer_load_dwordx4 v220, s[12:15], s27 offen offset:3072 nt lds
    v_mfma_f32_16x16x32_bf16 v[88:91], a[240:243], a[176:179], v[88:91]
    v_mfma_f32_16x16x32_bf16 v[88:91], a[244:247], a[180:183], v[88:91]
    s_mov_b32 m0, 20480
    v_mfma_f32_16x16x32_bf16 v[120:123], a[244:247], a[188:191], v[120:123]
    s_and_b32 s27, s30, 0x3ffff
    buffer_load_dwordx4 v217, s[12:15], s27 offen nt lds
    v_mfma_f32_16x16x32_bf16 v[120:123], a[240:243], a[184:187], v[120:123]
    s_waitcnt vmcnt(21) lgkmcnt(0)
    s_barrier
    v_mfma_f32_16x16x32_bf16 v[28:31], a[248:251], a[160:163], v[28:31]
    s_add_u32 s30, s30, 4096
    buffer_load_dwordx4 v218, s[12:15], s27 offen offset:1024 nt lds
    ds_read_b64_tr_b16 a[240:241], v229 offset:16384
    v_mfma_f32_16x16x32_bf16 v[28:31], a[252:255], a[164:167], v[28:31]
    ds_read_b64_tr_b16 a[242:243], v229 offset:17408
    v_mfma_f32_16x16x32_bf16 v[60:63], a[252:255], a[172:175], v[60:63]
    ds_read_b64_tr_b16 a[244:245], v229 offset:24576
    v_mfma_f32_16x16x32_bf16 v[60:63], a[248:251], a[168:171], v[60:63]
    buffer_load_dwordx4 v219, s[12:15], s27 offen offset:2048 nt lds
    ds_read_b64_tr_b16 a[246:247], v229 offset:25600
    v_mfma_f32_16x16x32_bf16 v[92:95], a[248:251], a[176:179], v[92:95]
    v_mfma_f32_16x16x32_bf16 v[92:95], a[252:255], a[180:183], v[92:95]
    v_mfma_f32_16x16x32_bf16 v[124:127], a[252:255], a[188:191], v[124:127]
    buffer_load_dwordx4 v220, s[12:15], s27 offen offset:3072 nt lds
    v_mfma_f32_16x16x32_bf16 v[124:127], a[248:251], a[184:187], v[124:127]
    s_waitcnt lgkmcnt(2)
    v_mfma_f32_16x16x32_bf16 v[0:3], a[240:243], a[200:203], v[0:3]
    s_waitcnt lgkmcnt(0)
    ds_read_b64_tr_b16 a[248:249], v230 offset:16384
    v_mfma_f32_16x16x32_bf16 v[0:3], a[244:247], a[204:207], v[0:3]
    s_add_u32 m0, s34, 147456
    ds_read_b64_tr_b16 a[250:251], v230 offset:17408
    v_mfma_f32_16x16x32_bf16 v[32:35], a[244:247], a[212:215], v[32:35]
    s_add_u32 s27, s28, 0
    ds_read_b64_tr_b16 a[252:253], v230 offset:24576
    buffer_load_dwordx4 v251, s[56:59], s27 offen nt lds
    v_mfma_f32_16x16x32_bf16 v[32:35], a[240:243], a[208:211], v[32:35]
    ds_read_b64_tr_b16 a[254:255], v230 offset:25600
    v_mfma_f32_16x16x32_bf16 v[64:67], a[240:243], a[216:219], v[64:67]
    v_mfma_f32_16x16x32_bf16 v[64:67], a[244:247], a[220:223], v[64:67]
    s_add_u32 s27, s28, 7168
    buffer_load_dwordx4 v251, s[56:59], s27 offen offset:1024 nt lds
    v_mfma_f32_16x16x32_bf16 v[96:99], a[244:247], a[228:231], v[96:99]
    v_mfma_f32_16x16x32_bf16 v[96:99], a[240:243], a[224:227], v[96:99]
    s_waitcnt lgkmcnt(2)
    v_mfma_f32_16x16x32_bf16 v[4:7], a[248:251], a[200:203], v[4:7]
    s_waitcnt lgkmcnt(0)
    s_add_u32 s27, s28, 14336
    ds_read_b64_tr_b16 a[240:241], v231 offset:16384
    buffer_load_dwordx4 v251, s[56:59], s27 offen offset:2048 nt lds
    v_mfma_f32_16x16x32_bf16 v[4:7], a[252:255], a[204:207], v[4:7]
    ds_read_b64_tr_b16 a[242:243], v231 offset:17408
    v_mfma_f32_16x16x32_bf16 v[36:39], a[252:255], a[212:215], v[36:39]
    ds_read_b64_tr_b16 a[244:245], v231 offset:24576
    v_mfma_f32_16x16x32_bf16 v[36:39], a[248:251], a[208:211], v[36:39]
    s_add_u32 s27, s28, 21504
    ds_read_b64_tr_b16 a[246:247], v231 offset:25600
    buffer_load_dwordx4 v251, s[56:59], s27 offen offset:3072 nt lds
    v_mfma_f32_16x16x32_bf16 v[68:71], a[248:251], a[216:219], v[68:71]
    v_mfma_f32_16x16x32_bf16 v[68:71], a[252:255], a[220:223], v[68:71]
    s_mov_b32 m0, 24576
    v_mul_f32 v0, s33, v0
    v_mul_f32 v1, s33, v1
    v_mfma_f32_16x16x32_bf16 v[100:103], a[252:255], a[228:231], v[100:103]
    s_and_b32 s27, s30, 0x3ffff
    buffer_load_dwordx4 v217, s[12:15], s27 offen nt lds
    v_mfma_f32_16x16x32_bf16 v[100:103], a[248:251], a[224:227], v[100:103]
    s_waitcnt lgkmcnt(2)
    v_mul_f32 v2, s33, v2
    v_mul_f32 v3, s33, v3
    v_mfma_f32_16x16x32_bf16 v[8:11], a[240:243], a[200:203], v[8:11]
    s_waitcnt lgkmcnt(0)
    ds_read_b64_tr_b16 a[248:249], v232 offset:16384
    v_mul_f32 v32, s33, v32
    v_mfma_f32_16x16x32_bf16 v[8:11], a[244:247], a[204:207], v[8:11]
    s_add_u32 s30, s30, 4096
    ds_read_b64_tr_b16 a[250:251], v232 offset:17408
    buffer_load_dwordx4 v218, s[12:15], s27 offen offset:1024 nt lds
    v_mfma_f32_16x16x32_bf16 v[40:43], a[244:247], a[212:215], v[40:43]
    ds_read_b64_tr_b16 a[252:253], v232 offset:24576
    v_mul_f32 v33, s33, v33
    v_mfma_f32_16x16x32_bf16 v[40:43], a[240:243], a[208:211], v[40:43]
    ds_read_b64_tr_b16 a[254:255], v232 offset:25600
    v_mul_f32 v34, s33, v34
    v_mfma_f32_16x16x32_bf16 v[72:75], a[240:243], a[216:219], v[72:75]
    buffer_load_dwordx4 v219, s[12:15], s27 offen offset:2048 nt lds
    v_mfma_f32_16x16x32_bf16 v[72:75], a[244:247], a[220:223], v[72:75]
    v_mul_f32 v35, s33, v35
    v_mul_f32 v64, s33, v64
    v_mfma_f32_16x16x32_bf16 v[104:107], a[244:247], a[228:231], v[104:107]
    v_mul_f32 v65, s33, v65
    v_mul_f32 v66, s33, v66
    v_mfma_f32_16x16x32_bf16 v[104:107], a[240:243], a[224:227], v[104:107]
    s_waitcnt lgkmcnt(2)
    v_mul_f32 v67, s33, v67
    v_mul_f32 v96, s33, v96
    v_mfma_f32_16x16x32_bf16 v[12:15], a[248:251], a[200:203], v[12:15]
    s_waitcnt lgkmcnt(0)
    ds_read_b64_tr_b16 a[240:241], v233 offset:16384
    buffer_load_dwordx4 v220, s[12:15], s27 offen offset:3072 nt lds
    v_mfma_f32_16x16x32_bf16 v[12:15], a[252:255], a[204:207], v[12:15]
    ds_read_b64_tr_b16 a[242:243], v233 offset:17408
    v_mul_f32 v97, s33, v97
    v_mfma_f32_16x16x32_bf16 v[44:47], a[252:255], a[212:215], v[44:47]
    s_mov_b32 m0, 28672
    ds_read_b64_tr_b16 a[244:245], v233 offset:24576
    v_mul_f32 v98, s33, v98
    v_mfma_f32_16x16x32_bf16 v[44:47], a[248:251], a[208:211], v[44:47]
    s_and_b32 s27, s30, 0x3ffff
    ds_read_b64_tr_b16 a[246:247], v233 offset:25600
    buffer_load_dwordx4 v217, s[12:15], s27 offen nt lds
    v_mfma_f32_16x16x32_bf16 v[76:79], a[248:251], a[216:219], v[76:79]
    v_mul_f32 v99, s33, v99
    v_mul_f32 v4, s33, v4
    v_mfma_f32_16x16x32_bf16 v[76:79], a[252:255], a[220:223], v[76:79]
    v_mul_f32 v5, s33, v5
    v_mul_f32 v6, s33, v6
    v_mfma_f32_16x16x32_bf16 v[108:111], a[252:255], a[228:231], v[108:111]
    s_add_u32 s30, s30, 4096
    buffer_load_dwordx4 v218, s[12:15], s27 offen offset:1024 nt lds
    v_mfma_f32_16x16x32_bf16 v[108:111], a[248:251], a[224:227], v[108:111]
    s_waitcnt lgkmcnt(2)
    v_mul_f32 v7, s33, v7
    v_mul_f32 v36, s33, v36
    v_mfma_f32_16x16x32_bf16 v[16:19], a[240:243], a[200:203], v[16:19]
    s_waitcnt lgkmcnt(0)
    ds_read_b64_tr_b16 a[248:249], v234 offset:16384
    v_mul_f32 v37, s33, v37
    v_mfma_f32_16x16x32_bf16 v[16:19], a[244:247], a[204:207], v[16:19]
    ds_read_b64_tr_b16 a[250:251], v234 offset:17408
    buffer_load_dwordx4 v219, s[12:15], s27 offen offset:2048 nt lds
    v_mfma_f32_16x16x32_bf16 v[48:51], a[244:247], a[212:215], v[48:51]
    ds_read_b64_tr_b16 a[252:253], v234 offset:24576
    v_mul_f32 v38, s33, v38
    v_mfma_f32_16x16x32_bf16 v[48:51], a[240:243], a[208:211], v[48:51]
    ds_read_b64_tr_b16 a[254:255], v234 offset:25600
    v_mul_f32 v39, s33, v39
    v_mfma_f32_16x16x32_bf16 v[80:83], a[240:243], a[216:219], v[80:83]
    buffer_load_dwordx4 v220, s[12:15], s27 offen offset:3072 nt lds
    v_mfma_f32_16x16x32_bf16 v[80:83], a[244:247], a[220:223], v[80:83]
    v_mul_f32 v68, s33, v68
    v_mul_f32 v69, s33, v69
    v_mfma_f32_16x16x32_bf16 v[112:115], a[244:247], a[228:231], v[112:115]
    s_mov_b32 m0, 65536
    v_mul_f32 v70, s33, v70
    v_mul_f32 v71, s33, v71
    v_mfma_f32_16x16x32_bf16 v[112:115], a[240:243], a[224:227], v[112:115]
    s_waitcnt lgkmcnt(2)
    s_and_b32 s27, s3, 0x3ffff
    buffer_load_dwordx4 v221, s[16:19], s27 offen nt lds
    v_mfma_f32_16x16x32_bf16 v[20:23], a[248:251], a[200:203], v[20:23]
    s_waitcnt lgkmcnt(0)
    ds_read_b64_tr_b16 a[240:241], v235 offset:16384
    v_mul_f32 v100, s33, v100
    v_mfma_f32_16x16x32_bf16 v[20:23], a[252:255], a[204:207], v[20:23]
    ds_read_b64_tr_b16 a[242:243], v235 offset:17408
    v_mul_f32 v101, s33, v101
    v_mfma_f32_16x16x32_bf16 v[52:55], a[252:255], a[212:215], v[52:55]
    ds_read_b64_tr_b16 a[244:245], v235 offset:24576
    v_mul_f32 v102, s33, v102
    v_mfma_f32_16x16x32_bf16 v[52:55], a[248:251], a[208:211], v[52:55]
    s_add_u32 s3, s3, 4096
    ds_read_b64_tr_b16 a[246:247], v235 offset:25600
    buffer_load_dwordx4 v222, s[16:19], s27 offen offset:1024 nt lds
    v_mfma_f32_16x16x32_bf16 v[84:87], a[248:251], a[216:219], v[84:87]
    v_mul_f32 v103, s33, v103
    v_mul_f32 v8, s33, v8
    v_mfma_f32_16x16x32_bf16 v[84:87], a[252:255], a[220:223], v[84:87]
    v_mul_f32 v9, s33, v9
    v_mul_f32 v10, s33, v10
    v_mfma_f32_16x16x32_bf16 v[116:119], a[252:255], a[228:231], v[116:119]
    buffer_load_dwordx4 v221, s[16:19], s27 offen offset:2048 nt lds
    v_mfma_f32_16x16x32_bf16 v[116:119], a[248:251], a[224:227], v[116:119]
    s_waitcnt lgkmcnt(2)
    v_mul_f32 v11, s33, v11
    v_mul_f32 v40, s33, v40
    v_mfma_f32_16x16x32_bf16 v[24:27], a[240:243], a[200:203], v[24:27]
    s_waitcnt lgkmcnt(0)
    ds_read_b64_tr_b16 a[248:249], v236 offset:16384
    v_mul_f32 v41, s33, v41
    v_mfma_f32_16x16x32_bf16 v[24:27], a[244:247], a[204:207], v[24:27]
    ds_read_b64_tr_b16 a[250:251], v236 offset:17408
    buffer_load_dwordx4 v222, s[16:19], s27 offen offset:3072 nt lds
    v_mfma_f32_16x16x32_bf16 v[56:59], a[244:247], a[212:215], v[56:59]
    ds_read_b64_tr_b16 a[252:253], v236 offset:24576
    v_mul_f32 v42, s33, v42
    v_mfma_f32_16x16x32_bf16 v[56:59], a[240:243], a[208:211], v[56:59]
    s_mov_b32 m0, 69632
    ds_read_b64_tr_b16 a[254:255], v236 offset:25600
    v_mul_f32 v43, s33, v43
    v_mfma_f32_16x16x32_bf16 v[88:91], a[240:243], a[216:219], v[88:91]
    s_and_b32 s27, s3, 0x3ffff
    buffer_load_dwordx4 v221, s[16:19], s27 offen nt lds
    v_mfma_f32_16x16x32_bf16 v[88:91], a[244:247], a[220:223], v[88:91]
    v_mul_f32 v72, s33, v72
    v_mul_f32 v73, s33, v73
    v_mfma_f32_16x16x32_bf16 v[120:123], a[244:247], a[228:231], v[120:123]
    v_mul_f32 v74, s33, v74
    v_mul_f32 v75, s33, v75
    v_mfma_f32_16x16x32_bf16 v[120:123], a[240:243], a[224:227], v[120:123]
    s_add_u32 s3, s3, 4096
    s_waitcnt vmcnt(25) lgkmcnt(0)
    s_barrier
    buffer_load_dwordx4 v222, s[16:19], s27 offen offset:1024 nt lds
    v_mfma_f32_16x16x32_bf16 v[28:31], a[248:251], a[200:203], v[28:31]
    ds_read_b128 a[160:163], v205 offset:0
    v_mul_f32 v104, s33, v104
    v_mfma_f32_16x16x32_bf16 v[28:31], a[252:255], a[204:207], v[28:31]
    ds_read_b128 a[164:167], v206 offset:0
    v_mul_f32 v105, s33, v105
    v_mfma_f32_16x16x32_bf16 v[60:63], a[252:255], a[212:215], v[60:63]
    buffer_load_dwordx4 v221, s[16:19], s27 offen offset:2048 nt lds
    ds_read_b128 a[168:171], v207 offset:0
    v_mfma_f32_16x16x32_bf16 v[60:63], a[248:251], a[208:211], v[60:63]
    ds_read_b128 a[172:175], v208 offset:0
    v_mul_f32 v106, s33, v106
    v_mfma_f32_16x16x32_bf16 v[92:95], a[248:251], a[216:219], v[92:95]
    v_mul_f32 v107, s33, v107
    v_mul_f32 v12, s33, v12
    v_mfma_f32_16x16x32_bf16 v[92:95], a[252:255], a[220:223], v[92:95]
    v_mul_f32 v13, s33, v13
    v_mul_f32 v14, s33, v14
    v_mfma_f32_16x16x32_bf16 v[124:127], a[252:255], a[228:231], v[124:127]
    buffer_load_dwordx4 v222, s[16:19], s27 offen offset:3072 nt lds
    v_mfma_f32_16x16x32_bf16 v[124:127], a[248:251], a[224:227], v[124:127]
    v_mul_f32 v15, s33, v15
    v_mul_f32 v44, s33, v44
    s_cmp_lg_u32 s85, 0
    s_cbranch_scc1 L_sconvB
    s_getpc_b64 s[4:5]
L_pcref:
    s_sub_u32 s4, s4, 0xec00
    s_subb_u32 s5, s5, 0
    s_mov_b32 s6, 0x14a20
    s_mov_b32 s7, 0x20000
    s_mul_i32 s35, s1, 3072
    v_lshlrev_b32 v236, 7, v237
    v_cmp_gt_u32 vcc, 24, v237
    v_mov_b32 v252, 0x7ffffff0
    s_nop 0
    v_cndmask_b32 v236, v252, v236, vcc
    buffer_load_dword v252, v236, s[4:7], s35 offen
    s_lshl_b32 s32, s0, 1
    s_lshr_b32 s27, s1, 4
    s_add_u32 s32, s32, s27
    s_lshl_b32 s32, s32, 2
    s_add_u32 s32, s32, s24
    s_and_b32 s27, s1, 15
    s_lshl_b32 s27, s27, 6
    s_add_u32 s32, s32, s27
    s_lshl_b32 s32, s32, 12
    s_add_u32 s32, s32, 0x2800000
    s_add_u32 s8, s50, s32
    s_addc_u32 s9, s51, 0
    s_mov_b32 s10, 4096
    s_mov_b32 s11, 0x20000
    s_lshl_b32 s32, s54, 1
    s_and_b32 s27, s55, 1
    s_add_u32 s32, s32, s27
    s_lshl_b32 s32, s32, 2
    s_add_u32 s32, s32, s24
    s_lshl_b32 s32, s32, 12
    s_add_u32 s32, s32, 0x2800000
    s_add_u32 s56, s50, s32
    s_addc_u32 s57, s51, 0
    s_mov_b32 s58, 3936256
    s_mov_b32 s59, 0x20000
    s_mov_b32 s31, 4
    s_mov_b32 s20, s48
    s_mov_b32 s21, s49
    s_mov_b32 s22, 256
    s_mov_b32 s23, 0x20000
    s_nop 3
    s_mov_b32 m0, 73728
    s_and_b32 s27, s3, 0x3ffff
    buffer_load_dwordx4 v221, s[16:19], s27 offen nt lds
    s_add_u32 s3, s3, 4096
    buffer_load_dwordx4 v222, s[16:19], s27 offen offset:1024 nt lds
    buffer_load_dwordx4 v221, s[16:19], s27 offen offset:2048 nt lds
    buffer_load_dwordx4 v222, s[16:19], s27 offen offset:3072 nt lds
    v_cvt_pk_bf16_f32 v0, v0, v1
    v_cvt_pk_bf16_f32 v1, v2, v3
    v_cvt_pk_bf16_f32 v2, v4, v5
    v_cvt_pk_bf16_f32 v3, v6, v7
    v_cvt_pk_bf16_f32 v8, v8, v9
    v_cvt_pk_bf16_f32 v9, v10, v11
    v_cvt_pk_bf16_f32 v10, v12, v13
    v_cvt_pk_bf16_f32 v11, v14, v15
    v_mul_f32 v16, s33, v16
    v_mul_f32 v17, s33, v17
    v_mul_f32 v18, s33, v18
    v_mul_f32 v19, s33, v19
    v_mul_f32 v20, s33, v20
    v_mul_f32 v21, s33, v21
    v_mul_f32 v22, s33, v22
    v_mul_f32 v23, s33, v23
    v_cvt_pk_bf16_f32 v16, v16, v17
    v_cvt_pk_bf16_f32 v17, v18, v19
    v_cvt_pk_bf16_f32 v18, v20, v21
    v_cvt_pk_bf16_f32 v19, v22, v23
    v_mul_f32 v24, s33, v24
    v_mul_f32 v25, s33, v25
    v_mul_f32 v26, s33, v26
    v_mul_f32 v27, s33, v27
    v_mul_f32 v28, s33, v28
    v_mul_f32 v29, s33, v29
    v_mul_f32 v30, s33, v30
    v_mul_f32 v31, s33, v31
    v_cvt_pk_bf16_f32 v24, v24, v25
    v_cvt_pk_bf16_f32 v25, v26, v27
    v_cvt_pk_bf16_f32 v26, v28, v29
    v_cvt_pk_bf16_f32 v27, v30, v31
    v_permlane16_swap_b32 v0, v2
    v_permlane16_swap_b32 v1, v3
    v_permlane16_swap_b32 v8, v10
    v_permlane16_swap_b32 v9, v11
    v_permlane16_swap_b32 v16, v18
    v_permlane16_swap_b32 v17, v19
    v_permlane16_swap_b32 v24, v26
    v_permlane16_swap_b32 v25, v27
    ds_read_b128 a[176:179], v205 offset:4096
    s_mov_b32 m0, 77824
    s_and_b32 s27, s3, 0x3ffff
    s_waitcnt lgkmcnt(4)
    v_mfma_f32_16x16x32_bf16 v[160:163], a[160:163], v[0:3], 0
    s_waitcnt lgkmcnt(3)
    buffer_load_dwordx4 v221, s[16:19], s27 offen nt lds
    s_add_u32 s3, s3, 4096
    buffer_load_dwordx4 v222, s[16:19], s27 offen offset:1024 nt lds
    buffer_load_dwordx4 v221, s[16:19], s27 offen offset:2048 nt lds
    buffer_load_dwordx4 v222, s[16:19], s27 offen offset:3072 nt lds
    v_cvt_pk_bf16_f32 v32, v32, v33
    v_cvt_pk_bf16_f32 v33, v34, v35
    v_cvt_pk_bf16_f32 v34, v36, v37
    v_cvt_pk_bf16_f32 v35, v38, v39
    v_mul_f32 v45, s33, v45
    v_mul_f32 v46, s33, v46
    v_mul_f32 v47, s33, v47
    v_mfma_f32_16x16x32_bf16 v[160:163], a[164:167], v[8:11], v[160:163]
    s_waitcnt lgkmcnt(2)
    v_cvt_pk_bf16_f32 v40, v40, v41
    v_cvt_pk_bf16_f32 v41, v42, v43
    v_cvt_pk_bf16_f32 v42, v44, v45
    v_cvt_pk_bf16_f32 v43, v46, v47
    v_mul_f32 v48, s33, v48
    v_mul_f32 v49, s33, v49
    v_mul_f32 v50, s33, v50
    v_mul_f32 v51, s33, v51
    v_mul_f32 v52, s33, v52
    v_mul_f32 v53, s33, v53
    v_mul_f32 v54, s33, v54
    v_mul_f32 v55, s33, v55
    v_mfma_f32_16x16x32_bf16 v[160:163], a[168:171], v[16:19], v[160:163]
    s_waitcnt lgkmcnt(1)
    v_cvt_pk_bf16_f32 v48, v48, v49
    v_cvt_pk_bf16_f32 v49, v50, v51
    v_cvt_pk_bf16_f32 v50, v52, v53
    v_cvt_pk_bf16_f32 v51, v54, v55
    v_mul_f32 v56, s33, v56
    v_mul_f32 v57, s33, v57
    v_mul_f32 v58, s33, v58
    v_mul_f32 v59, s33, v59
    v_mul_f32 v60, s33, v60
    v_mul_f32 v61, s33, v61
    v_mul_f32 v62, s33, v62
    v_mul_f32 v63, s33, v63
    v_mfma_f32_16x16x32_bf16 v[160:163], a[172:175], v[24:27], v[160:163]
    v_cvt_pk_bf16_f32 v56, v56, v57
    v_cvt_pk_bf16_f32 v57, v58, v59
    v_cvt_pk_bf16_f32 v58, v60, v61
    v_cvt_pk_bf16_f32 v59, v62, v63
    v_permlane16_swap_b32 v32, v34
    v_permlane16_swap_b32 v33, v35
    v_permlane16_swap_b32 v40, v42
    v_permlane16_swap_b32 v41, v43
    v_permlane16_swap_b32 v48, v50
    v_permlane16_swap_b32 v49, v51
    v_permlane16_swap_b32 v56, v58
    v_permlane16_swap_b32 v57, v59
    ds_read_b128 a[180:183], v206 offset:4096
    s_mov_b32 m0, 32768
    s_and_b32 s27, s30, 0x3ffff
    v_mfma_f32_16x16x32_bf16 v[164:167], a[172:175], v[56:59], 0
    buffer_load_dwordx4 v217, s[12:15], s27 offen nt lds
    s_add_u32 s30, s30, 4096
    buffer_load_dwordx4 v218, s[12:15], s27 offen offset:1024 nt lds
    buffer_load_dwordx4 v219, s[12:15], s27 offen offset:2048 nt lds
    buffer_load_dwordx4 v220, s[12:15], s27 offen offset:3072 nt lds
    v_cvt_pk_bf16_f32 v64, v64, v65
    v_cvt_pk_bf16_f32 v65, v66, v67
    v_cvt_pk_bf16_f32 v66, v68, v69
    v_cvt_pk_bf16_f32 v67, v70, v71
    v_max3_f32 v239, v160, v161, v162
    v_mul_f32 v76, s33, v76
    v_mul_f32 v77, s33, v77
    v_max_f32 v239, v239, v163
    v_mul_f32 v78, s33, v78
    v_mul_f32 v79, s33, v79
    v_mov_b32 v240, v239
    v_mfma_f32_16x16x32_bf16 v[164:167], a[168:171], v[48:51], v[164:167]
    v_cvt_pk_bf16_f32 v72, v72, v73
    v_cvt_pk_bf16_f32 v73, v74, v75
    v_permlane16_swap_b32 v239, v240
    v_cvt_pk_bf16_f32 v74, v76, v77
    v_cvt_pk_bf16_f32 v75, v78, v79
    v_max_f32 v239, v239, v240
    v_mul_f32 v80, s33, v80
    v_mul_f32 v81, s33, v81
    v_mov_b32 v240, v239
    v_mul_f32 v82, s33, v82
    v_mul_f32 v83, s33, v83
    v_permlane32_swap_b32 v239, v240
    v_mul_f32 v84, s33, v84
    v_mul_f32 v85, s33, v85
    v_max_f32 v239, v239, v240
    v_mul_f32 v86, s33, v86
    v_mfma_f32_16x16x32_bf16 v[164:167], a[164:167], v[40:43], v[164:167]
    v_mul_f32 v87, s33, v87
    v_sub_f32 v180, 0, v239
    v_cvt_pk_bf16_f32 v80, v80, v81
    v_cvt_pk_bf16_f32 v81, v82, v83
    v_sub_f32 v181, 0, v239
    v_cvt_pk_bf16_f32 v82, v84, v85
    v_cvt_pk_bf16_f32 v83, v86, v87
    v_sub_f32 v182, 0, v239
    v_mul_f32 v88, s33, v88
    v_mul_f32 v89, s33, v89
    v_sub_f32 v183, 0, v239
    v_mul_f32 v90, s33, v90
    v_mul_f32 v91, s33, v91
    v_add_f32 v160, v160, v180
    v_mul_f32 v92, s33, v92
    v_mul_f32 v93, s33, v93
    v_mfma_f32_16x16x32_bf16 v[164:167], a[160:163], v[32:35], v[164:167]
    v_add_f32 v161, v161, v180
    v_mul_f32 v94, s33, v94
    v_mul_f32 v95, s33, v95
    v_add_f32 v162, v162, v180
    v_cvt_pk_bf16_f32 v88, v88, v89
    v_cvt_pk_bf16_f32 v89, v90, v91
    v_add_f32 v163, v163, v180
    v_cvt_pk_bf16_f32 v90, v92, v93
    v_cvt_pk_bf16_f32 v91, v94, v95
    v_permlane16_swap_b32 v64, v66
    v_permlane16_swap_b32 v65, v67
    v_permlane16_swap_b32 v72, v74
    v_permlane16_swap_b32 v73, v75
    v_permlane16_swap_b32 v80, v82
    v_permlane16_swap_b32 v81, v83
    v_permlane16_swap_b32 v88, v90
    v_permlane16_swap_b32 v89, v91
    ds_read_b128 a[184:187], v207 offset:4096
    s_mov_b32 m0, 36864
    s_and_b32 s27, s30, 0x3ffff
    v_mfma_f32_16x16x32_bf16 v[168:171], a[160:163], v[64:67], 0
    buffer_load_dwordx4 v217, s[12:15], s27 offen nt lds
    s_add_u32 s30, s30, 4096
    buffer_load_dwordx4 v218, s[12:15], s27 offen offset:1024 nt lds
    buffer_load_dwordx4 v219, s[12:15], s27 offen offset:2048 nt lds
    buffer_load_dwordx4 v220, s[12:15], s27 offen offset:3072 nt lds
    v_cvt_pk_bf16_f32 v96, v96, v97
    v_cvt_pk_bf16_f32 v97, v98, v99
    v_cvt_pk_bf16_f32 v98, v100, v101
    v_cvt_pk_bf16_f32 v99, v102, v103
    v_max3_f32 v241, v164, v165, v166
    v_mul_f32 v108, s33, v108
    v_mul_f32 v109, s33, v109
    v_max_f32 v241, v241, v167
    v_mul_f32 v110, s33, v110
    v_mul_f32 v111, s33, v111
    v_mov_b32 v242, v241
    v_mfma_f32_16x16x32_bf16 v[168:171], a[164:167], v[72:75], v[168:171]
    v_cvt_pk_bf16_f32 v104, v104, v105
    v_cvt_pk_bf16_f32 v105, v106, v107
    v_permlane16_swap_b32 v241, v242
    v_cvt_pk_bf16_f32 v106, v108, v109
    v_cvt_pk_bf16_f32 v107, v110, v111
    v_max_f32 v241, v241, v242
    v_mul_f32 v112, s33, v112
    v_mul_f32 v113, s33, v113
    v_mov_b32 v242, v241
    v_mul_f32 v114, s33, v114
    v_mul_f32 v115, s33, v115
    v_permlane32_swap_b32 v241, v242
    v_mul_f32 v116, s33, v116
    v_mul_f32 v117, s33, v117
    v_max_f32 v241, v241, v242
    v_mul_f32 v118, s33, v118
    v_mfma_f32_16x16x32_bf16 v[168:171], a[168:171], v[80:83], v[168:171]
    v_mul_f32 v119, s33, v119
    v_sub_f32 v184, 0, v241
    v_cvt_pk_bf16_f32 v112, v112, v113
    v_cvt_pk_bf16_f32 v113, v114, v115
    v_sub_f32 v185, 0, v241
    v_cvt_pk_bf16_f32 v114, v116, v117
    v_cvt_pk_bf16_f32 v115, v118, v119
    v_sub_f32 v186, 0, v241
    v_mul_f32 v120, s33, v120
    v_mul_f32 v121, s33, v121
    v_sub_f32 v187, 0, v241
    v_mul_f32 v122, s33, v122
    v_mul_f32 v123, s33, v123
    v_add_f32 v164, v164, v184
    v_mul_f32 v124, s33, v124
    v_mul_f32 v125, s33, v125
    v_mfma_f32_16x16x32_bf16 v[168:171], a[172:175], v[88:91], v[168:171]
    v_add_f32 v165, v165, v184
    v_mul_f32 v126, s33, v126
    v_mul_f32 v127, s33, v127
    v_add_f32 v166, v166, v184
    v_cvt_pk_bf16_f32 v120, v120, v121
    v_cvt_pk_bf16_f32 v121, v122, v123
    v_add_f32 v167, v167, v184
    v_cvt_pk_bf16_f32 v122, v124, v125
    v_cvt_pk_bf16_f32 v123, v126, v127
    v_permlane16_swap_b32 v96, v98
    v_permlane16_swap_b32 v97, v99
    v_permlane16_swap_b32 v104, v106
    v_permlane16_swap_b32 v105, v107
    v_permlane16_swap_b32 v112, v114
    v_permlane16_swap_b32 v113, v115
    v_permlane16_swap_b32 v120, v122
    v_permlane16_swap_b32 v121, v123
    ds_read_b128 a[188:191], v208 offset:4096
    v_exp_f32 v160, v160
    v_exp_f32 v161, v161
    v_mfma_f32_16x16x32_bf16 v[172:175], a[172:175], v[120:123], 0
    v_add_f32 v200, v160, v200
    v_exp_f32 v162, v162
    v_max3_f32 v243, v168, v169, v170
    v_add_f32 v200, v161, v200
    v_cvt_pk_bf16_f32 v4, v160, v161
    v_max_f32 v243, v243, v171
    v_mfma_f32_16x16x32_bf16 v[172:175], a[168:171], v[112:115], v[172:175]
    v_exp_f32 v163, v163
    v_add_f32 v200, v162, v200
    v_mov_b32 v244, v243
    v_exp_f32 v164, v164
    v_add_f32 v200, v163, v200
    v_permlane16_swap_b32 v243, v244
    v_mfma_f32_16x16x32_bf16 v[172:175], a[164:167], v[104:107], v[172:175]
    v_cvt_pk_bf16_f32 v5, v162, v163
    v_max_f32 v243, v243, v244
    v_mov_b32 v244, v243
    s_nop 1
    v_permlane32_swap_b32 v243, v244
    v_max_f32 v243, v243, v244
    v_sub_f32 v188, 0, v243
    v_mfma_f32_16x16x32_bf16 v[172:175], a[160:163], v[96:99], v[172:175]
    s_waitcnt lgkmcnt(3)
    v_sub_f32 v189, 0, v243
    v_sub_f32 v190, 0, v243
    v_sub_f32 v191, 0, v243
    v_add_f32 v168, v168, v188
    v_add_f32 v169, v169, v188
    v_add_f32 v170, v170, v188
    v_add_f32 v171, v171, v188
    v_exp_f32 v165, v165
    v_add_f32 v201, v164, v201
    v_exp_f32 v166, v166
    v_add_f32 v201, v165, v201
    v_cvt_pk_bf16_f32 v20, v164, v165
    v_exp_f32 v167, v167
    v_max3_f32 v245, v172, v173, v174
    v_add_f32 v201, v166, v201
    v_exp_f32 v168, v168
    v_max_f32 v245, v245, v175
    v_add_f32 v201, v167, v201
    v_cvt_pk_bf16_f32 v21, v166, v167
    v_mov_b32 v246, v245
    s_nop 1
    v_permlane16_swap_b32 v245, v246
    v_max_f32 v245, v245, v246
    v_mov_b32 v246, v245
    s_nop 1
    v_permlane32_swap_b32 v245, v246
    v_max_f32 v245, v245, v246
    v_sub_f32 v192, 0, v245
    v_sub_f32 v193, 0, v245
    v_sub_f32 v194, 0, v245
    v_sub_f32 v195, 0, v245
    v_add_f32 v172, v172, v192
    v_add_f32 v173, v173, v192
    v_add_f32 v174, v174, v192
    v_add_f32 v175, v175, v192
    v_mfma_f32_16x16x32_bf16 v[160:163], a[176:179], v[0:3], v[180:183]
    s_waitcnt lgkmcnt(2)
    s_mov_b32 m0, 40960
    ds_read_b128 a[160:163], v205 offset:8192
    v_exp_f32 v169, v169
    v_add_f32 v202, v168, v202
    v_mfma_f32_16x16x32_bf16 v[160:163], a[180:183], v[8:11], v[160:163]
    s_waitcnt lgkmcnt(2)
    s_and_b32 s27, s30, 0x3ffff
    buffer_load_dwordx4 v217, s[12:15], s27 offen nt lds
    v_exp_f32 v170, v170
    v_add_f32 v202, v169, v202
    v_cvt_pk_bf16_f32 v36, v168, v169
    v_mfma_f32_16x16x32_bf16 v[160:163], a[184:187], v[16:19], v[160:163]
    s_waitcnt lgkmcnt(1)
    s_add_u32 s30, s30, 4096
    ds_read_b128 a[164:167], v206 offset:8192
    buffer_load_dwordx4 v218, s[12:15], s27 offen offset:1024 nt lds
    v_exp_f32 v171, v171
    v_add_f32 v202, v170, v202
    v_mfma_f32_16x16x32_bf16 v[160:163], a[188:191], v[24:27], v[160:163]
    v_exp_f32 v172, v172
    v_add_f32 v202, v171, v202
    v_cvt_pk_bf16_f32 v37, v170, v171
    v_mfma_f32_16x16x32_bf16 v[164:167], a[188:191], v[56:59], v[184:187]
    ds_read_b128 a[168:171], v207 offset:8192
    buffer_load_dwordx4 v219, s[12:15], s27 offen offset:2048 nt lds
    v_exp_f32 v173, v173
    v_add_f32 v203, v172, v203
    v_mfma_f32_16x16x32_bf16 v[164:167], a[184:187], v[48:51], v[164:167]
    v_exp_f32 v174, v174
    v_add_f32 v203, v173, v203
    v_cvt_pk_bf16_f32 v52, v172, v173
    v_mfma_f32_16x16x32_bf16 v[164:167], a[180:183], v[40:43], v[164:167]
    ds_read_b128 a[172:175], v208 offset:8192
    buffer_load_dwordx4 v220, s[12:15], s27 offen offset:3072 nt lds
    v_exp_f32 v175, v175
    v_add_f32 v203, v174, v203
    v_mfma_f32_16x16x32_bf16 v[164:167], a[176:179], v[32:35], v[164:167]
    s_mov_b32 m0, 45056
    v_exp_f32 v160, v160
    v_add_f32 v203, v175, v203
    v_cvt_pk_bf16_f32 v53, v174, v175
    v_mfma_f32_16x16x32_bf16 v[168:171], a[176:179], v[64:67], v[188:191]
    s_and_b32 s27, s30, 0x3ffff
    buffer_load_dwordx4 v217, s[12:15], s27 offen nt lds
    v_exp_f32 v161, v161
    v_add_f32 v200, v160, v200
    v_mfma_f32_16x16x32_bf16 v[168:171], a[180:183], v[72:75], v[168:171]
    s_add_u32 s30, s30, 4096
    buffer_load_dwordx4 v218, s[12:15], s27 offen offset:1024 nt lds
    v_exp_f32 v162, v162
    v_add_f32 v200, v161, v200
    v_cvt_pk_bf16_f32 v6, v160, v161
    v_mfma_f32_16x16x32_bf16 v[168:171], a[184:187], v[80:83], v[168:171]
    v_exp_f32 v163, v163
    v_add_f32 v200, v162, v200
    v_mfma_f32_16x16x32_bf16 v[168:171], a[188:191], v[88:91], v[168:171]
    buffer_load_dwordx4 v219, s[12:15], s27 offen offset:2048 nt lds
    v_exp_f32 v164, v164
    v_add_f32 v200, v163, v200
    v_cvt_pk_bf16_f32 v7, v162, v163
    v_mfma_f32_16x16x32_bf16 v[172:175], a[188:191], v[120:123], v[192:195]
    v_exp_f32 v165, v165
    v_add_f32 v201, v164, v201
    v_mfma_f32_16x16x32_bf16 v[172:175], a[184:187], v[112:115], v[172:175]
    buffer_load_dwordx4 v220, s[12:15], s27 offen offset:3072 nt lds
    v_exp_f32 v166, v166
    v_add_f32 v201, v165, v201
    v_cvt_pk_bf16_f32 v22, v164, v165
    v_mfma_f32_16x16x32_bf16 v[172:175], a[180:183], v[104:107], v[172:175]
    s_mov_b32 m0, 81920
    v_exp_f32 v167, v167
    v_add_f32 v201, v166, v201
    v_mfma_f32_16x16x32_bf16 v[172:175], a[176:179], v[96:99], v[172:175]
    s_waitcnt lgkmcnt(3)
    s_and_b32 s27, s3, 0x3ffff
    buffer_load_dwordx4 v221, s[16:19], s27 offen nt lds
    v_exp_f32 v168, v168
    v_add_f32 v201, v167, v201
    v_cvt_pk_bf16_f32 v23, v166, v167
    v_mfma_f32_16x16x32_bf16 v[160:163], a[160:163], v[0:3], v[180:183]
    s_waitcnt lgkmcnt(2)
    ds_read_b128 a[176:179], v205 offset:12288
    v_exp_f32 v169, v169
    v_add_f32 v202, v168, v202
    v_mfma_f32_16x16x32_bf16 v[160:163], a[164:167], v[8:11], v[160:163]
    s_waitcnt lgkmcnt(2)
    s_add_u32 s3, s3, 4096
    buffer_load_dwordx4 v222, s[16:19], s27 offen offset:1024 nt lds
    v_exp_f32 v170, v170
    v_add_f32 v202, v169, v202
    v_cvt_pk_bf16_f32 v38, v168, v169
    v_mfma_f32_16x16x32_bf16 v[160:163], a[168:171], v[16:19], v[160:163]
    s_waitcnt lgkmcnt(1)
    ds_read_b128 a[180:183], v206 offset:12288
    buffer_load_dwordx4 v221, s[16:19], s27 offen offset:2048 nt lds
    v_exp_f32 v171, v171
    v_add_f32 v202, v170, v202
    v_mfma_f32_16x16x32_bf16 v[160:163], a[172:175], v[24:27], v[160:163]
    v_exp_f32 v172, v172
    v_add_f32 v202, v171, v202
    v_cvt_pk_bf16_f32 v39, v170, v171
    v_mfma_f32_16x16x32_bf16 v[164:167], a[172:175], v[56:59], v[184:187]
    ds_read_b128 a[184:187], v207 offset:12288
    buffer_load_dwordx4 v222, s[16:19], s27 offen offset:3072 nt lds
    v_exp_f32 v173, v173
    v_add_f32 v203, v172, v203
    v_mfma_f32_16x16x32_bf16 v[164:167], a[168:171], v[48:51], v[164:167]
    s_mov_b32 m0, 86016
    v_exp_f32 v174, v174
    v_add_f32 v203, v173, v203
    v_cvt_pk_bf16_f32 v54, v172, v173
    v_mfma_f32_16x16x32_bf16 v[164:167], a[164:167], v[40:43], v[164:167]
    s_and_b32 s27, s3, 0x3ffff
    ds_read_b128 a[188:191], v208 offset:12288
    buffer_load_dwordx4 v221, s[16:19], s27 offen nt lds
    v_exp_f32 v175, v175
    v_add_f32 v203, v174, v203
    v_mfma_f32_16x16x32_bf16 v[164:167], a[160:163], v[32:35], v[164:167]
    s_waitcnt vmcnt(46)
    v_exp_f32 v160, v160
    v_add_f32 v203, v175, v203
    v_cvt_pk_bf16_f32 v55, v174, v175
    v_mfma_f32_16x16x32_bf16 v[168:171], a[160:163], v[64:67], v[188:191]
    s_add_u32 s3, s3, 4096
    buffer_load_dwordx4 v222, s[16:19], s27 offen offset:1024 nt lds
    ds_read_b64_tr_b16 a[192:193], v223 offset:0
    v_exp_f32 v161, v161
    v_add_f32 v200, v160, v200
    v_mfma_f32_16x16x32_bf16 v[168:171], a[164:167], v[72:75], v[168:171]
    buffer_load_dwordx4 v221, s[16:19], s27 offen offset:2048 nt lds
    ds_read_b64_tr_b16 a[194:195], v223 offset:2048
    v_exp_f32 v162, v162
    v_add_f32 v200, v161, v200
    v_cvt_pk_bf16_f32 v12, v160, v161
    v_mfma_f32_16x16x32_bf16 v[168:171], a[168:171], v[80:83], v[168:171]
    ds_read_b64_tr_b16 a[196:197], v224 offset:0
    v_exp_f32 v163, v163
    v_add_f32 v200, v162, v200
    v_mfma_f32_16x16x32_bf16 v[168:171], a[172:175], v[88:91], v[168:171]
    buffer_load_dwordx4 v222, s[16:19], s27 offen offset:3072 nt lds
    ds_read_b64_tr_b16 a[198:199], v224 offset:2048
    v_exp_f32 v164, v164
    v_add_f32 v200, v163, v200
    v_cvt_pk_bf16_f32 v13, v162, v163
    v_mfma_f32_16x16x32_bf16 v[172:175], a[172:175], v[120:123], v[192:195]
    s_mov_b32 m0, 90112
    ds_read_b64_tr_b16 a[200:201], v225 offset:0
    v_exp_f32 v165, v165
    v_add_f32 v201, v164, v201
    v_mfma_f32_16x16x32_bf16 v[172:175], a[168:171], v[112:115], v[172:175]
    s_and_b32 s27, s3, 0x3ffff
    buffer_load_dwordx4 v221, s[16:19], s27 offen nt lds
    ds_read_b64_tr_b16 a[202:203], v225 offset:2048
    v_exp_f32 v166, v166
    v_add_f32 v201, v165, v201
    v_cvt_pk_bf16_f32 v28, v164, v165
    v_mfma_f32_16x16x32_bf16 v[172:175], a[164:167], v[104:107], v[172:175]
    ds_read_b64_tr_b16 a[204:205], v226 offset:0
    v_exp_f32 v167, v167
    v_add_f32 v201, v166, v201
    v_mfma_f32_16x16x32_bf16 v[172:175], a[160:163], v[96:99], v[172:175]
    s_waitcnt lgkmcnt(10)
    s_add_u32 s3, s3, 4096
    buffer_load_dwordx4 v222, s[16:19], s27 offen offset:1024 nt lds
    ds_read_b64_tr_b16 a[206:207], v226 offset:2048
    v_exp_f32 v168, v168
    v_add_f32 v201, v167, v201
    v_cvt_pk_bf16_f32 v29, v166, v167
    v_mfma_f32_16x16x32_bf16 v[160:163], a[176:179], v[0:3], v[180:183]
    s_waitcnt lgkmcnt(10)
    v_exp_f32 v169, v169
    v_add_f32 v202, v168, v202
    v_mfma_f32_16x16x32_bf16 v[160:163], a[180:183], v[8:11], v[160:163]
    s_waitcnt lgkmcnt(9)
    buffer_load_dwordx4 v221, s[16:19], s27 offen offset:2048 nt lds
    v_exp_f32 v170, v170
    v_add_f32 v202, v169, v202
    v_cvt_pk_bf16_f32 v44, v168, v169
    v_mfma_f32_16x16x32_bf16 v[160:163], a[184:187], v[16:19], v[160:163]
    s_waitcnt vmcnt(27) lgkmcnt(0)
    v_exp_f32 v171, v171
    v_add_f32 v202, v170, v202
    v_mfma_f32_16x16x32_bf16 v[160:163], a[188:191], v[24:27], v[160:163]
    s_barrier
    v_exp_f32 v172, v172
    v_add_f32 v202, v171, v202
    v_cvt_pk_bf16_f32 v45, v170, v171
    v_mfma_f32_16x16x32_bf16 v[164:167], a[188:191], v[56:59], v[184:187]
    buffer_load_dwordx4 v222, s[16:19], s27 offen offset:3072 nt lds
    ds_read_b128 a[160:163], v205 offset:16384
    v_exp_f32 v173, v173
    v_add_f32 v203, v172, v203
    v_mfma_f32_16x16x32_bf16 v[164:167], a[184:187], v[48:51], v[164:167]
    s_mov_b32 m0, 94208
    buffer_store_dwordx4 a[192:195], v238, s[8:11], 0 offen sc0 sc1
    v_exp_f32 v174, v174
    v_add_f32 v203, v173, v203
    v_cvt_pk_bf16_f32 v60, v172, v173
    v_mfma_f32_16x16x32_bf16 v[164:167], a[180:183], v[40:43], v[164:167]
    s_and_b32 s27, s3, 0x3ffff
    buffer_load_dwordx4 v221, s[16:19], s27 offen nt lds
    ds_read_b128 a[164:167], v206 offset:16384
    v_exp_f32 v175, v175
    v_add_f32 v203, v174, v203
    v_mfma_f32_16x16x32_bf16 v[164:167], a[176:179], v[32:35], v[164:167]
    buffer_store_dwordx4 a[196:199], v238, s[8:11], 0 offen offset:1024 sc0 sc1
    v_exp_f32 v160, v160
    v_add_f32 v203, v175, v203
    v_cvt_pk_bf16_f32 v61, v174, v175
    v_mfma_f32_16x16x32_bf16 v[168:171], a[176:179], v[64:67], v[188:191]
    s_add_u32 s3, s3, 4096
    buffer_load_dwordx4 v222, s[16:19], s27 offen offset:1024 nt lds
    ds_read_b128 a[168:171], v207 offset:16384
    v_exp_f32 v161, v161
    v_add_f32 v200, v160, v200
    v_mfma_f32_16x16x32_bf16 v[168:171], a[180:183], v[72:75], v[168:171]
    buffer_store_dwordx4 a[200:203], v238, s[8:11], 0 offen offset:2048 sc0 sc1
    v_exp_f32 v162, v162
    v_add_f32 v200, v161, v200
    v_cvt_pk_bf16_f32 v14, v160, v161
    v_mfma_f32_16x16x32_bf16 v[168:171], a[184:187], v[80:83], v[168:171]
    buffer_load_dwordx4 v221, s[16:19], s27 offen offset:2048 nt lds
    ds_read_b128 a[172:175], v208 offset:16384
    v_exp_f32 v163, v163
    v_add_f32 v200, v162, v200
    v_mfma_f32_16x16x32_bf16 v[168:171], a[188:191], v[88:91], v[168:171]
    buffer_store_dwordx4 a[204:207], v238, s[8:11], 0 offen offset:3072 sc0 sc1
    v_exp_f32 v164, v164
    v_add_f32 v200, v163, v200
    v_cvt_pk_bf16_f32 v15, v162, v163
    v_mfma_f32_16x16x32_bf16 v[172:175], a[188:191], v[120:123], v[192:195]
    buffer_load_dwordx4 v222, s[16:19], s27 offen offset:3072 nt lds
    v_exp_f32 v165, v165
    v_add_f32 v201, v164, v201
    v_mfma_f32_16x16x32_bf16 v[172:175], a[184:187], v[112:115], v[172:175]
    v_exp_f32 v166, v166
    v_add_f32 v201, v165, v201
    v_cvt_pk_bf16_f32 v30, v164, v165
    v_mov_b32 v250, 1
    v_mfma_f32_16x16x32_bf16 v[172:175], a[180:183], v[104:107], v[172:175]
    s_lshl_b32 s33, s0, 5
    s_cmp_eq_u32 s24, 0
    s_cselect_b32 s33, s33, 0x1000
    v_exp_f32 v167, v167
    v_add_f32 v201, v166, v201
    v_mfma_f32_16x16x32_bf16 v[172:175], a[176:179], v[96:99], v[172:175]
    v_exp_f32 v168, v168
    v_add_f32 v201, v167, v201
    v_cvt_pk_bf16_f32 v31, v166, v167
    v_exp_f32 v169, v169
    v_add_f32 v202, v168, v202
    v_exp_f32 v170, v170
    v_add_f32 v202, v169, v202
    v_cvt_pk_bf16_f32 v46, v168, v169
    v_exp_f32 v171, v171
    v_add_f32 v202, v170, v202
    v_exp_f32 v172, v172
    v_add_f32 v202, v171, v202
    v_cvt_pk_bf16_f32 v47, v170, v171
.p2align 6
L_loopB:
    s_waitcnt lgkmcnt(3)
    v_mfma_f32_16x16x32_bf16 v[160:163], a[160:163], v[0:3], v[180:183]
    s_waitcnt lgkmcnt(2)
    s_lshl_b32 s29, s31, 12
    s_sub_u32 s29, 8192, s29
    s_max_i32 s28, s29, 0
    s_lshl_b32 s28, s28, 2
    s_add_u32 s28, s28, 131072
    s_lshl_b32 s29, s29, 6
    ds_read_b64_tr_b16 a[176:177], v209 offset:0
    v_add_f32 v203, v172, v203
    v_mfma_f32_16x16x32_bf16 v[160:163], a[164:167], v[8:11], v[160:163]
    s_waitcnt lgkmcnt(2)
    v_exp_f32 v173, v173
    v_mfma_f32_16x16x32_bf16 v[160:163], a[168:171], v[16:19], v[160:163]
    s_waitcnt lgkmcnt(1)
    s_mov_b32 m0, 49152
    ds_read_b64_tr_b16 a[178:179], v209 offset:4096
    v_add_f32 v203, v173, v203
    v_cvt_pk_bf16_f32 v62, v172, v173
    v_mfma_f32_16x16x32_bf16 v[160:163], a[172:175], v[24:27], v[160:163]
    s_and_b32 s27, s30, 0x3ffff
    buffer_load_dwordx4 v217, s[12:15], s27 offen nt lds
    v_exp_f32 v174, v174
    v_mfma_f32_16x16x32_bf16 v[164:167], a[172:175], v[56:59], v[184:187]
    ds_read_b64_tr_b16 a[180:181], v209 offset:8192
    v_add_f32 v203, v174, v203
    v_mfma_f32_16x16x32_bf16 v[164:167], a[168:171], v[48:51], v[164:167]
    v_exp_f32 v175, v175
    v_mfma_f32_16x16x32_bf16 v[164:167], a[164:167], v[40:43], v[164:167]
    s_add_u32 s30, s30, 4096
    buffer_load_dwordx4 v218, s[12:15], s27 offen offset:1024 nt lds
    v_add_f32 v203, v175, v203
    v_cvt_pk_bf16_f32 v63, v174, v175
    v_mfma_f32_16x16x32_bf16 v[164:167], a[160:163], v[32:35], v[164:167]
    v_exp_f32 v160, v160
    v_mfma_f32_16x16x32_bf16 v[168:171], a[160:163], v[64:67], v[188:191]
    ds_read_b64_tr_b16 a[182:183], v209 offset:12288
    v_add_f32 v200, v160, v200
    v_mfma_f32_16x16x32_bf16 v[168:171], a[164:167], v[72:75], v[168:171]
    buffer_load_dwordx4 v219, s[12:15], s27 offen offset:2048 nt lds
    v_exp_f32 v161, v161
    v_mfma_f32_16x16x32_bf16 v[168:171], a[168:171], v[80:83], v[168:171]
    ds_read_b64_tr_b16 a[184:185], v210 offset:0
    v_add_f32 v200, v161, v200
    v_cvt_pk_bf16_f32 v84, v160, v161
    v_mfma_f32_16x16x32_bf16 v[168:171], a[172:175], v[88:91], v[168:171]
    v_exp_f32 v162, v162
    v_mfma_f32_16x16x32_bf16 v[172:175], a[172:175], v[120:123], v[192:195]
    ds_read_b64_tr_b16 a[186:187], v210 offset:4096
    v_add_f32 v200, v162, v200
    v_mfma_f32_16x16x32_bf16 v[172:175], a[168:171], v[112:115], v[172:175]
    buffer_load_dwordx4 v220, s[12:15], s27 offen offset:3072 nt lds
    v_exp_f32 v163, v163
    v_mfma_f32_16x16x32_bf16 v[172:175], a[164:167], v[104:107], v[172:175]
    ds_read_b64_tr_b16 a[188:189], v210 offset:8192
    v_add_f32 v200, v163, v200
    v_cvt_pk_bf16_f32 v85, v162, v163
    v_mfma_f32_16x16x32_bf16 v[172:175], a[160:163], v[96:99], v[172:175]
    s_waitcnt lgkmcnt(5)
    s_mov_b32 m0, 53248
    v_exp_f32 v164, v164
    v_mfma_f32_16x16x32_bf16 a[0:3], a[176:179], v[4:7], a[0:3]
    s_waitcnt lgkmcnt(3)
    s_and_b32 s27, s30, 0x3ffff
    ds_read_b64_tr_b16 a[190:191], v210 offset:12288
    buffer_load_dwordx4 v217, s[12:15], s27 offen nt lds
    v_add_f32 v201, v164, v201
    v_mfma_f32_16x16x32_bf16 a[0:3], a[180:183], v[12:15], a[0:3]
    v_exp_f32 v165, v165
    v_mfma_f32_16x16x32_bf16 a[32:35], a[180:183], v[28:31], a[32:35]
    v_add_f32 v201, v165, v201
    v_cvt_pk_bf16_f32 v100, v164, v165
    v_mfma_f32_16x16x32_bf16 a[32:35], a[176:179], v[20:23], a[32:35]
    v_exp_f32 v166, v166
    v_mfma_f32_16x16x32_bf16 a[64:67], a[176:179], v[36:39], a[64:67]
    s_add_u32 s30, s30, 4096
    ds_read_b128 a[160:163], v205 offset:20480
    buffer_load_dwordx4 v218, s[12:15], s27 offen offset:1024 nt lds
    v_add_f32 v201, v166, v201
    v_mfma_f32_16x16x32_bf16 a[64:67], a[180:183], v[44:47], a[64:67]
    v_exp_f32 v167, v167
    v_mfma_f32_16x16x32_bf16 a[96:99], a[180:183], v[60:63], a[96:99]
    ds_read_b128 a[164:167], v206 offset:20480
    v_add_f32 v201, v167, v201
    v_cvt_pk_bf16_f32 v101, v166, v167
    v_mfma_f32_16x16x32_bf16 a[96:99], a[176:179], v[52:55], a[96:99]
    s_waitcnt lgkmcnt(4)
    buffer_load_dwordx4 v219, s[12:15], s27 offen offset:2048 nt lds
    v_exp_f32 v168, v168
    v_mfma_f32_16x16x32_bf16 a[4:7], a[184:187], v[4:7], a[4:7]
    s_waitcnt lgkmcnt(2)
    ds_read_b128 a[168:171], v207 offset:20480
    v_add_f32 v202, v168, v202
    v_mfma_f32_16x16x32_bf16 a[4:7], a[188:191], v[12:15], a[4:7]
    v_exp_f32 v169, v169
    v_mfma_f32_16x16x32_bf16 a[36:39], a[188:191], v[28:31], a[36:39]
    v_add_f32 v202, v169, v202
    v_cvt_pk_bf16_f32 v116, v168, v169
    v_mfma_f32_16x16x32_bf16 a[36:39], a[184:187], v[20:23], a[36:39]
    buffer_load_dwordx4 v220, s[12:15], s27 offen offset:3072 nt lds
    v_exp_f32 v170, v170
    v_mfma_f32_16x16x32_bf16 a[68:71], a[184:187], v[36:39], a[68:71]
    ds_read_b128 a[172:175], v208 offset:20480
    v_add_f32 v202, v170, v202
    v_mfma_f32_16x16x32_bf16 a[68:71], a[188:191], v[44:47], a[68:71]
    s_mov_b32 m0, 57344
    v_exp_f32 v171, v171
    v_mfma_f32_16x16x32_bf16 a[100:103], a[188:191], v[60:63], a[100:103]
    s_and_b32 s27, s30, 0x3ffff
    buffer_load_dwordx4 v217, s[12:15], s27 offen nt lds
    v_add_f32 v202, v171, v202
    v_cvt_pk_bf16_f32 v117, v170, v171
    v_mfma_f32_16x16x32_bf16 a[100:103], a[184:187], v[52:55], a[100:103]
    s_waitcnt lgkmcnt(3)
    v_exp_f32 v172, v172
    v_mfma_f32_16x16x32_bf16 v[160:163], a[160:163], v[0:3], v[180:183]
    s_waitcnt lgkmcnt(2)
    ds_read_b64_tr_b16 a[176:177], v211 offset:0
    v_add_f32 v203, v172, v203
    v_mfma_f32_16x16x32_bf16 v[160:163], a[164:167], v[8:11], v[160:163]
    s_waitcnt lgkmcnt(2)
    v_exp_f32 v173, v173
    v_mfma_f32_16x16x32_bf16 v[160:163], a[168:171], v[16:19], v[160:163]
    s_waitcnt lgkmcnt(1)
    s_add_u32 s30, s30, 4096
    ds_read_b64_tr_b16 a[178:179], v211 offset:4096
    buffer_load_dwordx4 v218, s[12:15], s27 offen offset:1024 nt lds
    v_add_f32 v203, v173, v203
    v_cvt_pk_bf16_f32 v132, v172, v173
    v_mfma_f32_16x16x32_bf16 v[160:163], a[172:175], v[24:27], v[160:163]
    v_exp_f32 v174, v174
    v_mfma_f32_16x16x32_bf16 v[164:167], a[172:175], v[56:59], v[184:187]
    ds_read_b64_tr_b16 a[180:181], v211 offset:8192
    v_add_f32 v203, v174, v203
    v_mfma_f32_16x16x32_bf16 v[164:167], a[168:171], v[48:51], v[164:167]
    buffer_load_dwordx4 v219, s[12:15], s27 offen offset:2048 nt lds
    v_exp_f32 v175, v175
    v_mfma_f32_16x16x32_bf16 v[164:167], a[164:167], v[40:43], v[164:167]
    v_add_f32 v203, v175, v203
    v_cvt_pk_bf16_f32 v133, v174, v175
    v_mfma_f32_16x16x32_bf16 v[164:167], a[160:163], v[32:35], v[164:167]
    v_exp_f32 v160, v160
    v_mfma_f32_16x16x32_bf16 v[168:171], a[160:163], v[64:67], v[188:191]
    ds_read_b64_tr_b16 a[182:183], v211 offset:12288
    v_add_f32 v200, v160, v200
    v_mfma_f32_16x16x32_bf16 v[168:171], a[164:167], v[72:75], v[168:171]
    buffer_load_dwordx4 v220, s[12:15], s27 offen offset:3072 nt lds
    v_exp_f32 v161, v161
    v_mfma_f32_16x16x32_bf16 v[168:171], a[168:171], v[80:83], v[168:171]
    ds_read_b64_tr_b16 a[184:185], v212 offset:0
    v_add_f32 v200, v161, v200
    v_cvt_pk_bf16_f32 v86, v160, v161
    v_mfma_f32_16x16x32_bf16 v[168:171], a[172:175], v[88:91], v[168:171]
    s_mov_b32 m0, 61440
    v_exp_f32 v162, v162
    v_mfma_f32_16x16x32_bf16 v[172:175], a[172:175], v[120:123], v[192:195]
    s_and_b32 s27, s30, 0x3ffff
    ds_read_b64_tr_b16 a[186:187], v212 offset:4096
    buffer_load_dwordx4 v217, s[12:15], s27 offen nt lds
    v_add_f32 v200, v162, v200
    v_mfma_f32_16x16x32_bf16 v[172:175], a[168:171], v[112:115], v[172:175]
    v_exp_f32 v163, v163
    v_mfma_f32_16x16x32_bf16 v[172:175], a[164:167], v[104:107], v[172:175]
    ds_read_b64_tr_b16 a[188:189], v212 offset:8192
    v_add_f32 v200, v163, v200
    v_cvt_pk_bf16_f32 v87, v162, v163
    v_mfma_f32_16x16x32_bf16 v[172:175], a[160:163], v[96:99], v[172:175]
    s_waitcnt lgkmcnt(5)
    v_exp_f32 v164, v164
    v_mfma_f32_16x16x32_bf16 a[8:11], a[176:179], v[4:7], a[8:11]
    s_waitcnt lgkmcnt(3)
    s_add_u32 s30, s30, 4096
    ds_read_b64_tr_b16 a[190:191], v212 offset:12288
    buffer_load_dwordx4 v218, s[12:15], s27 offen offset:1024 nt lds
    v_add_f32 v201, v164, v201
    v_mfma_f32_16x16x32_bf16 a[8:11], a[180:183], v[12:15], a[8:11]
    v_exp_f32 v165, v165
    v_mfma_f32_16x16x32_bf16 a[40:43], a[180:183], v[28:31], a[40:43]
    v_add_f32 v201, v165, v201
    v_cvt_pk_bf16_f32 v102, v164, v165
    v_mfma_f32_16x16x32_bf16 a[40:43], a[176:179], v[20:23], a[40:43]
    buffer_load_dwordx4 v219, s[12:15], s27 offen offset:2048 nt lds
    v_exp_f32 v166, v166
    v_mfma_f32_16x16x32_bf16 a[72:75], a[176:179], v[36:39], a[72:75]
    ds_read_b128 a[160:163], v205 offset:24576
    v_add_f32 v201, v166, v201
    v_mfma_f32_16x16x32_bf16 a[72:75], a[180:183], v[44:47], a[72:75]
    v_exp_f32 v167, v167
    v_mfma_f32_16x16x32_bf16 a[104:107], a[180:183], v[60:63], a[104:107]
    ds_read_b128 a[164:167], v206 offset:24576
    v_add_f32 v201, v167, v201
    v_cvt_pk_bf16_f32 v103, v166, v167
    v_mfma_f32_16x16x32_bf16 a[104:107], a[176:179], v[52:55], a[104:107]
    s_waitcnt lgkmcnt(4)
    buffer_load_dwordx4 v220, s[12:15], s27 offen offset:3072 nt lds
    v_exp_f32 v168, v168
    v_mfma_f32_16x16x32_bf16 a[12:15], a[184:187], v[4:7], a[12:15]
    s_waitcnt lgkmcnt(2)
    ds_read_b128 a[168:171], v207 offset:24576
    v_add_f32 v202, v168, v202
    v_mfma_f32_16x16x32_bf16 a[12:15], a[188:191], v[12:15], a[12:15]
    s_add_u32 m0, s34, s28
    v_exp_f32 v169, v169
    v_mfma_f32_16x16x32_bf16 a[44:47], a[188:191], v[28:31], a[44:47]
    s_or_b32 s27, s29, 0x200000
    buffer_load_dwordx4 v238, s[56:59], s27 offen sc1 lds
    v_add_f32 v202, v169, v202
    v_cvt_pk_bf16_f32 v118, v168, v169
    v_mfma_f32_16x16x32_bf16 a[44:47], a[184:187], v[20:23], a[44:47]
    v_exp_f32 v170, v170
    v_mfma_f32_16x16x32_bf16 a[76:79], a[184:187], v[36:39], a[76:79]
    ds_read_b128 a[172:175], v208 offset:24576
    v_add_f32 v202, v170, v202
    v_mfma_f32_16x16x32_bf16 a[76:79], a[188:191], v[44:47], a[76:79]
    v_exp_f32 v171, v171
    v_mfma_f32_16x16x32_bf16 a[108:111], a[188:191], v[60:63], a[108:111]
    buffer_load_dwordx4 v238, s[56:59], s27 offen offset:1024 sc1 lds
    v_add_f32 v202, v171, v202
    v_cvt_pk_bf16_f32 v119, v170, v171
    v_mfma_f32_16x16x32_bf16 a[108:111], a[184:187], v[52:55], a[108:111]
    s_waitcnt lgkmcnt(3)
    v_exp_f32 v172, v172
    v_mfma_f32_16x16x32_bf16 v[160:163], a[160:163], v[0:3], v[180:183]
    s_waitcnt lgkmcnt(2)
    ds_read_b64_tr_b16 a[176:177], v213 offset:0
    v_add_f32 v203, v172, v203
    v_mfma_f32_16x16x32_bf16 v[160:163], a[164:167], v[8:11], v[160:163]
    s_waitcnt lgkmcnt(2)
    buffer_load_dwordx4 v238, s[56:59], s27 offen offset:2048 sc1 lds
    v_exp_f32 v173, v173
    v_mfma_f32_16x16x32_bf16 v[160:163], a[168:171], v[16:19], v[160:163]
    s_waitcnt lgkmcnt(1)
    ds_read_b64_tr_b16 a[178:179], v213 offset:4096
    v_add_f32 v203, v173, v203
    v_cvt_pk_bf16_f32 v134, v172, v173
    v_mfma_f32_16x16x32_bf16 v[160:163], a[172:175], v[24:27], v[160:163]
    v_exp_f32 v174, v174
    v_mfma_f32_16x16x32_bf16 v[164:167], a[172:175], v[56:59], v[184:187]
    ds_read_b64_tr_b16 a[180:181], v213 offset:8192
    v_add_f32 v203, v174, v203
    v_mfma_f32_16x16x32_bf16 v[164:167], a[168:171], v[48:51], v[164:167]
    buffer_load_dwordx4 v238, s[56:59], s27 offen offset:3072 sc1 lds
    v_exp_f32 v175, v175
    v_mfma_f32_16x16x32_bf16 v[164:167], a[164:167], v[40:43], v[164:167]
    v_add_f32 v203, v175, v203
    v_cvt_pk_bf16_f32 v135, v174, v175
    v_mfma_f32_16x16x32_bf16 v[164:167], a[160:163], v[32:35], v[164:167]
    s_mov_b32 m0, 98304
    v_exp_f32 v160, v160
    v_mfma_f32_16x16x32_bf16 v[168:171], a[160:163], v[64:67], v[188:191]
    s_and_b32 s27, s3, 0x3ffff
    ds_read_b64_tr_b16 a[182:183], v213 offset:12288
    buffer_load_dwordx4 v221, s[16:19], s27 offen nt lds
    v_add_f32 v200, v160, v200
    v_mfma_f32_16x16x32_bf16 v[168:171], a[164:167], v[72:75], v[168:171]
    v_exp_f32 v161, v161
    v_mfma_f32_16x16x32_bf16 v[168:171], a[168:171], v[80:83], v[168:171]
    ds_read_b64_tr_b16 a[184:185], v214 offset:0
    v_add_f32 v200, v161, v200
    v_cvt_pk_bf16_f32 v92, v160, v161
    v_mfma_f32_16x16x32_bf16 v[168:171], a[172:175], v[88:91], v[168:171]
    v_exp_f32 v162, v162
    v_mfma_f32_16x16x32_bf16 v[172:175], a[172:175], v[120:123], v[192:195]
    s_add_u32 s3, s3, 4096
    ds_read_b64_tr_b16 a[186:187], v214 offset:4096
    buffer_load_dwordx4 v222, s[16:19], s27 offen offset:1024 nt lds
    v_add_f32 v200, v162, v200
    v_mfma_f32_16x16x32_bf16 v[172:175], a[168:171], v[112:115], v[172:175]
    v_exp_f32 v163, v163
    v_mfma_f32_16x16x32_bf16 v[172:175], a[164:167], v[104:107], v[172:175]
    ds_read_b64_tr_b16 a[188:189], v214 offset:8192
    v_add_f32 v200, v163, v200
    v_cvt_pk_bf16_f32 v93, v162, v163
    v_mfma_f32_16x16x32_bf16 v[172:175], a[160:163], v[96:99], v[172:175]
    s_waitcnt lgkmcnt(5)
    buffer_load_dwordx4 v221, s[16:19], s27 offen offset:2048 nt lds
    v_exp_f32 v164, v164
    v_mfma_f32_16x16x32_bf16 a[16:19], a[176:179], v[4:7], a[16:19]
    s_waitcnt lgkmcnt(3)
    ds_read_b64_tr_b16 a[190:191], v214 offset:12288
    v_add_f32 v201, v164, v201
    v_mfma_f32_16x16x32_bf16 a[16:19], a[180:183], v[12:15], a[16:19]
    v_exp_f32 v165, v165
    v_mfma_f32_16x16x32_bf16 a[48:51], a[180:183], v[28:31], a[48:51]
    v_add_f32 v201, v165, v201
    v_cvt_pk_bf16_f32 v108, v164, v165
    v_mfma_f32_16x16x32_bf16 a[48:51], a[176:179], v[20:23], a[48:51]
    buffer_load_dwordx4 v222, s[16:19], s27 offen offset:3072 nt lds
    v_exp_f32 v166, v166
    v_mfma_f32_16x16x32_bf16 a[80:83], a[176:179], v[36:39], a[80:83]
    ds_read_b128 a[160:163], v205 offset:28672
    v_add_f32 v201, v166, v201
    v_mfma_f32_16x16x32_bf16 a[80:83], a[180:183], v[44:47], a[80:83]
    s_mov_b32 m0, 102400
    v_exp_f32 v167, v167
    v_mfma_f32_16x16x32_bf16 a[112:115], a[180:183], v[60:63], a[112:115]
    s_and_b32 s27, s3, 0x3ffff
    ds_read_b128 a[164:167], v206 offset:28672
    buffer_load_dwordx4 v221, s[16:19], s27 offen nt lds
    v_add_f32 v201, v167, v201
    v_cvt_pk_bf16_f32 v109, v166, v167
    v_mfma_f32_16x16x32_bf16 a[112:115], a[176:179], v[52:55], a[112:115]
    s_waitcnt lgkmcnt(4)
    v_exp_f32 v168, v168
    v_mfma_f32_16x16x32_bf16 a[20:23], a[184:187], v[4:7], a[20:23]
    s_waitcnt lgkmcnt(2)
    ds_read_b128 a[168:171], v207 offset:28672
    v_add_f32 v202, v168, v202
    v_mfma_f32_16x16x32_bf16 a[20:23], a[188:191], v[12:15], a[20:23]
    v_exp_f32 v169, v169
    v_mfma_f32_16x16x32_bf16 a[52:55], a[188:191], v[28:31], a[52:55]
    s_add_u32 s3, s3, 4096
    buffer_load_dwordx4 v222, s[16:19], s27 offen offset:1024 nt lds
    v_add_f32 v202, v169, v202
    v_cvt_pk_bf16_f32 v124, v168, v169
    v_mfma_f32_16x16x32_bf16 a[52:55], a[184:187], v[20:23], a[52:55]
    v_exp_f32 v170, v170
    v_mfma_f32_16x16x32_bf16 a[84:87], a[184:187], v[36:39], a[84:87]
    ds_read_b128 a[172:175], v208 offset:28672
    v_add_f32 v202, v170, v202
    v_mfma_f32_16x16x32_bf16 a[84:87], a[188:191], v[44:47], a[84:87]
    buffer_load_dwordx4 v221, s[16:19], s27 offen offset:2048 nt lds
    v_exp_f32 v171, v171
    v_mfma_f32_16x16x32_bf16 a[116:119], a[188:191], v[60:63], a[116:119]
    v_add_f32 v202, v171, v202
    v_cvt_pk_bf16_f32 v125, v170, v171
    v_mfma_f32_16x16x32_bf16 a[116:119], a[184:187], v[52:55], a[116:119]
    s_waitcnt lgkmcnt(3)
    v_exp_f32 v172, v172
    v_mfma_f32_16x16x32_bf16 v[160:163], a[160:163], v[0:3], v[180:183]
    s_waitcnt lgkmcnt(2)
    ds_read_b64_tr_b16 a[176:177], v215 offset:0
    v_add_f32 v203, v172, v203
    v_mfma_f32_16x16x32_bf16 v[160:163], a[164:167], v[8:11], v[160:163]
    s_waitcnt lgkmcnt(2)
    buffer_load_dwordx4 v222, s[16:19], s27 offen offset:3072 nt lds
    v_exp_f32 v173, v173
    v_mfma_f32_16x16x32_bf16 v[160:163], a[168:171], v[16:19], v[160:163]
    s_waitcnt lgkmcnt(1)
    ds_read_b64_tr_b16 a[178:179], v215 offset:4096
    v_add_f32 v203, v173, v203
    v_cvt_pk_bf16_f32 v140, v172, v173
    v_mfma_f32_16x16x32_bf16 v[160:163], a[172:175], v[24:27], v[160:163]
    s_mov_b32 m0, 106496
    v_exp_f32 v174, v174
    v_mfma_f32_16x16x32_bf16 v[164:167], a[172:175], v[56:59], v[184:187]
    s_and_b32 s27, s3, 0x3ffff
    ds_read_b64_tr_b16 a[180:181], v215 offset:8192
    buffer_load_dwordx4 v221, s[16:19], s27 offen nt lds
    v_add_f32 v203, v174, v203
    v_mfma_f32_16x16x32_bf16 v[164:167], a[168:171], v[48:51], v[164:167]
    v_exp_f32 v175, v175
    v_mfma_f32_16x16x32_bf16 v[164:167], a[164:167], v[40:43], v[164:167]
    v_add_f32 v203, v175, v203
    v_cvt_pk_bf16_f32 v141, v174, v175
    v_mfma_f32_16x16x32_bf16 v[164:167], a[160:163], v[32:35], v[164:167]
    v_exp_f32 v160, v160
    v_mfma_f32_16x16x32_bf16 v[168:171], a[160:163], v[64:67], v[188:191]
    s_add_u32 s3, s3, 4096
    ds_read_b64_tr_b16 a[182:183], v215 offset:12288
    buffer_load_dwordx4 v222, s[16:19], s27 offen offset:1024 nt lds
    v_add_f32 v200, v160, v200
    v_mfma_f32_16x16x32_bf16 v[168:171], a[164:167], v[72:75], v[168:171]
    v_exp_f32 v161, v161
    v_mfma_f32_16x16x32_bf16 v[168:171], a[168:171], v[80:83], v[168:171]
    ds_read_b64_tr_b16 a[184:185], v216 offset:0
    v_add_f32 v200, v161, v200
    v_cvt_pk_bf16_f32 v94, v160, v161
    v_mfma_f32_16x16x32_bf16 v[168:171], a[172:175], v[88:91], v[168:171]
    buffer_load_dwordx4 v221, s[16:19], s27 offen offset:2048 nt lds
    v_exp_f32 v162, v162
    v_mfma_f32_16x16x32_bf16 v[172:175], a[172:175], v[120:123], v[192:195]
    ds_read_b64_tr_b16 a[186:187], v216 offset:4096
    v_add_f32 v200, v162, v200
    v_mfma_f32_16x16x32_bf16 v[172:175], a[168:171], v[112:115], v[172:175]
    v_exp_f32 v163, v163
    v_mfma_f32_16x16x32_bf16 v[172:175], a[164:167], v[104:107], v[172:175]
    ds_read_b64_tr_b16 a[188:189], v216 offset:8192
    v_add_f32 v200, v163, v200
    v_cvt_pk_bf16_f32 v95, v162, v163
    v_mfma_f32_16x16x32_bf16 v[172:175], a[160:163], v[96:99], v[172:175]
    s_waitcnt lgkmcnt(5)
    buffer_load_dwordx4 v222, s[16:19], s27 offen offset:3072 nt lds
    v_exp_f32 v164, v164
    v_mfma_f32_16x16x32_bf16 a[24:27], a[176:179], v[4:7], a[24:27]
    s_waitcnt lgkmcnt(3)
    ds_read_b64_tr_b16 a[190:191], v216 offset:12288
    v_add_f32 v201, v164, v201
    v_mfma_f32_16x16x32_bf16 a[24:27], a[180:183], v[12:15], a[24:27]
    s_mov_b32 m0, 110592
    v_exp_f32 v165, v165
    v_mfma_f32_16x16x32_bf16 a[56:59], a[180:183], v[28:31], a[56:59]
    s_and_b32 s27, s3, 0x3ffff
    buffer_load_dwordx4 v221, s[16:19], s27 offen nt lds
    v_add_f32 v201, v165, v201
    v_cvt_pk_bf16_f32 v110, v164, v165
    v_mfma_f32_16x16x32_bf16 a[56:59], a[176:179], v[20:23], a[56:59]
    v_exp_f32 v166, v166
    v_mfma_f32_16x16x32_bf16 a[88:91], a[176:179], v[36:39], a[88:91]
    v_add_f32 v201, v166, v201
    v_mfma_f32_16x16x32_bf16 a[88:91], a[180:183], v[44:47], a[88:91]
    s_waitcnt vmcnt(33) lgkmcnt(0)
    v_exp_f32 v167, v167
    v_mfma_f32_16x16x32_bf16 a[120:123], a[180:183], v[60:63], a[120:123]
    s_barrier
    v_add_f32 v201, v167, v201
    v_cvt_pk_bf16_f32 v111, v166, v167
    v_mfma_f32_16x16x32_bf16 a[120:123], a[176:179], v[52:55], a[120:123]
    ds_read_b128 a[160:163], v205 offset:32768
    v_exp_f32 v168, v168
    v_mfma_f32_16x16x32_bf16 a[28:31], a[184:187], v[4:7], a[28:31]
    s_add_u32 s3, s3, 4096
    ds_read_b128 a[164:167], v206 offset:32768
    buffer_load_dwordx4 v222, s[16:19], s27 offen offset:1024 nt lds
    v_add_f32 v202, v168, v202
    v_mfma_f32_16x16x32_bf16 a[28:31], a[188:191], v[12:15], a[28:31]
    v_exp_f32 v169, v169
    v_mfma_f32_16x16x32_bf16 a[60:63], a[188:191], v[28:31], a[60:63]
    ds_read_b128 a[168:171], v207 offset:32768
    buffer_load_dwordx4 v221, s[16:19], s27 offen offset:2048 nt lds
    v_add_f32 v202, v169, v202
    v_cvt_pk_bf16_f32 v126, v168, v169
    v_mfma_f32_16x16x32_bf16 a[60:63], a[184:187], v[20:23], a[60:63]
    v_exp_f32 v170, v170
    v_mfma_f32_16x16x32_bf16 a[92:95], a[184:187], v[36:39], a[92:95]
    ds_read_b128 a[172:175], v208 offset:32768
    v_add_f32 v202, v170, v202
    v_mfma_f32_16x16x32_bf16 a[92:95], a[188:191], v[44:47], a[92:95]
    buffer_load_dwordx4 v222, s[16:19], s27 offen offset:3072 nt lds
    v_exp_f32 v171, v171
    v_mfma_f32_16x16x32_bf16 a[124:127], a[188:191], v[60:63], a[124:127]
    v_add_f32 v202, v171, v202
    v_cvt_pk_bf16_f32 v127, v170, v171
    v_mfma_f32_16x16x32_bf16 a[124:127], a[184:187], v[52:55], a[124:127]
    v_exp_f32 v172, v172
    s_sub_u32 s31, s31, 1
    s_cmp_eq_u32 s31, 0
    s_cbranch_scc1 L_p14B
    s_waitcnt lgkmcnt(3)
    v_mfma_f32_16x16x32_bf16 v[160:163], a[160:163], v[0:3], v[180:183]
    s_waitcnt lgkmcnt(2)
    ds_read_b64_tr_b16 a[176:177], v209 offset:16384
    v_add_f32 v203, v172, v203
    v_mfma_f32_16x16x32_bf16 v[160:163], a[164:167], v[8:11], v[160:163]
    s_waitcnt lgkmcnt(2)
    v_exp_f32 v173, v173
    v_mfma_f32_16x16x32_bf16 v[160:163], a[168:171], v[16:19], v[160:163]
    s_waitcnt lgkmcnt(1)
    ds_read_b64_tr_b16 a[178:179], v209 offset:20480
    v_add_f32 v203, v173, v203
    v_cvt_pk_bf16_f32 v142, v172, v173
    v_mfma_f32_16x16x32_bf16 v[160:163], a[172:175], v[24:27], v[160:163]
    buffer_load_dword v254, v255, s[20:23], 0 offen sc0 sc1
    v_exp_f32 v174, v174
    v_mfma_f32_16x16x32_bf16 v[164:167], a[172:175], v[56:59], v[184:187]
    ds_read_b64_tr_b16 a[180:181], v209 offset:24576
    v_add_f32 v203, v174, v203
    v_mfma_f32_16x16x32_bf16 v[164:167], a[168:171], v[48:51], v[164:167]
    s_mov_b32 m0, 0
    v_exp_f32 v175, v175
    v_mfma_f32_16x16x32_bf16 v[164:167], a[164:167], v[40:43], v[164:167]
    s_and_b32 s27, s30, 0x3ffff
    buffer_load_dwordx4 v217, s[12:15], s27 offen nt lds
    v_add_f32 v203, v175, v203
    v_cvt_pk_bf16_f32 v143, v174, v175
    v_mfma_f32_16x16x32_bf16 v[164:167], a[160:163], v[32:35], v[164:167]
    v_exp_f32 v160, v160
    v_mfma_f32_16x16x32_bf16 v[168:171], a[160:163], v[64:67], v[188:191]
    ds_read_b64_tr_b16 a[182:183], v209 offset:28672
    v_add_f32 v200, v160, v200
    v_mfma_f32_16x16x32_bf16 v[168:171], a[164:167], v[72:75], v[168:171]
    v_exp_f32 v161, v161
    v_mfma_f32_16x16x32_bf16 v[168:171], a[168:171], v[80:83], v[168:171]
    s_add_u32 s30, s30, 4096
    ds_read_b64_tr_b16 a[184:185], v210 offset:16384
    buffer_load_dwordx4 v218, s[12:15], s27 offen offset:1024 nt lds
    v_add_f32 v200, v161, v200
    v_cvt_pk_bf16_f32 v4, v160, v161
    v_mfma_f32_16x16x32_bf16 v[168:171], a[172:175], v[88:91], v[168:171]
    v_exp_f32 v162, v162
    v_mfma_f32_16x16x32_bf16 v[172:175], a[172:175], v[120:123], v[192:195]
    ds_read_b64_tr_b16 a[186:187], v210 offset:20480
    v_add_f32 v200, v162, v200
    v_mfma_f32_16x16x32_bf16 v[172:175], a[168:171], v[112:115], v[172:175]
    v_exp_f32 v163, v163
    v_mfma_f32_16x16x32_bf16 v[172:175], a[164:167], v[104:107], v[172:175]
    ds_read_b64_tr_b16 a[188:189], v210 offset:24576
    buffer_load_dwordx4 v219, s[12:15], s27 offen offset:2048 nt lds
    v_add_f32 v200, v163, v200
    v_cvt_pk_bf16_f32 v5, v162, v163
    v_mfma_f32_16x16x32_bf16 v[172:175], a[160:163], v[96:99], v[172:175]
    s_waitcnt lgkmcnt(5)
    v_exp_f32 v164, v164
    v_mfma_f32_16x16x32_bf16 a[0:3], a[176:179], v[84:87], a[0:3]
    s_waitcnt lgkmcnt(3)
    ds_read_b64_tr_b16 a[190:191], v210 offset:28672
    v_add_f32 v201, v164, v201
    v_mfma_f32_16x16x32_bf16 a[0:3], a[180:183], v[92:95], a[0:3]
    v_exp_f32 v165, v165
    v_mfma_f32_16x16x32_bf16 a[32:35], a[180:183], v[108:111], a[32:35]
    buffer_load_dwordx4 v220, s[12:15], s27 offen offset:3072 nt lds
    v_add_f32 v201, v165, v201
    v_cvt_pk_bf16_f32 v20, v164, v165
    v_mfma_f32_16x16x32_bf16 a[32:35], a[176:179], v[100:103], a[32:35]
    v_exp_f32 v166, v166
    v_mfma_f32_16x16x32_bf16 a[64:67], a[176:179], v[116:119], a[64:67]
    ds_read_b128 a[160:163], v205 offset:36864
    v_add_f32 v201, v166, v201
    v_mfma_f32_16x16x32_bf16 a[64:67], a[180:183], v[124:127], a[64:67]
    s_mov_b32 m0, 4096
    v_exp_f32 v167, v167
    v_mfma_f32_16x16x32_bf16 a[96:99], a[180:183], v[140:143], a[96:99]
    s_and_b32 s27, s30, 0x3ffff
    ds_read_b128 a[164:167], v206 offset:36864
    buffer_load_dwordx4 v217, s[12:15], s27 offen nt lds
    v_add_f32 v201, v167, v201
    v_cvt_pk_bf16_f32 v21, v166, v167
    v_mfma_f32_16x16x32_bf16 a[96:99], a[176:179], v[132:135], a[96:99]
    s_waitcnt lgkmcnt(4)
    v_exp_f32 v168, v168
    v_mfma_f32_16x16x32_bf16 a[4:7], a[184:187], v[84:87], a[4:7]
    s_waitcnt lgkmcnt(2)
    ds_read_b128 a[168:171], v207 offset:36864
    v_add_f32 v202, v168, v202
    v_mfma_f32_16x16x32_bf16 a[4:7], a[188:191], v[92:95], a[4:7]
    s_add_u32 s30, s30, 4096
    buffer_load_dwordx4 v218, s[12:15], s27 offen offset:1024 nt lds
    v_exp_f32 v169, v169
    v_mfma_f32_16x16x32_bf16 a[36:39], a[188:191], v[108:111], a[36:39]
    v_add_f32 v202, v169, v202
    v_cvt_pk_bf16_f32 v36, v168, v169
    v_mfma_f32_16x16x32_bf16 a[36:39], a[184:187], v[100:103], a[36:39]
    v_exp_f32 v170, v170
    v_mfma_f32_16x16x32_bf16 a[68:71], a[184:187], v[116:119], a[68:71]
    ds_read_b128 a[172:175], v208 offset:36864
    v_add_f32 v202, v170, v202
    v_mfma_f32_16x16x32_bf16 a[68:71], a[188:191], v[124:127], a[68:71]
    buffer_load_dwordx4 v219, s[12:15], s27 offen offset:2048 nt lds
    v_exp_f32 v171, v171
    v_mfma_f32_16x16x32_bf16 a[100:103], a[188:191], v[140:143], a[100:103]
    v_add_f32 v202, v171, v202
    v_cvt_pk_bf16_f32 v37, v170, v171
    v_mfma_f32_16x16x32_bf16 a[100:103], a[184:187], v[132:135], a[100:103]
    s_waitcnt lgkmcnt(3)
    v_exp_f32 v172, v172
    v_mfma_f32_16x16x32_bf16 v[160:163], a[160:163], v[0:3], v[180:183]
    s_waitcnt lgkmcnt(2)
    ds_read_b64_tr_b16 a[176:177], v211 offset:16384
    v_add_f32 v203, v172, v203
    v_mfma_f32_16x16x32_bf16 v[160:163], a[164:167], v[8:11], v[160:163]
    s_waitcnt lgkmcnt(2)
    buffer_load_dwordx4 v220, s[12:15], s27 offen offset:3072 nt lds
    v_exp_f32 v173, v173
    v_mfma_f32_16x16x32_bf16 v[160:163], a[168:171], v[16:19], v[160:163]
    s_waitcnt lgkmcnt(1)
    ds_read_b64_tr_b16 a[178:179], v211 offset:20480
    v_add_f32 v203, v173, v203
    v_cvt_pk_bf16_f32 v52, v172, v173
    v_mfma_f32_16x16x32_bf16 v[160:163], a[172:175], v[24:27], v[160:163]
    v_exp_f32 v174, v174
    v_mfma_f32_16x16x32_bf16 v[164:167], a[172:175], v[56:59], v[184:187]
    s_mov_b32 m0, 8192
    ds_read_b64_tr_b16 a[180:181], v211 offset:24576
    v_add_f32 v203, v174, v203
    v_mfma_f32_16x16x32_bf16 v[164:167], a[168:171], v[48:51], v[164:167]
    s_and_b32 s27, s30, 0x3ffff
    buffer_load_dwordx4 v217, s[12:15], s27 offen nt lds
    v_exp_f32 v175, v175
    v_mfma_f32_16x16x32_bf16 v[164:167], a[164:167], v[40:43], v[164:167]
    v_add_f32 v203, v175, v203
    v_cvt_pk_bf16_f32 v53, v174, v175
    v_mfma_f32_16x16x32_bf16 v[164:167], a[160:163], v[32:35], v[164:167]
    v_exp_f32 v160, v160
    v_mfma_f32_16x16x32_bf16 v[168:171], a[160:163], v[64:67], v[188:191]
    ds_read_b64_tr_b16 a[182:183], v211 offset:28672
    v_add_f32 v200, v160, v200
    v_mfma_f32_16x16x32_bf16 v[168:171], a[164:167], v[72:75], v[168:171]
    s_add_u32 s30, s30, 4096
    buffer_load_dwordx4 v218, s[12:15], s27 offen offset:1024 nt lds
    v_exp_f32 v161, v161
    v_mfma_f32_16x16x32_bf16 v[168:171], a[168:171], v[80:83], v[168:171]
    ds_read_b64_tr_b16 a[184:185], v212 offset:16384
    v_add_f32 v200, v161, v200
    v_cvt_pk_bf16_f32 v6, v160, v161
    v_mfma_f32_16x16x32_bf16 v[168:171], a[172:175], v[88:91], v[168:171]
    v_exp_f32 v162, v162
    v_mfma_f32_16x16x32_bf16 v[172:175], a[172:175], v[120:123], v[192:195]
    ds_read_b64_tr_b16 a[186:187], v212 offset:20480
    buffer_load_dwordx4 v219, s[12:15], s27 offen offset:2048 nt lds
    v_add_f32 v200, v162, v200
    v_mfma_f32_16x16x32_bf16 v[172:175], a[168:171], v[112:115], v[172:175]
    v_exp_f32 v163, v163
    v_mfma_f32_16x16x32_bf16 v[172:175], a[164:167], v[104:107], v[172:175]
    ds_read_b64_tr_b16 a[188:189], v212 offset:24576
    v_add_f32 v200, v163, v200
    v_cvt_pk_bf16_f32 v7, v162, v163
    v_mfma_f32_16x16x32_bf16 v[172:175], a[160:163], v[96:99], v[172:175]
    s_waitcnt lgkmcnt(5)
    v_exp_f32 v164, v164
    v_mfma_f32_16x16x32_bf16 a[8:11], a[176:179], v[84:87], a[8:11]
    s_waitcnt lgkmcnt(3)
    ds_read_b64_tr_b16 a[190:191], v212 offset:28672
    buffer_load_dwordx4 v220, s[12:15], s27 offen offset:3072 nt lds
    v_add_f32 v201, v164, v201
    v_mfma_f32_16x16x32_bf16 a[8:11], a[180:183], v[92:95], a[8:11]
    v_exp_f32 v165, v165
    v_mfma_f32_16x16x32_bf16 a[40:43], a[180:183], v[108:111], a[40:43]
    v_add_f32 v201, v165, v201
    v_cvt_pk_bf16_f32 v22, v164, v165
    v_mfma_f32_16x16x32_bf16 a[40:43], a[176:179], v[100:103], a[40:43]
    s_mov_b32 m0, 12288
    v_exp_f32 v166, v166
    v_mfma_f32_16x16x32_bf16 a[72:75], a[176:179], v[116:119], a[72:75]
    s_and_b32 s27, s30, 0x3ffff
    ds_read_b128 a[160:163], v205 offset:40960
    buffer_load_dwordx4 v217, s[12:15], s27 offen nt lds
    v_add_f32 v201, v166, v201
    v_mfma_f32_16x16x32_bf16 a[72:75], a[180:183], v[124:127], a[72:75]
    v_exp_f32 v167, v167
    v_mfma_f32_16x16x32_bf16 a[104:107], a[180:183], v[140:143], a[104:107]
    ds_read_b128 a[164:167], v206 offset:40960
    v_add_f32 v201, v167, v201
    v_cvt_pk_bf16_f32 v23, v166, v167
    v_mfma_f32_16x16x32_bf16 a[104:107], a[176:179], v[132:135], a[104:107]
    s_waitcnt lgkmcnt(4)
    v_exp_f32 v168, v168
    v_mfma_f32_16x16x32_bf16 a[12:15], a[184:187], v[84:87], a[12:15]
    s_waitcnt lgkmcnt(2)
    s_add_u32 s30, s30, 4096
    ds_read_b128 a[168:171], v207 offset:40960
    buffer_load_dwordx4 v218, s[12:15], s27 offen offset:1024 nt lds
    v_add_f32 v202, v168, v202
    v_mfma_f32_16x16x32_bf16 a[12:15], a[188:191], v[92:95], a[12:15]
    v_exp_f32 v169, v169
    v_mfma_f32_16x16x32_bf16 a[44:47], a[188:191], v[108:111], a[44:47]
    v_add_f32 v202, v169, v202
    v_cvt_pk_bf16_f32 v38, v168, v169
    v_mfma_f32_16x16x32_bf16 a[44:47], a[184:187], v[100:103], a[44:47]
    v_exp_f32 v170, v170
    v_mfma_f32_16x16x32_bf16 a[76:79], a[184:187], v[116:119], a[76:79]
    ds_read_b128 a[172:175], v208 offset:40960
    buffer_load_dwordx4 v219, s[12:15], s27 offen offset:2048 nt lds
    v_add_f32 v202, v170, v202
    v_mfma_f32_16x16x32_bf16 a[76:79], a[188:191], v[124:127], a[76:79]
    v_exp_f32 v171, v171
    v_mfma_f32_16x16x32_bf16 a[108:111], a[188:191], v[140:143], a[108:111]
    v_add_f32 v202, v171, v202
    v_cvt_pk_bf16_f32 v39, v170, v171
    v_mfma_f32_16x16x32_bf16 a[108:111], a[184:187], v[132:135], a[108:111]
    s_waitcnt lgkmcnt(3)
    v_exp_f32 v172, v172
    v_mfma_f32_16x16x32_bf16 v[160:163], a[160:163], v[0:3], v[180:183]
    s_waitcnt lgkmcnt(2)
    ds_read_b64_tr_b16 a[176:177], v213 offset:16384
    buffer_load_dwordx4 v220, s[12:15], s27 offen offset:3072 nt lds
    v_add_f32 v203, v172, v203
    v_mfma_f32_16x16x32_bf16 v[160:163], a[164:167], v[8:11], v[160:163]
    s_waitcnt lgkmcnt(2)
    v_exp_f32 v173, v173
    v_mfma_f32_16x16x32_bf16 v[160:163], a[168:171], v[16:19], v[160:163]
    s_waitcnt lgkmcnt(1)
    s_mov_b32 m0, 114688
    ds_read_b64_tr_b16 a[178:179], v213 offset:20480
    v_add_f32 v203, v173, v203
    v_cvt_pk_bf16_f32 v54, v172, v173
    v_mfma_f32_16x16x32_bf16 v[160:163], a[172:175], v[24:27], v[160:163]
    s_and_b32 s27, s3, 0x3ffff
    buffer_load_dwordx4 v221, s[16:19], s27 offen nt lds
    v_exp_f32 v174, v174
    v_mfma_f32_16x16x32_bf16 v[164:167], a[172:175], v[56:59], v[184:187]
    ds_read_b64_tr_b16 a[180:181], v213 offset:24576
    v_add_f32 v203, v174, v203
    v_mfma_f32_16x16x32_bf16 v[164:167], a[168:171], v[48:51], v[164:167]
    v_exp_f32 v175, v175
    v_mfma_f32_16x16x32_bf16 v[164:167], a[164:167], v[40:43], v[164:167]
    v_add_f32 v203, v175, v203
    v_cvt_pk_bf16_f32 v55, v174, v175
    v_mfma_f32_16x16x32_bf16 v[164:167], a[160:163], v[32:35], v[164:167]
    s_add_u32 s3, s3, 4096
    buffer_load_dwordx4 v222, s[16:19], s27 offen offset:1024 nt lds
    v_exp_f32 v160, v160
    v_mfma_f32_16x16x32_bf16 v[168:171], a[160:163], v[64:67], v[188:191]
    ds_read_b64_tr_b16 a[182:183], v213 offset:28672
    v_add_f32 v200, v160, v200
    v_mfma_f32_16x16x32_bf16 v[168:171], a[164:167], v[72:75], v[168:171]
    v_exp_f32 v161, v161
    v_mfma_f32_16x16x32_bf16 v[168:171], a[168:171], v[80:83], v[168:171]
    ds_read_b64_tr_b16 a[184:185], v214 offset:16384
    v_add_f32 v200, v161, v200
    v_cvt_pk_bf16_f32 v12, v160, v161
    v_mfma_f32_16x16x32_bf16 v[168:171], a[172:175], v[88:91], v[168:171]
    buffer_load_dwordx4 v221, s[16:19], s27 offen offset:2048 nt lds
    v_exp_f32 v162, v162
    v_mfma_f32_16x16x32_bf16 v[172:175], a[172:175], v[120:123], v[192:195]
    ds_read_b64_tr_b16 a[186:187], v214 offset:20480
    v_add_f32 v200, v162, v200
    v_mfma_f32_16x16x32_bf16 v[172:175], a[168:171], v[112:115], v[172:175]
    v_exp_f32 v163, v163
    v_mfma_f32_16x16x32_bf16 v[172:175], a[164:167], v[104:107], v[172:175]
    ds_read_b64_tr_b16 a[188:189], v214 offset:24576
    v_add_f32 v200, v163, v200
    v_cvt_pk_bf16_f32 v13, v162, v163
    v_mfma_f32_16x16x32_bf16 v[172:175], a[160:163], v[96:99], v[172:175]
    s_waitcnt lgkmcnt(5)
    buffer_load_dwordx4 v222, s[16:19], s27 offen offset:3072 nt lds
    v_exp_f32 v164, v164
    v_mfma_f32_16x16x32_bf16 a[16:19], a[176:179], v[84:87], a[16:19]
    s_waitcnt lgkmcnt(3)
    ds_read_b64_tr_b16 a[190:191], v214 offset:28672
    v_add_f32 v201, v164, v201
    v_mfma_f32_16x16x32_bf16 a[16:19], a[180:183], v[92:95], a[16:19]
    v_exp_f32 v165, v165
    v_mfma_f32_16x16x32_bf16 a[48:51], a[180:183], v[108:111], a[48:51]
    s_mov_b32 m0, 118784
    v_add_f32 v201, v165, v201
    v_cvt_pk_bf16_f32 v28, v164, v165
    v_mfma_f32_16x16x32_bf16 a[48:51], a[176:179], v[100:103], a[48:51]
    s_and_b32 s27, s3, 0x3ffff
    buffer_load_dwordx4 v221, s[16:19], s27 offen nt lds
    v_exp_f32 v166, v166
    v_mfma_f32_16x16x32_bf16 a[80:83], a[176:179], v[116:119], a[80:83]
    ds_read_b128 a[160:163], v205 offset:45056
    v_add_f32 v201, v166, v201
    v_mfma_f32_16x16x32_bf16 a[80:83], a[180:183], v[124:127], a[80:83]
    v_exp_f32 v167, v167
    v_mfma_f32_16x16x32_bf16 a[112:115], a[180:183], v[140:143], a[112:115]
    s_add_u32 s3, s3, 4096
    ds_read_b128 a[164:167], v206 offset:45056
    buffer_load_dwordx4 v222, s[16:19], s27 offen offset:1024 nt lds
    v_add_f32 v201, v167, v201
    v_cvt_pk_bf16_f32 v29, v166, v167
    v_mfma_f32_16x16x32_bf16 a[112:115], a[176:179], v[132:135], a[112:115]
    s_waitcnt lgkmcnt(4)
    v_exp_f32 v168, v168
    v_mfma_f32_16x16x32_bf16 a[20:23], a[184:187], v[84:87], a[20:23]
    s_waitcnt lgkmcnt(2)
    ds_read_b128 a[168:171], v207 offset:45056
    v_add_f32 v202, v168, v202
    v_mfma_f32_16x16x32_bf16 a[20:23], a[188:191], v[92:95], a[20:23]
    v_exp_f32 v169, v169
    v_mfma_f32_16x16x32_bf16 a[52:55], a[188:191], v[108:111], a[52:55]
    buffer_load_dwordx4 v221, s[16:19], s27 offen offset:2048 nt lds
    v_add_f32 v202, v169, v202
    v_cvt_pk_bf16_f32 v44, v168, v169
    v_mfma_f32_16x16x32_bf16 a[52:55], a[184:187], v[100:103], a[52:55]
    v_exp_f32 v170, v170
    v_mfma_f32_16x16x32_bf16 a[84:87], a[184:187], v[116:119], a[84:87]
    ds_read_b128 a[172:175], v208 offset:45056
    v_add_f32 v202, v170, v202
    v_mfma_f32_16x16x32_bf16 a[84:87], a[188:191], v[124:127], a[84:87]
    v_exp_f32 v171, v171
    v_mfma_f32_16x16x32_bf16 a[116:119], a[188:191], v[140:143], a[116:119]
    buffer_load_dwordx4 v222, s[16:19], s27 offen offset:3072 nt lds
    v_add_f32 v202, v171, v202
    v_cvt_pk_bf16_f32 v45, v170, v171
    v_mfma_f32_16x16x32_bf16 a[116:119], a[184:187], v[132:135], a[116:119]
    s_waitcnt lgkmcnt(3)
    v_exp_f32 v172, v172
    v_mfma_f32_16x16x32_bf16 v[160:163], a[160:163], v[0:3], v[180:183]
    s_waitcnt lgkmcnt(2)
    ds_read_b64_tr_b16 a[176:177], v215 offset:16384
    v_add_f32 v203, v172, v203
    v_mfma_f32_16x16x32_bf16 v[160:163], a[164:167], v[8:11], v[160:163]
    s_waitcnt lgkmcnt(2)
    s_mov_b32 m0, 122880
    v_exp_f32 v173, v173
    v_mfma_f32_16x16x32_bf16 v[160:163], a[168:171], v[16:19], v[160:163]
    s_waitcnt lgkmcnt(1)
    s_and_b32 s27, s3, 0x3ffff
    ds_read_b64_tr_b16 a[178:179], v215 offset:20480
    buffer_load_dwordx4 v221, s[16:19], s27 offen nt lds
    v_add_f32 v203, v173, v203
    v_cvt_pk_bf16_f32 v60, v172, v173
    v_mfma_f32_16x16x32_bf16 v[160:163], a[172:175], v[24:27], v[160:163]
    v_exp_f32 v174, v174
    v_mfma_f32_16x16x32_bf16 v[164:167], a[172:175], v[56:59], v[184:187]
    ds_read_b64_tr_b16 a[180:181], v215 offset:24576
    v_add_f32 v203, v174, v203
    v_mfma_f32_16x16x32_bf16 v[164:167], a[168:171], v[48:51], v[164:167]
    v_exp_f32 v175, v175
    v_mfma_f32_16x16x32_bf16 v[164:167], a[164:167], v[40:43], v[164:167]
    s_add_u32 s3, s3, 4096
    buffer_load_dwordx4 v222, s[16:19], s27 offen offset:1024 nt lds
    v_add_f32 v203, v175, v203
    v_cvt_pk_bf16_f32 v61, v174, v175
    v_mfma_f32_16x16x32_bf16 v[164:167], a[160:163], v[32:35], v[164:167]
    v_exp_f32 v160, v160
    v_mfma_f32_16x16x32_bf16 v[168:171], a[160:163], v[64:67], v[188:191]
    ds_read_b64_tr_b16 a[182:183], v215 offset:28672
    v_add_f32 v200, v160, v200
    v_mfma_f32_16x16x32_bf16 v[168:171], a[164:167], v[72:75], v[168:171]
    buffer_load_dwordx4 v221, s[16:19], s27 offen offset:2048 nt lds
    v_exp_f32 v161, v161
    v_mfma_f32_16x16x32_bf16 v[168:171], a[168:171], v[80:83], v[168:171]
    ds_read_b64_tr_b16 a[184:185], v216 offset:16384
    v_add_f32 v200, v161, v200
    v_cvt_pk_bf16_f32 v14, v160, v161
    v_mfma_f32_16x16x32_bf16 v[168:171], a[172:175], v[88:91], v[168:171]
    v_exp_f32 v162, v162
    v_mfma_f32_16x16x32_bf16 v[172:175], a[172:175], v[120:123], v[192:195]
    ds_read_b64_tr_b16 a[186:187], v216 offset:20480
    v_add_f32 v200, v162, v200
    v_mfma_f32_16x16x32_bf16 v[172:175], a[168:171], v[112:115], v[172:175]
    buffer_load_dwordx4 v222, s[16:19], s27 offen offset:3072 nt lds
    v_exp_f32 v163, v163
    v_mfma_f32_16x16x32_bf16 v[172:175], a[164:167], v[104:107], v[172:175]
    ds_read_b64_tr_b16 a[188:189], v216 offset:24576
    v_add_f32 v200, v163, v200
    v_cvt_pk_bf16_f32 v15, v162, v163
    v_mfma_f32_16x16x32_bf16 v[172:175], a[160:163], v[96:99], v[172:175]
    s_waitcnt lgkmcnt(5)
    v_exp_f32 v164, v164
    v_mfma_f32_16x16x32_bf16 a[24:27], a[176:179], v[84:87], a[24:27]
    s_waitcnt lgkmcnt(3)
    s_mov_b32 m0, 126976
    ds_read_b64_tr_b16 a[190:191], v216 offset:28672
    v_add_f32 v201, v164, v201
    v_mfma_f32_16x16x32_bf16 a[24:27], a[180:183], v[92:95], a[24:27]
    s_and_b32 s27, s3, 0x3ffff
    buffer_load_dwordx4 v221, s[16:19], s27 offen nt lds
    v_exp_f32 v165, v165
    v_mfma_f32_16x16x32_bf16 a[56:59], a[180:183], v[108:111], a[56:59]
    v_add_f32 v201, v165, v201
    v_cvt_pk_bf16_f32 v30, v164, v165
    v_mfma_f32_16x16x32_bf16 a[56:59], a[176:179], v[100:103], a[56:59]
    v_exp_f32 v166, v166
    v_mfma_f32_16x16x32_bf16 a[88:91], a[176:179], v[116:119], a[88:91]
    v_add_f32 v201, v166, v201
    v_mfma_f32_16x16x32_bf16 a[88:91], a[180:183], v[124:127], a[88:91]
    s_waitcnt vmcnt(30) lgkmcnt(0)
    v_exp_f32 v167, v167
    v_mfma_f32_16x16x32_bf16 a[120:123], a[180:183], v[140:143], a[120:123]
    s_barrier
    v_add_f32 v201, v167, v201
    v_cvt_pk_bf16_f32 v31, v166, v167
    v_mfma_f32_16x16x32_bf16 a[120:123], a[176:179], v[132:135], a[120:123]
    s_add_u32 s3, s3, 4096
    ds_read_b128 a[160:163], v205 offset:49152
    buffer_load_dwordx4 v222, s[16:19], s27 offen offset:1024 nt lds
    v_exp_f32 v168, v168
    v_mfma_f32_16x16x32_bf16 a[28:31], a[184:187], v[84:87], a[28:31]
    ds_read_b128 a[164:167], v206 offset:49152
    v_add_f32 v202, v168, v202
    v_mfma_f32_16x16x32_bf16 a[28:31], a[188:191], v[92:95], a[28:31]
    buffer_load_dwordx4 v221, s[16:19], s27 offen offset:2048 nt lds
    v_exp_f32 v169, v169
    v_mfma_f32_16x16x32_bf16 a[60:63], a[188:191], v[108:111], a[60:63]
    ds_read_b128 a[168:171], v207 offset:49152
    v_add_f32 v202, v169, v202
    v_cvt_pk_bf16_f32 v46, v168, v169
    v_mfma_f32_16x16x32_bf16 a[60:63], a[184:187], v[100:103], a[60:63]
    v_exp_f32 v170, v170
    v_mfma_f32_16x16x32_bf16 a[92:95], a[184:187], v[116:119], a[92:95]
    ds_read_b128 a[172:175], v208 offset:49152
    v_add_f32 v202, v170, v202
    v_mfma_f32_16x16x32_bf16 a[92:95], a[188:191], v[124:127], a[92:95]
    buffer_load_dwordx4 v222, s[16:19], s27 offen offset:3072 nt lds
    v_exp_f32 v171, v171
    v_mfma_f32_16x16x32_bf16 a[124:127], a[188:191], v[140:143], a[124:127]
    v_add_f32 v202, v171, v202
    v_cvt_pk_bf16_f32 v47, v170, v171
    v_mfma_f32_16x16x32_bf16 a[124:127], a[184:187], v[132:135], a[124:127]
    s_waitcnt lgkmcnt(3)
    v_exp_f32 v172, v172
    v_mfma_f32_16x16x32_bf16 v[160:163], a[160:163], v[0:3], v[180:183]
    s_waitcnt lgkmcnt(2)
    ds_read_b64_tr_b16 a[176:177], v209 offset:32768
    v_add_f32 v203, v172, v203
    v_mfma_f32_16x16x32_bf16 v[160:163], a[164:167], v[8:11], v[160:163]
    s_waitcnt lgkmcnt(2)
    v_exp_f32 v173, v173
    v_mfma_f32_16x16x32_bf16 v[160:163], a[168:171], v[16:19], v[160:163]
    s_waitcnt lgkmcnt(1)
    ds_read_b64_tr_b16 a[178:179], v209 offset:36864
    v_add_f32 v203, v173, v203
    v_cvt_pk_bf16_f32 v62, v172, v173
    v_mfma_f32_16x16x32_bf16 v[160:163], a[172:175], v[24:27], v[160:163]
    buffer_atomic_add v250, v253, s[20:23], s33 offen sc1
    v_exp_f32 v174, v174
    v_mfma_f32_16x16x32_bf16 v[164:167], a[172:175], v[56:59], v[184:187]
    ds_read_b64_tr_b16 a[180:181], v209 offset:40960
    v_add_f32 v203, v174, v203
    v_mfma_f32_16x16x32_bf16 v[164:167], a[168:171], v[48:51], v[164:167]
    s_mov_b32 m0, 16384
    v_exp_f32 v175, v175
    v_mfma_f32_16x16x32_bf16 v[164:167], a[164:167], v[40:43], v[164:167]
    s_and_b32 s27, s30, 0x3ffff
    buffer_load_dwordx4 v217, s[12:15], s27 offen nt lds
    v_add_f32 v203, v175, v203
    v_cvt_pk_bf16_f32 v63, v174, v175
    v_mfma_f32_16x16x32_bf16 v[164:167], a[160:163], v[32:35], v[164:167]
    v_exp_f32 v160, v160
    v_mfma_f32_16x16x32_bf16 v[168:171], a[160:163], v[64:67], v[188:191]
    ds_read_b64_tr_b16 a[182:183], v209 offset:45056
    v_add_f32 v200, v160, v200
    v_mfma_f32_16x16x32_bf16 v[168:171], a[164:167], v[72:75], v[168:171]
    v_exp_f32 v161, v161
    v_mfma_f32_16x16x32_bf16 v[168:171], a[168:171], v[80:83], v[168:171]
    s_add_u32 s30, s30, 4096
    ds_read_b64_tr_b16 a[184:185], v210 offset:32768
    buffer_load_dwordx4 v218, s[12:15], s27 offen offset:1024 nt lds
    v_add_f32 v200, v161, v200
    v_cvt_pk_bf16_f32 v84, v160, v161
    v_mfma_f32_16x16x32_bf16 v[168:171], a[172:175], v[88:91], v[168:171]
    v_exp_f32 v162, v162
    v_mfma_f32_16x16x32_bf16 v[172:175], a[172:175], v[120:123], v[192:195]
    ds_read_b64_tr_b16 a[186:187], v210 offset:36864
    v_add_f32 v200, v162, v200
    v_mfma_f32_16x16x32_bf16 v[172:175], a[168:171], v[112:115], v[172:175]
    v_exp_f32 v163, v163
    v_mfma_f32_16x16x32_bf16 v[172:175], a[164:167], v[104:107], v[172:175]
    ds_read_b64_tr_b16 a[188:189], v210 offset:40960
    buffer_load_dwordx4 v219, s[12:15], s27 offen offset:2048 nt lds
    v_add_f32 v200, v163, v200
    v_cvt_pk_bf16_f32 v85, v162, v163
    v_mfma_f32_16x16x32_bf16 v[172:175], a[160:163], v[96:99], v[172:175]
    s_waitcnt lgkmcnt(5)
    v_exp_f32 v164, v164
    v_mfma_f32_16x16x32_bf16 a[0:3], a[176:179], v[4:7], a[0:3]
    s_waitcnt lgkmcnt(3)
    ds_read_b64_tr_b16 a[190:191], v210 offset:45056
    v_add_f32 v201, v164, v201
    v_mfma_f32_16x16x32_bf16 a[0:3], a[180:183], v[12:15], a[0:3]
    v_exp_f32 v165, v165
    v_mfma_f32_16x16x32_bf16 a[32:35], a[180:183], v[28:31], a[32:35]
    buffer_load_dwordx4 v220, s[12:15], s27 offen offset:3072 nt lds
    v_add_f32 v201, v165, v201
    v_cvt_pk_bf16_f32 v100, v164, v165
    v_mfma_f32_16x16x32_bf16 a[32:35], a[176:179], v[20:23], a[32:35]
    v_exp_f32 v166, v166
    v_mfma_f32_16x16x32_bf16 a[64:67], a[176:179], v[36:39], a[64:67]
    ds_read_b128 a[160:163], v205 offset:53248
    v_add_f32 v201, v166, v201
    v_mfma_f32_16x16x32_bf16 a[64:67], a[180:183], v[44:47], a[64:67]
    s_mov_b32 m0, 20480
    v_exp_f32 v167, v167
    v_mfma_f32_16x16x32_bf16 a[96:99], a[180:183], v[60:63], a[96:99]
    s_and_b32 s27, s30, 0x3ffff
    ds_read_b128 a[164:167], v206 offset:53248
    buffer_load_dwordx4 v217, s[12:15], s27 offen nt lds
    v_add_f32 v201, v167, v201
    v_cvt_pk_bf16_f32 v101, v166, v167
    v_mfma_f32_16x16x32_bf16 a[96:99], a[176:179], v[52:55], a[96:99]
    s_waitcnt lgkmcnt(4)
    v_exp_f32 v168, v168
    v_mfma_f32_16x16x32_bf16 a[4:7], a[184:187], v[4:7], a[4:7]
    s_waitcnt lgkmcnt(2)
    ds_read_b128 a[168:171], v207 offset:53248
    v_add_f32 v202, v168, v202
    v_mfma_f32_16x16x32_bf16 a[4:7], a[188:191], v[12:15], a[4:7]
    s_add_u32 s30, s30, 4096
    buffer_load_dwordx4 v218, s[12:15], s27 offen offset:1024 nt lds
    v_exp_f32 v169, v169
    v_mfma_f32_16x16x32_bf16 a[36:39], a[188:191], v[28:31], a[36:39]
    v_add_f32 v202, v169, v202
    v_cvt_pk_bf16_f32 v116, v168, v169
    v_mfma_f32_16x16x32_bf16 a[36:39], a[184:187], v[20:23], a[36:39]
    v_exp_f32 v170, v170
    v_mfma_f32_16x16x32_bf16 a[68:71], a[184:187], v[36:39], a[68:71]
    ds_read_b128 a[172:175], v208 offset:53248
    v_add_f32 v202, v170, v202
    v_mfma_f32_16x16x32_bf16 a[68:71], a[188:191], v[44:47], a[68:71]
    buffer_load_dwordx4 v219, s[12:15], s27 offen offset:2048 nt lds
    v_exp_f32 v171, v171
    v_mfma_f32_16x16x32_bf16 a[100:103], a[188:191], v[60:63], a[100:103]
    v_add_f32 v202, v171, v202
    v_cvt_pk_bf16_f32 v117, v170, v171
    v_mfma_f32_16x16x32_bf16 a[100:103], a[184:187], v[52:55], a[100:103]
    s_waitcnt lgkmcnt(3)
    v_exp_f32 v172, v172
    v_mfma_f32_16x16x32_bf16 v[160:163], a[160:163], v[0:3], v[180:183]
    s_waitcnt lgkmcnt(2)
    ds_read_b64_tr_b16 a[176:177], v211 offset:32768
    v_add_f32 v203, v172, v203
    v_mfma_f32_16x16x32_bf16 v[160:163], a[164:167], v[8:11], v[160:163]
    s_waitcnt lgkmcnt(2)
    buffer_load_dwordx4 v220, s[12:15], s27 offen offset:3072 nt lds
    v_exp_f32 v173, v173
    v_mfma_f32_16x16x32_bf16 v[160:163], a[168:171], v[16:19], v[160:163]
    s_waitcnt lgkmcnt(1)
    ds_read_b64_tr_b16 a[178:179], v211 offset:36864
    v_add_f32 v203, v173, v203
    v_cvt_pk_bf16_f32 v132, v172, v173
    v_mfma_f32_16x16x32_bf16 v[160:163], a[172:175], v[24:27], v[160:163]
    v_exp_f32 v174, v174
    v_mfma_f32_16x16x32_bf16 v[164:167], a[172:175], v[56:59], v[184:187]
    s_mov_b32 m0, 24576
    ds_read_b64_tr_b16 a[180:181], v211 offset:40960
    v_add_f32 v203, v174, v203
    v_mfma_f32_16x16x32_bf16 v[164:167], a[168:171], v[48:51], v[164:167]
    s_and_b32 s27, s30, 0x3ffff
    buffer_load_dwordx4 v217, s[12:15], s27 offen nt lds
    v_exp_f32 v175, v175
    v_mfma_f32_16x16x32_bf16 v[164:167], a[164:167], v[40:43], v[164:167]
    v_add_f32 v203, v175, v203
    v_cvt_pk_bf16_f32 v133, v174, v175
    v_mfma_f32_16x16x32_bf16 v[164:167], a[160:163], v[32:35], v[164:167]
    v_exp_f32 v160, v160
    v_mfma_f32_16x16x32_bf16 v[168:171], a[160:163], v[64:67], v[188:191]
    ds_read_b64_tr_b16 a[182:183], v211 offset:45056
    v_add_f32 v200, v160, v200
    v_mfma_f32_16x16x32_bf16 v[168:171], a[164:167], v[72:75], v[168:171]
    s_add_u32 s30, s30, 4096
    buffer_load_dwordx4 v218, s[12:15], s27 offen offset:1024 nt lds
    v_exp_f32 v161, v161
    v_mfma_f32_16x16x32_bf16 v[168:171], a[168:171], v[80:83], v[168:171]
    ds_read_b64_tr_b16 a[184:185], v212 offset:32768
    v_add_f32 v200, v161, v200
    v_cvt_pk_bf16_f32 v86, v160, v161
    v_mfma_f32_16x16x32_bf16 v[168:171], a[172:175], v[88:91], v[168:171]
    v_exp_f32 v162, v162
    v_mfma_f32_16x16x32_bf16 v[172:175], a[172:175], v[120:123], v[192:195]
    ds_read_b64_tr_b16 a[186:187], v212 offset:36864
    buffer_load_dwordx4 v219, s[12:15], s27 offen offset:2048 nt lds
    v_add_f32 v200, v162, v200
    v_mfma_f32_16x16x32_bf16 v[172:175], a[168:171], v[112:115], v[172:175]
    v_exp_f32 v163, v163
    v_mfma_f32_16x16x32_bf16 v[172:175], a[164:167], v[104:107], v[172:175]
    ds_read_b64_tr_b16 a[188:189], v212 offset:40960
    v_add_f32 v200, v163, v200
    v_cvt_pk_bf16_f32 v87, v162, v163
    v_mfma_f32_16x16x32_bf16 v[172:175], a[160:163], v[96:99], v[172:175]
    s_waitcnt lgkmcnt(5)
    v_exp_f32 v164, v164
    v_mfma_f32_16x16x32_bf16 a[8:11], a[176:179], v[4:7], a[8:11]
    s_waitcnt lgkmcnt(3)
    ds_read_b64_tr_b16 a[190:191], v212 offset:45056
    buffer_load_dwordx4 v220, s[12:15], s27 offen offset:3072 nt lds
    v_add_f32 v201, v164, v201
    v_mfma_f32_16x16x32_bf16 a[8:11], a[180:183], v[12:15], a[8:11]
    v_exp_f32 v165, v165
    v_mfma_f32_16x16x32_bf16 a[40:43], a[180:183], v[28:31], a[40:43]
    v_add_f32 v201, v165, v201
    v_cvt_pk_bf16_f32 v102, v164, v165
    v_mfma_f32_16x16x32_bf16 a[40:43], a[176:179], v[20:23], a[40:43]
    s_mov_b32 m0, 28672
    v_exp_f32 v166, v166
    v_mfma_f32_16x16x32_bf16 a[72:75], a[176:179], v[36:39], a[72:75]
    s_and_b32 s27, s30, 0x3ffff
    ds_read_b128 a[160:163], v205 offset:57344
    buffer_load_dwordx4 v217, s[12:15], s27 offen nt lds
    v_add_f32 v201, v166, v201
    v_mfma_f32_16x16x32_bf16 a[72:75], a[180:183], v[44:47], a[72:75]
    v_exp_f32 v167, v167
    v_mfma_f32_16x16x32_bf16 a[104:107], a[180:183], v[60:63], a[104:107]
    ds_read_b128 a[164:167], v206 offset:57344
    v_add_f32 v201, v167, v201
    v_cvt_pk_bf16_f32 v103, v166, v167
    v_mfma_f32_16x16x32_bf16 a[104:107], a[176:179], v[52:55], a[104:107]
    s_waitcnt lgkmcnt(4)
    v_exp_f32 v168, v168
    v_mfma_f32_16x16x32_bf16 a[12:15], a[184:187], v[4:7], a[12:15]
    s_waitcnt lgkmcnt(2)
    s_add_u32 s30, s30, 4096
    ds_read_b128 a[168:171], v207 offset:57344
    buffer_load_dwordx4 v218, s[12:15], s27 offen offset:1024 nt lds
    v_add_f32 v202, v168, v202
    v_mfma_f32_16x16x32_bf16 a[12:15], a[188:191], v[12:15], a[12:15]
    v_exp_f32 v169, v169
    v_mfma_f32_16x16x32_bf16 a[44:47], a[188:191], v[28:31], a[44:47]
    v_add_f32 v202, v169, v202
    v_cvt_pk_bf16_f32 v118, v168, v169
    v_mfma_f32_16x16x32_bf16 a[44:47], a[184:187], v[20:23], a[44:47]
    v_exp_f32 v170, v170
    v_mfma_f32_16x16x32_bf16 a[76:79], a[184:187], v[36:39], a[76:79]
    ds_read_b128 a[172:175], v208 offset:57344
    buffer_load_dwordx4 v219, s[12:15], s27 offen offset:2048 nt lds
    v_add_f32 v202, v170, v202
    v_mfma_f32_16x16x32_bf16 a[76:79], a[188:191], v[44:47], a[76:79]
    v_exp_f32 v171, v171
    v_mfma_f32_16x16x32_bf16 a[108:111], a[188:191], v[60:63], a[108:111]
    v_add_f32 v202, v171, v202
    v_cvt_pk_bf16_f32 v119, v170, v171
    v_mfma_f32_16x16x32_bf16 a[108:111], a[184:187], v[52:55], a[108:111]
    s_waitcnt lgkmcnt(3)
    v_exp_f32 v172, v172
    v_mfma_f32_16x16x32_bf16 v[160:163], a[160:163], v[0:3], v[180:183]
    s_waitcnt lgkmcnt(2)
    ds_read_b64_tr_b16 a[176:177], v213 offset:32768
    buffer_load_dwordx4 v220, s[12:15], s27 offen offset:3072 nt lds
    v_add_f32 v203, v172, v203
    v_mfma_f32_16x16x32_bf16 v[160:163], a[164:167], v[8:11], v[160:163]
    s_waitcnt lgkmcnt(2)
    v_exp_f32 v173, v173
    v_mfma_f32_16x16x32_bf16 v[160:163], a[168:171], v[16:19], v[160:163]
    s_waitcnt lgkmcnt(1)
    s_mov_b32 m0, 65536
    ds_read_b64_tr_b16 a[178:179], v213 offset:36864
    v_add_f32 v203, v173, v203
    v_cvt_pk_bf16_f32 v134, v172, v173
    v_mfma_f32_16x16x32_bf16 v[160:163], a[172:175], v[24:27], v[160:163]
    s_and_b32 s27, s3, 0x3ffff
    buffer_load_dwordx4 v221, s[16:19], s27 offen nt lds
    v_exp_f32 v174, v174
    v_mfma_f32_16x16x32_bf16 v[164:167], a[172:175], v[56:59], v[184:187]
    ds_read_b64_tr_b16 a[180:181], v213 offset:40960
    v_add_f32 v203, v174, v203
    v_mfma_f32_16x16x32_bf16 v[164:167], a[168:171], v[48:51], v[164:167]
    v_exp_f32 v175, v175
    v_mfma_f32_16x16x32_bf16 v[164:167], a[164:167], v[40:43], v[164:167]
    v_add_f32 v203, v175, v203
    v_cvt_pk_bf16_f32 v135, v174, v175
    v_mfma_f32_16x16x32_bf16 v[164:167], a[160:163], v[32:35], v[164:167]
    s_add_u32 s3, s3, 4096
    buffer_load_dwordx4 v222, s[16:19], s27 offen offset:1024 nt lds
    v_exp_f32 v160, v160
    v_mfma_f32_16x16x32_bf16 v[168:171], a[160:163], v[64:67], v[188:191]
    ds_read_b64_tr_b16 a[182:183], v213 offset:45056
    v_add_f32 v200, v160, v200
    v_mfma_f32_16x16x32_bf16 v[168:171], a[164:167], v[72:75], v[168:171]
    v_exp_f32 v161, v161
    v_mfma_f32_16x16x32_bf16 v[168:171], a[168:171], v[80:83], v[168:171]
    ds_read_b64_tr_b16 a[184:185], v214 offset:32768
    v_add_f32 v200, v161, v200
    v_cvt_pk_bf16_f32 v92, v160, v161
    v_mfma_f32_16x16x32_bf16 v[168:171], a[172:175], v[88:91], v[168:171]
    buffer_load_dwordx4 v221, s[16:19], s27 offen offset:2048 nt lds
    v_exp_f32 v162, v162
    v_mfma_f32_16x16x32_bf16 v[172:175], a[172:175], v[120:123], v[192:195]
    ds_read_b64_tr_b16 a[186:187], v214 offset:36864
    v_add_f32 v200, v162, v200
    v_mfma_f32_16x16x32_bf16 v[172:175], a[168:171], v[112:115], v[172:175]
    v_exp_f32 v163, v163
    v_mfma_f32_16x16x32_bf16 v[172:175], a[164:167], v[104:107], v[172:175]
    ds_read_b64_tr_b16 a[188:189], v214 offset:40960
    v_add_f32 v200, v163, v200
    v_cvt_pk_bf16_f32 v93, v162, v163
    v_mfma_f32_16x16x32_bf16 v[172:175], a[160:163], v[96:99], v[172:175]
    s_waitcnt lgkmcnt(5)
    buffer_load_dwordx4 v222, s[16:19], s27 offen offset:3072 nt lds
    v_exp_f32 v164, v164
    v_mfma_f32_16x16x32_bf16 a[16:19], a[176:179], v[4:7], a[16:19]
    s_waitcnt lgkmcnt(3)
    ds_read_b64_tr_b16 a[190:191], v214 offset:45056
    v_add_f32 v201, v164, v201
    v_mfma_f32_16x16x32_bf16 a[16:19], a[180:183], v[12:15], a[16:19]
    v_exp_f32 v165, v165
    v_mfma_f32_16x16x32_bf16 a[48:51], a[180:183], v[28:31], a[48:51]
    s_mov_b32 m0, 69632
    v_add_f32 v201, v165, v201
    v_cvt_pk_bf16_f32 v108, v164, v165
    v_mfma_f32_16x16x32_bf16 a[48:51], a[176:179], v[20:23], a[48:51]
    s_and_b32 s27, s3, 0x3ffff
    buffer_load_dwordx4 v221, s[16:19], s27 offen nt lds
    v_exp_f32 v166, v166
    v_mfma_f32_16x16x32_bf16 a[80:83], a[176:179], v[36:39], a[80:83]
    ds_read_b128 a[160:163], v205 offset:61440
    v_add_f32 v201, v166, v201
    v_mfma_f32_16x16x32_bf16 a[80:83], a[180:183], v[44:47], a[80:83]
    v_exp_f32 v167, v167
    v_mfma_f32_16x16x32_bf16 a[112:115], a[180:183], v[60:63], a[112:115]
    s_add_u32 s3, s3, 4096
    ds_read_b128 a[164:167], v206 offset:61440
    buffer_load_dwordx4 v222, s[16:19], s27 offen offset:1024 nt lds
    v_add_f32 v201, v167, v201
    v_cvt_pk_bf16_f32 v109, v166, v167
    v_mfma_f32_16x16x32_bf16 a[112:115], a[176:179], v[52:55], a[112:115]
    s_waitcnt lgkmcnt(4)
    v_exp_f32 v168, v168
    v_mfma_f32_16x16x32_bf16 a[20:23], a[184:187], v[4:7], a[20:23]
    s_waitcnt lgkmcnt(2)
    ds_read_b128 a[168:171], v207 offset:61440
    v_add_f32 v202, v168, v202
    v_mfma_f32_16x16x32_bf16 a[20:23], a[188:191], v[12:15], a[20:23]
    v_exp_f32 v169, v169
    v_mfma_f32_16x16x32_bf16 a[52:55], a[188:191], v[28:31], a[52:55]
    buffer_load_dwordx4 v221, s[16:19], s27 offen offset:2048 nt lds
    v_add_f32 v202, v169, v202
    v_cvt_pk_bf16_f32 v124, v168, v169
    v_mfma_f32_16x16x32_bf16 a[52:55], a[184:187], v[20:23], a[52:55]
    v_exp_f32 v170, v170
    v_mfma_f32_16x16x32_bf16 a[84:87], a[184:187], v[36:39], a[84:87]
    ds_read_b128 a[172:175], v208 offset:61440
    v_add_f32 v202, v170, v202
    v_mfma_f32_16x16x32_bf16 a[84:87], a[188:191], v[44:47], a[84:87]
    v_exp_f32 v171, v171
    v_mfma_f32_16x16x32_bf16 a[116:119], a[188:191], v[60:63], a[116:119]
    buffer_load_dwordx4 v222, s[16:19], s27 offen offset:3072 nt lds
    v_add_f32 v202, v171, v202
    v_cvt_pk_bf16_f32 v125, v170, v171
    v_mfma_f32_16x16x32_bf16 a[116:119], a[184:187], v[52:55], a[116:119]
    s_waitcnt lgkmcnt(3)
    v_exp_f32 v172, v172
    v_mfma_f32_16x16x32_bf16 v[160:163], a[160:163], v[0:3], v[180:183]
    s_waitcnt lgkmcnt(2)
    ds_read_b64_tr_b16 a[176:177], v215 offset:32768
    v_add_f32 v203, v172, v203
    v_mfma_f32_16x16x32_bf16 v[160:163], a[164:167], v[8:11], v[160:163]
    s_waitcnt lgkmcnt(2)
    s_mov_b32 m0, 73728
    v_exp_f32 v173, v173
    v_mfma_f32_16x16x32_bf16 v[160:163], a[168:171], v[16:19], v[160:163]
    s_waitcnt lgkmcnt(1)
    s_and_b32 s27, s3, 0x3ffff
    ds_read_b64_tr_b16 a[178:179], v215 offset:36864
    buffer_load_dwordx4 v221, s[16:19], s27 offen nt lds
    v_add_f32 v203, v173, v203
    v_cvt_pk_bf16_f32 v140, v172, v173
    v_mfma_f32_16x16x32_bf16 v[160:163], a[172:175], v[24:27], v[160:163]
    v_exp_f32 v174, v174
    v_mfma_f32_16x16x32_bf16 v[164:167], a[172:175], v[56:59], v[184:187]
    ds_read_b64_tr_b16 a[180:181], v215 offset:40960
    v_add_f32 v203, v174, v203
    v_mfma_f32_16x16x32_bf16 v[164:167], a[168:171], v[48:51], v[164:167]
    v_exp_f32 v175, v175
    v_mfma_f32_16x16x32_bf16 v[164:167], a[164:167], v[40:43], v[164:167]
    s_add_u32 s3, s3, 4096
    buffer_load_dwordx4 v222, s[16:19], s27 offen offset:1024 nt lds
    v_add_f32 v203, v175, v203
    v_cvt_pk_bf16_f32 v141, v174, v175
    v_mfma_f32_16x16x32_bf16 v[164:167], a[160:163], v[32:35], v[164:167]
    v_exp_f32 v160, v160
    v_mfma_f32_16x16x32_bf16 v[168:171], a[160:163], v[64:67], v[188:191]
    ds_read_b64_tr_b16 a[182:183], v215 offset:45056
    v_add_f32 v200, v160, v200
    v_mfma_f32_16x16x32_bf16 v[168:171], a[164:167], v[72:75], v[168:171]
    buffer_load_dwordx4 v221, s[16:19], s27 offen offset:2048 nt lds
    v_exp_f32 v161, v161
    v_mfma_f32_16x16x32_bf16 v[168:171], a[168:171], v[80:83], v[168:171]
    ds_read_b64_tr_b16 a[184:185], v216 offset:32768
    v_add_f32 v200, v161, v200
    v_cvt_pk_bf16_f32 v94, v160, v161
    v_mfma_f32_16x16x32_bf16 v[168:171], a[172:175], v[88:91], v[168:171]
    v_exp_f32 v162, v162
    v_mfma_f32_16x16x32_bf16 v[172:175], a[172:175], v[120:123], v[192:195]
    ds_read_b64_tr_b16 a[186:187], v216 offset:36864
    v_add_f32 v200, v162, v200
    v_mfma_f32_16x16x32_bf16 v[172:175], a[168:171], v[112:115], v[172:175]
    buffer_load_dwordx4 v222, s[16:19], s27 offen offset:3072 nt lds
    v_exp_f32 v163, v163
    v_mfma_f32_16x16x32_bf16 v[172:175], a[164:167], v[104:107], v[172:175]
    ds_read_b64_tr_b16 a[188:189], v216 offset:40960
    v_add_f32 v200, v163, v200
    v_cvt_pk_bf16_f32 v95, v162, v163
    v_mfma_f32_16x16x32_bf16 v[172:175], a[160:163], v[96:99], v[172:175]
    s_waitcnt lgkmcnt(5)
    v_exp_f32 v164, v164
    v_mfma_f32_16x16x32_bf16 a[24:27], a[176:179], v[4:7], a[24:27]
    s_waitcnt lgkmcnt(3)
    s_mov_b32 m0, 77824
    ds_read_b64_tr_b16 a[190:191], v216 offset:45056
    v_add_f32 v201, v164, v201
    v_mfma_f32_16x16x32_bf16 a[24:27], a[180:183], v[12:15], a[24:27]
    s_and_b32 s27, s3, 0x3ffff
    buffer_load_dwordx4 v221, s[16:19], s27 offen nt lds
    v_exp_f32 v165, v165
    v_mfma_f32_16x16x32_bf16 a[56:59], a[180:183], v[28:31], a[56:59]
    v_add_f32 v201, v165, v201
    v_cvt_pk_bf16_f32 v110, v164, v165
    v_mfma_f32_16x16x32_bf16 a[56:59], a[176:179], v[20:23], a[56:59]
    v_exp_f32 v166, v166
    v_mfma_f32_16x16x32_bf16 a[88:91], a[176:179], v[36:39], a[88:91]
    v_add_f32 v201, v166, v201
    v_mfma_f32_16x16x32_bf16 a[88:91], a[180:183], v[44:47], a[88:91]
    s_waitcnt vmcnt(30) lgkmcnt(0)
    v_exp_f32 v167, v167
    v_mfma_f32_16x16x32_bf16 a[120:123], a[180:183], v[60:63], a[120:123]
    s_barrier
    v_add_f32 v201, v167, v201
    v_cvt_pk_bf16_f32 v111, v166, v167
    v_mfma_f32_16x16x32_bf16 a[120:123], a[176:179], v[52:55], a[120:123]
    s_add_u32 s3, s3, 4096
    ds_read_b128 a[160:163], v205 offset:0
    buffer_load_dwordx4 v222, s[16:19], s27 offen offset:1024 nt lds
    v_exp_f32 v168, v168
    v_mfma_f32_16x16x32_bf16 a[28:31], a[184:187], v[4:7], a[28:31]
    ds_read_b128 a[164:167], v206 offset:0
    v_add_f32 v202, v168, v202
    v_mfma_f32_16x16x32_bf16 a[28:31], a[188:191], v[12:15], a[28:31]
    buffer_load_dwordx4 v221, s[16:19], s27 offen offset:2048 nt lds
    v_exp_f32 v169, v169
    v_mfma_f32_16x16x32_bf16 a[60:63], a[188:191], v[28:31], a[60:63]
    ds_read_b128 a[168:171], v207 offset:0
    v_add_f32 v202, v169, v202
    v_cvt_pk_bf16_f32 v126, v168, v169
    v_mfma_f32_16x16x32_bf16 a[60:63], a[184:187], v[20:23], a[60:63]
    v_exp_f32 v170, v170
    v_mfma_f32_16x16x32_bf16 a[92:95], a[184:187], v[36:39], a[92:95]
    ds_read_b128 a[172:175], v208 offset:0
    v_add_f32 v202, v170, v202
    v_mfma_f32_16x16x32_bf16 a[92:95], a[188:191], v[44:47], a[92:95]
    buffer_load_dwordx4 v222, s[16:19], s27 offen offset:3072 nt lds
    v_exp_f32 v171, v171
    v_mfma_f32_16x16x32_bf16 a[124:127], a[188:191], v[60:63], a[124:127]
    v_add_f32 v202, v171, v202
    v_cvt_pk_bf16_f32 v127, v170, v171
    v_mfma_f32_16x16x32_bf16 a[124:127], a[184:187], v[52:55], a[124:127]
    s_waitcnt lgkmcnt(3)
    s_mov_b32 s33, 0x1000
    v_exp_f32 v172, v172
    v_mfma_f32_16x16x32_bf16 v[160:163], a[160:163], v[0:3], v[180:183]
    s_waitcnt lgkmcnt(2)
    ds_read_b64_tr_b16 a[176:177], v209 offset:49152
    v_add_f32 v203, v172, v203
    v_mfma_f32_16x16x32_bf16 v[160:163], a[164:167], v[8:11], v[160:163]
    s_waitcnt lgkmcnt(2)
    v_exp_f32 v173, v173
    v_mfma_f32_16x16x32_bf16 v[160:163], a[168:171], v[16:19], v[160:163]
    s_waitcnt lgkmcnt(1)
    ds_read_b64_tr_b16 a[178:179], v209 offset:53248
    v_add_f32 v203, v173, v203
    v_cvt_pk_bf16_f32 v142, v172, v173
    v_mfma_f32_16x16x32_bf16 v[160:163], a[172:175], v[24:27], v[160:163]
    buffer_load_dword v252, v236, s[4:7], s35 offen
    v_exp_f32 v174, v174
    v_mfma_f32_16x16x32_bf16 v[164:167], a[172:175], v[56:59], v[184:187]
    ds_read_b64_tr_b16 a[180:181], v209 offset:57344
    v_add_f32 v203, v174, v203
    v_mfma_f32_16x16x32_bf16 v[164:167], a[168:171], v[48:51], v[164:167]
    s_mov_b32 m0, 32768
    v_exp_f32 v175, v175
    v_mfma_f32_16x16x32_bf16 v[164:167], a[164:167], v[40:43], v[164:167]
    s_and_b32 s27, s30, 0x3ffff
    buffer_load_dwordx4 v217, s[12:15], s27 offen nt lds
    v_add_f32 v203, v175, v203
    v_cvt_pk_bf16_f32 v143, v174, v175
    v_mfma_f32_16x16x32_bf16 v[164:167], a[160:163], v[32:35], v[164:167]
    v_exp_f32 v160, v160
    v_mfma_f32_16x16x32_bf16 v[168:171], a[160:163], v[64:67], v[188:191]
    ds_read_b64_tr_b16 a[182:183], v209 offset:61440
    v_add_f32 v200, v160, v200
    v_mfma_f32_16x16x32_bf16 v[168:171], a[164:167], v[72:75], v[168:171]
    v_exp_f32 v161, v161
    v_mfma_f32_16x16x32_bf16 v[168:171], a[168:171], v[80:83], v[168:171]
    s_add_u32 s30, s30, 4096
    ds_read_b64_tr_b16 a[184:185], v210 offset:49152
    buffer_load_dwordx4 v218, s[12:15], s27 offen offset:1024 nt lds
    v_add_f32 v200, v161, v200
    v_cvt_pk_bf16_f32 v4, v160, v161
    v_mfma_f32_16x16x32_bf16 v[168:171], a[172:175], v[88:91], v[168:171]
    v_exp_f32 v162, v162
    v_mfma_f32_16x16x32_bf16 v[172:175], a[172:175], v[120:123], v[192:195]
    ds_read_b64_tr_b16 a[186:187], v210 offset:53248
    v_add_f32 v200, v162, v200
    v_mfma_f32_16x16x32_bf16 v[172:175], a[168:171], v[112:115], v[172:175]
    v_exp_f32 v163, v163
    v_mfma_f32_16x16x32_bf16 v[172:175], a[164:167], v[104:107], v[172:175]
    ds_read_b64_tr_b16 a[188:189], v210 offset:57344
    buffer_load_dwordx4 v219, s[12:15], s27 offen offset:2048 nt lds
    v_add_f32 v200, v163, v200
    v_cvt_pk_bf16_f32 v5, v162, v163
    v_mfma_f32_16x16x32_bf16 v[172:175], a[160:163], v[96:99], v[172:175]
    s_waitcnt lgkmcnt(5)
    v_exp_f32 v164, v164
    v_mfma_f32_16x16x32_bf16 a[0:3], a[176:179], v[84:87], a[0:3]
    s_waitcnt lgkmcnt(3)
    ds_read_b64_tr_b16 a[190:191], v210 offset:61440
    v_add_f32 v201, v164, v201
    v_mfma_f32_16x16x32_bf16 a[0:3], a[180:183], v[92:95], a[0:3]
    v_exp_f32 v165, v165
    v_mfma_f32_16x16x32_bf16 a[32:35], a[180:183], v[108:111], a[32:35]
    buffer_load_dwordx4 v220, s[12:15], s27 offen offset:3072 nt lds
    v_add_f32 v201, v165, v201
    v_cvt_pk_bf16_f32 v20, v164, v165
    v_mfma_f32_16x16x32_bf16 a[32:35], a[176:179], v[100:103], a[32:35]
    v_exp_f32 v166, v166
    v_mfma_f32_16x16x32_bf16 a[64:67], a[176:179], v[116:119], a[64:67]
    ds_read_b128 a[160:163], v205 offset:4096
    v_add_f32 v201, v166, v201
    v_mfma_f32_16x16x32_bf16 a[64:67], a[180:183], v[124:127], a[64:67]
    s_mov_b32 m0, 36864
    v_exp_f32 v167, v167
    v_mfma_f32_16x16x32_bf16 a[96:99], a[180:183], v[140:143], a[96:99]
    s_and_b32 s27, s30, 0x3ffff
    ds_read_b128 a[164:167], v206 offset:4096
    buffer_load_dwordx4 v217, s[12:15], s27 offen nt lds
    v_add_f32 v201, v167, v201
    v_cvt_pk_bf16_f32 v21, v166, v167
    v_mfma_f32_16x16x32_bf16 a[96:99], a[176:179], v[132:135], a[96:99]
    s_waitcnt lgkmcnt(4)
    v_exp_f32 v168, v168
    v_mfma_f32_16x16x32_bf16 a[4:7], a[184:187], v[84:87], a[4:7]
    s_waitcnt lgkmcnt(2)
    ds_read_b128 a[168:171], v207 offset:4096
    v_add_f32 v202, v168, v202
    v_mfma_f32_16x16x32_bf16 a[4:7], a[188:191], v[92:95], a[4:7]
    s_add_u32 s30, s30, 4096
    buffer_load_dwordx4 v218, s[12:15], s27 offen offset:1024 nt lds
    v_exp_f32 v169, v169
    v_mfma_f32_16x16x32_bf16 a[36:39], a[188:191], v[108:111], a[36:39]
    v_add_f32 v202, v169, v202
    v_cvt_pk_bf16_f32 v36, v168, v169
    v_mfma_f32_16x16x32_bf16 a[36:39], a[184:187], v[100:103], a[36:39]
    v_exp_f32 v170, v170
    v_mfma_f32_16x16x32_bf16 a[68:71], a[184:187], v[116:119], a[68:71]
    ds_read_b128 a[172:175], v208 offset:4096
    v_add_f32 v202, v170, v202
    v_mfma_f32_16x16x32_bf16 a[68:71], a[188:191], v[124:127], a[68:71]
    buffer_load_dwordx4 v219, s[12:15], s27 offen offset:2048 nt lds
    v_exp_f32 v171, v171
    v_mfma_f32_16x16x32_bf16 a[100:103], a[188:191], v[140:143], a[100:103]
    v_add_f32 v202, v171, v202
    v_cvt_pk_bf16_f32 v37, v170, v171
    v_mfma_f32_16x16x32_bf16 a[100:103], a[184:187], v[132:135], a[100:103]
    s_waitcnt lgkmcnt(3)
    v_exp_f32 v172, v172
    v_mfma_f32_16x16x32_bf16 v[160:163], a[160:163], v[0:3], v[180:183]
    s_waitcnt lgkmcnt(2)
    ds_read_b64_tr_b16 a[176:177], v211 offset:49152
    v_add_f32 v203, v172, v203
    v_mfma_f32_16x16x32_bf16 v[160:163], a[164:167], v[8:11], v[160:163]
    s_waitcnt lgkmcnt(2)
    buffer_load_dwordx4 v220, s[12:15], s27 offen offset:3072 nt lds
    v_exp_f32 v173, v173
    v_mfma_f32_16x16x32_bf16 v[160:163], a[168:171], v[16:19], v[160:163]
    s_waitcnt lgkmcnt(1)
    ds_read_b64_tr_b16 a[178:179], v211 offset:53248
    v_add_f32 v203, v173, v203
    v_cvt_pk_bf16_f32 v52, v172, v173
    v_mfma_f32_16x16x32_bf16 v[160:163], a[172:175], v[24:27], v[160:163]
    v_exp_f32 v174, v174
    v_mfma_f32_16x16x32_bf16 v[164:167], a[172:175], v[56:59], v[184:187]
    s_mov_b32 m0, 40960
    ds_read_b64_tr_b16 a[180:181], v211 offset:57344
    v_add_f32 v203, v174, v203
    v_mfma_f32_16x16x32_bf16 v[164:167], a[168:171], v[48:51], v[164:167]
    s_and_b32 s27, s30, 0x3ffff
    buffer_load_dwordx4 v217, s[12:15], s27 offen nt lds
    v_exp_f32 v175, v175
    v_mfma_f32_16x16x32_bf16 v[164:167], a[164:167], v[40:43], v[164:167]
    v_add_f32 v203, v175, v203
    v_cvt_pk_bf16_f32 v53, v174, v175
    v_mfma_f32_16x16x32_bf16 v[164:167], a[160:163], v[32:35], v[164:167]
    v_exp_f32 v160, v160
    v_mfma_f32_16x16x32_bf16 v[168:171], a[160:163], v[64:67], v[188:191]
    ds_read_b64_tr_b16 a[182:183], v211 offset:61440
    v_add_f32 v200, v160, v200
    v_mfma_f32_16x16x32_bf16 v[168:171], a[164:167], v[72:75], v[168:171]
    s_add_u32 s30, s30, 4096
    buffer_load_dwordx4 v218, s[12:15], s27 offen offset:1024 nt lds
    v_exp_f32 v161, v161
    v_mfma_f32_16x16x32_bf16 v[168:171], a[168:171], v[80:83], v[168:171]
    ds_read_b64_tr_b16 a[184:185], v212 offset:49152
    v_add_f32 v200, v161, v200
    v_cvt_pk_bf16_f32 v6, v160, v161
    v_mfma_f32_16x16x32_bf16 v[168:171], a[172:175], v[88:91], v[168:171]
    v_exp_f32 v162, v162
    v_mfma_f32_16x16x32_bf16 v[172:175], a[172:175], v[120:123], v[192:195]
    ds_read_b64_tr_b16 a[186:187], v212 offset:53248
    buffer_load_dwordx4 v219, s[12:15], s27 offen offset:2048 nt lds
    v_add_f32 v200, v162, v200
    v_mfma_f32_16x16x32_bf16 v[172:175], a[168:171], v[112:115], v[172:175]
    v_exp_f32 v163, v163
    v_mfma_f32_16x16x32_bf16 v[172:175], a[164:167], v[104:107], v[172:175]
    ds_read_b64_tr_b16 a[188:189], v212 offset:57344
    v_add_f32 v200, v163, v200
    v_cvt_pk_bf16_f32 v7, v162, v163
    v_mfma_f32_16x16x32_bf16 v[172:175], a[160:163], v[96:99], v[172:175]
    s_waitcnt lgkmcnt(5)
    v_exp_f32 v164, v164
    v_mfma_f32_16x16x32_bf16 a[8:11], a[176:179], v[84:87], a[8:11]
    s_waitcnt lgkmcnt(3)
    ds_read_b64_tr_b16 a[190:191], v212 offset:61440
    buffer_load_dwordx4 v220, s[12:15], s27 offen offset:3072 nt lds
    v_add_f32 v201, v164, v201
    v_mfma_f32_16x16x32_bf16 a[8:11], a[180:183], v[92:95], a[8:11]
    v_exp_f32 v165, v165
    v_mfma_f32_16x16x32_bf16 a[40:43], a[180:183], v[108:111], a[40:43]
    v_add_f32 v201, v165, v201
    v_cvt_pk_bf16_f32 v22, v164, v165
    v_mfma_f32_16x16x32_bf16 a[40:43], a[176:179], v[100:103], a[40:43]
    s_mov_b32 m0, 45056
    v_exp_f32 v166, v166
    v_mfma_f32_16x16x32_bf16 a[72:75], a[176:179], v[116:119], a[72:75]
    s_and_b32 s27, s30, 0x3ffff
    ds_read_b128 a[160:163], v205 offset:8192
    buffer_load_dwordx4 v217, s[12:15], s27 offen nt lds
    v_add_f32 v201, v166, v201
    v_mfma_f32_16x16x32_bf16 a[72:75], a[180:183], v[124:127], a[72:75]
    v_exp_f32 v167, v167
    v_mfma_f32_16x16x32_bf16 a[104:107], a[180:183], v[140:143], a[104:107]
    ds_read_b128 a[164:167], v206 offset:8192
    v_add_f32 v201, v167, v201
    v_cvt_pk_bf16_f32 v23, v166, v167
    v_mfma_f32_16x16x32_bf16 a[104:107], a[176:179], v[132:135], a[104:107]
    s_waitcnt lgkmcnt(4)
    v_exp_f32 v168, v168
    v_mfma_f32_16x16x32_bf16 a[12:15], a[184:187], v[84:87], a[12:15]
    s_waitcnt lgkmcnt(2)
    s_add_u32 s30, s30, 4096
    ds_read_b128 a[168:171], v207 offset:8192
    buffer_load_dwordx4 v218, s[12:15], s27 offen offset:1024 nt lds
    v_add_f32 v202, v168, v202
    v_mfma_f32_16x16x32_bf16 a[12:15], a[188:191], v[92:95], a[12:15]
    v_exp_f32 v169, v169
    v_mfma_f32_16x16x32_bf16 a[44:47], a[188:191], v[108:111], a[44:47]
    v_add_f32 v202, v169, v202
    v_cvt_pk_bf16_f32 v38, v168, v169
    v_mfma_f32_16x16x32_bf16 a[44:47], a[184:187], v[100:103], a[44:47]
    v_exp_f32 v170, v170
    v_mfma_f32_16x16x32_bf16 a[76:79], a[184:187], v[116:119], a[76:79]
    ds_read_b128 a[172:175], v208 offset:8192
    buffer_load_dwordx4 v219, s[12:15], s27 offen offset:2048 nt lds
    v_add_f32 v202, v170, v202
    v_mfma_f32_16x16x32_bf16 a[76:79], a[188:191], v[124:127], a[76:79]
    v_exp_f32 v171, v171
    v_mfma_f32_16x16x32_bf16 a[108:111], a[188:191], v[140:143], a[108:111]
    v_add_f32 v202, v171, v202
    v_cvt_pk_bf16_f32 v39, v170, v171
    v_mfma_f32_16x16x32_bf16 a[108:111], a[184:187], v[132:135], a[108:111]
    s_waitcnt lgkmcnt(3)
    v_exp_f32 v172, v172
    v_mfma_f32_16x16x32_bf16 v[160:163], a[160:163], v[0:3], v[180:183]
    s_waitcnt lgkmcnt(2)
    ds_read_b64_tr_b16 a[176:177], v213 offset:49152
    buffer_load_dwordx4 v220, s[12:15], s27 offen offset:3072 nt lds
    v_add_f32 v203, v172, v203
    v_mfma_f32_16x16x32_bf16 v[160:163], a[164:167], v[8:11], v[160:163]
    s_waitcnt lgkmcnt(2)
    v_exp_f32 v173, v173
    v_mfma_f32_16x16x32_bf16 v[160:163], a[168:171], v[16:19], v[160:163]
    s_waitcnt lgkmcnt(1)
    s_mov_b32 m0, 81920
    ds_read_b64_tr_b16 a[178:179], v213 offset:53248
    v_add_f32 v203, v173, v203
    v_cvt_pk_bf16_f32 v54, v172, v173
    v_mfma_f32_16x16x32_bf16 v[160:163], a[172:175], v[24:27], v[160:163]
    s_and_b32 s27, s3, 0x3ffff
    buffer_load_dwordx4 v221, s[16:19], s27 offen nt lds
    v_exp_f32 v174, v174
    v_mfma_f32_16x16x32_bf16 v[164:167], a[172:175], v[56:59], v[184:187]
    ds_read_b64_tr_b16 a[180:181], v213 offset:57344
    v_add_f32 v203, v174, v203
    v_mfma_f32_16x16x32_bf16 v[164:167], a[168:171], v[48:51], v[164:167]
    v_exp_f32 v175, v175
    v_mfma_f32_16x16x32_bf16 v[164:167], a[164:167], v[40:43], v[164:167]
    v_add_f32 v203, v175, v203
    v_cvt_pk_bf16_f32 v55, v174, v175
    v_mfma_f32_16x16x32_bf16 v[164:167], a[160:163], v[32:35], v[164:167]
    s_add_u32 s3, s3, 4096
    buffer_load_dwordx4 v222, s[16:19], s27 offen offset:1024 nt lds
    v_exp_f32 v160, v160
    v_mfma_f32_16x16x32_bf16 v[168:171], a[160:163], v[64:67], v[188:191]
    ds_read_b64_tr_b16 a[182:183], v213 offset:61440
    v_add_f32 v200, v160, v200
    v_mfma_f32_16x16x32_bf16 v[168:171], a[164:167], v[72:75], v[168:171]
    v_exp_f32 v161, v161
    v_mfma_f32_16x16x32_bf16 v[168:171], a[168:171], v[80:83], v[168:171]
    ds_read_b64_tr_b16 a[184:185], v214 offset:49152
    v_add_f32 v200, v161, v200
    v_cvt_pk_bf16_f32 v12, v160, v161
    v_mfma_f32_16x16x32_bf16 v[168:171], a[172:175], v[88:91], v[168:171]
    buffer_load_dwordx4 v221, s[16:19], s27 offen offset:2048 nt lds
    v_exp_f32 v162, v162
    v_mfma_f32_16x16x32_bf16 v[172:175], a[172:175], v[120:123], v[192:195]
    ds_read_b64_tr_b16 a[186:187], v214 offset:53248
    v_add_f32 v200, v162, v200
    v_mfma_f32_16x16x32_bf16 v[172:175], a[168:171], v[112:115], v[172:175]
    v_exp_f32 v163, v163
    v_mfma_f32_16x16x32_bf16 v[172:175], a[164:167], v[104:107], v[172:175]
    ds_read_b64_tr_b16 a[188:189], v214 offset:57344
    v_add_f32 v200, v163, v200
    v_cvt_pk_bf16_f32 v13, v162, v163
    v_mfma_f32_16x16x32_bf16 v[172:175], a[160:163], v[96:99], v[172:175]
    s_waitcnt lgkmcnt(5)
    buffer_load_dwordx4 v222, s[16:19], s27 offen offset:3072 nt lds
    v_exp_f32 v164, v164
    v_mfma_f32_16x16x32_bf16 a[16:19], a[176:179], v[84:87], a[16:19]
    s_waitcnt lgkmcnt(3)
    ds_read_b64_tr_b16 a[190:191], v214 offset:61440
    v_add_f32 v201, v164, v201
    v_mfma_f32_16x16x32_bf16 a[16:19], a[180:183], v[92:95], a[16:19]
    v_exp_f32 v165, v165
    v_mfma_f32_16x16x32_bf16 a[48:51], a[180:183], v[108:111], a[48:51]
    s_mov_b32 m0, 86016
    v_add_f32 v201, v165, v201
    v_cvt_pk_bf16_f32 v28, v164, v165
    v_mfma_f32_16x16x32_bf16 a[48:51], a[176:179], v[100:103], a[48:51]
    s_and_b32 s27, s3, 0x3ffff
    buffer_load_dwordx4 v221, s[16:19], s27 offen nt lds
    v_exp_f32 v166, v166
    v_mfma_f32_16x16x32_bf16 a[80:83], a[176:179], v[116:119], a[80:83]
    ds_read_b128 a[160:163], v205 offset:12288
    v_add_f32 v201, v166, v201
    v_mfma_f32_16x16x32_bf16 a[80:83], a[180:183], v[124:127], a[80:83]
    v_exp_f32 v167, v167
    v_mfma_f32_16x16x32_bf16 a[112:115], a[180:183], v[140:143], a[112:115]
    s_add_u32 s3, s3, 4096
    ds_read_b128 a[164:167], v206 offset:12288
    buffer_load_dwordx4 v222, s[16:19], s27 offen offset:1024 nt lds
    v_add_f32 v201, v167, v201
    v_cvt_pk_bf16_f32 v29, v166, v167
    v_mfma_f32_16x16x32_bf16 a[112:115], a[176:179], v[132:135], a[112:115]
    s_waitcnt lgkmcnt(4)
    v_exp_f32 v168, v168
    v_mfma_f32_16x16x32_bf16 a[20:23], a[184:187], v[84:87], a[20:23]
    s_waitcnt lgkmcnt(2)
    ds_read_b128 a[168:171], v207 offset:12288
    v_add_f32 v202, v168, v202
    v_mfma_f32_16x16x32_bf16 a[20:23], a[188:191], v[92:95], a[20:23]
    v_exp_f32 v169, v169
    v_mfma_f32_16x16x32_bf16 a[52:55], a[188:191], v[108:111], a[52:55]
    buffer_load_dwordx4 v221, s[16:19], s27 offen offset:2048 nt lds
    v_add_f32 v202, v169, v202
    v_cvt_pk_bf16_f32 v44, v168, v169
    v_mfma_f32_16x16x32_bf16 a[52:55], a[184:187], v[100:103], a[52:55]
    v_exp_f32 v170, v170
    v_mfma_f32_16x16x32_bf16 a[84:87], a[184:187], v[116:119], a[84:87]
    ds_read_b128 a[172:175], v208 offset:12288
    v_add_f32 v202, v170, v202
    v_mfma_f32_16x16x32_bf16 a[84:87], a[188:191], v[124:127], a[84:87]
    v_exp_f32 v171, v171
    v_mfma_f32_16x16x32_bf16 a[116:119], a[188:191], v[140:143], a[116:119]
    buffer_load_dwordx4 v222, s[16:19], s27 offen offset:3072 nt lds
    v_add_f32 v202, v171, v202
    v_cvt_pk_bf16_f32 v45, v170, v171
    v_mfma_f32_16x16x32_bf16 a[116:119], a[184:187], v[132:135], a[116:119]
    s_waitcnt lgkmcnt(3)
    v_exp_f32 v172, v172
    v_mfma_f32_16x16x32_bf16 v[160:163], a[160:163], v[0:3], v[180:183]
    s_waitcnt lgkmcnt(2)
    ds_read_b64_tr_b16 a[176:177], v215 offset:49152
    v_add_f32 v203, v172, v203
    v_mfma_f32_16x16x32_bf16 v[160:163], a[164:167], v[8:11], v[160:163]
    s_waitcnt lgkmcnt(2)
    s_mov_b32 m0, 90112
    v_exp_f32 v173, v173
    v_mfma_f32_16x16x32_bf16 v[160:163], a[168:171], v[16:19], v[160:163]
    s_waitcnt lgkmcnt(1)
    s_and_b32 s27, s3, 0x3ffff
    ds_read_b64_tr_b16 a[178:179], v215 offset:53248
    buffer_load_dwordx4 v221, s[16:19], s27 offen nt lds
    v_add_f32 v203, v173, v203
    v_cvt_pk_bf16_f32 v60, v172, v173
    v_mfma_f32_16x16x32_bf16 v[160:163], a[172:175], v[24:27], v[160:163]
    v_exp_f32 v174, v174
    v_mfma_f32_16x16x32_bf16 v[164:167], a[172:175], v[56:59], v[184:187]
    ds_read_b64_tr_b16 a[180:181], v215 offset:57344
    v_add_f32 v203, v174, v203
    v_mfma_f32_16x16x32_bf16 v[164:167], a[168:171], v[48:51], v[164:167]
    v_exp_f32 v175, v175
    v_mfma_f32_16x16x32_bf16 v[164:167], a[164:167], v[40:43], v[164:167]
    s_add_u32 s3, s3, 4096
    buffer_load_dwordx4 v222, s[16:19], s27 offen offset:1024 nt lds
    v_add_f32 v203, v175, v203
    v_cvt_pk_bf16_f32 v61, v174, v175
    v_mfma_f32_16x16x32_bf16 v[164:167], a[160:163], v[32:35], v[164:167]
    v_exp_f32 v160, v160
    v_mfma_f32_16x16x32_bf16 v[168:171], a[160:163], v[64:67], v[188:191]
    ds_read_b64_tr_b16 a[182:183], v215 offset:61440
    v_add_f32 v200, v160, v200
    v_mfma_f32_16x16x32_bf16 v[168:171], a[164:167], v[72:75], v[168:171]
    buffer_load_dwordx4 v221, s[16:19], s27 offen offset:2048 nt lds
    v_exp_f32 v161, v161
    v_mfma_f32_16x16x32_bf16 v[168:171], a[168:171], v[80:83], v[168:171]
    ds_read_b64_tr_b16 a[184:185], v216 offset:49152
    v_add_f32 v200, v161, v200
    v_cvt_pk_bf16_f32 v14, v160, v161
    v_mfma_f32_16x16x32_bf16 v[168:171], a[172:175], v[88:91], v[168:171]
    v_exp_f32 v162, v162
    v_mfma_f32_16x16x32_bf16 v[172:175], a[172:175], v[120:123], v[192:195]
    ds_read_b64_tr_b16 a[186:187], v216 offset:53248
    v_add_f32 v200, v162, v200
    v_mfma_f32_16x16x32_bf16 v[172:175], a[168:171], v[112:115], v[172:175]
    buffer_load_dwordx4 v222, s[16:19], s27 offen offset:3072 nt lds
    v_exp_f32 v163, v163
    v_mfma_f32_16x16x32_bf16 v[172:175], a[164:167], v[104:107], v[172:175]
    ds_read_b64_tr_b16 a[188:189], v216 offset:57344
    v_add_f32 v200, v163, v200
    v_cvt_pk_bf16_f32 v15, v162, v163
    v_mfma_f32_16x16x32_bf16 v[172:175], a[160:163], v[96:99], v[172:175]
    s_waitcnt lgkmcnt(5)
    v_exp_f32 v164, v164
    v_mfma_f32_16x16x32_bf16 a[24:27], a[176:179], v[84:87], a[24:27]
    s_waitcnt lgkmcnt(3)
    s_mov_b32 m0, 94208
    ds_read_b64_tr_b16 a[190:191], v216 offset:61440
    v_add_f32 v201, v164, v201
    v_mfma_f32_16x16x32_bf16 a[24:27], a[180:183], v[92:95], a[24:27]
    s_and_b32 s27, s3, 0x3ffff
    buffer_load_dwordx4 v221, s[16:19], s27 offen nt lds
    v_exp_f32 v165, v165
    v_mfma_f32_16x16x32_bf16 a[56:59], a[180:183], v[108:111], a[56:59]
    v_add_f32 v201, v165, v201
    v_cvt_pk_bf16_f32 v30, v164, v165
    v_mfma_f32_16x16x32_bf16 a[56:59], a[176:179], v[100:103], a[56:59]
    v_exp_f32 v166, v166
    v_mfma_f32_16x16x32_bf16 a[88:91], a[176:179], v[116:119], a[88:91]
    v_add_f32 v201, v166, v201
    v_mfma_f32_16x16x32_bf16 a[88:91], a[180:183], v[124:127], a[88:91]
    s_waitcnt vmcnt(30) lgkmcnt(0)
    v_exp_f32 v167, v167
    v_mfma_f32_16x16x32_bf16 a[120:123], a[180:183], v[140:143], a[120:123]
    s_barrier
    v_add_f32 v201, v167, v201
    v_cvt_pk_bf16_f32 v31, v166, v167
    v_mfma_f32_16x16x32_bf16 a[120:123], a[176:179], v[132:135], a[120:123]
    s_add_u32 s3, s3, 4096
    ds_read_b128 a[160:163], v205 offset:16384
    buffer_load_dwordx4 v222, s[16:19], s27 offen offset:1024 nt lds
    v_exp_f32 v168, v168
    v_mfma_f32_16x16x32_bf16 a[28:31], a[184:187], v[84:87], a[28:31]
    ds_read_b128 a[164:167], v206 offset:16384
    v_add_f32 v202, v168, v202
    v_mfma_f32_16x16x32_bf16 a[28:31], a[188:191], v[92:95], a[28:31]
    buffer_load_dwordx4 v221, s[16:19], s27 offen offset:2048 nt lds
    v_exp_f32 v169, v169
    v_mfma_f32_16x16x32_bf16 a[60:63], a[188:191], v[108:111], a[60:63]
    ds_read_b128 a[168:171], v207 offset:16384
    v_add_f32 v202, v169, v202
    v_cvt_pk_bf16_f32 v46, v168, v169
    v_mfma_f32_16x16x32_bf16 a[60:63], a[184:187], v[100:103], a[60:63]
    v_exp_f32 v170, v170
    v_mfma_f32_16x16x32_bf16 a[92:95], a[184:187], v[116:119], a[92:95]
    ds_read_b128 a[172:175], v208 offset:16384
    v_add_f32 v202, v170, v202
    v_mfma_f32_16x16x32_bf16 a[92:95], a[188:191], v[124:127], a[92:95]
    buffer_load_dwordx4 v222, s[16:19], s27 offen offset:3072 nt lds
    v_exp_f32 v171, v171
    v_mfma_f32_16x16x32_bf16 a[124:127], a[188:191], v[140:143], a[124:127]
    v_add_f32 v202, v171, v202
    v_cvt_pk_bf16_f32 v47, v170, v171
    v_mfma_f32_16x16x32_bf16 a[124:127], a[184:187], v[132:135], a[124:127]
    v_exp_f32 v172, v172
    v_cmp_gt_u32 vcc, 32, v254
    s_mov_b32 s32, 0x40000
    s_cmp_eq_u32 s31, 3
    s_cbranch_scc1 L_loopB
    s_nop 1
    s_cbranch_vccz L_loopB
L_spinB:
    s_sleep 8
    buffer_load_dword v254, v255, s[20:23], 0 offen sc0 sc1
    s_waitcnt vmcnt(0)
    v_cmp_gt_u32 vcc, 32, v254
    s_sub_u32 s32, s32, 1
    s_nop 3
    s_cbranch_vccz L_loopB
    s_cmp_eq_u32 s32, 0
    s_cbranch_scc0 L_spinB
    s_branch L_loopB
L_p14B:
    s_waitcnt lgkmcnt(3)
    v_mfma_f32_16x16x32_bf16 v[160:163], a[160:163], v[0:3], v[180:183]
    s_waitcnt lgkmcnt(2)
    ds_read_b64_tr_b16 a[176:177], v209 offset:16384
    v_add_f32 v203, v172, v203
    v_mfma_f32_16x16x32_bf16 v[160:163], a[164:167], v[8:11], v[160:163]
    s_waitcnt lgkmcnt(2)
    v_exp_f32 v173, v173
    v_mfma_f32_16x16x32_bf16 v[160:163], a[168:171], v[16:19], v[160:163]
    s_waitcnt lgkmcnt(1)
    s_mov_b32 m0, 114688
    ds_read_b64_tr_b16 a[178:179], v209 offset:20480
    v_add_f32 v203, v173, v203
    v_cvt_pk_bf16_f32 v142, v172, v173
    v_mfma_f32_16x16x32_bf16 v[160:163], a[172:175], v[24:27], v[160:163]
    s_and_b32 s27, s3, 0x3ffff
    buffer_load_dwordx4 v221, s[16:19], s27 offen nt lds
    v_exp_f32 v174, v174
    v_mfma_f32_16x16x32_bf16 v[164:167], a[172:175], v[56:59], v[184:187]
    ds_read_b64_tr_b16 a[180:181], v209 offset:24576
    v_add_f32 v203, v174, v203
    v_mfma_f32_16x16x32_bf16 v[164:167], a[168:171], v[48:51], v[164:167]
    v_exp_f32 v175, v175
    v_mfma_f32_16x16x32_bf16 v[164:167], a[164:167], v[40:43], v[164:167]
    s_add_u32 s3, s3, 4096
    buffer_load_dwordx4 v222, s[16:19], s27 offen offset:1024 nt lds
    v_add_f32 v203, v175, v203
    v_cvt_pk_bf16_f32 v143, v174, v175
    v_mfma_f32_16x16x32_bf16 v[164:167], a[160:163], v[32:35], v[164:167]
    v_exp_f32 v160, v160
    v_mfma_f32_16x16x32_bf16 v[168:171], a[160:163], v[64:67], v[188:191]
    ds_read_b64_tr_b16 a[182:183], v209 offset:28672
    v_add_f32 v200, v160, v200
    v_mfma_f32_16x16x32_bf16 v[168:171], a[164:167], v[72:75], v[168:171]
    v_exp_f32 v161, v161
    v_mfma_f32_16x16x32_bf16 v[168:171], a[168:171], v[80:83], v[168:171]
    ds_read_b64_tr_b16 a[184:185], v210 offset:16384
    buffer_load_dwordx4 v221, s[16:19], s27 offen offset:2048 nt lds
    v_add_f32 v200, v161, v200
    v_cvt_pk_bf16_f32 v4, v160, v161
    v_mfma_f32_16x16x32_bf16 v[168:171], a[172:175], v[88:91], v[168:171]
    v_exp_f32 v162, v162
    v_mfma_f32_16x16x32_bf16 v[172:175], a[172:175], v[120:123], v[192:195]
    ds_read_b64_tr_b16 a[186:187], v210 offset:20480
    v_add_f32 v200, v162, v200
    v_mfma_f32_16x16x32_bf16 v[172:175], a[168:171], v[112:115], v[172:175]
    v_exp_f32 v163, v163
    v_mfma_f32_16x16x32_bf16 v[172:175], a[164:167], v[104:107], v[172:175]
    ds_read_b64_tr_b16 a[188:189], v210 offset:24576
    buffer_load_dwordx4 v222, s[16:19], s27 offen offset:3072 nt lds
    v_add_f32 v200, v163, v200
    v_cvt_pk_bf16_f32 v5, v162, v163
    v_mfma_f32_16x16x32_bf16 v[172:175], a[160:163], v[96:99], v[172:175]
    s_waitcnt lgkmcnt(5)
    v_exp_f32 v164, v164
    v_mfma_f32_16x16x32_bf16 a[0:3], a[176:179], v[84:87], a[0:3]
    s_waitcnt lgkmcnt(3)
    ds_read_b64_tr_b16 a[190:191], v210 offset:28672
    v_add_f32 v201, v164, v201
    v_mfma_f32_16x16x32_bf16 a[0:3], a[180:183], v[92:95], a[0:3]
    s_mov_b32 m0, 118784
    v_exp_f32 v165, v165
    v_mfma_f32_16x16x32_bf16 a[32:35], a[180:183], v[108:111], a[32:35]
    s_and_b32 s27, s3, 0x3ffff
    buffer_load_dwordx4 v221, s[16:19], s27 offen nt lds
    v_add_f32 v201, v165, v201
    v_cvt_pk_bf16_f32 v20, v164, v165
    v_mfma_f32_16x16x32_bf16 a[32:35], a[176:179], v[100:103], a[32:35]
    v_exp_f32 v166, v166
    v_mfma_f32_16x16x32_bf16 a[64:67], a[176:179], v[116:119], a[64:67]
    ds_read_b128 a[160:163], v205 offset:36864
    v_add_f32 v201, v166, v201
    v_mfma_f32_16x16x32_bf16 a[64:67], a[180:183], v[124:127], a[64:67]
    v_exp_f32 v167, v167
    v_mfma_f32_16x16x32_bf16 a[96:99], a[180:183], v[140:143], a[96:99]
    s_add_u32 s3, s3, 4096
    ds_read_b128 a[164:167], v206 offset:36864
    buffer_load_dwordx4 v222, s[16:19], s27 offen offset:1024 nt lds
    v_add_f32 v201, v167, v201
    v_cvt_pk_bf16_f32 v21, v166, v167
    v_mfma_f32_16x16x32_bf16 a[96:99], a[176:179], v[132:135], a[96:99]
    s_waitcnt lgkmcnt(4)
    v_exp_f32 v168, v168
    v_mfma_f32_16x16x32_bf16 a[4:7], a[184:187], v[84:87], a[4:7]
    s_waitcnt lgkmcnt(2)
    ds_read_b128 a[168:171], v207 offset:36864
    v_add_f32 v202, v168, v202
    v_mfma_f32_16x16x32_bf16 a[4:7], a[188:191], v[92:95], a[4:7]
    v_exp_f32 v169, v169
    v_mfma_f32_16x16x32_bf16 a[36:39], a[188:191], v[108:111], a[36:39]
    buffer_load_dwordx4 v221, s[16:19], s27 offen offset:2048 nt lds
    v_add_f32 v202, v169, v202
    v_cvt_pk_bf16_f32 v36, v168, v169
    v_mfma_f32_16x16x32_bf16 a[36:39], a[184:187], v[100:103], a[36:39]
    v_exp_f32 v170, v170
    v_mfma_f32_16x16x32_bf16 a[68:71], a[184:187], v[116:119], a[68:71]
    ds_read_b128 a[172:175], v208 offset:36864
    v_add_f32 v202, v170, v202
    v_mfma_f32_16x16x32_bf16 a[68:71], a[188:191], v[124:127], a[68:71]
    v_exp_f32 v171, v171
    v_mfma_f32_16x16x32_bf16 a[100:103], a[188:191], v[140:143], a[100:103]
    buffer_load_dwordx4 v222, s[16:19], s27 offen offset:3072 nt lds
    v_add_f32 v202, v171, v202
    v_cvt_pk_bf16_f32 v37, v170, v171
    v_mfma_f32_16x16x32_bf16 a[100:103], a[184:187], v[132:135], a[100:103]
    s_waitcnt lgkmcnt(3)
    v_exp_f32 v172, v172
    v_mfma_f32_16x16x32_bf16 v[160:163], a[160:163], v[0:3], v[180:183]
    s_waitcnt lgkmcnt(2)
    ds_read_b64_tr_b16 a[176:177], v211 offset:16384
    v_add_f32 v203, v172, v203
    v_mfma_f32_16x16x32_bf16 v[160:163], a[164:167], v[8:11], v[160:163]
    s_waitcnt lgkmcnt(2)
    s_mov_b32 m0, 122880
    v_exp_f32 v173, v173
    v_mfma_f32_16x16x32_bf16 v[160:163], a[168:171], v[16:19], v[160:163]
    s_waitcnt lgkmcnt(1)
    s_and_b32 s27, s3, 0x3ffff
    ds_read_b64_tr_b16 a[178:179], v211 offset:20480
    buffer_load_dwordx4 v221, s[16:19], s27 offen nt lds
    v_add_f32 v203, v173, v203
    v_cvt_pk_bf16_f32 v52, v172, v173
    v_mfma_f32_16x16x32_bf16 v[160:163], a[172:175], v[24:27], v[160:163]
    v_exp_f32 v174, v174
    v_mfma_f32_16x16x32_bf16 v[164:167], a[172:175], v[56:59], v[184:187]
    ds_read_b64_tr_b16 a[180:181], v211 offset:24576
    v_add_f32 v203, v174, v203
    v_mfma_f32_16x16x32_bf16 v[164:167], a[168:171], v[48:51], v[164:167]
    v_exp_f32 v175, v175
    v_mfma_f32_16x16x32_bf16 v[164:167], a[164:167], v[40:43], v[164:167]
    s_add_u32 s3, s3, 4096
    buffer_load_dwordx4 v222, s[16:19], s27 offen offset:1024 nt lds
    v_add_f32 v203, v175, v203
    v_cvt_pk_bf16_f32 v53, v174, v175
    v_mfma_f32_16x16x32_bf16 v[164:167], a[160:163], v[32:35], v[164:167]
    v_exp_f32 v160, v160
    v_mfma_f32_16x16x32_bf16 v[168:171], a[160:163], v[64:67], v[188:191]
    ds_read_b64_tr_b16 a[182:183], v211 offset:28672
    v_add_f32 v200, v160, v200
    v_mfma_f32_16x16x32_bf16 v[168:171], a[164:167], v[72:75], v[168:171]
    v_exp_f32 v161, v161
    v_mfma_f32_16x16x32_bf16 v[168:171], a[168:171], v[80:83], v[168:171]
    ds_read_b64_tr_b16 a[184:185], v212 offset:16384
    buffer_load_dwordx4 v221, s[16:19], s27 offen offset:2048 nt lds
    v_add_f32 v200, v161, v200
    v_cvt_pk_bf16_f32 v6, v160, v161
    v_mfma_f32_16x16x32_bf16 v[168:171], a[172:175], v[88:91], v[168:171]
    v_exp_f32 v162, v162
    v_mfma_f32_16x16x32_bf16 v[172:175], a[172:175], v[120:123], v[192:195]
    ds_read_b64_tr_b16 a[186:187], v212 offset:20480
    v_add_f32 v200, v162, v200
    v_mfma_f32_16x16x32_bf16 v[172:175], a[168:171], v[112:115], v[172:175]
    v_exp_f32 v163, v163
    v_mfma_f32_16x16x32_bf16 v[172:175], a[164:167], v[104:107], v[172:175]
    ds_read_b64_tr_b16 a[188:189], v212 offset:24576
    buffer_load_dwordx4 v222, s[16:19], s27 offen offset:3072 nt lds
    v_add_f32 v200, v163, v200
    v_cvt_pk_bf16_f32 v7, v162, v163
    v_mfma_f32_16x16x32_bf16 v[172:175], a[160:163], v[96:99], v[172:175]
    s_waitcnt lgkmcnt(5)
    v_exp_f32 v164, v164
    v_mfma_f32_16x16x32_bf16 a[8:11], a[176:179], v[84:87], a[8:11]
    s_waitcnt lgkmcnt(3)
    ds_read_b64_tr_b16 a[190:191], v212 offset:28672
    v_add_f32 v201, v164, v201
    v_mfma_f32_16x16x32_bf16 a[8:11], a[180:183], v[92:95], a[8:11]
    s_mov_b32 m0, 126976
    v_exp_f32 v165, v165
    v_mfma_f32_16x16x32_bf16 a[40:43], a[180:183], v[108:111], a[40:43]
    s_and_b32 s27, s3, 0x3ffff
    buffer_load_dwordx4 v221, s[16:19], s27 offen nt lds
    v_add_f32 v201, v165, v201
    v_cvt_pk_bf16_f32 v22, v164, v165
    v_mfma_f32_16x16x32_bf16 a[40:43], a[176:179], v[100:103], a[40:43]
    v_exp_f32 v166, v166
    v_mfma_f32_16x16x32_bf16 a[72:75], a[176:179], v[116:119], a[72:75]
    ds_read_b128 a[160:163], v205 offset:40960
    v_add_f32 v201, v166, v201
    v_mfma_f32_16x16x32_bf16 a[72:75], a[180:183], v[124:127], a[72:75]
    v_exp_f32 v167, v167
    v_mfma_f32_16x16x32_bf16 a[104:107], a[180:183], v[140:143], a[104:107]
    s_add_u32 s3, s3, 4096
    ds_read_b128 a[164:167], v206 offset:40960
    buffer_load_dwordx4 v222, s[16:19], s27 offen offset:1024 nt lds
    v_add_f32 v201, v167, v201
    v_cvt_pk_bf16_f32 v23, v166, v167
    v_mfma_f32_16x16x32_bf16 a[104:107], a[176:179], v[132:135], a[104:107]
    s_waitcnt lgkmcnt(4)
    v_exp_f32 v168, v168
    v_mfma_f32_16x16x32_bf16 a[12:15], a[184:187], v[84:87], a[12:15]
    s_waitcnt lgkmcnt(2)
    ds_read_b128 a[168:171], v207 offset:40960
    v_add_f32 v202, v168, v202
    v_mfma_f32_16x16x32_bf16 a[12:15], a[188:191], v[92:95], a[12:15]
    v_exp_f32 v169, v169
    v_mfma_f32_16x16x32_bf16 a[44:47], a[188:191], v[108:111], a[44:47]
    buffer_load_dwordx4 v221, s[16:19], s27 offen offset:2048 nt lds
    v_add_f32 v202, v169, v202
    v_cvt_pk_bf16_f32 v38, v168, v169
    v_mfma_f32_16x16x32_bf16 a[44:47], a[184:187], v[100:103], a[44:47]
    v_exp_f32 v170, v170
    v_mfma_f32_16x16x32_bf16 a[76:79], a[184:187], v[116:119], a[76:79]
    ds_read_b128 a[172:175], v208 offset:40960
    v_add_f32 v202, v170, v202
    v_mfma_f32_16x16x32_bf16 a[76:79], a[188:191], v[124:127], a[76:79]
    v_exp_f32 v171, v171
    v_mfma_f32_16x16x32_bf16 a[108:111], a[188:191], v[140:143], a[108:111]
    buffer_load_dwordx4 v222, s[16:19], s27 offen offset:3072 nt lds
    v_add_f32 v202, v171, v202
    v_cvt_pk_bf16_f32 v39, v170, v171
    v_mfma_f32_16x16x32_bf16 a[108:111], a[184:187], v[132:135], a[108:111]
    s_waitcnt lgkmcnt(3)
    v_exp_f32 v172, v172
    v_mfma_f32_16x16x32_bf16 v[160:163], a[160:163], v[0:3], v[180:183]
    s_waitcnt lgkmcnt(2)
    ds_read_b64_tr_b16 a[176:177], v213 offset:16384
    v_add_f32 v203, v172, v203
    v_mfma_f32_16x16x32_bf16 v[160:163], a[164:167], v[8:11], v[160:163]
    s_waitcnt lgkmcnt(2)
    s_mov_b32 s27, 0
    buffer_load_dwordx4 a[192:195], v238, s[56:59], s27 offen sc1
    v_exp_f32 v173, v173
    v_mfma_f32_16x16x32_bf16 v[160:163], a[168:171], v[16:19], v[160:163]
    s_waitcnt lgkmcnt(1)
    ds_read_b64_tr_b16 a[178:179], v213 offset:20480
    v_add_f32 v203, v173, v203
    v_cvt_pk_bf16_f32 v54, v172, v173
    v_mfma_f32_16x16x32_bf16 v[160:163], a[172:175], v[24:27], v[160:163]
    v_exp_f32 v174, v174
    v_mfma_f32_16x16x32_bf16 v[164:167], a[172:175], v[56:59], v[184:187]
    ds_read_b64_tr_b16 a[180:181], v213 offset:24576
    v_add_f32 v203, v174, v203
    v_mfma_f32_16x16x32_bf16 v[164:167], a[168:171], v[48:51], v[164:167]
    buffer_load_dwordx4 a[196:199], v238, s[56:59], s27 offen offset:1024 sc1
    v_exp_f32 v175, v175
    v_mfma_f32_16x16x32_bf16 v[164:167], a[164:167], v[40:43], v[164:167]
    v_add_f32 v203, v175, v203
    v_cvt_pk_bf16_f32 v55, v174, v175
    v_mfma_f32_16x16x32_bf16 v[164:167], a[160:163], v[32:35], v[164:167]
    v_exp_f32 v160, v160
    v_mfma_f32_16x16x32_bf16 v[168:171], a[160:163], v[64:67], v[188:191]
    ds_read_b64_tr_b16 a[182:183], v213 offset:28672
    v_add_f32 v200, v160, v200
    v_mfma_f32_16x16x32_bf16 v[168:171], a[164:167], v[72:75], v[168:171]
    buffer_load_dwordx4 a[200:203], v238, s[56:59], s27 offen offset:2048 sc1
    v_exp_f32 v161, v161
    v_mfma_f32_16x16x32_bf16 v[168:171], a[168:171], v[80:83], v[168:171]
    ds_read_b64_tr_b16 a[184:185], v214 offset:16384
    v_add_f32 v200, v161, v200
    v_cvt_pk_bf16_f32 v12, v160, v161
    v_mfma_f32_16x16x32_bf16 v[168:171], a[172:175], v[88:91], v[168:171]
    v_exp_f32 v162, v162
    v_mfma_f32_16x16x32_bf16 v[172:175], a[172:175], v[120:123], v[192:195]
    ds_read_b64_tr_b16 a[186:187], v214 offset:20480
    v_add_f32 v200, v162, v200
    v_mfma_f32_16x16x32_bf16 v[172:175], a[168:171], v[112:115], v[172:175]
    buffer_load_dwordx4 a[204:207], v238, s[56:59], s27 offen offset:3072 sc1
    v_exp_f32 v163, v163
    v_mfma_f32_16x16x32_bf16 v[172:175], a[164:167], v[104:107], v[172:175]
    ds_read_b64_tr_b16 a[188:189], v214 offset:24576
    v_add_f32 v200, v163, v200
    v_cvt_pk_bf16_f32 v13, v162, v163
    v_mfma_f32_16x16x32_bf16 v[172:175], a[160:163], v[96:99], v[172:175]
    s_waitcnt lgkmcnt(5)
    v_exp_f32 v164, v164
    v_mfma_f32_16x16x32_bf16 a[16:19], a[176:179], v[84:87], a[16:19]
    s_waitcnt lgkmcnt(3)
    ds_read_b64_tr_b16 a[190:191], v214 offset:28672
    v_add_f32 v201, v164, v201
    v_mfma_f32_16x16x32_bf16 a[16:19], a[180:183], v[92:95], a[16:19]
    s_mov_b32 s27, 262144
    buffer_load_dwordx4 a[208:211], v238, s[56:59], s27 offen sc1
    v_exp_f32 v165, v165
    v_mfma_f32_16x16x32_bf16 a[48:51], a[180:183], v[108:111], a[48:51]
    v_add_f32 v201, v165, v201
    v_cvt_pk_bf16_f32 v28, v164, v165
    v_mfma_f32_16x16x32_bf16 a[48:51], a[176:179], v[100:103], a[48:51]
    v_exp_f32 v166, v166
    v_mfma_f32_16x16x32_bf16 a[80:83], a[176:179], v[116:119], a[80:83]
    ds_read_b128 a[160:163], v205 offset:45056
    v_add_f32 v201, v166, v201
    v_mfma_f32_16x16x32_bf16 a[80:83], a[180:183], v[124:127], a[80:83]
    buffer_load_dwordx4 a[212:215], v238, s[56:59], s27 offen offset:1024 sc1
    v_exp_f32 v167, v167
    v_mfma_f32_16x16x32_bf16 a[112:115], a[180:183], v[140:143], a[112:115]
    ds_read_b128 a[164:167], v206 offset:45056
    v_add_f32 v201, v167, v201
    v_cvt_pk_bf16_f32 v29, v166, v167
    v_mfma_f32_16x16x32_bf16 a[112:115], a[176:179], v[132:135], a[112:115]
    s_waitcnt lgkmcnt(4)
    v_exp_f32 v168, v168
    v_mfma_f32_16x16x32_bf16 a[20:23], a[184:187], v[84:87], a[20:23]
    s_waitcnt lgkmcnt(2)
    ds_read_b128 a[168:171], v207 offset:45056
    v_add_f32 v202, v168, v202
    v_mfma_f32_16x16x32_bf16 a[20:23], a[188:191], v[92:95], a[20:23]
    buffer_load_dwordx4 a[216:219], v238, s[56:59], s27 offen offset:2048 sc1
    v_exp_f32 v169, v169
    v_mfma_f32_16x16x32_bf16 a[52:55], a[188:191], v[108:111], a[52:55]
    v_add_f32 v202, v169, v202
    v_cvt_pk_bf16_f32 v44, v168, v169
    v_mfma_f32_16x16x32_bf16 a[52:55], a[184:187], v[100:103], a[52:55]
    v_exp_f32 v170, v170
    v_mfma_f32_16x16x32_bf16 a[84:87], a[184:187], v[116:119], a[84:87]
    ds_read_b128 a[172:175], v208 offset:45056
    v_add_f32 v202, v170, v202
    v_mfma_f32_16x16x32_bf16 a[84:87], a[188:191], v[124:127], a[84:87]
    buffer_load_dwordx4 a[220:223], v238, s[56:59], s27 offen offset:3072 sc1
    v_exp_f32 v171, v171
    v_mfma_f32_16x16x32_bf16 a[116:119], a[188:191], v[140:143], a[116:119]
    v_add_f32 v202, v171, v202
    v_cvt_pk_bf16_f32 v45, v170, v171
    v_mfma_f32_16x16x32_bf16 a[116:119], a[184:187], v[132:135], a[116:119]
    s_waitcnt lgkmcnt(3)
    v_exp_f32 v172, v172
    v_mfma_f32_16x16x32_bf16 v[160:163], a[160:163], v[0:3], v[180:183]
    s_waitcnt lgkmcnt(2)
    ds_read_b64_tr_b16 a[176:177], v215 offset:16384
    v_add_f32 v203, v172, v203
    v_mfma_f32_16x16x32_bf16 v[160:163], a[164:167], v[8:11], v[160:163]
    s_waitcnt lgkmcnt(2)
    s_mov_b32 s27, 524288
    buffer_load_dwordx4 a[224:227], v238, s[56:59], s27 offen sc1
    v_exp_f32 v173, v173
    v_mfma_f32_16x16x32_bf16 v[160:163], a[168:171], v[16:19], v[160:163]
    s_waitcnt lgkmcnt(1)
    ds_read_b64_tr_b16 a[178:179], v215 offset:20480
    v_add_f32 v203, v173, v203
    v_cvt_pk_bf16_f32 v60, v172, v173
    v_mfma_f32_16x16x32_bf16 v[160:163], a[172:175], v[24:27], v[160:163]
    v_exp_f32 v174, v174
    v_mfma_f32_16x16x32_bf16 v[164:167], a[172:175], v[56:59], v[184:187]
    ds_read_b64_tr_b16 a[180:181], v215 offset:24576
    v_add_f32 v203, v174, v203
    v_mfma_f32_16x16x32_bf16 v[164:167], a[168:171], v[48:51], v[164:167]
    buffer_load_dwordx4 a[228:231], v238, s[56:59], s27 offen offset:1024 sc1
    v_exp_f32 v175, v175
    v_mfma_f32_16x16x32_bf16 v[164:167], a[164:167], v[40:43], v[164:167]
    v_add_f32 v203, v175, v203
    v_cvt_pk_bf16_f32 v61, v174, v175
    v_mfma_f32_16x16x32_bf16 v[164:167], a[160:163], v[32:35], v[164:167]
    v_exp_f32 v160, v160
    v_mfma_f32_16x16x32_bf16 v[168:171], a[160:163], v[64:67], v[188:191]
    ds_read_b64_tr_b16 a[182:183], v215 offset:28672
    v_add_f32 v200, v160, v200
    v_mfma_f32_16x16x32_bf16 v[168:171], a[164:167], v[72:75], v[168:171]
    buffer_load_dwordx4 a[232:235], v238, s[56:59], s27 offen offset:2048 sc1
    v_exp_f32 v161, v161
    v_mfma_f32_16x16x32_bf16 v[168:171], a[168:171], v[80:83], v[168:171]
    ds_read_b64_tr_b16 a[184:185], v216 offset:16384
    v_add_f32 v200, v161, v200
    v_cvt_pk_bf16_f32 v14, v160, v161
    v_mfma_f32_16x16x32_bf16 v[168:171], a[172:175], v[88:91], v[168:171]
    v_exp_f32 v162, v162
    v_mfma_f32_16x16x32_bf16 v[172:175], a[172:175], v[120:123], v[192:195]
    ds_read_b64_tr_b16 a[186:187], v216 offset:20480
    v_add_f32 v200, v162, v200
    v_mfma_f32_16x16x32_bf16 v[172:175], a[168:171], v[112:115], v[172:175]
    buffer_load_dwordx4 a[236:239], v238, s[56:59], s27 offen offset:3072 sc1
    v_exp_f32 v163, v163
    v_mfma_f32_16x16x32_bf16 v[172:175], a[164:167], v[104:107], v[172:175]
    ds_read_b64_tr_b16 a[188:189], v216 offset:24576
    v_add_f32 v200, v163, v200
    v_cvt_pk_bf16_f32 v15, v162, v163
    v_mfma_f32_16x16x32_bf16 v[172:175], a[160:163], v[96:99], v[172:175]
    s_waitcnt lgkmcnt(5)
    v_exp_f32 v164, v164
    v_mfma_f32_16x16x32_bf16 a[24:27], a[176:179], v[84:87], a[24:27]
    s_waitcnt lgkmcnt(3)
    s_add_u32 m0, s34, 16384
    ds_read_b64_tr_b16 a[190:191], v216 offset:28672
    v_add_f32 v201, v164, v201
    v_mfma_f32_16x16x32_bf16 a[24:27], a[180:183], v[92:95], a[24:27]
    s_mov_b32 s27, 2621440
    buffer_load_dwordx4 v238, s[56:59], s27 offen sc1 lds
    v_exp_f32 v165, v165
    v_mfma_f32_16x16x32_bf16 a[56:59], a[180:183], v[108:111], a[56:59]
    v_add_f32 v201, v165, v201
    v_cvt_pk_bf16_f32 v30, v164, v165
    v_mfma_f32_16x16x32_bf16 a[56:59], a[176:179], v[100:103], a[56:59]
    v_exp_f32 v166, v166
    v_mfma_f32_16x16x32_bf16 a[88:91], a[176:179], v[116:119], a[88:91]
    v_add_f32 v201, v166, v201
    v_mfma_f32_16x16x32_bf16 a[88:91], a[180:183], v[124:127], a[88:91]
    s_waitcnt vmcnt(29) lgkmcnt(0)
    v_exp_f32 v167, v167
    v_mfma_f32_16x16x32_bf16 a[120:123], a[180:183], v[140:143], a[120:123]
    s_barrier
    v_add_f32 v201, v167, v201
    v_cvt_pk_bf16_f32 v31, v166, v167
    v_mfma_f32_16x16x32_bf16 a[120:123], a[176:179], v[132:135], a[120:123]
    ds_read_b128 a[160:163], v205 offset:49152
    buffer_load_dwordx4 v238, s[56:59], s27 offen offset:1024 sc1 lds
    v_exp_f32 v168, v168
    v_mfma_f32_16x16x32_bf16 a[28:31], a[184:187], v[84:87], a[28:31]
    ds_read_b128 a[164:167], v206 offset:49152
    v_add_f32 v202, v168, v202
    v_mfma_f32_16x16x32_bf16 a[28:31], a[188:191], v[92:95], a[28:31]
    buffer_load_dwordx4 v238, s[56:59], s27 offen offset:2048 sc1 lds
    v_exp_f32 v169, v169
    v_mfma_f32_16x16x32_bf16 a[60:63], a[188:191], v[108:111], a[60:63]
    ds_read_b128 a[168:171], v207 offset:49152
    v_add_f32 v202, v169, v202
    v_cvt_pk_bf16_f32 v46, v168, v169
    v_mfma_f32_16x16x32_bf16 a[60:63], a[184:187], v[100:103], a[60:63]
    v_exp_f32 v170, v170
    v_mfma_f32_16x16x32_bf16 a[92:95], a[184:187], v[116:119], a[92:95]
    ds_read_b128 a[172:175], v208 offset:49152
    v_add_f32 v202, v170, v202
    v_mfma_f32_16x16x32_bf16 a[92:95], a[188:191], v[124:127], a[92:95]
    buffer_load_dwordx4 v238, s[56:59], s27 offen offset:3072 sc1 lds
    v_exp_f32 v171, v171
    v_mfma_f32_16x16x32_bf16 a[124:127], a[188:191], v[140:143], a[124:127]
    v_add_f32 v202, v171, v202
    v_cvt_pk_bf16_f32 v47, v170, v171
    v_mfma_f32_16x16x32_bf16 a[124:127], a[184:187], v[132:135], a[124:127]
    s_waitcnt lgkmcnt(3)
    v_exp_f32 v172, v172
    v_mfma_f32_16x16x32_bf16 v[160:163], a[160:163], v[0:3], v[180:183]
    s_waitcnt lgkmcnt(2)
    v_add_f32 v203, v172, v203
    v_mfma_f32_16x16x32_bf16 v[160:163], a[164:167], v[8:11], v[160:163]
    s_waitcnt lgkmcnt(1)
    ds_read_b64_tr_b16 a[176:177], v209 offset:32768
    v_exp_f32 v173, v173
    v_mfma_f32_16x16x32_bf16 v[160:163], a[168:171], v[16:19], v[160:163]
    s_waitcnt lgkmcnt(1)
    v_add_f32 v203, v173, v203
    v_cvt_pk_bf16_f32 v62, v172, v173
    v_mfma_f32_16x16x32_bf16 v[160:163], a[172:175], v[24:27], v[160:163]
    s_mov_b32 s27, 786432
    buffer_load_dwordx4 a[240:243], v238, s[56:59], s27 offen sc1
    v_exp_f32 v174, v174
    v_mfma_f32_16x16x32_bf16 v[164:167], a[172:175], v[56:59], v[184:187]
    ds_read_b64_tr_b16 a[178:179], v209 offset:36864
    v_add_f32 v203, v174, v203
    v_mfma_f32_16x16x32_bf16 v[164:167], a[168:171], v[48:51], v[164:167]
    v_exp_f32 v175, v175
    v_mfma_f32_16x16x32_bf16 v[164:167], a[164:167], v[40:43], v[164:167]
    v_add_f32 v203, v175, v203
    v_cvt_pk_bf16_f32 v63, v174, v175
    v_mfma_f32_16x16x32_bf16 v[164:167], a[160:163], v[32:35], v[164:167]
    ds_read_b64_tr_b16 a[180:181], v209 offset:40960
    v_exp_f32 v160, v160
    v_mfma_f32_16x16x32_bf16 v[168:171], a[160:163], v[64:67], v[188:191]
    v_add_f32 v200, v160, v200
    v_exp_f32 v161, v161
    v_mfma_f32_16x16x32_bf16 v[168:171], a[164:167], v[72:75], v[168:171]
    buffer_load_dwordx4 a[244:247], v238, s[56:59], s27 offen offset:1024 sc1
    v_add_f32 v200, v161, v200
    v_cvt_pk_bf16_f32 v84, v160, v161
    v_mfma_f32_16x16x32_bf16 v[168:171], a[168:171], v[80:83], v[168:171]
    ds_read_b64_tr_b16 a[182:183], v209 offset:45056
    v_exp_f32 v162, v162
    v_mfma_f32_16x16x32_bf16 v[168:171], a[172:175], v[88:91], v[168:171]
    v_add_f32 v200, v162, v200
    v_exp_f32 v163, v163
    v_mfma_f32_16x16x32_bf16 v[172:175], a[172:175], v[120:123], v[192:195]
    v_add_f32 v200, v163, v200
    v_cvt_pk_bf16_f32 v85, v162, v163
    v_mfma_f32_16x16x32_bf16 v[172:175], a[168:171], v[112:115], v[172:175]
    v_exp_f32 v164, v164
    v_mfma_f32_16x16x32_bf16 v[172:175], a[164:167], v[104:107], v[172:175]
    v_add_f32 v201, v164, v201
    v_exp_f32 v165, v165
    v_mfma_f32_16x16x32_bf16 v[172:175], a[160:163], v[96:99], v[172:175]
    s_waitcnt lgkmcnt(2)
    buffer_load_dwordx4 a[248:251], v238, s[56:59], s27 offen offset:2048 sc1
    v_add_f32 v201, v165, v201
    v_cvt_pk_bf16_f32 v100, v164, v165
    v_mfma_f32_16x16x32_bf16 a[0:3], a[176:179], v[4:7], a[0:3]
    s_waitcnt lgkmcnt(0)
    ds_read_b128 a[160:163], v205 offset:53248
    v_exp_f32 v166, v166
    v_mfma_f32_16x16x32_bf16 a[0:3], a[180:183], v[12:15], a[0:3]
    ds_read_b128 a[164:167], v206 offset:53248
    v_add_f32 v201, v166, v201
    v_exp_f32 v167, v167
    v_mfma_f32_16x16x32_bf16 a[32:35], a[180:183], v[28:31], a[32:35]
    ds_read_b128 a[168:171], v207 offset:53248
    v_add_f32 v201, v167, v201
    v_cvt_pk_bf16_f32 v101, v166, v167
    v_mfma_f32_16x16x32_bf16 a[32:35], a[176:179], v[20:23], a[32:35]
    ds_read_b128 a[172:175], v208 offset:53248
    v_exp_f32 v168, v168
    v_mfma_f32_16x16x32_bf16 a[64:67], a[176:179], v[36:39], a[64:67]
    v_add_f32 v202, v168, v202
    v_exp_f32 v169, v169
    v_mfma_f32_16x16x32_bf16 a[64:67], a[180:183], v[44:47], a[64:67]
    buffer_load_dwordx4 a[252:255], v238, s[56:59], s27 offen offset:3072 sc1
    v_add_f32 v202, v169, v202
    v_cvt_pk_bf16_f32 v116, v168, v169
    v_mfma_f32_16x16x32_bf16 a[96:99], a[180:183], v[60:63], a[96:99]
    v_exp_f32 v170, v170
    v_mfma_f32_16x16x32_bf16 a[96:99], a[176:179], v[52:55], a[96:99]
    s_waitcnt lgkmcnt(3)
    v_add_f32 v202, v170, v202
    v_exp_f32 v171, v171
    v_mfma_f32_16x16x32_bf16 v[160:163], a[160:163], v[0:3], v[180:183]
    s_waitcnt lgkmcnt(2)
    v_add_f32 v202, v171, v202
    v_cvt_pk_bf16_f32 v117, v170, v171
    v_mfma_f32_16x16x32_bf16 v[160:163], a[164:167], v[8:11], v[160:163]
    s_waitcnt lgkmcnt(1)
    ds_read_b64_tr_b16 a[176:177], v210 offset:32768
    v_exp_f32 v172, v172
    v_mfma_f32_16x16x32_bf16 v[160:163], a[168:171], v[16:19], v[160:163]
    s_waitcnt lgkmcnt(1)
    s_add_u32 m0, s34, 65536
    v_add_f32 v203, v172, v203
    v_exp_f32 v173, v173
    v_mfma_f32_16x16x32_bf16 v[160:163], a[172:175], v[24:27], v[160:163]
    s_mov_b32 s27, 2883584
    buffer_load_dwordx4 v238, s[56:59], s27 offen sc1 lds
    v_add_f32 v203, v173, v203
    v_cvt_pk_bf16_f32 v132, v172, v173
    v_mfma_f32_16x16x32_bf16 v[164:167], a[172:175], v[56:59], v[184:187]
    ds_read_b64_tr_b16 a[178:179], v210 offset:36864
    v_exp_f32 v174, v174
    v_mfma_f32_16x16x32_bf16 v[164:167], a[168:171], v[48:51], v[164:167]
    v_add_f32 v203, v174, v203
    v_exp_f32 v175, v175
    v_mfma_f32_16x16x32_bf16 v[164:167], a[164:167], v[40:43], v[164:167]
    v_add_f32 v203, v175, v203
    v_cvt_pk_bf16_f32 v133, v174, v175
    v_mfma_f32_16x16x32_bf16 v[164:167], a[160:163], v[32:35], v[164:167]
    ds_read_b64_tr_b16 a[180:181], v210 offset:40960
    v_exp_f32 v160, v160
    v_mfma_f32_16x16x32_bf16 v[168:171], a[160:163], v[64:67], v[188:191]
    v_add_f32 v200, v160, v200
    v_exp_f32 v161, v161
    v_mfma_f32_16x16x32_bf16 v[168:171], a[164:167], v[72:75], v[168:171]
    buffer_load_dwordx4 v238, s[56:59], s27 offen offset:1024 sc1 lds
    v_add_f32 v200, v161, v200
    v_cvt_pk_bf16_f32 v86, v160, v161
    v_mfma_f32_16x16x32_bf16 v[168:171], a[168:171], v[80:83], v[168:171]
    ds_read_b64_tr_b16 a[182:183], v210 offset:45056
    v_exp_f32 v162, v162
    v_mfma_f32_16x16x32_bf16 v[168:171], a[172:175], v[88:91], v[168:171]
    v_add_f32 v200, v162, v200
    v_exp_f32 v163, v163
    v_mfma_f32_16x16x32_bf16 v[172:175], a[172:175], v[120:123], v[192:195]
    v_add_f32 v200, v163, v200
    v_cvt_pk_bf16_f32 v87, v162, v163
    v_mfma_f32_16x16x32_bf16 v[172:175], a[168:171], v[112:115], v[172:175]
    v_exp_f32 v164, v164
    v_mfma_f32_16x16x32_bf16 v[172:175], a[164:167], v[104:107], v[172:175]
    v_add_f32 v201, v164, v201
    v_exp_f32 v165, v165
    v_mfma_f32_16x16x32_bf16 v[172:175], a[160:163], v[96:99], v[172:175]
    s_waitcnt lgkmcnt(2)
    buffer_load_dwordx4 v238, s[56:59], s27 offen offset:2048 sc1 lds
    v_add_f32 v201, v165, v201
    v_cvt_pk_bf16_f32 v102, v164, v165
    v_mfma_f32_16x16x32_bf16 a[4:7], a[176:179], v[4:7], a[4:7]
    s_waitcnt lgkmcnt(0)
    ds_read_b128 a[160:163], v205 offset:57344
    v_exp_f32 v166, v166
    v_mfma_f32_16x16x32_bf16 a[4:7], a[180:183], v[12:15], a[4:7]
    ds_read_b128 a[164:167], v206 offset:57344
    v_add_f32 v201, v166, v201
    v_exp_f32 v167, v167
    v_mfma_f32_16x16x32_bf16 a[36:39], a[180:183], v[28:31], a[36:39]
    ds_read_b128 a[168:171], v207 offset:57344
    v_add_f32 v201, v167, v201
    v_cvt_pk_bf16_f32 v103, v166, v167
    v_mfma_f32_16x16x32_bf16 a[36:39], a[176:179], v[20:23], a[36:39]
    ds_read_b128 a[172:175], v208 offset:57344
    v_exp_f32 v168, v168
    v_mfma_f32_16x16x32_bf16 a[68:71], a[176:179], v[36:39], a[68:71]
    v_add_f32 v202, v168, v202
    v_exp_f32 v169, v169
    v_mfma_f32_16x16x32_bf16 a[68:71], a[180:183], v[44:47], a[68:71]
    buffer_load_dwordx4 v238, s[56:59], s27 offen offset:3072 sc1 lds
    v_add_f32 v202, v169, v202
    v_cvt_pk_bf16_f32 v118, v168, v169
    v_mfma_f32_16x16x32_bf16 a[100:103], a[180:183], v[60:63], a[100:103]
    v_exp_f32 v170, v170
    v_mfma_f32_16x16x32_bf16 a[100:103], a[176:179], v[52:55], a[100:103]
    s_waitcnt lgkmcnt(3)
    v_add_f32 v202, v170, v202
    v_exp_f32 v171, v171
    v_mfma_f32_16x16x32_bf16 v[160:163], a[160:163], v[0:3], v[180:183]
    s_waitcnt lgkmcnt(2)
    v_add_f32 v202, v171, v202
    v_cvt_pk_bf16_f32 v119, v170, v171
    v_mfma_f32_16x16x32_bf16 v[160:163], a[164:167], v[8:11], v[160:163]
    s_waitcnt lgkmcnt(1)
    ds_read_b64_tr_b16 a[176:177], v211 offset:32768
    v_exp_f32 v172, v172
    v_mfma_f32_16x16x32_bf16 v[160:163], a[168:171], v[16:19], v[160:163]
    s_waitcnt lgkmcnt(1)
    s_add_u32 m0, s34, 32768
    v_add_f32 v203, v172, v203
    v_exp_f32 v173, v173
    v_mfma_f32_16x16x32_bf16 v[160:163], a[172:175], v[24:27], v[160:163]
    s_mov_b32 s27, 3670016
    buffer_load_dwordx4 v238, s[56:59], s27 offen sc1 lds
    v_add_f32 v203, v173, v203
    v_cvt_pk_bf16_f32 v134, v172, v173
    v_mfma_f32_16x16x32_bf16 v[164:167], a[172:175], v[56:59], v[184:187]
    ds_read_b64_tr_b16 a[178:179], v211 offset:36864
    v_exp_f32 v174, v174
    v_mfma_f32_16x16x32_bf16 v[164:167], a[168:171], v[48:51], v[164:167]
    v_add_f32 v203, v174, v203
    v_exp_f32 v175, v175
    v_mfma_f32_16x16x32_bf16 v[164:167], a[164:167], v[40:43], v[164:167]
    v_add_f32 v203, v175, v203
    v_cvt_pk_bf16_f32 v135, v174, v175
    v_mfma_f32_16x16x32_bf16 v[164:167], a[160:163], v[32:35], v[164:167]
    ds_read_b64_tr_b16 a[180:181], v211 offset:40960
    v_exp_f32 v160, v160
    v_mfma_f32_16x16x32_bf16 v[168:171], a[160:163], v[64:67], v[188:191]
    v_add_f32 v200, v160, v200
    v_exp_f32 v161, v161
    v_mfma_f32_16x16x32_bf16 v[168:171], a[164:167], v[72:75], v[168:171]
    buffer_load_dwordx4 v238, s[56:59], s27 offen offset:1024 sc1 lds
    v_add_f32 v200, v161, v200
    v_cvt_pk_bf16_f32 v92, v160, v161
    v_mfma_f32_16x16x32_bf16 v[168:171], a[168:171], v[80:83], v[168:171]
    ds_read_b64_tr_b16 a[182:183], v211 offset:45056
    v_exp_f32 v162, v162
    v_mfma_f32_16x16x32_bf16 v[168:171], a[172:175], v[88:91], v[168:171]
    v_add_f32 v200, v162, v200
    v_exp_f32 v163, v163
    v_mfma_f32_16x16x32_bf16 v[172:175], a[172:175], v[120:123], v[192:195]
    v_add_f32 v200, v163, v200
    v_cvt_pk_bf16_f32 v93, v162, v163
    v_mfma_f32_16x16x32_bf16 v[172:175], a[168:171], v[112:115], v[172:175]
    v_exp_f32 v164, v164
    v_mfma_f32_16x16x32_bf16 v[172:175], a[164:167], v[104:107], v[172:175]
    v_add_f32 v201, v164, v201
    v_exp_f32 v165, v165
    v_mfma_f32_16x16x32_bf16 v[172:175], a[160:163], v[96:99], v[172:175]
    s_waitcnt lgkmcnt(2)
    buffer_load_dwordx4 v238, s[56:59], s27 offen offset:2048 sc1 lds
    v_add_f32 v201, v165, v201
    v_cvt_pk_bf16_f32 v108, v164, v165
    v_mfma_f32_16x16x32_bf16 a[8:11], a[176:179], v[4:7], a[8:11]
    s_waitcnt lgkmcnt(0)
    ds_read_b128 a[160:163], v205 offset:61440
    v_exp_f32 v166, v166
    v_mfma_f32_16x16x32_bf16 a[8:11], a[180:183], v[12:15], a[8:11]
    ds_read_b128 a[164:167], v206 offset:61440
    v_add_f32 v201, v166, v201
    v_exp_f32 v167, v167
    v_mfma_f32_16x16x32_bf16 a[40:43], a[180:183], v[28:31], a[40:43]
    ds_read_b128 a[168:171], v207 offset:61440
    v_add_f32 v201, v167, v201
    v_cvt_pk_bf16_f32 v109, v166, v167
    v_mfma_f32_16x16x32_bf16 a[40:43], a[176:179], v[20:23], a[40:43]
    ds_read_b128 a[172:175], v208 offset:61440
    v_exp_f32 v168, v168
    v_mfma_f32_16x16x32_bf16 a[72:75], a[176:179], v[36:39], a[72:75]
    v_add_f32 v202, v168, v202
    v_exp_f32 v169, v169
    v_mfma_f32_16x16x32_bf16 a[72:75], a[180:183], v[44:47], a[72:75]
    buffer_load_dwordx4 v238, s[56:59], s27 offen offset:3072 sc1 lds
    v_add_f32 v202, v169, v202
    v_cvt_pk_bf16_f32 v124, v168, v169
    v_mfma_f32_16x16x32_bf16 a[104:107], a[180:183], v[60:63], a[104:107]
    v_exp_f32 v170, v170
    v_mfma_f32_16x16x32_bf16 a[104:107], a[176:179], v[52:55], a[104:107]
    s_waitcnt lgkmcnt(3)
    v_add_f32 v202, v170, v202
    v_exp_f32 v171, v171
    v_mfma_f32_16x16x32_bf16 v[160:163], a[160:163], v[0:3], v[180:183]
    s_waitcnt lgkmcnt(2)
    v_add_f32 v202, v171, v202
    v_cvt_pk_bf16_f32 v125, v170, v171
    v_mfma_f32_16x16x32_bf16 v[160:163], a[164:167], v[8:11], v[160:163]
    s_waitcnt lgkmcnt(1)
    ds_read_b64_tr_b16 a[176:177], v212 offset:32768
    v_exp_f32 v172, v172
    v_mfma_f32_16x16x32_bf16 v[160:163], a[168:171], v[16:19], v[160:163]
    s_waitcnt lgkmcnt(1)
    s_add_u32 m0, s34, 81920
    v_add_f32 v203, v172, v203
    v_exp_f32 v173, v173
    v_mfma_f32_16x16x32_bf16 v[160:163], a[172:175], v[24:27], v[160:163]
    s_mov_b32 s27, 3932160
    buffer_load_dwordx4 v238, s[56:59], s27 offen sc1 lds
    v_add_f32 v203, v173, v203
    v_cvt_pk_bf16_f32 v140, v172, v173
    v_mfma_f32_16x16x32_bf16 v[164:167], a[172:175], v[56:59], v[184:187]
    ds_read_b64_tr_b16 a[178:179], v212 offset:36864
    v_exp_f32 v174, v174
    v_mfma_f32_16x16x32_bf16 v[164:167], a[168:171], v[48:51], v[164:167]
    v_add_f32 v203, v174, v203
    v_exp_f32 v175, v175
    v_mfma_f32_16x16x32_bf16 v[164:167], a[164:167], v[40:43], v[164:167]
    v_add_f32 v203, v175, v203
    v_cvt_pk_bf16_f32 v141, v174, v175
    v_mfma_f32_16x16x32_bf16 v[164:167], a[160:163], v[32:35], v[164:167]
    ds_read_b64_tr_b16 a[180:181], v212 offset:40960
    v_exp_f32 v160, v160
    v_mfma_f32_16x16x32_bf16 v[168:171], a[160:163], v[64:67], v[188:191]
    v_add_f32 v200, v160, v200
    v_exp_f32 v161, v161
    v_mfma_f32_16x16x32_bf16 v[168:171], a[164:167], v[72:75], v[168:171]
    buffer_load_dwordx4 v238, s[56:59], s27 offen offset:1024 sc1 lds
    v_add_f32 v200, v161, v200
    v_cvt_pk_bf16_f32 v94, v160, v161
    v_mfma_f32_16x16x32_bf16 v[168:171], a[168:171], v[80:83], v[168:171]
    ds_read_b64_tr_b16 a[182:183], v212 offset:45056
    v_exp_f32 v162, v162
    v_mfma_f32_16x16x32_bf16 v[168:171], a[172:175], v[88:91], v[168:171]
    v_add_f32 v200, v162, v200
    v_exp_f32 v163, v163
    v_mfma_f32_16x16x32_bf16 v[172:175], a[172:175], v[120:123], v[192:195]
    v_add_f32 v200, v163, v200
    v_cvt_pk_bf16_f32 v95, v162, v163
    v_mfma_f32_16x16x32_bf16 v[172:175], a[168:171], v[112:115], v[172:175]
    s_waitcnt vmcnt(30) lgkmcnt(0)
    v_exp_f32 v164, v164
    v_mfma_f32_16x16x32_bf16 v[172:175], a[164:167], v[104:107], v[172:175]
    s_barrier
    v_add_f32 v201, v164, v201
    v_exp_f32 v165, v165
    v_mfma_f32_16x16x32_bf16 v[172:175], a[160:163], v[96:99], v[172:175]
    buffer_load_dwordx4 v238, s[56:59], s27 offen offset:2048 sc1 lds
    v_add_f32 v201, v165, v201
    v_cvt_pk_bf16_f32 v110, v164, v165
    v_mfma_f32_16x16x32_bf16 a[12:15], a[176:179], v[4:7], a[12:15]
    ds_read_b64_tr_b16 a[160:161], v209 offset:49152
    v_exp_f32 v166, v166
    v_mfma_f32_16x16x32_bf16 a[12:15], a[180:183], v[12:15], a[12:15]
    ds_read_b64_tr_b16 a[162:163], v209 offset:53248
    v_add_f32 v201, v166, v201
    v_exp_f32 v167, v167
    v_mfma_f32_16x16x32_bf16 a[44:47], a[180:183], v[28:31], a[44:47]
    ds_read_b64_tr_b16 a[164:165], v209 offset:57344
    v_add_f32 v201, v167, v201
    v_cvt_pk_bf16_f32 v111, v166, v167
    v_mfma_f32_16x16x32_bf16 a[44:47], a[176:179], v[20:23], a[44:47]
    ds_read_b64_tr_b16 a[166:167], v209 offset:61440
    v_exp_f32 v168, v168
    v_mfma_f32_16x16x32_bf16 a[76:79], a[176:179], v[36:39], a[76:79]
    ds_read_b64_tr_b16 a[168:169], v210 offset:49152
    v_add_f32 v202, v168, v202
    v_exp_f32 v169, v169
    v_mfma_f32_16x16x32_bf16 a[76:79], a[180:183], v[44:47], a[76:79]
    ds_read_b64_tr_b16 a[170:171], v210 offset:53248
    buffer_load_dwordx4 v238, s[56:59], s27 offen offset:3072 sc1 lds
    v_add_f32 v202, v169, v202
    v_cvt_pk_bf16_f32 v126, v168, v169
    v_mfma_f32_16x16x32_bf16 a[108:111], a[180:183], v[60:63], a[108:111]
    ds_read_b64_tr_b16 a[172:173], v210 offset:57344
    v_exp_f32 v170, v170
    v_mfma_f32_16x16x32_bf16 a[108:111], a[176:179], v[52:55], a[108:111]
    s_waitcnt lgkmcnt(5)
    ds_read_b64_tr_b16 a[174:175], v210 offset:61440
    v_add_f32 v202, v170, v202
    v_exp_f32 v171, v171
    s_mul_i32 s27, s25, 20
    v_add_f32 v202, v171, v202
    v_cvt_pk_bf16_f32 v127, v170, v171
    v_exp_f32 v172, v172
    s_mul_i32 s32, s24, 5
    v_add_f32 v203, v172, v203
    v_exp_f32 v173, v173
    s_add_u32 s27, s27, s32
    v_add_f32 v203, v173, v203
    v_cvt_pk_bf16_f32 v142, v172, v173
    v_exp_f32 v174, v174
    s_lshl_b32 s27, s27, 5
    v_add_f32 v203, v174, v203
    v_exp_f32 v175, v175
    s_add_u32 s27, s27, s26
    v_add_f32 v203, v175, v203
    v_cvt_pk_bf16_f32 v143, v174, v175
    s_lshl_b32 s27, s27, 12
    s_add_u32 s8, s50, s27
    s_addc_u32 s9, s51, 0
    s_mov_b32 s10, 397312
    s_mov_b32 s11, 0x20000
    s_and_b32 s98, s26, 3
    s_lshl_b32 s98, s98, 10
    s_mov_b32 s33, 0x58800000
    v_mfma_f32_16x16x32_bf16 a[0:3], a[160:163], v[84:87], a[0:3]
    s_waitcnt lgkmcnt(4)
    ds_read_b64_tr_b16 a[176:177], v211 offset:49152
    v_mov_b32 v239, v200
    v_mfma_f32_16x16x32_bf16 a[0:3], a[164:167], v[92:95], a[0:3]
    ds_read_b64_tr_b16 a[178:179], v211 offset:53248
    v_mov_b32 v240, v201
    v_mfma_f32_16x16x32_bf16 a[32:35], a[164:167], v[108:111], a[32:35]
    s_mov_b32 s27, 1048576
    ds_read_b64_tr_b16 a[180:181], v211 offset:57344
    buffer_load_dwordx4 v[0:3], v238, s[56:59], s27 offen sc1
    v_mfma_f32_16x16x32_bf16 a[32:35], a[160:163], v[100:103], a[32:35]
    ds_read_b64_tr_b16 a[182:183], v211 offset:61440
    v_mov_b32 v241, v202
    v_mfma_f32_16x16x32_bf16 a[64:67], a[160:163], v[116:119], a[64:67]
    v_mov_b32 v242, v203
    s_nop 0
    v_mfma_f32_16x16x32_bf16 a[64:67], a[164:167], v[124:127], a[64:67]
    v_permlane16_swap_b32 v200, v239
    v_permlane16_swap_b32 v201, v240
    v_mfma_f32_16x16x32_bf16 a[96:99], a[164:167], v[140:143], a[96:99]
    buffer_load_dwordx4 v[8:11], v238, s[56:59], s27 offen offset:1024 sc1
    v_permlane16_swap_b32 v202, v241
    v_mfma_f32_16x16x32_bf16 a[96:99], a[160:163], v[132:135], a[96:99]
    s_waitcnt lgkmcnt(6)
    v_permlane16_swap_b32 v203, v242
    v_add_f32 v200, v200, v239
    v_mfma_f32_16x16x32_bf16 a[4:7], a[168:171], v[84:87], a[4:7]
    s_waitcnt lgkmcnt(4)
    ds_read_b64_tr_b16 a[184:185], v212 offset:49152
    v_mov_b32 v239, v200
    v_mfma_f32_16x16x32_bf16 a[4:7], a[172:175], v[92:95], a[4:7]
    ds_read_b64_tr_b16 a[186:187], v212 offset:53248
    v_add_f32 v201, v201, v240
    v_mfma_f32_16x16x32_bf16 a[36:39], a[172:175], v[108:111], a[36:39]
    ds_read_b64_tr_b16 a[188:189], v212 offset:57344
    buffer_load_dwordx4 v[16:19], v238, s[56:59], s27 offen offset:2048 sc1
    v_mfma_f32_16x16x32_bf16 a[36:39], a[168:171], v[100:103], a[36:39]
    ds_read_b64_tr_b16 a[190:191], v212 offset:61440
    v_mov_b32 v240, v201
    v_mfma_f32_16x16x32_bf16 a[68:71], a[168:171], v[116:119], a[68:71]
    v_add_f32 v202, v202, v241
    v_mov_b32 v241, v202
    v_mfma_f32_16x16x32_bf16 a[68:71], a[172:175], v[124:127], a[68:71]
    v_add_f32 v203, v203, v242
    v_mov_b32 v242, v203
    v_mfma_f32_16x16x32_bf16 a[100:103], a[172:175], v[140:143], a[100:103]
    buffer_load_dwordx4 v[24:27], v238, s[56:59], s27 offen offset:3072 sc1
    s_nop 0
    v_mfma_f32_16x16x32_bf16 a[100:103], a[168:171], v[132:135], a[100:103]
    s_waitcnt lgkmcnt(6)
    v_permlane32_swap_b32 v200, v239
    v_permlane32_swap_b32 v201, v240
    v_mfma_f32_16x16x32_bf16 a[8:11], a[176:179], v[84:87], a[8:11]
    s_waitcnt lgkmcnt(4)
    ds_read_b64_tr_b16 a[160:161], v213 offset:32768
    v_permlane32_swap_b32 v202, v241
    v_mfma_f32_16x16x32_bf16 a[8:11], a[180:183], v[92:95], a[8:11]
    ds_read_b64_tr_b16 a[162:163], v213 offset:36864
    v_permlane32_swap_b32 v203, v242
    v_mfma_f32_16x16x32_bf16 a[40:43], a[180:183], v[108:111], a[40:43]
    s_mov_b32 s27, 1310720
    ds_read_b64_tr_b16 a[164:165], v213 offset:40960
    buffer_load_dwordx4 v[32:35], v238, s[56:59], s27 offen sc1
    v_mfma_f32_16x16x32_bf16 a[40:43], a[176:179], v[100:103], a[40:43]
    ds_read_b64_tr_b16 a[166:167], v213 offset:45056
    v_add_f32 v200, v200, v239
    v_mfma_f32_16x16x32_bf16 a[72:75], a[176:179], v[116:119], a[72:75]
    v_add_f32 v201, v201, v240
    v_add_f32 v202, v202, v241
    v_mfma_f32_16x16x32_bf16 a[72:75], a[180:183], v[124:127], a[72:75]
    v_add_f32 v203, v203, v242
    v_cmp_nlt_f32 s[86:87], v200, s33
    v_mfma_f32_16x16x32_bf16 a[104:107], a[180:183], v[140:143], a[104:107]
    buffer_load_dwordx4 v[40:43], v238, s[56:59], s27 offen offset:1024 sc1
    v_cmp_nlt_f32 s[88:89], v201, s33
    v_mfma_f32_16x16x32_bf16 a[104:107], a[176:179], v[132:135], a[104:107]
    s_waitcnt lgkmcnt(6)
    v_cmp_nlt_f32 s[90:91], v202, s33
    v_cmp_nlt_f32 s[92:93], v203, s33
    v_mfma_f32_16x16x32_bf16 a[12:15], a[184:187], v[84:87], a[12:15]
    s_waitcnt lgkmcnt(4)
    ds_read_b64_tr_b16 a[168:169], v214 offset:32768
    v_rcp_f32 v200, v200
    v_mfma_f32_16x16x32_bf16 a[12:15], a[188:191], v[92:95], a[12:15]
    ds_read_b64_tr_b16 a[170:171], v214 offset:36864
    v_rcp_f32 v201, v201
    v_mfma_f32_16x16x32_bf16 a[44:47], a[188:191], v[108:111], a[44:47]
    ds_read_b64_tr_b16 a[172:173], v214 offset:40960
    buffer_load_dwordx4 v[48:51], v238, s[56:59], s27 offen offset:2048 sc1
    v_mfma_f32_16x16x32_bf16 a[44:47], a[184:187], v[100:103], a[44:47]
    ds_read_b64_tr_b16 a[174:175], v214 offset:45056
    v_rcp_f32 v202, v202
    v_mfma_f32_16x16x32_bf16 a[76:79], a[184:187], v[116:119], a[76:79]
    v_rcp_f32 v203, v203
    v_mfma_f32_16x16x32_bf16 a[76:79], a[188:191], v[124:127], a[76:79]
    s_or_b64 s[86:87], s[86:87], s[88:89]
    s_or_b64 s[86:87], s[86:87], s[90:91]
    s_or_b64 s[86:87], s[86:87], s[92:93]
    s_or_b32 s86, s86, s87
    v_and_b32 v245, 3, v237
    v_lshlrev_b32 v245, 12, v245
    v_mfma_f32_16x16x32_bf16 a[108:111], a[188:191], v[140:143], a[108:111]
    buffer_load_dwordx4 v[56:59], v238, s[56:59], s27 offen offset:3072 sc1
    v_lshl_add_u32 v245, s24, 2, v245
    v_mfma_f32_16x16x32_bf16 a[108:111], a[184:187], v[132:135], a[108:111]
    s_waitcnt lgkmcnt(6)
    v_add_u32 v245, 0x10000, v245
    v_mov_b32 v228, 0
    v_mfma_f32_16x16x32_bf16 a[16:19], a[160:163], v[4:7], a[16:19]
    s_waitcnt lgkmcnt(4)
    ds_read_b64_tr_b16 a[176:177], v215 offset:32768
    v_mov_b32 v229, 0
    v_mfma_f32_16x16x32_bf16 a[16:19], a[164:167], v[12:15], a[16:19]
    ds_read_b64_tr_b16 a[178:179], v215 offset:36864
    v_mov_b32 v230, 0
    v_mfma_f32_16x16x32_bf16 a[48:51], a[164:167], v[28:31], a[48:51]
    s_mov_b32 s27, 1572864
    ds_read_b64_tr_b16 a[180:181], v215 offset:40960
    buffer_load_dwordx4 v[64:67], v238, s[56:59], s27 offen sc1
    v_mfma_f32_16x16x32_bf16 a[48:51], a[160:163], v[20:23], a[48:51]
    ds_read_b64_tr_b16 a[182:183], v215 offset:45056
    v_mov_b32 v231, 0
    v_mfma_f32_16x16x32_bf16 a[80:83], a[160:163], v[36:39], a[80:83]
    v_mov_b32 v232, 0
    v_mov_b32 v233, 0
    v_mfma_f32_16x16x32_bf16 a[80:83], a[164:167], v[44:47], a[80:83]
    v_mov_b32 v234, 0
    v_mov_b32 v235, 0
    v_mfma_f32_16x16x32_bf16 a[112:115], a[164:167], v[60:63], a[112:115]
    buffer_load_dwordx4 v[72:75], v238, s[56:59], s27 offen offset:1024 sc1
    v_add_u32 v223, s34, v238
    v_mfma_f32_16x16x32_bf16 a[112:115], a[160:163], v[52:55], a[112:115]
    s_waitcnt lgkmcnt(6)
    v_add_u32 v224, 0x10000, v223
    v_add_u32 v225, 0x20000, v223
    v_mfma_f32_16x16x32_bf16 a[20:23], a[168:171], v[4:7], a[20:23]
    s_waitcnt lgkmcnt(4)
    ds_read_b64_tr_b16 a[184:185], v216 offset:32768
    v_accvgpr_read_b32 v160, a0
    v_mfma_f32_16x16x32_bf16 a[20:23], a[172:175], v[12:15], a[20:23]
    ds_read_b64_tr_b16 a[186:187], v216 offset:36864
    v_accvgpr_read_b32 v161, a1
    v_mfma_f32_16x16x32_bf16 a[52:55], a[172:175], v[28:31], a[52:55]
    ds_read_b64_tr_b16 a[188:189], v216 offset:40960
    buffer_load_dwordx4 v[80:83], v238, s[56:59], s27 offen offset:2048 sc1
    v_mfma_f32_16x16x32_bf16 a[52:55], a[168:171], v[20:23], a[52:55]
    ds_read_b64_tr_b16 a[190:191], v216 offset:45056
    v_accvgpr_read_b32 v162, a2
    v_mfma_f32_16x16x32_bf16 a[84:87], a[168:171], v[36:39], a[84:87]
    v_accvgpr_read_b32 v163, a3
    v_accvgpr_read_b32 v164, a4
    v_mfma_f32_16x16x32_bf16 a[84:87], a[172:175], v[44:47], a[84:87]
    v_accvgpr_read_b32 v165, a5
    v_accvgpr_read_b32 v166, a6
    v_mfma_f32_16x16x32_bf16 a[116:119], a[172:175], v[60:63], a[116:119]
    buffer_load_dwordx4 v[88:91], v238, s[56:59], s27 offen offset:3072 sc1
    v_accvgpr_read_b32 v167, a7
    v_mfma_f32_16x16x32_bf16 a[116:119], a[168:171], v[52:55], a[116:119]
    s_waitcnt lgkmcnt(6)
    v_mul_f32 v160, v160, v200
    v_mul_f32 v161, v161, v200
    v_mfma_f32_16x16x32_bf16 a[24:27], a[176:179], v[4:7], a[24:27]
    s_waitcnt lgkmcnt(4)
    ds_read_b64_tr_b16 a[160:161], v213 offset:49152
    v_mul_f32 v162, v162, v200
    v_mfma_f32_16x16x32_bf16 a[24:27], a[180:183], v[12:15], a[24:27]
    ds_read_b64_tr_b16 a[162:163], v213 offset:53248
    v_mul_f32 v163, v163, v200
    v_mfma_f32_16x16x32_bf16 a[56:59], a[180:183], v[28:31], a[56:59]
    s_mov_b32 s27, 1835008
    ds_read_b64_tr_b16 a[164:165], v213 offset:57344
    buffer_load_dwordx4 v[96:99], v238, s[56:59], s27 offen sc1
    v_mfma_f32_16x16x32_bf16 a[56:59], a[176:179], v[20:23], a[56:59]
    ds_read_b64_tr_b16 a[166:167], v213 offset:61440
    v_mul_f32 v164, v164, v200
    v_mfma_f32_16x16x32_bf16 a[88:91], a[176:179], v[36:39], a[88:91]
    v_mul_f32 v165, v165, v200
    v_mul_f32 v166, v166, v200
    v_mfma_f32_16x16x32_bf16 a[88:91], a[180:183], v[44:47], a[88:91]
    v_mul_f32 v167, v167, v200
    v_cvt_pk_bf16_f32 v160, v160, v161
    v_mfma_f32_16x16x32_bf16 a[120:123], a[180:183], v[60:63], a[120:123]
    buffer_load_dwordx4 v[104:107], v238, s[56:59], s27 offen offset:1024 sc1
    v_cvt_pk_bf16_f32 v161, v162, v163
    v_mfma_f32_16x16x32_bf16 a[120:123], a[176:179], v[52:55], a[120:123]
    s_waitcnt lgkmcnt(6)
    v_cvt_pk_bf16_f32 v162, v164, v165
    v_cvt_pk_bf16_f32 v163, v166, v167
    v_mfma_f32_16x16x32_bf16 a[28:31], a[184:187], v[4:7], a[28:31]
    s_waitcnt lgkmcnt(4)
    ds_read_b64_tr_b16 a[168:169], v214 offset:49152
    s_xor_b32 s29, s98, 0
    buffer_store_dwordx4 v[160:163], v238, s[8:11], s29 offen sc0 sc1
    v_mfma_f32_16x16x32_bf16 a[28:31], a[188:191], v[12:15], a[28:31]
    ds_read_b64_tr_b16 a[170:171], v214 offset:53248
    v_mfma_f32_16x16x32_bf16 v[232:235], v[228:231], v[160:163], v[232:235]
    v_mfma_f32_16x16x32_bf16 a[60:63], a[188:191], v[28:31], a[60:63]
    ds_read_b64_tr_b16 a[172:173], v214 offset:57344
    buffer_load_dwordx4 v[112:115], v238, s[56:59], s27 offen offset:2048 sc1
    v_mfma_f32_16x16x32_bf16 a[60:63], a[184:187], v[20:23], a[60:63]
    ds_read_b64_tr_b16 a[174:175], v214 offset:61440
    v_accvgpr_read_b32 v168, a32
    v_mfma_f32_16x16x32_bf16 a[92:95], a[184:187], v[36:39], a[92:95]
    v_accvgpr_read_b32 v169, a33
    v_accvgpr_read_b32 v170, a34
    v_mfma_f32_16x16x32_bf16 a[92:95], a[188:191], v[44:47], a[92:95]
    v_accvgpr_read_b32 v171, a35
    v_accvgpr_read_b32 v172, a36
    v_mfma_f32_16x16x32_bf16 a[124:127], a[188:191], v[60:63], a[124:127]
    buffer_load_dwordx4 v[120:123], v238, s[56:59], s27 offen offset:3072 sc1
    v_accvgpr_read_b32 v173, a37
    v_mfma_f32_16x16x32_bf16 a[124:127], a[184:187], v[52:55], a[124:127]
    s_waitcnt lgkmcnt(6)
    v_accvgpr_read_b32 v174, a38
    v_accvgpr_read_b32 v175, a39
    v_mfma_f32_16x16x32_bf16 a[16:19], a[160:163], v[84:87], a[16:19]
    s_waitcnt lgkmcnt(4)
    ds_read_b64_tr_b16 a[176:177], v215 offset:49152
    v_mul_f32 v168, v168, v201
    v_mfma_f32_16x16x32_bf16 a[16:19], a[164:167], v[92:95], a[16:19]
    ds_read_b64_tr_b16 a[178:179], v215 offset:53248
    v_mul_f32 v169, v169, v201
    v_mfma_f32_16x16x32_bf16 a[48:51], a[164:167], v[108:111], a[48:51]
    ds_read_b64_tr_b16 a[180:181], v215 offset:57344
    v_mul_f32 v170, v170, v201
    v_mfma_f32_16x16x32_bf16 a[48:51], a[160:163], v[100:103], a[48:51]
    ds_read_b64_tr_b16 a[182:183], v215 offset:61440
    v_mul_f32 v171, v171, v201
    v_mfma_f32_16x16x32_bf16 a[80:83], a[160:163], v[116:119], a[80:83]
    v_mul_f32 v172, v172, v201
    v_mul_f32 v173, v173, v201
    v_mfma_f32_16x16x32_bf16 a[80:83], a[164:167], v[124:127], a[80:83]
    v_mul_f32 v174, v174, v201
    v_mul_f32 v175, v175, v201
    v_mfma_f32_16x16x32_bf16 a[112:115], a[164:167], v[140:143], a[112:115]
    v_cvt_pk_bf16_f32 v168, v168, v169
    v_cvt_pk_bf16_f32 v169, v170, v171
    v_mfma_f32_16x16x32_bf16 a[112:115], a[160:163], v[132:135], a[112:115]
    s_waitcnt lgkmcnt(6)
    v_cvt_pk_bf16_f32 v170, v172, v173
    v_cvt_pk_bf16_f32 v171, v174, v175
    v_mfma_f32_16x16x32_bf16 a[20:23], a[168:171], v[84:87], a[20:23]
    s_waitcnt lgkmcnt(4)
    ds_read_b64_tr_b16 a[184:185], v216 offset:49152
    s_xor_b32 s29, s98, 131072
    buffer_store_dwordx4 v[168:171], v238, s[8:11], s29 offen sc0 sc1
    v_mfma_f32_16x16x32_bf16 a[20:23], a[172:175], v[92:95], a[20:23]
    ds_read_b64_tr_b16 a[186:187], v216 offset:53248
    v_mfma_f32_16x16x32_bf16 v[232:235], v[228:231], v[168:171], v[232:235]
    v_mfma_f32_16x16x32_bf16 a[52:55], a[172:175], v[108:111], a[52:55]
    ds_read_b64_tr_b16 a[188:189], v216 offset:57344
    v_accvgpr_read_b32 v176, a64
    v_mfma_f32_16x16x32_bf16 a[52:55], a[168:171], v[100:103], a[52:55]
    ds_read_b64_tr_b16 a[190:191], v216 offset:61440
    v_accvgpr_read_b32 v177, a65
    v_mfma_f32_16x16x32_bf16 a[84:87], a[168:171], v[116:119], a[84:87]
    v_accvgpr_read_b32 v178, a66
    v_accvgpr_read_b32 v179, a67
    v_mfma_f32_16x16x32_bf16 a[84:87], a[172:175], v[124:127], a[84:87]
    v_accvgpr_read_b32 v180, a68
    v_accvgpr_read_b32 v181, a69
    v_mfma_f32_16x16x32_bf16 a[116:119], a[172:175], v[140:143], a[116:119]
    v_accvgpr_read_b32 v182, a70
    v_accvgpr_read_b32 v183, a71
    v_mfma_f32_16x16x32_bf16 a[116:119], a[168:171], v[132:135], a[116:119]
    s_waitcnt lgkmcnt(6)
    v_mul_f32 v176, v176, v202
    v_mul_f32 v177, v177, v202
    v_mfma_f32_16x16x32_bf16 a[24:27], a[176:179], v[84:87], a[24:27]
    s_waitcnt lgkmcnt(4)
    v_mul_f32 v178, v178, v202
    v_mul_f32 v179, v179, v202
    v_mfma_f32_16x16x32_bf16 a[24:27], a[180:183], v[92:95], a[24:27]
    v_mul_f32 v180, v180, v202
    v_mul_f32 v181, v181, v202
    v_mfma_f32_16x16x32_bf16 a[56:59], a[180:183], v[108:111], a[56:59]
    v_mul_f32 v182, v182, v202
    v_mul_f32 v183, v183, v202
    v_mfma_f32_16x16x32_bf16 a[56:59], a[176:179], v[100:103], a[56:59]
    v_cvt_pk_bf16_f32 v176, v176, v177
    v_cvt_pk_bf16_f32 v177, v178, v179
    v_mfma_f32_16x16x32_bf16 a[88:91], a[176:179], v[116:119], a[88:91]
    v_cvt_pk_bf16_f32 v178, v180, v181
    v_cvt_pk_bf16_f32 v179, v182, v183
    v_mfma_f32_16x16x32_bf16 a[88:91], a[180:183], v[124:127], a[88:91]
    s_xor_b32 s29, s98, 262144
    buffer_store_dwordx4 v[176:179], v238, s[8:11], s29 offen sc0 sc1
    v_mfma_f32_16x16x32_bf16 a[120:123], a[180:183], v[140:143], a[120:123]
    v_mfma_f32_16x16x32_bf16 v[232:235], v[228:231], v[176:179], v[232:235]
    v_accvgpr_read_b32 v184, a96
    v_mfma_f32_16x16x32_bf16 a[120:123], a[176:179], v[132:135], a[120:123]
    s_waitcnt lgkmcnt(2)
    v_accvgpr_read_b32 v185, a97
    v_accvgpr_read_b32 v186, a98
    v_mfma_f32_16x16x32_bf16 a[28:31], a[184:187], v[84:87], a[28:31]
    s_waitcnt lgkmcnt(0)
    v_accvgpr_read_b32 v187, a99
    v_accvgpr_read_b32 v188, a100
    v_mfma_f32_16x16x32_bf16 a[28:31], a[188:191], v[92:95], a[28:31]
    v_accvgpr_read_b32 v189, a101
    v_accvgpr_read_b32 v190, a102
    v_mfma_f32_16x16x32_bf16 a[60:63], a[188:191], v[108:111], a[60:63]
    v_accvgpr_read_b32 v191, a103
    v_mul_f32 v184, v184, v203
    v_mfma_f32_16x16x32_bf16 a[60:63], a[184:187], v[100:103], a[60:63]
    v_mul_f32 v185, v185, v203
    v_mul_f32 v186, v186, v203
    v_mfma_f32_16x16x32_bf16 a[92:95], a[184:187], v[116:119], a[92:95]
    v_mul_f32 v187, v187, v203
    v_mul_f32 v188, v188, v203
    v_mfma_f32_16x16x32_bf16 a[92:95], a[188:191], v[124:127], a[92:95]
    v_mul_f32 v189, v189, v203
    v_mul_f32 v190, v190, v203
    v_mfma_f32_16x16x32_bf16 a[124:127], a[188:191], v[140:143], a[124:127]
    v_mul_f32 v191, v191, v203
    v_cvt_pk_bf16_f32 v184, v184, v185
    v_mfma_f32_16x16x32_bf16 a[124:127], a[184:187], v[132:135], a[124:127]
    v_cvt_pk_bf16_f32 v185, v186, v187
    v_cvt_pk_bf16_f32 v186, v188, v189
    v_cvt_pk_bf16_f32 v187, v190, v191
    s_xor_b32 s29, s98, 393216
    buffer_store_dwordx4 v[184:187], v238, s[8:11], s29 offen sc0 sc1
    v_mfma_f32_16x16x32_bf16 v[232:235], v[228:231], v[184:187], v[232:235]
    v_accvgpr_read_b32 v192, a8
    v_accvgpr_read_b32 v193, a9
    v_accvgpr_read_b32 v194, a10
    v_accvgpr_read_b32 v195, a11
    v_accvgpr_read_b32 v196, a12
    v_accvgpr_read_b32 v197, a13
    v_accvgpr_read_b32 v198, a14
    v_accvgpr_read_b32 v199, a15
    v_mul_f32 v192, v192, v200
    v_mul_f32 v193, v193, v200
    v_mul_f32 v194, v194, v200
    v_mul_f32 v195, v195, v200
    v_mul_f32 v196, v196, v200
    v_mul_f32 v197, v197, v200
    v_mul_f32 v198, v198, v200
    v_mul_f32 v199, v199, v200
    v_cvt_pk_bf16_f32 v192, v192, v193
    v_cvt_pk_bf16_f32 v193, v194, v195
    v_cvt_pk_bf16_f32 v194, v196, v197
    v_cvt_pk_bf16_f32 v195, v198, v199
    s_xor_b32 s29, s98, 1024
    buffer_store_dwordx4 v[192:195], v238, s[8:11], s29 offen sc0 sc1
    v_mfma_f32_16x16x32_bf16 v[232:235], v[228:231], v[192:195], v[232:235]
    v_accvgpr_read_b32 v160, a40
    v_accvgpr_read_b32 v161, a41
    v_accvgpr_read_b32 v162, a42
    v_accvgpr_read_b32 v163, a43
    v_accvgpr_read_b32 v164, a44
    v_accvgpr_read_b32 v165, a45
    v_accvgpr_read_b32 v166, a46
    v_accvgpr_read_b32 v167, a47
    v_mul_f32 v160, v160, v201
    v_mul_f32 v161, v161, v201
    v_mul_f32 v162, v162, v201
    v_mul_f32 v163, v163, v201
    v_mul_f32 v164, v164, v201
    v_mul_f32 v165, v165, v201
    v_mul_f32 v166, v166, v201
    v_mul_f32 v167, v167, v201
    v_cvt_pk_bf16_f32 v160, v160, v161
    v_cvt_pk_bf16_f32 v161, v162, v163
    v_cvt_pk_bf16_f32 v162, v164, v165
    v_cvt_pk_bf16_f32 v163, v166, v167
    s_xor_b32 s29, s98, 132096
    buffer_store_dwordx4 v[160:163], v238, s[8:11], s29 offen sc0 sc1
    v_mfma_f32_16x16x32_bf16 v[232:235], v[228:231], v[160:163], v[232:235]
    v_accvgpr_read_b32 v168, a72
    v_accvgpr_read_b32 v169, a73
    v_accvgpr_read_b32 v170, a74
    v_accvgpr_read_b32 v171, a75
    v_accvgpr_read_b32 v172, a76
    v_accvgpr_read_b32 v173, a77
    v_accvgpr_read_b32 v174, a78
    v_accvgpr_read_b32 v175, a79
    v_mul_f32 v168, v168, v202
    v_mul_f32 v169, v169, v202
    v_mul_f32 v170, v170, v202
    v_mul_f32 v171, v171, v202
    v_mul_f32 v172, v172, v202
    v_mul_f32 v173, v173, v202
    v_mul_f32 v174, v174, v202
    v_mul_f32 v175, v175, v202
    v_cvt_pk_bf16_f32 v168, v168, v169
    v_cvt_pk_bf16_f32 v169, v170, v171
    v_cvt_pk_bf16_f32 v170, v172, v173
    v_cvt_pk_bf16_f32 v171, v174, v175
    s_xor_b32 s29, s98, 263168
    buffer_store_dwordx4 v[168:171], v238, s[8:11], s29 offen sc0 sc1
    v_mfma_f32_16x16x32_bf16 v[232:235], v[228:231], v[168:171], v[232:235]
    v_accvgpr_read_b32 v176, a104
    v_accvgpr_read_b32 v177, a105
    v_accvgpr_read_b32 v178, a106
    v_accvgpr_read_b32 v179, a107
    v_accvgpr_read_b32 v180, a108
    v_accvgpr_read_b32 v181, a109
    v_accvgpr_read_b32 v182, a110
    v_accvgpr_read_b32 v183, a111
    v_mul_f32 v176, v176, v203
    v_mul_f32 v177, v177, v203
    v_mul_f32 v178, v178, v203
    v_mul_f32 v179, v179, v203
    v_mul_f32 v180, v180, v203
    v_mul_f32 v181, v181, v203
    v_mul_f32 v182, v182, v203
    v_mul_f32 v183, v183, v203
    v_cvt_pk_bf16_f32 v176, v176, v177
    v_cvt_pk_bf16_f32 v177, v178, v179
    v_cvt_pk_bf16_f32 v178, v180, v181
    v_cvt_pk_bf16_f32 v179, v182, v183
    s_xor_b32 s29, s98, 394240
    buffer_store_dwordx4 v[176:179], v238, s[8:11], s29 offen sc0 sc1
    v_mfma_f32_16x16x32_bf16 v[232:235], v[228:231], v[176:179], v[232:235]
    s_barrier
    s_nop 7
    v_accvgpr_read_b32 v184, a16
    v_accvgpr_read_b32 v185, a17
    v_accvgpr_read_b32 v186, a18
    v_accvgpr_read_b32 v187, a19
    v_accvgpr_read_b32 v188, a20
    v_accvgpr_read_b32 v189, a21
    v_accvgpr_read_b32 v190, a22
    v_accvgpr_read_b32 v191, a23
    v_mul_f32 v184, v184, v200
    v_mul_f32 v185, v185, v200
    v_mul_f32 v186, v186, v200
    v_mul_f32 v187, v187, v200
    v_mul_f32 v188, v188, v200
    v_mul_f32 v189, v189, v200
    v_mul_f32 v190, v190, v200
    v_mul_f32 v191, v191, v200
    v_cvt_pk_bf16_f32 v128, v184, v185
    v_cvt_pk_bf16_f32 v129, v186, v187
    v_cvt_pk_bf16_f32 v130, v188, v189
    v_cvt_pk_bf16_f32 v131, v190, v191
    v_accvgpr_read_b32 v192, a48
    v_accvgpr_read_b32 v193, a49
    v_mfma_f32_16x16x32_bf16 v[232:235], v[228:231], v[128:131], v[232:235]
    v_accvgpr_read_b32 v194, a50
    v_accvgpr_read_b32 v195, a51
    v_accvgpr_read_b32 v196, a52
    v_accvgpr_read_b32 v197, a53
    v_accvgpr_read_b32 v198, a54
    v_accvgpr_read_b32 v199, a55
    v_mul_f32 v192, v192, v201
    v_mul_f32 v193, v193, v201
    v_mul_f32 v194, v194, v201
    v_mul_f32 v195, v195, v201
    v_mul_f32 v196, v196, v201
    v_mul_f32 v197, v197, v201
    v_mul_f32 v198, v198, v201
    v_mul_f32 v199, v199, v201
    v_cvt_pk_bf16_f32 v136, v192, v193
    v_cvt_pk_bf16_f32 v137, v194, v195
    v_cvt_pk_bf16_f32 v138, v196, v197
    v_cvt_pk_bf16_f32 v139, v198, v199
    v_accvgpr_read_b32 v160, a80
    v_accvgpr_read_b32 v161, a81
    v_mfma_f32_16x16x32_bf16 v[232:235], v[228:231], v[136:139], v[232:235]
    v_accvgpr_read_b32 v162, a82
    v_accvgpr_read_b32 v163, a83
    v_accvgpr_read_b32 v164, a84
    v_accvgpr_read_b32 v165, a85
    v_accvgpr_read_b32 v166, a86
    v_accvgpr_read_b32 v167, a87
    v_mul_f32 v160, v160, v202
    v_mul_f32 v161, v161, v202
    v_mul_f32 v162, v162, v202
    v_mul_f32 v163, v163, v202
    v_mul_f32 v164, v164, v202
    v_mul_f32 v165, v165, v202
    v_mul_f32 v166, v166, v202
    v_mul_f32 v167, v167, v202
    v_cvt_pk_bf16_f32 v144, v160, v161
    v_cvt_pk_bf16_f32 v145, v162, v163
    v_cvt_pk_bf16_f32 v146, v164, v165
    v_cvt_pk_bf16_f32 v147, v166, v167
    v_accvgpr_read_b32 v168, a112
    v_accvgpr_read_b32 v169, a113
    v_mfma_f32_16x16x32_bf16 v[232:235], v[228:231], v[144:147], v[232:235]
    v_accvgpr_read_b32 v170, a114
    v_accvgpr_read_b32 v171, a115
    v_accvgpr_read_b32 v172, a116
    v_accvgpr_read_b32 v173, a117
    v_accvgpr_read_b32 v174, a118
    v_accvgpr_read_b32 v175, a119
    v_mul_f32 v168, v168, v203
    v_mul_f32 v169, v169, v203
    v_mul_f32 v170, v170, v203
    v_mul_f32 v171, v171, v203
    v_mul_f32 v172, v172, v203
    v_mul_f32 v173, v173, v203
    v_mul_f32 v174, v174, v203
    v_mul_f32 v175, v175, v203
    v_cvt_pk_bf16_f32 v152, v168, v169
    v_cvt_pk_bf16_f32 v153, v170, v171
    v_cvt_pk_bf16_f32 v154, v172, v173
    v_cvt_pk_bf16_f32 v155, v174, v175
    v_accvgpr_read_b32 v176, a24
    v_accvgpr_read_b32 v177, a25
    v_mfma_f32_16x16x32_bf16 v[232:235], v[228:231], v[152:155], v[232:235]
    v_accvgpr_read_b32 v178, a26
    v_accvgpr_read_b32 v179, a27
    v_accvgpr_read_b32 v180, a28
    v_accvgpr_read_b32 v181, a29
    v_accvgpr_read_b32 v182, a30
    v_accvgpr_read_b32 v183, a31
    v_mul_f32 v176, v176, v200
    v_mul_f32 v177, v177, v200
    v_mul_f32 v178, v178, v200
    v_mul_f32 v179, v179, v200
    v_mul_f32 v180, v180, v200
    v_mul_f32 v181, v181, v200
    v_mul_f32 v182, v182, v200
    v_mul_f32 v183, v183, v200
    v_cvt_pk_bf16_f32 v132, v176, v177
    v_cvt_pk_bf16_f32 v133, v178, v179
    v_cvt_pk_bf16_f32 v134, v180, v181
    v_cvt_pk_bf16_f32 v135, v182, v183
    v_accvgpr_read_b32 v184, a56
    v_accvgpr_read_b32 v185, a57
    v_mfma_f32_16x16x32_bf16 v[232:235], v[228:231], v[132:135], v[232:235]
    v_accvgpr_read_b32 v186, a58
    v_accvgpr_read_b32 v187, a59
    v_accvgpr_read_b32 v188, a60
    v_accvgpr_read_b32 v189, a61
    v_accvgpr_read_b32 v190, a62
    v_accvgpr_read_b32 v191, a63
    v_mul_f32 v184, v184, v201
    v_mul_f32 v185, v185, v201
    v_mul_f32 v186, v186, v201
    v_mul_f32 v187, v187, v201
    v_mul_f32 v188, v188, v201
    v_mul_f32 v189, v189, v201
    v_mul_f32 v190, v190, v201
    v_mul_f32 v191, v191, v201
    v_cvt_pk_bf16_f32 v140, v184, v185
    v_cvt_pk_bf16_f32 v141, v186, v187
    v_cvt_pk_bf16_f32 v142, v188, v189
    v_cvt_pk_bf16_f32 v143, v190, v191
    v_cmp_u_f32 vcc, v232, v232
    v_mov_b32 v254, 1
    s_or_b32 s86, s86, vcc_lo
    s_or_b32 s86, s86, vcc_hi
    s_cmp_eq_u32 s86, 0
    s_cselect_b32 s32, s53, 0x7ff00000
    s_waitcnt vmcnt(0)
    buffer_store_dword v254, v253, s[60:63], s32 offen sc0 sc1
    s_xor_b32 s29, s98, 2048
    buffer_store_dwordx4 v[128:131], v238, s[8:11], s29 offen sc0 sc1
    s_xor_b32 s29, s98, 133120
    buffer_store_dwordx4 v[136:139], v238, s[8:11], s29 offen sc0 sc1
    s_xor_b32 s29, s98, 264192
    buffer_store_dwordx4 v[144:147], v238, s[8:11], s29 offen sc0 sc1
    s_xor_b32 s29, s98, 395264
    buffer_store_dwordx4 v[152:155], v238, s[8:11], s29 offen sc0 sc1
    s_xor_b32 s29, s98, 3072
    buffer_store_dwordx4 v[132:135], v238, s[8:11], s29 offen sc0 sc1
    s_xor_b32 s29, s98, 134144
    buffer_store_dwordx4 v[140:143], v238, s[8:11], s29 offen sc0 sc1
    v_accvgpr_read_b32 v192, a88
    v_accvgpr_read_b32 v193, a89
    v_mfma_f32_16x16x32_bf16 v[232:235], v[228:231], v[140:143], v[232:235]
    v_accvgpr_read_b32 v194, a90
    v_accvgpr_read_b32 v195, a91
    v_accvgpr_read_b32 v196, a92
    v_accvgpr_read_b32 v197, a93
    v_accvgpr_read_b32 v198, a94
    v_accvgpr_read_b32 v199, a95
    v_mul_f32 v192, v192, v202
    v_mul_f32 v193, v193, v202
    v_mul_f32 v194, v194, v202
    v_mul_f32 v195, v195, v202
    v_mul_f32 v196, v196, v202
    v_mul_f32 v197, v197, v202
    v_mul_f32 v198, v198, v202
    v_mul_f32 v199, v199, v202
    v_cvt_pk_bf16_f32 v148, v192, v193
    v_cvt_pk_bf16_f32 v149, v194, v195
    v_cvt_pk_bf16_f32 v150, v196, v197
    v_cvt_pk_bf16_f32 v151, v198, v199
    s_xor_b32 s29, s98, 265216
    buffer_store_dwordx4 v[148:151], v238, s[8:11], s29 offen sc0 sc1
    v_accvgpr_read_b32 v160, a120
    v_accvgpr_read_b32 v161, a121
    v_mfma_f32_16x16x32_bf16 v[232:235], v[228:231], v[148:151], v[232:235]
    v_accvgpr_read_b32 v162, a122
    v_accvgpr_read_b32 v163, a123
    v_accvgpr_read_b32 v164, a124
    v_accvgpr_read_b32 v165, a125
    v_accvgpr_read_b32 v166, a126
    v_accvgpr_read_b32 v167, a127
    v_mul_f32 v160, v160, v203
    v_mul_f32 v161, v161, v203
    v_mul_f32 v162, v162, v203
    v_mul_f32 v163, v163, v203
    v_mul_f32 v164, v164, v203
    v_mul_f32 v165, v165, v203
    v_mul_f32 v166, v166, v203
    v_mul_f32 v167, v167, v203
    v_cvt_pk_bf16_f32 v156, v160, v161
    v_cvt_pk_bf16_f32 v157, v162, v163
    v_cvt_pk_bf16_f32 v158, v164, v165
    v_cvt_pk_bf16_f32 v159, v166, v167
    s_and_b32 s0, s2, 3
    s_lshl_b32 s0, s0, 1
    v_mfma_f32_16x16x32_bf16 v[232:235], v[228:231], v[156:159], v[232:235]
    s_lshr_b32 s27, s1, 4
    s_add_u32 s0, s0, s27
    s_and_b32 s28, s55, 1
    s_lshl_b32 s28, s28, 2
    s_add_u32 s28, s28, s24
    s_xor_b32 s29, s55, 1
    s_mul_i32 s27, s0, 20
    s_mul_i32 s32, s29, 5
    s_add_u32 s27, s27, s32
    s_lshl_b32 s27, s27, 17
    s_lshl_b32 s32, s28, 14
    s_add_u32 s27, s27, s32
    s_add_u32 s12, s50, s27
    s_addc_u32 s13, s51, 0
    s_mov_b32 s14, 655360
    s_mov_b32 s15, 0x20000
    s_cmp_eq_u32 s29, 3
    s_cselect_b32 s14, 524288, s14
    s_xor_b32 s29, s55, 0
    s_mul_i32 s27, s0, 20
    s_mul_i32 s32, s29, 5
    s_add_u32 s27, s27, s32
    s_lshl_b32 s27, s27, 17
    s_lshl_b32 s32, s28, 14
    s_add_u32 s27, s27, s32
    s_add_u32 s20, s50, s27
    s_addc_u32 s21, s51, 0
    s_mov_b32 s22, 655360
    s_mov_b32 s23, 0x20000
    s_cmp_eq_u32 s29, 3
    s_cselect_b32 s22, 524288, s22
    s_lshr_b32 s27, s55, 1
    s_lshl_b32 s30, s0, 1
    s_add_u32 s30, s30, s27
    s_lshl_b32 s30, s30, 3
    s_add_u32 s30, s30, s28
    s_lshl_b32 s30, s30, 7
    v_and_b32 v255, 7, v237
    v_lshlrev_b32 v255, 2, v255
    s_mov_b32 s31, 0x40000
    s_mov_b32 s27, 3145728
    buffer_load_dwordx4 v[4:7], v238, s[56:59], s27 offen sc1
    buffer_load_dwordx4 v[12:15], v238, s[56:59], s27 offen offset:1024 sc1
    buffer_load_dwordx4 v[20:23], v238, s[56:59], s27 offen offset:2048 sc1
    buffer_load_dwordx4 v[28:31], v238, s[56:59], s27 offen offset:3072 sc1
    s_mov_b32 s27, 3407872
    buffer_load_dwordx4 v[36:39], v238, s[56:59], s27 offen sc1
    buffer_load_dwordx4 v[44:47], v238, s[56:59], s27 offen offset:1024 sc1
    buffer_load_dwordx4 v[52:55], v238, s[56:59], s27 offen offset:2048 sc1
    buffer_load_dwordx4 v[60:63], v238, s[56:59], s27 offen offset:3072 sc1
    v_cmp_u_f32 vcc, v232, v232
    v_mov_b32 v244, s34
    v_add_u32 v244, 0x10000, v244
    s_or_b32 s86, s86, vcc_lo
    s_or_b32 s86, s86, vcc_hi
    v_mov_b32 v246, s86
    ds_write_b32 v245, v246 offset:32768
    s_waitcnt lgkmcnt(0)
    s_barrier
    ds_read_b128 v[240:243], v244 offset:32768
    s_waitcnt lgkmcnt(0)
    v_or3_b32 v240, v240, v241, v242
    v_or_b32 v240, v240, v243
    s_nop 0
    v_readfirstlane_b32 s33, v240
    s_cmp_lg_u32 s33, 0
    s_cbranch_scc1 L_fail
    s_branch L_merge
L_code_end:
L_fail:
    s_waitcnt vmcnt(0) lgkmcnt(0)
    s_barrier
    s_mov_b32 s85, 1
    s_branch L_restart
L_sconvA:
    s_nop 7
    v_cvt_pk_bf16_f32 v0, v0, v1
    v_cvt_pk_bf16_f32 v1, v2, v3
    v_cvt_pk_bf16_f32 v2, v4, v5
    v_cvt_pk_bf16_f32 v3, v6, v7
    v_cvt_pk_bf16_f32 v8, v8, v9
    v_cvt_pk_bf16_f32 v9, v10, v11
    v_cvt_pk_bf16_f32 v10, v12, v13
    v_cvt_pk_bf16_f32 v11, v14, v15
    v_cvt_pk_bf16_f32 v16, v16, v17
    v_cvt_pk_bf16_f32 v17, v18, v19
    v_cvt_pk_bf16_f32 v18, v20, v21
    v_cvt_pk_bf16_f32 v19, v22, v23
    v_mul_f32 v24, s33, v24
    v_mul_f32 v25, s33, v25
    v_mul_f32 v26, s33, v26
    v_mul_f32 v27, s33, v27
    v_mul_f32 v28, s33, v28
    v_mul_f32 v29, s33, v29
    v_mul_f32 v30, s33, v30
    v_mul_f32 v31, s33, v31
    v_cvt_pk_bf16_f32 v24, v24, v25
    v_cvt_pk_bf16_f32 v25, v26, v27
    v_cvt_pk_bf16_f32 v26, v28, v29
    v_cvt_pk_bf16_f32 v27, v30, v31
    s_nop 0
    v_permlane16_swap_b32 v0, v2
    v_permlane16_swap_b32 v1, v3
    v_permlane16_swap_b32 v8, v10
    v_permlane16_swap_b32 v9, v11
    v_permlane16_swap_b32 v16, v18
    v_permlane16_swap_b32 v17, v19
    v_permlane16_swap_b32 v24, v26
    v_permlane16_swap_b32 v25, v27
    v_cvt_pk_bf16_f32 v32, v32, v33
    v_cvt_pk_bf16_f32 v33, v34, v35
    v_cvt_pk_bf16_f32 v34, v36, v37
    v_cvt_pk_bf16_f32 v35, v38, v39
    v_cvt_pk_bf16_f32 v40, v40, v41
    v_cvt_pk_bf16_f32 v41, v42, v43
    v_cvt_pk_bf16_f32 v42, v44, v45
    v_cvt_pk_bf16_f32 v43, v46, v47
    v_mul_f32 v53, s33, v53
    v_mul_f32 v54, s33, v54
    v_mul_f32 v55, s33, v55
    v_cvt_pk_bf16_f32 v48, v48, v49
    v_cvt_pk_bf16_f32 v49, v50, v51
    v_cvt_pk_bf16_f32 v50, v52, v53
    v_cvt_pk_bf16_f32 v51, v54, v55
    v_mul_f32 v56, s33, v56
    v_mul_f32 v57, s33, v57
    v_mul_f32 v58, s33, v58
    v_mul_f32 v59, s33, v59
    v_mul_f32 v60, s33, v60
    v_mul_f32 v61, s33, v61
    v_mul_f32 v62, s33, v62
    v_mul_f32 v63, s33, v63
    v_cvt_pk_bf16_f32 v56, v56, v57
    v_cvt_pk_bf16_f32 v57, v58, v59
    v_cvt_pk_bf16_f32 v58, v60, v61
    v_cvt_pk_bf16_f32 v59, v62, v63
    s_nop 0
    v_permlane16_swap_b32 v32, v34
    v_permlane16_swap_b32 v33, v35
    v_permlane16_swap_b32 v40, v42
    v_permlane16_swap_b32 v41, v43
    v_permlane16_swap_b32 v48, v50
    v_permlane16_swap_b32 v49, v51
    v_permlane16_swap_b32 v56, v58
    v_permlane16_swap_b32 v57, v59
    v_cvt_pk_bf16_f32 v64, v64, v65
    v_cvt_pk_bf16_f32 v65, v66, v67
    v_cvt_pk_bf16_f32 v66, v68, v69
    v_cvt_pk_bf16_f32 v67, v70, v71
    v_cvt_pk_bf16_f32 v72, v72, v73
    v_cvt_pk_bf16_f32 v73, v74, v75
    v_cvt_pk_bf16_f32 v74, v76, v77
    v_cvt_pk_bf16_f32 v75, v78, v79
    v_mul_f32 v84, s33, v84
    v_mul_f32 v85, s33, v85
    v_mul_f32 v86, s33, v86
    v_mul_f32 v87, s33, v87
    v_cvt_pk_bf16_f32 v80, v80, v81
    v_cvt_pk_bf16_f32 v81, v82, v83
    v_cvt_pk_bf16_f32 v82, v84, v85
    v_cvt_pk_bf16_f32 v83, v86, v87
    v_mul_f32 v88, s33, v88
    v_mul_f32 v89, s33, v89
    v_mul_f32 v90, s33, v90
    v_mul_f32 v91, s33, v91
    v_mul_f32 v92, s33, v92
    v_mul_f32 v93, s33, v93
    v_mul_f32 v94, s33, v94
    v_mul_f32 v95, s33, v95
    v_cvt_pk_bf16_f32 v88, v88, v89
    v_cvt_pk_bf16_f32 v89, v90, v91
    v_cvt_pk_bf16_f32 v90, v92, v93
    v_cvt_pk_bf16_f32 v91, v94, v95
    s_nop 0
    v_permlane16_swap_b32 v64, v66
    v_permlane16_swap_b32 v65, v67
    v_permlane16_swap_b32 v72, v74
    v_permlane16_swap_b32 v73, v75
    v_permlane16_swap_b32 v80, v82
    v_permlane16_swap_b32 v81, v83
    v_permlane16_swap_b32 v88, v90
    v_permlane16_swap_b32 v89, v91
    v_cvt_pk_bf16_f32 v96, v96, v97
    v_cvt_pk_bf16_f32 v97, v98, v99
    v_cvt_pk_bf16_f32 v98, v100, v101
    v_cvt_pk_bf16_f32 v99, v102, v103
    v_cvt_pk_bf16_f32 v104, v104, v105
    v_cvt_pk_bf16_f32 v105, v106, v107
    v_cvt_pk_bf16_f32 v106, v108, v109
    v_cvt_pk_bf16_f32 v107, v110, v111
    v_mul_f32 v116, s33, v116
    v_mul_f32 v117, s33, v117
    v_mul_f32 v118, s33, v118
    v_mul_f32 v119, s33, v119
    v_cvt_pk_bf16_f32 v112, v112, v113
    v_cvt_pk_bf16_f32 v113, v114, v115
    v_cvt_pk_bf16_f32 v114, v116, v117
    v_cvt_pk_bf16_f32 v115, v118, v119
    v_mul_f32 v120, s33, v120
    v_mul_f32 v121, s33, v121
    v_mul_f32 v122, s33, v122
    v_mul_f32 v123, s33, v123
    v_mul_f32 v124, s33, v124
    v_mul_f32 v125, s33, v125
    v_mul_f32 v126, s33, v126
    v_mul_f32 v127, s33, v127
    v_cvt_pk_bf16_f32 v120, v120, v121
    v_cvt_pk_bf16_f32 v121, v122, v123
    v_cvt_pk_bf16_f32 v122, v124, v125
    v_cvt_pk_bf16_f32 v123, v126, v127
    s_nop 0
    v_permlane16_swap_b32 v96, v98
    v_permlane16_swap_b32 v97, v99
    v_permlane16_swap_b32 v104, v106
    v_permlane16_swap_b32 v105, v107
    v_permlane16_swap_b32 v112, v114
    v_permlane16_swap_b32 v113, v115
    v_permlane16_swap_b32 v120, v122
    v_permlane16_swap_b32 v121, v123
    v_cvt_pk_bf16_f32 v128, v128, v129
    v_cvt_pk_bf16_f32 v129, v130, v131
    v_cvt_pk_bf16_f32 v130, v132, v133
    v_cvt_pk_bf16_f32 v131, v134, v135
    v_cvt_pk_bf16_f32 v136, v136, v137
    v_cvt_pk_bf16_f32 v137, v138, v139
    v_cvt_pk_bf16_f32 v138, v140, v141
    v_cvt_pk_bf16_f32 v139, v142, v143
    v_mul_f32 v148, s33, v148
    v_mul_f32 v149, s33, v149
    v_mul_f32 v150, s33, v150
    v_mul_f32 v151, s33, v151
    v_cvt_pk_bf16_f32 v144, v144, v145
    v_cvt_pk_bf16_f32 v145, v146, v147
    v_cvt_pk_bf16_f32 v146, v148, v149
    v_cvt_pk_bf16_f32 v147, v150, v151
    v_mul_f32 v152, s33, v152
    v_mul_f32 v153, s33, v153
    v_mul_f32 v154, s33, v154
    v_mul_f32 v155, s33, v155
    v_mul_f32 v156, s33, v156
    v_mul_f32 v157, s33, v157
    v_mul_f32 v158, s33, v158
    v_mul_f32 v159, s33, v159
    v_cvt_pk_bf16_f32 v152, v152, v153
    v_cvt_pk_bf16_f32 v153, v154, v155
    v_cvt_pk_bf16_f32 v154, v156, v157
    v_cvt_pk_bf16_f32 v155, v158, v159
    s_nop 0
    v_permlane16_swap_b32 v128, v130
    v_permlane16_swap_b32 v129, v131
    v_permlane16_swap_b32 v136, v138
    v_permlane16_swap_b32 v137, v139
    v_permlane16_swap_b32 v144, v146
    v_permlane16_swap_b32 v145, v147
    v_permlane16_swap_b32 v152, v154
    v_permlane16_swap_b32 v153, v155
    s_branch L_safe
L_sconvB:
    s_nop 7
    v_cvt_pk_bf16_f32 v0, v0, v1
    v_cvt_pk_bf16_f32 v1, v2, v3
    v_cvt_pk_bf16_f32 v2, v4, v5
    v_cvt_pk_bf16_f32 v3, v6, v7
    v_cvt_pk_bf16_f32 v8, v8, v9
    v_cvt_pk_bf16_f32 v9, v10, v11
    v_cvt_pk_bf16_f32 v10, v12, v13
    v_cvt_pk_bf16_f32 v11, v14, v15
    v_mul_f32 v16, s33, v16
    v_mul_f32 v17, s33, v17
    v_mul_f32 v18, s33, v18
    v_mul_f32 v19, s33, v19
    v_mul_f32 v20, s33, v20
    v_mul_f32 v21, s33, v21
    v_mul_f32 v22, s33, v22
    v_mul_f32 v23, s33, v23
    v_cvt_pk_bf16_f32 v16, v16, v17
    v_cvt_pk_bf16_f32 v17, v18, v19
    v_cvt_pk_bf16_f32 v18, v20, v21
    v_cvt_pk_bf16_f32 v19, v22, v23
    v_mul_f32 v24, s33, v24
    v_mul_f32 v25, s33, v25
    v_mul_f32 v26, s33, v26
    v_mul_f32 v27, s33, v27
    v_mul_f32 v28, s33, v28
    v_mul_f32 v29, s33, v29
    v_mul_f32 v30, s33, v30
    v_mul_f32 v31, s33, v31
    v_cvt_pk_bf16_f32 v24, v24, v25
    v_cvt_pk_bf16_f32 v25, v26, v27
    v_cvt_pk_bf16_f32 v26, v28, v29
    v_cvt_pk_bf16_f32 v27, v30, v31
    s_nop 0
    v_permlane16_swap_b32 v0, v2
    v_permlane16_swap_b32 v1, v3
    v_permlane16_swap_b32 v8, v10
    v_permlane16_swap_b32 v9, v11
    v_permlane16_swap_b32 v16, v18
    v_permlane16_swap_b32 v17, v19
    v_permlane16_swap_b32 v24, v26
    v_permlane16_swap_b32 v25, v27
    v_cvt_pk_bf16_f32 v32, v32, v33
    v_cvt_pk_bf16_f32 v33, v34, v35
    v_cvt_pk_bf16_f32 v34, v36, v37
    v_cvt_pk_bf16_f32 v35, v38, v39
    v_mul_f32 v45, s33, v45
    v_mul_f32 v46, s33, v46
    v_mul_f32 v47, s33, v47
    v_cvt_pk_bf16_f32 v40, v40, v41
    v_cvt_pk_bf16_f32 v41, v42, v43
    v_cvt_pk_bf16_f32 v42, v44, v45
    v_cvt_pk_bf16_f32 v43, v46, v47
    v_mul_f32 v48, s33, v48
    v_mul_f32 v49, s33, v49
    v_mul_f32 v50, s33, v50
    v_mul_f32 v51, s33, v51
    v_mul_f32 v52, s33, v52
    v_mul_f32 v53, s33, v53
    v_mul_f32 v54, s33, v54
    v_mul_f32 v55, s33, v55
    v_cvt_pk_bf16_f32 v48, v48, v49
    v_cvt_pk_bf16_f32 v49, v50, v51
    v_cvt_pk_bf16_f32 v50, v52, v53
    v_cvt_pk_bf16_f32 v51, v54, v55
    v_mul_f32 v56, s33, v56
    v_mul_f32 v57, s33, v57
    v_mul_f32 v58, s33, v58
    v_mul_f32 v59, s33, v59
    v_mul_f32 v60, s33, v60
    v_mul_f32 v61, s33, v61
    v_mul_f32 v62, s33, v62
    v_mul_f32 v63, s33, v63
    v_cvt_pk_bf16_f32 v56, v56, v57
    v_cvt_pk_bf16_f32 v57, v58, v59
    v_cvt_pk_bf16_f32 v58, v60, v61
    v_cvt_pk_bf16_f32 v59, v62, v63
    s_nop 0
    v_permlane16_swap_b32 v32, v34
    v_permlane16_swap_b32 v33, v35
    v_permlane16_swap_b32 v40, v42
    v_permlane16_swap_b32 v41, v43
    v_permlane16_swap_b32 v48, v50
    v_permlane16_swap_b32 v49, v51
    v_permlane16_swap_b32 v56, v58
    v_permlane16_swap_b32 v57, v59
    v_cvt_pk_bf16_f32 v64, v64, v65
    v_cvt_pk_bf16_f32 v65, v66, v67
    v_cvt_pk_bf16_f32 v66, v68, v69
    v_cvt_pk_bf16_f32 v67, v70, v71
    v_mul_f32 v76, s33, v76
    v_mul_f32 v77, s33, v77
    v_mul_f32 v78, s33, v78
    v_mul_f32 v79, s33, v79
    v_cvt_pk_bf16_f32 v72, v72, v73
    v_cvt_pk_bf16_f32 v73, v74, v75
    v_cvt_pk_bf16_f32 v74, v76, v77
    v_cvt_pk_bf16_f32 v75, v78, v79
    v_mul_f32 v80, s33, v80
    v_mul_f32 v81, s33, v81
    v_mul_f32 v82, s33, v82
    v_mul_f32 v83, s33, v83
    v_mul_f32 v84, s33, v84
    v_mul_f32 v85, s33, v85
    v_mul_f32 v86, s33, v86
    v_mul_f32 v87, s33, v87
    v_cvt_pk_bf16_f32 v80, v80, v81
    v_cvt_pk_bf16_f32 v81, v82, v83
    v_cvt_pk_bf16_f32 v82, v84, v85
    v_cvt_pk_bf16_f32 v83, v86, v87
    v_mul_f32 v88, s33, v88
    v_mul_f32 v89, s33, v89
    v_mul_f32 v90, s33, v90
    v_mul_f32 v91, s33, v91
    v_mul_f32 v92, s33, v92
    v_mul_f32 v93, s33, v93
    v_mul_f32 v94, s33, v94
    v_mul_f32 v95, s33, v95
    v_cvt_pk_bf16_f32 v88, v88, v89
    v_cvt_pk_bf16_f32 v89, v90, v91
    v_cvt_pk_bf16_f32 v90, v92, v93
    v_cvt_pk_bf16_f32 v91, v94, v95
    s_nop 0
    v_permlane16_swap_b32 v64, v66
    v_permlane16_swap_b32 v65, v67
    v_permlane16_swap_b32 v72, v74
    v_permlane16_swap_b32 v73, v75
    v_permlane16_swap_b32 v80, v82
    v_permlane16_swap_b32 v81, v83
    v_permlane16_swap_b32 v88, v90
    v_permlane16_swap_b32 v89, v91
    v_cvt_pk_bf16_f32 v96, v96, v97
    v_cvt_pk_bf16_f32 v97, v98, v99
    v_cvt_pk_bf16_f32 v98, v100, v101
    v_cvt_pk_bf16_f32 v99, v102, v103
    v_mul_f32 v108, s33, v108
    v_mul_f32 v109, s33, v109
    v_mul_f32 v110, s33, v110
    v_mul_f32 v111, s33, v111
    v_cvt_pk_bf16_f32 v104, v104, v105
    v_cvt_pk_bf16_f32 v105, v106, v107
    v_cvt_pk_bf16_f32 v106, v108, v109
    v_cvt_pk_bf16_f32 v107, v110, v111
    v_mul_f32 v112, s33, v112
    v_mul_f32 v113, s33, v113
    v_mul_f32 v114, s33, v114
    v_mul_f32 v115, s33, v115
    v_mul_f32 v116, s33, v116
    v_mul_f32 v117, s33, v117
    v_mul_f32 v118, s33, v118
    v_mul_f32 v119, s33, v119
    v_cvt_pk_bf16_f32 v112, v112, v113
    v_cvt_pk_bf16_f32 v113, v114, v115
    v_cvt_pk_bf16_f32 v114, v116, v117
    v_cvt_pk_bf16_f32 v115, v118, v119
    v_mul_f32 v120, s33, v120
    v_mul_f32 v121, s33, v121
    v_mul_f32 v122, s33, v122
    v_mul_f32 v123, s33, v123
    v_mul_f32 v124, s33, v124
    v_mul_f32 v125, s33, v125
    v_mul_f32 v126, s33, v126
    v_mul_f32 v127, s33, v127
    v_cvt_pk_bf16_f32 v120, v120, v121
    v_cvt_pk_bf16_f32 v121, v122, v123
    v_cvt_pk_bf16_f32 v122, v124, v125
    v_cvt_pk_bf16_f32 v123, v126, v127
    s_nop 0
    v_permlane16_swap_b32 v96, v98
    v_permlane16_swap_b32 v97, v99
    v_permlane16_swap_b32 v104, v106
    v_permlane16_swap_b32 v105, v107
    v_permlane16_swap_b32 v112, v114
    v_permlane16_swap_b32 v113, v115
    v_permlane16_swap_b32 v120, v122
    v_permlane16_swap_b32 v121, v123
    s_branch L_safe
L_safe:
    s_waitcnt vmcnt(0) lgkmcnt(0)
    s_barrier
    v_mov_b32 v180, 0xff800000
    v_mov_b32 v184, 0xff800000
    v_mov_b32 v188, 0xff800000
    v_mov_b32 v192, 0xff800000
    v_mov_b32 v196, 0xff800000
    s_mov_b32 s30, s34
    s_mov_b32 s31, 16
L_s1:
    s_add_u32 m0, s34, 0
    s_and_b32 s27, s30, 0x3ffff
    buffer_load_dwordx4 v217, s[12:15], s27 offen nt lds
    s_add_u32 s30, s30, 16384
    buffer_load_dwordx4 v218, s[12:15], s27 offen offset:1024 nt lds
    buffer_load_dwordx4 v219, s[12:15], s27 offen offset:2048 nt lds
    buffer_load_dwordx4 v220, s[12:15], s27 offen offset:3072 nt lds
    s_waitcnt vmcnt(0) lgkmcnt(0)
    s_barrier
    ds_read_b128 a[160:163], v205 offset:0
    ds_read_b128 a[164:167], v206 offset:0
    ds_read_b128 a[168:171], v207 offset:0
    ds_read_b128 a[172:175], v208 offset:0
    s_waitcnt lgkmcnt(3)
    v_mfma_f32_16x16x32_bf16 v[160:163], a[160:163], v[0:3], 0
    s_waitcnt lgkmcnt(2)
    v_mfma_f32_16x16x32_bf16 v[160:163], a[164:167], v[8:11], v[160:163]
    s_waitcnt lgkmcnt(1)
    v_mfma_f32_16x16x32_bf16 v[160:163], a[168:171], v[16:19], v[160:163]
    s_waitcnt lgkmcnt(0)
    v_mfma_f32_16x16x32_bf16 v[160:163], a[172:175], v[24:27], v[160:163]
    v_mfma_f32_16x16x32_bf16 v[164:167], a[172:175], v[56:59], 0
    v_mfma_f32_16x16x32_bf16 v[164:167], a[168:171], v[48:51], v[164:167]
    v_mfma_f32_16x16x32_bf16 v[164:167], a[164:167], v[40:43], v[164:167]
    v_mfma_f32_16x16x32_bf16 v[164:167], a[160:163], v[32:35], v[164:167]
    v_mfma_f32_16x16x32_bf16 v[168:171], a[160:163], v[64:67], 0
    v_mfma_f32_16x16x32_bf16 v[168:171], a[164:167], v[72:75], v[168:171]
    v_mfma_f32_16x16x32_bf16 v[168:171], a[168:171], v[80:83], v[168:171]
    v_mfma_f32_16x16x32_bf16 v[168:171], a[172:175], v[88:91], v[168:171]
    v_mfma_f32_16x16x32_bf16 v[172:175], a[172:175], v[120:123], 0
    v_mfma_f32_16x16x32_bf16 v[172:175], a[168:171], v[112:115], v[172:175]
    v_mfma_f32_16x16x32_bf16 v[172:175], a[164:167], v[104:107], v[172:175]
    v_mfma_f32_16x16x32_bf16 v[172:175], a[160:163], v[96:99], v[172:175]
    v_mfma_f32_16x16x32_bf16 v[176:179], a[160:163], v[128:131], 0
    v_mfma_f32_16x16x32_bf16 v[176:179], a[164:167], v[136:139], v[176:179]
    v_mfma_f32_16x16x32_bf16 v[176:179], a[168:171], v[144:147], v[176:179]
    v_mfma_f32_16x16x32_bf16 v[176:179], a[172:175], v[152:155], v[176:179]
    s_nop 7
    v_max3_f32 v180, v180, v160, v161
    v_max3_f32 v180, v180, v162, v163
    v_max3_f32 v184, v184, v164, v165
    v_max3_f32 v184, v184, v166, v167
    v_max3_f32 v188, v188, v168, v169
    v_max3_f32 v188, v188, v170, v171
    v_max3_f32 v192, v192, v172, v173
    v_max3_f32 v192, v192, v174, v175
    v_max3_f32 v196, v196, v176, v177
    v_max3_f32 v196, v196, v178, v179
    ds_read_b128 a[160:163], v205 offset:4096
    ds_read_b128 a[164:167], v206 offset:4096
    ds_read_b128 a[168:171], v207 offset:4096
    ds_read_b128 a[172:175], v208 offset:4096
    s_waitcnt lgkmcnt(3)
    v_mfma_f32_16x16x32_bf16 v[160:163], a[160:163], v[0:3], 0
    s_waitcnt lgkmcnt(2)
    v_mfma_f32_16x16x32_bf16 v[160:163], a[164:167], v[8:11], v[160:163]
    s_waitcnt lgkmcnt(1)
    v_mfma_f32_16x16x32_bf16 v[160:163], a[168:171], v[16:19], v[160:163]
    s_waitcnt lgkmcnt(0)
    v_mfma_f32_16x16x32_bf16 v[160:163], a[172:175], v[24:27], v[160:163]
    v_mfma_f32_16x16x32_bf16 v[164:167], a[172:175], v[56:59], 0
    v_mfma_f32_16x16x32_bf16 v[164:167], a[168:171], v[48:51], v[164:167]
    v_mfma_f32_16x16x32_bf16 v[164:167], a[164:167], v[40:43], v[164:167]
    v_mfma_f32_16x16x32_bf16 v[164:167], a[160:163], v[32:35], v[164:167]
    v_mfma_f32_16x16x32_bf16 v[168:171], a[160:163], v[64:67], 0
    v_mfma_f32_16x16x32_bf16 v[168:171], a[164:167], v[72:75], v[168:171]
    v_mfma_f32_16x16x32_bf16 v[168:171], a[168:171], v[80:83], v[168:171]
    v_mfma_f32_16x16x32_bf16 v[168:171], a[172:175], v[88:91], v[168:171]
    v_mfma_f32_16x16x32_bf16 v[172:175], a[172:175], v[120:123], 0
    v_mfma_f32_16x16x32_bf16 v[172:175], a[168:171], v[112:115], v[172:175]
    v_mfma_f32_16x16x32_bf16 v[172:175], a[164:167], v[104:107], v[172:175]
    v_mfma_f32_16x16x32_bf16 v[172:175], a[160:163], v[96:99], v[172:175]
    v_mfma_f32_16x16x32_bf16 v[176:179], a[160:163], v[128:131], 0
    v_mfma_f32_16x16x32_bf16 v[176:179], a[164:167], v[136:139], v[176:179]
    v_mfma_f32_16x16x32_bf16 v[176:179], a[168:171], v[144:147], v[176:179]
    v_mfma_f32_16x16x32_bf16 v[176:179], a[172:175], v[152:155], v[176:179]
    s_nop 7
    v_max3_f32 v180, v180, v160, v161
    v_max3_f32 v180, v180, v162, v163
    v_max3_f32 v184, v184, v164, v165
    v_max3_f32 v184, v184, v166, v167
    v_max3_f32 v188, v188, v168, v169
    v_max3_f32 v188, v188, v170, v171
    v_max3_f32 v192, v192, v172, v173
    v_max3_f32 v192, v192, v174, v175
    v_max3_f32 v196, v196, v176, v177
    v_max3_f32 v196, v196, v178, v179
    ds_read_b128 a[160:163], v205 offset:8192
    ds_read_b128 a[164:167], v206 offset:8192
    ds_read_b128 a[168:171], v207 offset:8192
    ds_read_b128 a[172:175], v208 offset:8192
    s_waitcnt lgkmcnt(3)
    v_mfma_f32_16x16x32_bf16 v[160:163], a[160:163], v[0:3], 0
    s_waitcnt lgkmcnt(2)
    v_mfma_f32_16x16x32_bf16 v[160:163], a[164:167], v[8:11], v[160:163]
    s_waitcnt lgkmcnt(1)
    v_mfma_f32_16x16x32_bf16 v[160:163], a[168:171], v[16:19], v[160:163]
    s_waitcnt lgkmcnt(0)
    v_mfma_f32_16x16x32_bf16 v[160:163], a[172:175], v[24:27], v[160:163]
    v_mfma_f32_16x16x32_bf16 v[164:167], a[172:175], v[56:59], 0
    v_mfma_f32_16x16x32_bf16 v[164:167], a[168:171], v[48:51], v[164:167]
    v_mfma_f32_16x16x32_bf16 v[164:167], a[164:167], v[40:43], v[164:167]
    v_mfma_f32_16x16x32_bf16 v[164:167], a[160:163], v[32:35], v[164:167]
    v_mfma_f32_16x16x32_bf16 v[168:171], a[160:163], v[64:67], 0
    v_mfma_f32_16x16x32_bf16 v[168:171], a[164:167], v[72:75], v[168:171]
    v_mfma_f32_16x16x32_bf16 v[168:171], a[168:171], v[80:83], v[168:171]
    v_mfma_f32_16x16x32_bf16 v[168:171], a[172:175], v[88:91], v[168:171]
    v_mfma_f32_16x16x32_bf16 v[172:175], a[172:175], v[120:123], 0
    v_mfma_f32_16x16x32_bf16 v[172:175], a[168:171], v[112:115], v[172:175]
    v_mfma_f32_16x16x32_bf16 v[172:175], a[164:167], v[104:107], v[172:175]
    v_mfma_f32_16x16x32_bf16 v[172:175], a[160:163], v[96:99], v[172:175]
    v_mfma_f32_16x16x32_bf16 v[176:179], a[160:163], v[128:131], 0
    v_mfma_f32_16x16x32_bf16 v[176:179], a[164:167], v[136:139], v[176:179]
    v_mfma_f32_16x16x32_bf16 v[176:179], a[168:171], v[144:147], v[176:179]
    v_mfma_f32_16x16x32_bf16 v[176:179], a[172:175], v[152:155], v[176:179]
    s_nop 7
    v_max3_f32 v180, v180, v160, v161
    v_max3_f32 v180, v180, v162, v163
    v_max3_f32 v184, v184, v164, v165
    v_max3_f32 v184, v184, v166, v167
    v_max3_f32 v188, v188, v168, v169
    v_max3_f32 v188, v188, v170, v171
    v_max3_f32 v192, v192, v172, v173
    v_max3_f32 v192, v192, v174, v175
    v_max3_f32 v196, v196, v176, v177
    v_max3_f32 v196, v196, v178, v179
    ds_read_b128 a[160:163], v205 offset:12288
    ds_read_b128 a[164:167], v206 offset:12288
    ds_read_b128 a[168:171], v207 offset:12288
    ds_read_b128 a[172:175], v208 offset:12288
    s_waitcnt lgkmcnt(3)
    v_mfma_f32_16x16x32_bf16 v[160:163], a[160:163], v[0:3], 0
    s_waitcnt lgkmcnt(2)
    v_mfma_f32_16x16x32_bf16 v[160:163], a[164:167], v[8:11], v[160:163]
    s_waitcnt lgkmcnt(1)
    v_mfma_f32_16x16x32_bf16 v[160:163], a[168:171], v[16:19], v[160:163]
    s_waitcnt lgkmcnt(0)
    v_mfma_f32_16x16x32_bf16 v[160:163], a[172:175], v[24:27], v[160:163]
    v_mfma_f32_16x16x32_bf16 v[164:167], a[172:175], v[56:59], 0
    v_mfma_f32_16x16x32_bf16 v[164:167], a[168:171], v[48:51], v[164:167]
    v_mfma_f32_16x16x32_bf16 v[164:167], a[164:167], v[40:43], v[164:167]
    v_mfma_f32_16x16x32_bf16 v[164:167], a[160:163], v[32:35], v[164:167]
    v_mfma_f32_16x16x32_bf16 v[168:171], a[160:163], v[64:67], 0
    v_mfma_f32_16x16x32_bf16 v[168:171], a[164:167], v[72:75], v[168:171]
    v_mfma_f32_16x16x32_bf16 v[168:171], a[168:171], v[80:83], v[168:171]
    v_mfma_f32_16x16x32_bf16 v[168:171], a[172:175], v[88:91], v[168:171]
    v_mfma_f32_16x16x32_bf16 v[172:175], a[172:175], v[120:123], 0
    v_mfma_f32_16x16x32_bf16 v[172:175], a[168:171], v[112:115], v[172:175]
    v_mfma_f32_16x16x32_bf16 v[172:175], a[164:167], v[104:107], v[172:175]
    v_mfma_f32_16x16x32_bf16 v[172:175], a[160:163], v[96:99], v[172:175]
    v_mfma_f32_16x16x32_bf16 v[176:179], a[160:163], v[128:131], 0
    v_mfma_f32_16x16x32_bf16 v[176:179], a[164:167], v[136:139], v[176:179]
    v_mfma_f32_16x16x32_bf16 v[176:179], a[168:171], v[144:147], v[176:179]
    v_mfma_f32_16x16x32_bf16 v[176:179], a[172:175], v[152:155], v[176:179]
    s_nop 7
    v_max3_f32 v180, v180, v160, v161
    v_max3_f32 v180, v180, v162, v163
    v_max3_f32 v184, v184, v164, v165
    v_max3_f32 v184, v184, v166, v167
    v_max3_f32 v188, v188, v168, v169
    v_max3_f32 v188, v188, v170, v171
    v_max3_f32 v192, v192, v172, v173
    v_max3_f32 v192, v192, v174, v175
    v_max3_f32 v196, v196, v176, v177
    v_max3_f32 v196, v196, v178, v179
    s_barrier
    s_sub_u32 s31, s31, 1
    s_cmp_lg_u32 s31, 0
    s_cbranch_scc1 L_s1
    v_mov_b32 v239, v180
    v_mov_b32 v240, v184
    v_mov_b32 v241, v188
    v_mov_b32 v242, v192
    v_mov_b32 v243, v196
    s_nop 0
    v_permlane16_swap_b32 v180, v239
    v_permlane16_swap_b32 v184, v240
    v_permlane16_swap_b32 v188, v241
    v_permlane16_swap_b32 v192, v242
    v_permlane16_swap_b32 v196, v243
    v_max_f32 v180, v180, v239
    v_mov_b32 v239, v180
    v_max_f32 v184, v184, v240
    v_mov_b32 v240, v184
    v_max_f32 v188, v188, v241
    v_mov_b32 v241, v188
    v_max_f32 v192, v192, v242
    v_mov_b32 v242, v192
    v_max_f32 v196, v196, v243
    v_mov_b32 v243, v196
    s_nop 0
    v_permlane32_swap_b32 v180, v239
    v_permlane32_swap_b32 v184, v240
    v_permlane32_swap_b32 v188, v241
    v_permlane32_swap_b32 v192, v242
    v_permlane32_swap_b32 v196, v243
    v_max_f32 v180, v180, v239
    v_max_f32 v184, v184, v240
    v_max_f32 v188, v188, v241
    v_max_f32 v192, v192, v242
    v_max_f32 v196, v196, v243
    s_mov_b32 s30, s34
    s_mov_b32 s3, s34
    s_mov_b32 s31, 16
L_s2:
    s_add_u32 m0, s34, 0
    s_and_b32 s27, s30, 0x3ffff
    buffer_load_dwordx4 v217, s[12:15], s27 offen nt lds
    s_add_u32 s30, s30, 16384
    buffer_load_dwordx4 v218, s[12:15], s27 offen offset:1024 nt lds
    buffer_load_dwordx4 v219, s[12:15], s27 offen offset:2048 nt lds
    buffer_load_dwordx4 v220, s[12:15], s27 offen offset:3072 nt lds
    s_add_u32 m0, s34, 65536
    s_and_b32 s27, s3, 0x3ffff
    buffer_load_dwordx4 v221, s[16:19], s27 offen nt lds
    s_add_u32 s3, s3, 16384
    buffer_load_dwordx4 v222, s[16:19], s27 offen offset:1024 nt lds
    buffer_load_dwordx4 v221, s[16:19], s27 offen offset:2048 nt lds
    buffer_load_dwordx4 v222, s[16:19], s27 offen offset:3072 nt lds
    s_waitcnt vmcnt(0) lgkmcnt(0)
    s_barrier
    ds_read_b128 a[160:163], v205 offset:0
    ds_read_b128 a[164:167], v206 offset:0
    ds_read_b128 a[168:171], v207 offset:0
    ds_read_b128 a[172:175], v208 offset:0
    s_waitcnt lgkmcnt(3)
    v_mfma_f32_16x16x32_bf16 v[160:163], a[160:163], v[0:3], 0
    s_waitcnt lgkmcnt(2)
    v_mfma_f32_16x16x32_bf16 v[160:163], a[164:167], v[8:11], v[160:163]
    s_waitcnt lgkmcnt(1)
    v_mfma_f32_16x16x32_bf16 v[160:163], a[168:171], v[16:19], v[160:163]
    s_waitcnt lgkmcnt(0)
    v_mfma_f32_16x16x32_bf16 v[160:163], a[172:175], v[24:27], v[160:163]
    v_mfma_f32_16x16x32_bf16 v[164:167], a[172:175], v[56:59], 0
    v_mfma_f32_16x16x32_bf16 v[164:167], a[168:171], v[48:51], v[164:167]
    v_mfma_f32_16x16x32_bf16 v[164:167], a[164:167], v[40:43], v[164:167]
    v_mfma_f32_16x16x32_bf16 v[164:167], a[160:163], v[32:35], v[164:167]
    v_mfma_f32_16x16x32_bf16 v[168:171], a[160:163], v[64:67], 0
    v_mfma_f32_16x16x32_bf16 v[168:171], a[164:167], v[72:75], v[168:171]
    v_mfma_f32_16x16x32_bf16 v[168:171], a[168:171], v[80:83], v[168:171]
    v_mfma_f32_16x16x32_bf16 v[168:171], a[172:175], v[88:91], v[168:171]
    v_mfma_f32_16x16x32_bf16 v[172:175], a[172:175], v[120:123], 0
    v_mfma_f32_16x16x32_bf16 v[172:175], a[168:171], v[112:115], v[172:175]
    v_mfma_f32_16x16x32_bf16 v[172:175], a[164:167], v[104:107], v[172:175]
    v_mfma_f32_16x16x32_bf16 v[172:175], a[160:163], v[96:99], v[172:175]
    v_mfma_f32_16x16x32_bf16 v[176:179], a[160:163], v[128:131], 0
    v_mfma_f32_16x16x32_bf16 v[176:179], a[164:167], v[136:139], v[176:179]
    v_mfma_f32_16x16x32_bf16 v[176:179], a[168:171], v[144:147], v[176:179]
    v_mfma_f32_16x16x32_bf16 v[176:179], a[172:175], v[152:155], v[176:179]
    s_nop 7
    v_sub_f32 v160, v160, v180
    v_sub_f32 v161, v161, v180
    v_sub_f32 v162, v162, v180
    v_sub_f32 v163, v163, v180
    v_exp_f32 v160, v160
    v_exp_f32 v161, v161
    v_exp_f32 v162, v162
    v_exp_f32 v163, v163
    s_nop 0
    v_add_f32 v200, v160, v200
    v_add_f32 v200, v161, v200
    v_add_f32 v200, v162, v200
    v_add_f32 v200, v163, v200
    v_cvt_pk_bf16_f32 v84, v160, v161
    v_cvt_pk_bf16_f32 v85, v162, v163
    v_sub_f32 v164, v164, v184
    v_sub_f32 v165, v165, v184
    v_sub_f32 v166, v166, v184
    v_sub_f32 v167, v167, v184
    v_exp_f32 v164, v164
    v_exp_f32 v165, v165
    v_exp_f32 v166, v166
    v_exp_f32 v167, v167
    s_nop 0
    v_add_f32 v201, v164, v201
    v_add_f32 v201, v165, v201
    v_add_f32 v201, v166, v201
    v_add_f32 v201, v167, v201
    v_cvt_pk_bf16_f32 v100, v164, v165
    v_cvt_pk_bf16_f32 v101, v166, v167
    v_sub_f32 v168, v168, v188
    v_sub_f32 v169, v169, v188
    v_sub_f32 v170, v170, v188
    v_sub_f32 v171, v171, v188
    v_exp_f32 v168, v168
    v_exp_f32 v169, v169
    v_exp_f32 v170, v170
    v_exp_f32 v171, v171
    s_nop 0
    v_add_f32 v202, v168, v202
    v_add_f32 v202, v169, v202
    v_add_f32 v202, v170, v202
    v_add_f32 v202, v171, v202
    v_cvt_pk_bf16_f32 v116, v168, v169
    v_cvt_pk_bf16_f32 v117, v170, v171
    v_sub_f32 v172, v172, v192
    v_sub_f32 v173, v173, v192
    v_sub_f32 v174, v174, v192
    v_sub_f32 v175, v175, v192
    v_exp_f32 v172, v172
    v_exp_f32 v173, v173
    v_exp_f32 v174, v174
    v_exp_f32 v175, v175
    s_nop 0
    v_add_f32 v203, v172, v203
    v_add_f32 v203, v173, v203
    v_add_f32 v203, v174, v203
    v_add_f32 v203, v175, v203
    v_cvt_pk_bf16_f32 v132, v172, v173
    v_cvt_pk_bf16_f32 v133, v174, v175
    v_sub_f32 v176, v176, v196
    v_sub_f32 v177, v177, v196
    v_sub_f32 v178, v178, v196
    v_sub_f32 v179, v179, v196
    v_exp_f32 v176, v176
    v_exp_f32 v177, v177
    v_exp_f32 v178, v178
    v_exp_f32 v179, v179
    s_nop 0
    v_add_f32 v204, v176, v204
    v_add_f32 v204, v177, v204
    v_add_f32 v204, v178, v204
    v_add_f32 v204, v179, v204
    v_cvt_pk_bf16_f32 v148, v176, v177
    v_cvt_pk_bf16_f32 v149, v178, v179
    ds_read_b128 a[160:163], v205 offset:4096
    ds_read_b128 a[164:167], v206 offset:4096
    ds_read_b128 a[168:171], v207 offset:4096
    ds_read_b128 a[172:175], v208 offset:4096
    s_waitcnt lgkmcnt(3)
    v_mfma_f32_16x16x32_bf16 v[160:163], a[160:163], v[0:3], 0
    s_waitcnt lgkmcnt(2)
    v_mfma_f32_16x16x32_bf16 v[160:163], a[164:167], v[8:11], v[160:163]
    s_waitcnt lgkmcnt(1)
    v_mfma_f32_16x16x32_bf16 v[160:163], a[168:171], v[16:19], v[160:163]
    s_waitcnt lgkmcnt(0)
    v_mfma_f32_16x16x32_bf16 v[160:163], a[172:175], v[24:27], v[160:163]
    v_mfma_f32_16x16x32_bf16 v[164:167], a[172:175], v[56:59], 0
    v_mfma_f32_16x16x32_bf16 v[164:167], a[168:171], v[48:51], v[164:167]
    v_mfma_f32_16x16x32_bf16 v[164:167], a[164:167], v[40:43], v[164:167]
    v_mfma_f32_16x16x32_bf16 v[164:167], a[160:163], v[32:35], v[164:167]
    v_mfma_f32_16x16x32_bf16 v[168:171], a[160:163], v[64:67], 0
    v_mfma_f32_16x16x32_bf16 v[168:171], a[164:167], v[72:75], v[168:171]
    v_mfma_f32_16x16x32_bf16 v[168:171], a[168:171], v[80:83], v[168:171]
    v_mfma_f32_16x16x32_bf16 v[168:171], a[172:175], v[88:91], v[168:171]
    v_mfma_f32_16x16x32_bf16 v[172:175], a[172:175], v[120:123], 0
    v_mfma_f32_16x16x32_bf16 v[172:175], a[168:171], v[112:115], v[172:175]
    v_mfma_f32_16x16x32_bf16 v[172:175], a[164:167], v[104:107], v[172:175]
    v_mfma_f32_16x16x32_bf16 v[172:175], a[160:163], v[96:99], v[172:175]
    v_mfma_f32_16x16x32_bf16 v[176:179], a[160:163], v[128:131], 0
    v_mfma_f32_16x16x32_bf16 v[176:179], a[164:167], v[136:139], v[176:179]
    v_mfma_f32_16x16x32_bf16 v[176:179], a[168:171], v[144:147], v[176:179]
    v_mfma_f32_16x16x32_bf16 v[176:179], a[172:175], v[152:155], v[176:179]
    s_nop 7
    v_sub_f32 v160, v160, v180
    v_sub_f32 v161, v161, v180
    v_sub_f32 v162, v162, v180
    v_sub_f32 v163, v163, v180
    v_exp_f32 v160, v160
    v_exp_f32 v161, v161
    v_exp_f32 v162, v162
    v_exp_f32 v163, v163
    s_nop 0
    v_add_f32 v200, v160, v200
    v_add_f32 v200, v161, v200
    v_add_f32 v200, v162, v200
    v_add_f32 v200, v163, v200
    v_cvt_pk_bf16_f32 v86, v160, v161
    v_cvt_pk_bf16_f32 v87, v162, v163
    v_sub_f32 v164, v164, v184
    v_sub_f32 v165, v165, v184
    v_sub_f32 v166, v166, v184
    v_sub_f32 v167, v167, v184
    v_exp_f32 v164, v164
    v_exp_f32 v165, v165
    v_exp_f32 v166, v166
    v_exp_f32 v167, v167
    s_nop 0
    v_add_f32 v201, v164, v201
    v_add_f32 v201, v165, v201
    v_add_f32 v201, v166, v201
    v_add_f32 v201, v167, v201
    v_cvt_pk_bf16_f32 v102, v164, v165
    v_cvt_pk_bf16_f32 v103, v166, v167
    v_sub_f32 v168, v168, v188
    v_sub_f32 v169, v169, v188
    v_sub_f32 v170, v170, v188
    v_sub_f32 v171, v171, v188
    v_exp_f32 v168, v168
    v_exp_f32 v169, v169
    v_exp_f32 v170, v170
    v_exp_f32 v171, v171
    s_nop 0
    v_add_f32 v202, v168, v202
    v_add_f32 v202, v169, v202
    v_add_f32 v202, v170, v202
    v_add_f32 v202, v171, v202
    v_cvt_pk_bf16_f32 v118, v168, v169
    v_cvt_pk_bf16_f32 v119, v170, v171
    v_sub_f32 v172, v172, v192
    v_sub_f32 v173, v173, v192
    v_sub_f32 v174, v174, v192
    v_sub_f32 v175, v175, v192
    v_exp_f32 v172, v172
    v_exp_f32 v173, v173
    v_exp_f32 v174, v174
    v_exp_f32 v175, v175
    s_nop 0
    v_add_f32 v203, v172, v203
    v_add_f32 v203, v173, v203
    v_add_f32 v203, v174, v203
    v_add_f32 v203, v175, v203
    v_cvt_pk_bf16_f32 v134, v172, v173
    v_cvt_pk_bf16_f32 v135, v174, v175
    v_sub_f32 v176, v176, v196
    v_sub_f32 v177, v177, v196
    v_sub_f32 v178, v178, v196
    v_sub_f32 v179, v179, v196
    v_exp_f32 v176, v176
    v_exp_f32 v177, v177
    v_exp_f32 v178, v178
    v_exp_f32 v179, v179
    s_nop 0
    v_add_f32 v204, v176, v204
    v_add_f32 v204, v177, v204
    v_add_f32 v204, v178, v204
    v_add_f32 v204, v179, v204
    v_cvt_pk_bf16_f32 v150, v176, v177
    v_cvt_pk_bf16_f32 v151, v178, v179
    ds_read_b128 a[160:163], v205 offset:8192
    ds_read_b128 a[164:167], v206 offset:8192
    ds_read_b128 a[168:171], v207 offset:8192
    ds_read_b128 a[172:175], v208 offset:8192
    s_waitcnt lgkmcnt(3)
    v_mfma_f32_16x16x32_bf16 v[160:163], a[160:163], v[0:3], 0
    s_waitcnt lgkmcnt(2)
    v_mfma_f32_16x16x32_bf16 v[160:163], a[164:167], v[8:11], v[160:163]
    s_waitcnt lgkmcnt(1)
    v_mfma_f32_16x16x32_bf16 v[160:163], a[168:171], v[16:19], v[160:163]
    s_waitcnt lgkmcnt(0)
    v_mfma_f32_16x16x32_bf16 v[160:163], a[172:175], v[24:27], v[160:163]
    v_mfma_f32_16x16x32_bf16 v[164:167], a[172:175], v[56:59], 0
    v_mfma_f32_16x16x32_bf16 v[164:167], a[168:171], v[48:51], v[164:167]
    v_mfma_f32_16x16x32_bf16 v[164:167], a[164:167], v[40:43], v[164:167]
    v_mfma_f32_16x16x32_bf16 v[164:167], a[160:163], v[32:35], v[164:167]
    v_mfma_f32_16x16x32_bf16 v[168:171], a[160:163], v[64:67], 0
    v_mfma_f32_16x16x32_bf16 v[168:171], a[164:167], v[72:75], v[168:171]
    v_mfma_f32_16x16x32_bf16 v[168:171], a[168:171], v[80:83], v[168:171]
    v_mfma_f32_16x16x32_bf16 v[168:171], a[172:175], v[88:91], v[168:171]
    v_mfma_f32_16x16x32_bf16 v[172:175], a[172:175], v[120:123], 0
    v_mfma_f32_16x16x32_bf16 v[172:175], a[168:171], v[112:115], v[172:175]
    v_mfma_f32_16x16x32_bf16 v[172:175], a[164:167], v[104:107], v[172:175]
    v_mfma_f32_16x16x32_bf16 v[172:175], a[160:163], v[96:99], v[172:175]
    v_mfma_f32_16x16x32_bf16 v[176:179], a[160:163], v[128:131], 0
    v_mfma_f32_16x16x32_bf16 v[176:179], a[164:167], v[136:139], v[176:179]
    v_mfma_f32_16x16x32_bf16 v[176:179], a[168:171], v[144:147], v[176:179]
    v_mfma_f32_16x16x32_bf16 v[176:179], a[172:175], v[152:155], v[176:179]
    s_nop 7
    v_sub_f32 v160, v160, v180
    v_sub_f32 v161, v161, v180
    v_sub_f32 v162, v162, v180
    v_sub_f32 v163, v163, v180
    v_exp_f32 v160, v160
    v_exp_f32 v161, v161
    v_exp_f32 v162, v162
    v_exp_f32 v163, v163
    s_nop 0
    v_add_f32 v200, v160, v200
    v_add_f32 v200, v161, v200
    v_add_f32 v200, v162, v200
    v_add_f32 v200, v163, v200
    v_cvt_pk_bf16_f32 v92, v160, v161
    v_cvt_pk_bf16_f32 v93, v162, v163
    v_sub_f32 v164, v164, v184
    v_sub_f32 v165, v165, v184
    v_sub_f32 v166, v166, v184
    v_sub_f32 v167, v167, v184
    v_exp_f32 v164, v164
    v_exp_f32 v165, v165
    v_exp_f32 v166, v166
    v_exp_f32 v167, v167
    s_nop 0
    v_add_f32 v201, v164, v201
    v_add_f32 v201, v165, v201
    v_add_f32 v201, v166, v201
    v_add_f32 v201, v167, v201
    v_cvt_pk_bf16_f32 v108, v164, v165
    v_cvt_pk_bf16_f32 v109, v166, v167
    v_sub_f32 v168, v168, v188
    v_sub_f32 v169, v169, v188
    v_sub_f32 v170, v170, v188
    v_sub_f32 v171, v171, v188
    v_exp_f32 v168, v168
    v_exp_f32 v169, v169
    v_exp_f32 v170, v170
    v_exp_f32 v171, v171
    s_nop 0
    v_add_f32 v202, v168, v202
    v_add_f32 v202, v169, v202
    v_add_f32 v202, v170, v202
    v_add_f32 v202, v171, v202
    v_cvt_pk_bf16_f32 v124, v168, v169
    v_cvt_pk_bf16_f32 v125, v170, v171
    v_sub_f32 v172, v172, v192
    v_sub_f32 v173, v173, v192
    v_sub_f32 v174, v174, v192
    v_sub_f32 v175, v175, v192
    v_exp_f32 v172, v172
    v_exp_f32 v173, v173
    v_exp_f32 v174, v174
    v_exp_f32 v175, v175
    s_nop 0
    v_add_f32 v203, v172, v203
    v_add_f32 v203, v173, v203
    v_add_f32 v203, v174, v203
    v_add_f32 v203, v175, v203
    v_cvt_pk_bf16_f32 v140, v172, v173
    v_cvt_pk_bf16_f32 v141, v174, v175
    v_sub_f32 v176, v176, v196
    v_sub_f32 v177, v177, v196
    v_sub_f32 v178, v178, v196
    v_sub_f32 v179, v179, v196
    v_exp_f32 v176, v176
    v_exp_f32 v177, v177
    v_exp_f32 v178, v178
    v_exp_f32 v179, v179
    s_nop 0
    v_add_f32 v204, v176, v204
    v_add_f32 v204, v177, v204
    v_add_f32 v204, v178, v204
    v_add_f32 v204, v179, v204
    v_cvt_pk_bf16_f32 v156, v176, v177
    v_cvt_pk_bf16_f32 v157, v178, v179
    ds_read_b128 a[160:163], v205 offset:12288
    ds_read_b128 a[164:167], v206 offset:12288
    ds_read_b128 a[168:171], v207 offset:12288
    ds_read_b128 a[172:175], v208 offset:12288
    s_waitcnt lgkmcnt(3)
    v_mfma_f32_16x16x32_bf16 v[160:163], a[160:163], v[0:3], 0
    s_waitcnt lgkmcnt(2)
    v_mfma_f32_16x16x32_bf16 v[160:163], a[164:167], v[8:11], v[160:163]
    s_waitcnt lgkmcnt(1)
    v_mfma_f32_16x16x32_bf16 v[160:163], a[168:171], v[16:19], v[160:163]
    s_waitcnt lgkmcnt(0)
    v_mfma_f32_16x16x32_bf16 v[160:163], a[172:175], v[24:27], v[160:163]
    v_mfma_f32_16x16x32_bf16 v[164:167], a[172:175], v[56:59], 0
    v_mfma_f32_16x16x32_bf16 v[164:167], a[168:171], v[48:51], v[164:167]
    v_mfma_f32_16x16x32_bf16 v[164:167], a[164:167], v[40:43], v[164:167]
    v_mfma_f32_16x16x32_bf16 v[164:167], a[160:163], v[32:35], v[164:167]
    v_mfma_f32_16x16x32_bf16 v[168:171], a[160:163], v[64:67], 0
    v_mfma_f32_16x16x32_bf16 v[168:171], a[164:167], v[72:75], v[168:171]
    v_mfma_f32_16x16x32_bf16 v[168:171], a[168:171], v[80:83], v[168:171]
    v_mfma_f32_16x16x32_bf16 v[168:171], a[172:175], v[88:91], v[168:171]
    v_mfma_f32_16x16x32_bf16 v[172:175], a[172:175], v[120:123], 0
    v_mfma_f32_16x16x32_bf16 v[172:175], a[168:171], v[112:115], v[172:175]
    v_mfma_f32_16x16x32_bf16 v[172:175], a[164:167], v[104:107], v[172:175]
    v_mfma_f32_16x16x32_bf16 v[172:175], a[160:163], v[96:99], v[172:175]
    v_mfma_f32_16x16x32_bf16 v[176:179], a[160:163], v[128:131], 0
    v_mfma_f32_16x16x32_bf16 v[176:179], a[164:167], v[136:139], v[176:179]
    v_mfma_f32_16x16x32_bf16 v[176:179], a[168:171], v[144:147], v[176:179]
    v_mfma_f32_16x16x32_bf16 v[176:179], a[172:175], v[152:155], v[176:179]
    s_nop 7
    v_sub_f32 v160, v160, v180
    v_sub_f32 v161, v161, v180
    v_sub_f32 v162, v162, v180
    v_sub_f32 v163, v163, v180
    v_exp_f32 v160, v160
    v_exp_f32 v161, v161
    v_exp_f32 v162, v162
    v_exp_f32 v163, v163
    s_nop 0
    v_add_f32 v200, v160, v200
    v_add_f32 v200, v161, v200
    v_add_f32 v200, v162, v200
    v_add_f32 v200, v163, v200
    v_cvt_pk_bf16_f32 v94, v160, v161
    v_cvt_pk_bf16_f32 v95, v162, v163
    v_sub_f32 v164, v164, v184
    v_sub_f32 v165, v165, v184
    v_sub_f32 v166, v166, v184
    v_sub_f32 v167, v167, v184
    v_exp_f32 v164, v164
    v_exp_f32 v165, v165
    v_exp_f32 v166, v166
    v_exp_f32 v167, v167
    s_nop 0
    v_add_f32 v201, v164, v201
    v_add_f32 v201, v165, v201
    v_add_f32 v201, v166, v201
    v_add_f32 v201, v167, v201
    v_cvt_pk_bf16_f32 v110, v164, v165
    v_cvt_pk_bf16_f32 v111, v166, v167
    v_sub_f32 v168, v168, v188
    v_sub_f32 v169, v169, v188
    v_sub_f32 v170, v170, v188
    v_sub_f32 v171, v171, v188
    v_exp_f32 v168, v168
    v_exp_f32 v169, v169
    v_exp_f32 v170, v170
    v_exp_f32 v171, v171
    s_nop 0
    v_add_f32 v202, v168, v202
    v_add_f32 v202, v169, v202
    v_add_f32 v202, v170, v202
    v_add_f32 v202, v171, v202
    v_cvt_pk_bf16_f32 v126, v168, v169
    v_cvt_pk_bf16_f32 v127, v170, v171
    v_sub_f32 v172, v172, v192
    v_sub_f32 v173, v173, v192
    v_sub_f32 v174, v174, v192
    v_sub_f32 v175, v175, v192
    v_exp_f32 v172, v172
    v_exp_f32 v173, v173
    v_exp_f32 v174, v174
    v_exp_f32 v175, v175
    s_nop 0
    v_add_f32 v203, v172, v203
    v_add_f32 v203, v173, v203
    v_add_f32 v203, v174, v203
    v_add_f32 v203, v175, v203
    v_cvt_pk_bf16_f32 v142, v172, v173
    v_cvt_pk_bf16_f32 v143, v174, v175
    v_sub_f32 v176, v176, v196
    v_sub_f32 v177, v177, v196
    v_sub_f32 v178, v178, v196
    v_sub_f32 v179, v179, v196
    v_exp_f32 v176, v176
    v_exp_f32 v177, v177
    v_exp_f32 v178, v178
    v_exp_f32 v179, v179
    s_nop 0
    v_add_f32 v204, v176, v204
    v_add_f32 v204, v177, v204
    v_add_f32 v204, v178, v204
    v_add_f32 v204, v179, v204
    v_cvt_pk_bf16_f32 v158, v176, v177
    v_cvt_pk_bf16_f32 v159, v178, v179
    s_nop 1
    ds_read_b64_tr_b16 a[176:177], v209 offset:0
    ds_read_b64_tr_b16 a[178:179], v209 offset:4096
    ds_read_b64_tr_b16 a[180:181], v209 offset:8192
    ds_read_b64_tr_b16 a[182:183], v209 offset:12288
    ds_read_b64_tr_b16 a[184:185], v210 offset:0
    ds_read_b64_tr_b16 a[186:187], v210 offset:4096
    ds_read_b64_tr_b16 a[188:189], v210 offset:8192
    ds_read_b64_tr_b16 a[190:191], v210 offset:12288
    s_waitcnt lgkmcnt(6)
    v_mfma_f32_16x16x32_bf16 a[0:3], a[176:179], v[84:87], a[0:3]
    s_waitcnt lgkmcnt(4)
    v_mfma_f32_16x16x32_bf16 a[0:3], a[180:183], v[92:95], a[0:3]
    v_mfma_f32_16x16x32_bf16 a[32:35], a[180:183], v[108:111], a[32:35]
    v_mfma_f32_16x16x32_bf16 a[32:35], a[176:179], v[100:103], a[32:35]
    v_mfma_f32_16x16x32_bf16 a[64:67], a[176:179], v[116:119], a[64:67]
    v_mfma_f32_16x16x32_bf16 a[64:67], a[180:183], v[124:127], a[64:67]
    v_mfma_f32_16x16x32_bf16 a[96:99], a[180:183], v[140:143], a[96:99]
    v_mfma_f32_16x16x32_bf16 a[96:99], a[176:179], v[132:135], a[96:99]
    v_mfma_f32_16x16x32_bf16 a[128:131], a[176:179], v[148:151], a[128:131]
    v_mfma_f32_16x16x32_bf16 a[128:131], a[180:183], v[156:159], a[128:131]
    s_waitcnt lgkmcnt(2)
    v_mfma_f32_16x16x32_bf16 a[4:7], a[184:187], v[84:87], a[4:7]
    s_waitcnt lgkmcnt(0)
    v_mfma_f32_16x16x32_bf16 a[4:7], a[188:191], v[92:95], a[4:7]
    v_mfma_f32_16x16x32_bf16 a[36:39], a[188:191], v[108:111], a[36:39]
    v_mfma_f32_16x16x32_bf16 a[36:39], a[184:187], v[100:103], a[36:39]
    v_mfma_f32_16x16x32_bf16 a[68:71], a[184:187], v[116:119], a[68:71]
    v_mfma_f32_16x16x32_bf16 a[68:71], a[188:191], v[124:127], a[68:71]
    v_mfma_f32_16x16x32_bf16 a[100:103], a[188:191], v[140:143], a[100:103]
    v_mfma_f32_16x16x32_bf16 a[100:103], a[184:187], v[132:135], a[100:103]
    v_mfma_f32_16x16x32_bf16 a[132:135], a[184:187], v[148:151], a[132:135]
    v_mfma_f32_16x16x32_bf16 a[132:135], a[188:191], v[156:159], a[132:135]
    ds_read_b64_tr_b16 a[176:177], v211 offset:0
    ds_read_b64_tr_b16 a[178:179], v211 offset:4096
    ds_read_b64_tr_b16 a[180:181], v211 offset:8192
    ds_read_b64_tr_b16 a[182:183], v211 offset:12288
    ds_read_b64_tr_b16 a[184:185], v212 offset:0
    ds_read_b64_tr_b16 a[186:187], v212 offset:4096
    ds_read_b64_tr_b16 a[188:189], v212 offset:8192
    ds_read_b64_tr_b16 a[190:191], v212 offset:12288
    s_waitcnt lgkmcnt(6)
    v_mfma_f32_16x16x32_bf16 a[8:11], a[176:179], v[84:87], a[8:11]
    s_waitcnt lgkmcnt(4)
    v_mfma_f32_16x16x32_bf16 a[8:11], a[180:183], v[92:95], a[8:11]
    v_mfma_f32_16x16x32_bf16 a[40:43], a[180:183], v[108:111], a[40:43]
    v_mfma_f32_16x16x32_bf16 a[40:43], a[176:179], v[100:103], a[40:43]
    v_mfma_f32_16x16x32_bf16 a[72:75], a[176:179], v[116:119], a[72:75]
    v_mfma_f32_16x16x32_bf16 a[72:75], a[180:183], v[124:127], a[72:75]
    v_mfma_f32_16x16x32_bf16 a[104:107], a[180:183], v[140:143], a[104:107]
    v_mfma_f32_16x16x32_bf16 a[104:107], a[176:179], v[132:135], a[104:107]
    v_mfma_f32_16x16x32_bf16 a[136:139], a[176:179], v[148:151], a[136:139]
    v_mfma_f32_16x16x32_bf16 a[136:139], a[180:183], v[156:159], a[136:139]
    s_waitcnt lgkmcnt(2)
    v_mfma_f32_16x16x32_bf16 a[12:15], a[184:187], v[84:87], a[12:15]
    s_waitcnt lgkmcnt(0)
    v_mfma_f32_16x16x32_bf16 a[12:15], a[188:191], v[92:95], a[12:15]
    v_mfma_f32_16x16x32_bf16 a[44:47], a[188:191], v[108:111], a[44:47]
    v_mfma_f32_16x16x32_bf16 a[44:47], a[184:187], v[100:103], a[44:47]
    v_mfma_f32_16x16x32_bf16 a[76:79], a[184:187], v[116:119], a[76:79]
    v_mfma_f32_16x16x32_bf16 a[76:79], a[188:191], v[124:127], a[76:79]
    v_mfma_f32_16x16x32_bf16 a[108:111], a[188:191], v[140:143], a[108:111]
    v_mfma_f32_16x16x32_bf16 a[108:111], a[184:187], v[132:135], a[108:111]
    v_mfma_f32_16x16x32_bf16 a[140:143], a[184:187], v[148:151], a[140:143]
    v_mfma_f32_16x16x32_bf16 a[140:143], a[188:191], v[156:159], a[140:143]
    ds_read_b64_tr_b16 a[176:177], v213 offset:0
    ds_read_b64_tr_b16 a[178:179], v213 offset:4096
    ds_read_b64_tr_b16 a[180:181], v213 offset:8192
    ds_read_b64_tr_b16 a[182:183], v213 offset:12288
    ds_read_b64_tr_b16 a[184:185], v214 offset:0
    ds_read_b64_tr_b16 a[186:187], v214 offset:4096
    ds_read_b64_tr_b16 a[188:189], v214 offset:8192
    ds_read_b64_tr_b16 a[190:191], v214 offset:12288
    s_waitcnt lgkmcnt(6)
    v_mfma_f32_16x16x32_bf16 a[16:19], a[176:179], v[84:87], a[16:19]
    s_waitcnt lgkmcnt(4)
    v_mfma_f32_16x16x32_bf16 a[16:19], a[180:183], v[92:95], a[16:19]
    v_mfma_f32_16x16x32_bf16 a[48:51], a[180:183], v[108:111], a[48:51]
    v_mfma_f32_16x16x32_bf16 a[48:51], a[176:179], v[100:103], a[48:51]
    v_mfma_f32_16x16x32_bf16 a[80:83], a[176:179], v[116:119], a[80:83]
    v_mfma_f32_16x16x32_bf16 a[80:83], a[180:183], v[124:127], a[80:83]
    v_mfma_f32_16x16x32_bf16 a[112:115], a[180:183], v[140:143], a[112:115]
    v_mfma_f32_16x16x32_bf16 a[112:115], a[176:179], v[132:135], a[112:115]
    v_mfma_f32_16x16x32_bf16 a[144:147], a[176:179], v[148:151], a[144:147]
    v_mfma_f32_16x16x32_bf16 a[144:147], a[180:183], v[156:159], a[144:147]
    s_waitcnt lgkmcnt(2)
    v_mfma_f32_16x16x32_bf16 a[20:23], a[184:187], v[84:87], a[20:23]
    s_waitcnt lgkmcnt(0)
    v_mfma_f32_16x16x32_bf16 a[20:23], a[188:191], v[92:95], a[20:23]
    v_mfma_f32_16x16x32_bf16 a[52:55], a[188:191], v[108:111], a[52:55]
    v_mfma_f32_16x16x32_bf16 a[52:55], a[184:187], v[100:103], a[52:55]
    v_mfma_f32_16x16x32_bf16 a[84:87], a[184:187], v[116:119], a[84:87]
    v_mfma_f32_16x16x32_bf16 a[84:87], a[188:191], v[124:127], a[84:87]
    v_mfma_f32_16x16x32_bf16 a[116:119], a[188:191], v[140:143], a[116:119]
    v_mfma_f32_16x16x32_bf16 a[116:119], a[184:187], v[132:135], a[116:119]
    v_mfma_f32_16x16x32_bf16 a[148:151], a[184:187], v[148:151], a[148:151]
    v_mfma_f32_16x16x32_bf16 a[148:151], a[188:191], v[156:159], a[148:151]
    ds_read_b64_tr_b16 a[176:177], v215 offset:0
    ds_read_b64_tr_b16 a[178:179], v215 offset:4096
    ds_read_b64_tr_b16 a[180:181], v215 offset:8192
    ds_read_b64_tr_b16 a[182:183], v215 offset:12288
    ds_read_b64_tr_b16 a[184:185], v216 offset:0
    ds_read_b64_tr_b16 a[186:187], v216 offset:4096
    ds_read_b64_tr_b16 a[188:189], v216 offset:8192
    ds_read_b64_tr_b16 a[190:191], v216 offset:12288
    s_waitcnt lgkmcnt(6)
    v_mfma_f32_16x16x32_bf16 a[24:27], a[176:179], v[84:87], a[24:27]
    s_waitcnt lgkmcnt(4)
    v_mfma_f32_16x16x32_bf16 a[24:27], a[180:183], v[92:95], a[24:27]
    v_mfma_f32_16x16x32_bf16 a[56:59], a[180:183], v[108:111], a[56:59]
    v_mfma_f32_16x16x32_bf16 a[56:59], a[176:179], v[100:103], a[56:59]
    v_mfma_f32_16x16x32_bf16 a[88:91], a[176:179], v[116:119], a[88:91]
    v_mfma_f32_16x16x32_bf16 a[88:91], a[180:183], v[124:127], a[88:91]
    v_mfma_f32_16x16x32_bf16 a[120:123], a[180:183], v[140:143], a[120:123]
    v_mfma_f32_16x16x32_bf16 a[120:123], a[176:179], v[132:135], a[120:123]
    v_mfma_f32_16x16x32_bf16 a[152:155], a[176:179], v[148:151], a[152:155]
    v_mfma_f32_16x16x32_bf16 a[152:155], a[180:183], v[156:159], a[152:155]
    s_waitcnt lgkmcnt(2)
    v_mfma_f32_16x16x32_bf16 a[28:31], a[184:187], v[84:87], a[28:31]
    s_waitcnt lgkmcnt(0)
    v_mfma_f32_16x16x32_bf16 a[28:31], a[188:191], v[92:95], a[28:31]
    v_mfma_f32_16x16x32_bf16 a[60:63], a[188:191], v[108:111], a[60:63]
    v_mfma_f32_16x16x32_bf16 a[60:63], a[184:187], v[100:103], a[60:63]
    v_mfma_f32_16x16x32_bf16 a[92:95], a[184:187], v[116:119], a[92:95]
    v_mfma_f32_16x16x32_bf16 a[92:95], a[188:191], v[124:127], a[92:95]
    v_mfma_f32_16x16x32_bf16 a[124:127], a[188:191], v[140:143], a[124:127]
    v_mfma_f32_16x16x32_bf16 a[124:127], a[184:187], v[132:135], a[124:127]
    v_mfma_f32_16x16x32_bf16 a[156:159], a[184:187], v[148:151], a[156:159]
    v_mfma_f32_16x16x32_bf16 a[156:159], a[188:191], v[156:159], a[156:159]
    s_barrier
    s_sub_u32 s31, s31, 1
    s_cmp_lg_u32 s31, 0
    s_cbranch_scc1 L_s2
    v_mov_b32 v239, v200
    v_mov_b32 v240, v201
    v_mov_b32 v241, v202
    v_mov_b32 v242, v203
    v_mov_b32 v243, v204
    s_nop 0
    v_permlane16_swap_b32 v200, v239
    v_permlane16_swap_b32 v201, v240
    v_permlane16_swap_b32 v202, v241
    v_permlane16_swap_b32 v203, v242
    v_permlane16_swap_b32 v204, v243
    v_add_f32 v200, v200, v239
    v_mov_b32 v239, v200
    v_add_f32 v201, v201, v240
    v_mov_b32 v240, v201
    v_add_f32 v202, v202, v241
    v_mov_b32 v241, v202
    v_add_f32 v203, v203, v242
    v_mov_b32 v242, v203
    v_add_f32 v204, v204, v243
    v_mov_b32 v243, v204
    s_nop 0
    v_permlane32_swap_b32 v200, v239
    v_permlane32_swap_b32 v201, v240
    v_permlane32_swap_b32 v202, v241
    v_permlane32_swap_b32 v203, v242
    v_permlane32_swap_b32 v204, v243
    v_add_f32 v200, v200, v239
    v_add_f32 v201, v201, v240
    v_add_f32 v202, v202, v241
    v_add_f32 v203, v203, v242
    v_add_f32 v204, v204, v243
    v_rcp_f32 v200, v200
    v_rcp_f32 v201, v201
    v_rcp_f32 v202, v202
    v_rcp_f32 v203, v203
    v_rcp_f32 v204, v204
    v_add_u32 v223, s34, v238
    v_add_u32 v224, 0x10000, v223
    v_add_u32 v225, 0x20000, v223
    s_lshl_b32 s32, s54, 1
    s_and_b32 s27, s55, 1
    s_add_u32 s32, s32, s27
    s_lshl_b32 s32, s32, 2
    s_add_u32 s32, s32, s24
    s_lshl_b32 s32, s32, 12
    s_add_u32 s32, s32, 0x2800000
    s_add_u32 s56, s50, s32
    s_addc_u32 s57, s51, 0
    s_mov_b32 s58, 3936256
    s_mov_b32 s59, 0x20000
    s_mul_i32 s27, s25, 20
    s_mul_i32 s32, s24, 5
    s_add_u32 s27, s27, s32
    s_lshl_b32 s27, s27, 5
    s_add_u32 s27, s27, s26
    s_lshl_b32 s27, s27, 12
    s_add_u32 s8, s50, s27
    s_addc_u32 s9, s51, 0
    s_mov_b32 s10, 528384
    s_mov_b32 s11, 0x20000
    s_and_b32 s98, s26, 3
    s_lshl_b32 s98, s98, 10
    s_cmp_eq_u32 s24, 3
    s_cselect_b32 s10, 397312, s10
    v_accvgpr_read_b32 v160, a0
    v_accvgpr_read_b32 v161, a1
    v_accvgpr_read_b32 v162, a2
    v_accvgpr_read_b32 v163, a3
    v_accvgpr_read_b32 v164, a4
    v_accvgpr_read_b32 v165, a5
    v_accvgpr_read_b32 v166, a6
    v_accvgpr_read_b32 v167, a7
    v_mul_f32 v160, v160, v200
    v_mul_f32 v161, v161, v200
    v_mul_f32 v162, v162, v200
    v_mul_f32 v163, v163, v200
    v_mul_f32 v164, v164, v200
    v_mul_f32 v165, v165, v200
    v_mul_f32 v166, v166, v200
    v_mul_f32 v167, v167, v200
    v_cvt_pk_bf16_f32 v160, v160, v161
    v_cvt_pk_bf16_f32 v161, v162, v163
    v_cvt_pk_bf16_f32 v162, v164, v165
    v_cvt_pk_bf16_f32 v163, v166, v167
    s_xor_b32 s29, s98, 0
    buffer_store_dwordx4 v[160:163], v238, s[8:11], s29 offen sc0 sc1
    v_accvgpr_read_b32 v168, a32
    v_accvgpr_read_b32 v169, a33
    v_accvgpr_read_b32 v170, a34
    v_accvgpr_read_b32 v171, a35
    v_accvgpr_read_b32 v172, a36
    v_accvgpr_read_b32 v173, a37
    v_accvgpr_read_b32 v174, a38
    v_accvgpr_read_b32 v175, a39
    v_mul_f32 v168, v168, v201
    v_mul_f32 v169, v169, v201
    v_mul_f32 v170, v170, v201
    v_mul_f32 v171, v171, v201
    v_mul_f32 v172, v172, v201
    v_mul_f32 v173, v173, v201
    v_mul_f32 v174, v174, v201
    v_mul_f32 v175, v175, v201
    v_cvt_pk_bf16_f32 v168, v168, v169
    v_cvt_pk_bf16_f32 v169, v170, v171
    v_cvt_pk_bf16_f32 v170, v172, v173
    v_cvt_pk_bf16_f32 v171, v174, v175
    s_xor_b32 s29, s98, 131072
    buffer_store_dwordx4 v[168:171], v238, s[8:11], s29 offen sc0 sc1
    v_accvgpr_read_b32 v176, a64
    v_accvgpr_read_b32 v177, a65
    v_accvgpr_read_b32 v178, a66
    v_accvgpr_read_b32 v179, a67
    v_accvgpr_read_b32 v180, a68
    v_accvgpr_read_b32 v181, a69
    v_accvgpr_read_b32 v182, a70
    v_accvgpr_read_b32 v183, a71
    v_mul_f32 v176, v176, v202
    v_mul_f32 v177, v177, v202
    v_mul_f32 v178, v178, v202
    v_mul_f32 v179, v179, v202
    v_mul_f32 v180, v180, v202
    v_mul_f32 v181, v181, v202
    v_mul_f32 v182, v182, v202
    v_mul_f32 v183, v183, v202
    v_cvt_pk_bf16_f32 v176, v176, v177
    v_cvt_pk_bf16_f32 v177, v178, v179
    v_cvt_pk_bf16_f32 v178, v180, v181
    v_cvt_pk_bf16_f32 v179, v182, v183
    s_xor_b32 s29, s98, 262144
    buffer_store_dwordx4 v[176:179], v238, s[8:11], s29 offen sc0 sc1
    v_accvgpr_read_b32 v184, a96
    v_accvgpr_read_b32 v185, a97
    v_accvgpr_read_b32 v186, a98
    v_accvgpr_read_b32 v187, a99
    v_accvgpr_read_b32 v188, a100
    v_accvgpr_read_b32 v189, a101
    v_accvgpr_read_b32 v190, a102
    v_accvgpr_read_b32 v191, a103
    v_mul_f32 v184, v184, v203
    v_mul_f32 v185, v185, v203
    v_mul_f32 v186, v186, v203
    v_mul_f32 v187, v187, v203
    v_mul_f32 v188, v188, v203
    v_mul_f32 v189, v189, v203
    v_mul_f32 v190, v190, v203
    v_mul_f32 v191, v191, v203
    v_cvt_pk_bf16_f32 v184, v184, v185
    v_cvt_pk_bf16_f32 v185, v186, v187
    v_cvt_pk_bf16_f32 v186, v188, v189
    v_cvt_pk_bf16_f32 v187, v190, v191
    s_xor_b32 s29, s98, 393216
    buffer_store_dwordx4 v[184:187], v238, s[8:11], s29 offen sc0 sc1
    v_accvgpr_read_b32 v192, a128
    v_accvgpr_read_b32 v193, a129
    v_accvgpr_read_b32 v194, a130
    v_accvgpr_read_b32 v195, a131
    v_accvgpr_read_b32 v196, a132
    v_accvgpr_read_b32 v197, a133
    v_accvgpr_read_b32 v198, a134
    v_accvgpr_read_b32 v199, a135
    v_mul_f32 v192, v192, v204
    v_mul_f32 v193, v193, v204
    v_mul_f32 v194, v194, v204
    v_mul_f32 v195, v195, v204
    v_mul_f32 v196, v196, v204
    v_mul_f32 v197, v197, v204
    v_mul_f32 v198, v198, v204
    v_mul_f32 v199, v199, v204
    v_cvt_pk_bf16_f32 v192, v192, v193
    v_cvt_pk_bf16_f32 v193, v194, v195
    v_cvt_pk_bf16_f32 v194, v196, v197
    v_cvt_pk_bf16_f32 v195, v198, v199
    s_xor_b32 s29, s98, 524288
    buffer_store_dwordx4 v[192:195], v238, s[8:11], s29 offen sc0 sc1
    v_accvgpr_read_b32 v160, a8
    v_accvgpr_read_b32 v161, a9
    v_accvgpr_read_b32 v162, a10
    v_accvgpr_read_b32 v163, a11
    v_accvgpr_read_b32 v164, a12
    v_accvgpr_read_b32 v165, a13
    v_accvgpr_read_b32 v166, a14
    v_accvgpr_read_b32 v167, a15
    v_mul_f32 v160, v160, v200
    v_mul_f32 v161, v161, v200
    v_mul_f32 v162, v162, v200
    v_mul_f32 v163, v163, v200
    v_mul_f32 v164, v164, v200
    v_mul_f32 v165, v165, v200
    v_mul_f32 v166, v166, v200
    v_mul_f32 v167, v167, v200
    v_cvt_pk_bf16_f32 v160, v160, v161
    v_cvt_pk_bf16_f32 v161, v162, v163
    v_cvt_pk_bf16_f32 v162, v164, v165
    v_cvt_pk_bf16_f32 v163, v166, v167
    s_xor_b32 s29, s98, 1024
    buffer_store_dwordx4 v[160:163], v238, s[8:11], s29 offen sc0 sc1
    v_accvgpr_read_b32 v168, a40
    v_accvgpr_read_b32 v169, a41
    v_accvgpr_read_b32 v170, a42
    v_accvgpr_read_b32 v171, a43
    v_accvgpr_read_b32 v172, a44
    v_accvgpr_read_b32 v173, a45
    v_accvgpr_read_b32 v174, a46
    v_accvgpr_read_b32 v175, a47
    v_mul_f32 v168, v168, v201
    v_mul_f32 v169, v169, v201
    v_mul_f32 v170, v170, v201
    v_mul_f32 v171, v171, v201
    v_mul_f32 v172, v172, v201
    v_mul_f32 v173, v173, v201
    v_mul_f32 v174, v174, v201
    v_mul_f32 v175, v175, v201
    v_cvt_pk_bf16_f32 v168, v168, v169
    v_cvt_pk_bf16_f32 v169, v170, v171
    v_cvt_pk_bf16_f32 v170, v172, v173
    v_cvt_pk_bf16_f32 v171, v174, v175
    s_xor_b32 s29, s98, 132096
    buffer_store_dwordx4 v[168:171], v238, s[8:11], s29 offen sc0 sc1
    v_accvgpr_read_b32 v176, a72
    v_accvgpr_read_b32 v177, a73
    v_accvgpr_read_b32 v178, a74
    v_accvgpr_read_b32 v179, a75
    v_accvgpr_read_b32 v180, a76
    v_accvgpr_read_b32 v181, a77
    v_accvgpr_read_b32 v182, a78
    v_accvgpr_read_b32 v183, a79
    v_mul_f32 v176, v176, v202
    v_mul_f32 v177, v177, v202
    v_mul_f32 v178, v178, v202
    v_mul_f32 v179, v179, v202
    v_mul_f32 v180, v180, v202
    v_mul_f32 v181, v181, v202
    v_mul_f32 v182, v182, v202
    v_mul_f32 v183, v183, v202
    v_cvt_pk_bf16_f32 v176, v176, v177
    v_cvt_pk_bf16_f32 v177, v178, v179
    v_cvt_pk_bf16_f32 v178, v180, v181
    v_cvt_pk_bf16_f32 v179, v182, v183
    s_xor_b32 s29, s98, 263168
    buffer_store_dwordx4 v[176:179], v238, s[8:11], s29 offen sc0 sc1
    v_accvgpr_read_b32 v184, a104
    v_accvgpr_read_b32 v185, a105
    v_accvgpr_read_b32 v186, a106
    v_accvgpr_read_b32 v187, a107
    v_accvgpr_read_b32 v188, a108
    v_accvgpr_read_b32 v189, a109
    v_accvgpr_read_b32 v190, a110
    v_accvgpr_read_b32 v191, a111
    v_mul_f32 v184, v184, v203
    v_mul_f32 v185, v185, v203
    v_mul_f32 v186, v186, v203
    v_mul_f32 v187, v187, v203
    v_mul_f32 v188, v188, v203
    v_mul_f32 v189, v189, v203
    v_mul_f32 v190, v190, v203
    v_mul_f32 v191, v191, v203
    v_cvt_pk_bf16_f32 v184, v184, v185
    v_cvt_pk_bf16_f32 v185, v186, v187
    v_cvt_pk_bf16_f32 v186, v188, v189
    v_cvt_pk_bf16_f32 v187, v190, v191
    s_xor_b32 s29, s98, 394240
    buffer_store_dwordx4 v[184:187], v238, s[8:11], s29 offen sc0 sc1
    v_accvgpr_read_b32 v192, a136
    v_accvgpr_read_b32 v193, a137
    v_accvgpr_read_b32 v194, a138
    v_accvgpr_read_b32 v195, a139
    v_accvgpr_read_b32 v196, a140
    v_accvgpr_read_b32 v197, a141
    v_accvgpr_read_b32 v198, a142
    v_accvgpr_read_b32 v199, a143
    v_mul_f32 v192, v192, v204
    v_mul_f32 v193, v193, v204
    v_mul_f32 v194, v194, v204
    v_mul_f32 v195, v195, v204
    v_mul_f32 v196, v196, v204
    v_mul_f32 v197, v197, v204
    v_mul_f32 v198, v198, v204
    v_mul_f32 v199, v199, v204
    v_cvt_pk_bf16_f32 v192, v192, v193
    v_cvt_pk_bf16_f32 v193, v194, v195
    v_cvt_pk_bf16_f32 v194, v196, v197
    v_cvt_pk_bf16_f32 v195, v198, v199
    s_xor_b32 s29, s98, 525312
    buffer_store_dwordx4 v[192:195], v238, s[8:11], s29 offen sc0 sc1
    v_accvgpr_read_b32 v160, a16
    v_accvgpr_read_b32 v161, a17
    v_accvgpr_read_b32 v162, a18
    v_accvgpr_read_b32 v163, a19
    v_accvgpr_read_b32 v164, a20
    v_accvgpr_read_b32 v165, a21
    v_accvgpr_read_b32 v166, a22
    v_accvgpr_read_b32 v167, a23
    v_mul_f32 v160, v160, v200
    v_mul_f32 v161, v161, v200
    v_mul_f32 v162, v162, v200
    v_mul_f32 v163, v163, v200
    v_mul_f32 v164, v164, v200
    v_mul_f32 v165, v165, v200
    v_mul_f32 v166, v166, v200
    v_mul_f32 v167, v167, v200
    v_cvt_pk_bf16_f32 v128, v160, v161
    v_cvt_pk_bf16_f32 v129, v162, v163
    v_cvt_pk_bf16_f32 v130, v164, v165
    v_cvt_pk_bf16_f32 v131, v166, v167
    s_xor_b32 s29, s98, 2048
    buffer_store_dwordx4 v[128:131], v238, s[8:11], s29 offen sc0 sc1
    v_accvgpr_read_b32 v168, a48
    v_accvgpr_read_b32 v169, a49
    v_accvgpr_read_b32 v170, a50
    v_accvgpr_read_b32 v171, a51
    v_accvgpr_read_b32 v172, a52
    v_accvgpr_read_b32 v173, a53
    v_accvgpr_read_b32 v174, a54
    v_accvgpr_read_b32 v175, a55
    v_mul_f32 v168, v168, v201
    v_mul_f32 v169, v169, v201
    v_mul_f32 v170, v170, v201
    v_mul_f32 v171, v171, v201
    v_mul_f32 v172, v172, v201
    v_mul_f32 v173, v173, v201
    v_mul_f32 v174, v174, v201
    v_mul_f32 v175, v175, v201
    v_cvt_pk_bf16_f32 v136, v168, v169
    v_cvt_pk_bf16_f32 v137, v170, v171
    v_cvt_pk_bf16_f32 v138, v172, v173
    v_cvt_pk_bf16_f32 v139, v174, v175
    s_xor_b32 s29, s98, 133120
    buffer_store_dwordx4 v[136:139], v238, s[8:11], s29 offen sc0 sc1
    v_accvgpr_read_b32 v176, a80
    v_accvgpr_read_b32 v177, a81
    v_accvgpr_read_b32 v178, a82
    v_accvgpr_read_b32 v179, a83
    v_accvgpr_read_b32 v180, a84
    v_accvgpr_read_b32 v181, a85
    v_accvgpr_read_b32 v182, a86
    v_accvgpr_read_b32 v183, a87
    v_mul_f32 v176, v176, v202
    v_mul_f32 v177, v177, v202
    v_mul_f32 v178, v178, v202
    v_mul_f32 v179, v179, v202
    v_mul_f32 v180, v180, v202
    v_mul_f32 v181, v181, v202
    v_mul_f32 v182, v182, v202
    v_mul_f32 v183, v183, v202
    v_cvt_pk_bf16_f32 v144, v176, v177
    v_cvt_pk_bf16_f32 v145, v178, v179
    v_cvt_pk_bf16_f32 v146, v180, v181
    v_cvt_pk_bf16_f32 v147, v182, v183
    s_xor_b32 s29, s98, 264192
    buffer_store_dwordx4 v[144:147], v238, s[8:11], s29 offen sc0 sc1
    v_accvgpr_read_b32 v184, a112
    v_accvgpr_read_b32 v185, a113
    v_accvgpr_read_b32 v186, a114
    v_accvgpr_read_b32 v187, a115
    v_accvgpr_read_b32 v188, a116
    v_accvgpr_read_b32 v189, a117
    v_accvgpr_read_b32 v190, a118
    v_accvgpr_read_b32 v191, a119
    v_mul_f32 v184, v184, v203
    v_mul_f32 v185, v185, v203
    v_mul_f32 v186, v186, v203
    v_mul_f32 v187, v187, v203
    v_mul_f32 v188, v188, v203
    v_mul_f32 v189, v189, v203
    v_mul_f32 v190, v190, v203
    v_mul_f32 v191, v191, v203
    v_cvt_pk_bf16_f32 v152, v184, v185
    v_cvt_pk_bf16_f32 v153, v186, v187
    v_cvt_pk_bf16_f32 v154, v188, v189
    v_cvt_pk_bf16_f32 v155, v190, v191
    s_xor_b32 s29, s98, 395264
    buffer_store_dwordx4 v[152:155], v238, s[8:11], s29 offen sc0 sc1
    v_accvgpr_read_b32 v192, a144
    v_accvgpr_read_b32 v193, a145
    v_accvgpr_read_b32 v194, a146
    v_accvgpr_read_b32 v195, a147
    v_accvgpr_read_b32 v196, a148
    v_accvgpr_read_b32 v197, a149
    v_accvgpr_read_b32 v198, a150
    v_accvgpr_read_b32 v199, a151
    v_mul_f32 v192, v192, v204
    v_mul_f32 v193, v193, v204
    v_mul_f32 v194, v194, v204
    v_mul_f32 v195, v195, v204
    v_mul_f32 v196, v196, v204
    v_mul_f32 v197, v197, v204
    v_mul_f32 v198, v198, v204
    v_mul_f32 v199, v199, v204
    v_cvt_pk_bf16_f32 v208, v192, v193
    v_cvt_pk_bf16_f32 v209, v194, v195
    v_cvt_pk_bf16_f32 v210, v196, v197
    v_cvt_pk_bf16_f32 v211, v198, v199
    s_xor_b32 s29, s98, 526336
    buffer_store_dwordx4 v[208:211], v238, s[8:11], s29 offen sc0 sc1
    v_accvgpr_read_b32 v160, a24
    v_accvgpr_read_b32 v161, a25
    v_accvgpr_read_b32 v162, a26
    v_accvgpr_read_b32 v163, a27
    v_accvgpr_read_b32 v164, a28
    v_accvgpr_read_b32 v165, a29
    v_accvgpr_read_b32 v166, a30
    v_accvgpr_read_b32 v167, a31
    v_mul_f32 v160, v160, v200
    v_mul_f32 v161, v161, v200
    v_mul_f32 v162, v162, v200
    v_mul_f32 v163, v163, v200
    v_mul_f32 v164, v164, v200
    v_mul_f32 v165, v165, v200
    v_mul_f32 v166, v166, v200
    v_mul_f32 v167, v167, v200
    v_cvt_pk_bf16_f32 v132, v160, v161
    v_cvt_pk_bf16_f32 v133, v162, v163
    v_cvt_pk_bf16_f32 v134, v164, v165
    v_cvt_pk_bf16_f32 v135, v166, v167
    s_xor_b32 s29, s98, 3072
    buffer_store_dwordx4 v[132:135], v238, s[8:11], s29 offen sc0 sc1
    v_accvgpr_read_b32 v168, a56
    v_accvgpr_read_b32 v169, a57
    v_accvgpr_read_b32 v170, a58
    v_accvgpr_read_b32 v171, a59
    v_accvgpr_read_b32 v172, a60
    v_accvgpr_read_b32 v173, a61
    v_accvgpr_read_b32 v174, a62
    v_accvgpr_read_b32 v175, a63
    v_mul_f32 v168, v168, v201
    v_mul_f32 v169, v169, v201
    v_mul_f32 v170, v170, v201
    v_mul_f32 v171, v171, v201
    v_mul_f32 v172, v172, v201
    v_mul_f32 v173, v173, v201
    v_mul_f32 v174, v174, v201
    v_mul_f32 v175, v175, v201
    v_cvt_pk_bf16_f32 v140, v168, v169
    v_cvt_pk_bf16_f32 v141, v170, v171
    v_cvt_pk_bf16_f32 v142, v172, v173
    v_cvt_pk_bf16_f32 v143, v174, v175
    s_xor_b32 s29, s98, 134144
    buffer_store_dwordx4 v[140:143], v238, s[8:11], s29 offen sc0 sc1
    v_accvgpr_read_b32 v176, a88
    v_accvgpr_read_b32 v177, a89
    v_accvgpr_read_b32 v178, a90
    v_accvgpr_read_b32 v179, a91
    v_accvgpr_read_b32 v180, a92
    v_accvgpr_read_b32 v181, a93
    v_accvgpr_read_b32 v182, a94
    v_accvgpr_read_b32 v183, a95
    v_mul_f32 v176, v176, v202
    v_mul_f32 v177, v177, v202
    v_mul_f32 v178, v178, v202
    v_mul_f32 v179, v179, v202
    v_mul_f32 v180, v180, v202
    v_mul_f32 v181, v181, v202
    v_mul_f32 v182, v182, v202
    v_mul_f32 v183, v183, v202
    v_cvt_pk_bf16_f32 v148, v176, v177
    v_cvt_pk_bf16_f32 v149, v178, v179
    v_cvt_pk_bf16_f32 v150, v180, v181
    v_cvt_pk_bf16_f32 v151, v182, v183
    s_xor_b32 s29, s98, 265216
    buffer_store_dwordx4 v[148:151], v238, s[8:11], s29 offen sc0 sc1
    v_accvgpr_read_b32 v184, a120
    v_accvgpr_read_b32 v185, a121
    v_accvgpr_read_b32 v186, a122
    v_accvgpr_read_b32 v187, a123
    v_accvgpr_read_b32 v188, a124
    v_accvgpr_read_b32 v189, a125
    v_accvgpr_read_b32 v190, a126
    v_accvgpr_read_b32 v191, a127
    v_mul_f32 v184, v184, v203
    v_mul_f32 v185, v185, v203
    v_mul_f32 v186, v186, v203
    v_mul_f32 v187, v187, v203
    v_mul_f32 v188, v188, v203
    v_mul_f32 v189, v189, v203
    v_mul_f32 v190, v190, v203
    v_mul_f32 v191, v191, v203
    v_cvt_pk_bf16_f32 v156, v184, v185
    v_cvt_pk_bf16_f32 v157, v186, v187
    v_cvt_pk_bf16_f32 v158, v188, v189
    v_cvt_pk_bf16_f32 v159, v190, v191
    v_accvgpr_read_b32 v192, a152
    v_accvgpr_read_b32 v193, a153
    v_accvgpr_read_b32 v194, a154
    v_accvgpr_read_b32 v195, a155
    v_accvgpr_read_b32 v196, a156
    v_accvgpr_read_b32 v197, a157
    v_accvgpr_read_b32 v198, a158
    v_accvgpr_read_b32 v199, a159
    v_mul_f32 v192, v192, v204
    v_mul_f32 v193, v193, v204
    v_mul_f32 v194, v194, v204
    v_mul_f32 v195, v195, v204
    v_mul_f32 v196, v196, v204
    v_mul_f32 v197, v197, v204
    v_mul_f32 v198, v198, v204
    v_mul_f32 v199, v199, v204
    v_cvt_pk_bf16_f32 v212, v192, v193
    v_cvt_pk_bf16_f32 v213, v194, v195
    v_cvt_pk_bf16_f32 v214, v196, v197
    v_cvt_pk_bf16_f32 v215, v198, v199
    s_mov_b32 s27, 0
    buffer_load_dwordx4 a[192:195], v238, s[56:59], s27 offen sc1
    buffer_load_dwordx4 a[196:199], v238, s[56:59], s27 offen offset:1024 sc1
    buffer_load_dwordx4 a[200:203], v238, s[56:59], s27 offen offset:2048 sc1
    buffer_load_dwordx4 a[204:207], v238, s[56:59], s27 offen offset:3072 sc1
    s_mov_b32 s27, 262144
    buffer_load_dwordx4 a[208:211], v238, s[56:59], s27 offen sc1
    buffer_load_dwordx4 a[212:215], v238, s[56:59], s27 offen offset:1024 sc1
    buffer_load_dwordx4 a[216:219], v238, s[56:59], s27 offen offset:2048 sc1
    buffer_load_dwordx4 a[220:223], v238, s[56:59], s27 offen offset:3072 sc1
    s_mov_b32 s27, 524288
    buffer_load_dwordx4 a[224:227], v238, s[56:59], s27 offen sc1
    buffer_load_dwordx4 a[228:231], v238, s[56:59], s27 offen offset:1024 sc1
    buffer_load_dwordx4 a[232:235], v238, s[56:59], s27 offen offset:2048 sc1
    buffer_load_dwordx4 a[236:239], v238, s[56:59], s27 offen offset:3072 sc1
    s_mov_b32 s27, 786432
    buffer_load_dwordx4 a[240:243], v238, s[56:59], s27 offen sc1
    buffer_load_dwordx4 a[244:247], v238, s[56:59], s27 offen offset:1024 sc1
    buffer_load_dwordx4 a[248:251], v238, s[56:59], s27 offen offset:2048 sc1
    buffer_load_dwordx4 a[252:255], v238, s[56:59], s27 offen offset:3072 sc1
    s_mov_b32 s27, 1048576
    buffer_load_dwordx4 v[0:3], v238, s[56:59], s27 offen sc1
    buffer_load_dwordx4 v[8:11], v238, s[56:59], s27 offen offset:1024 sc1
    buffer_load_dwordx4 v[16:19], v238, s[56:59], s27 offen offset:2048 sc1
    buffer_load_dwordx4 v[24:27], v238, s[56:59], s27 offen offset:3072 sc1
    s_mov_b32 s27, 1310720
    buffer_load_dwordx4 v[32:35], v238, s[56:59], s27 offen sc1
    buffer_load_dwordx4 v[40:43], v238, s[56:59], s27 offen offset:1024 sc1
    buffer_load_dwordx4 v[48:51], v238, s[56:59], s27 offen offset:2048 sc1
    buffer_load_dwordx4 v[56:59], v238, s[56:59], s27 offen offset:3072 sc1
    s_mov_b32 s27, 1572864
    buffer_load_dwordx4 v[64:67], v238, s[56:59], s27 offen sc1
    buffer_load_dwordx4 v[72:75], v238, s[56:59], s27 offen offset:1024 sc1
    buffer_load_dwordx4 v[80:83], v238, s[56:59], s27 offen offset:2048 sc1
    buffer_load_dwordx4 v[88:91], v238, s[56:59], s27 offen offset:3072 sc1
    s_mov_b32 s27, 1835008
    buffer_load_dwordx4 v[96:99], v238, s[56:59], s27 offen sc1
    buffer_load_dwordx4 v[104:107], v238, s[56:59], s27 offen offset:1024 sc1
    buffer_load_dwordx4 v[112:115], v238, s[56:59], s27 offen offset:2048 sc1
    buffer_load_dwordx4 v[120:123], v238, s[56:59], s27 offen offset:3072 sc1
    s_add_u32 m0, s34, 131072
    s_mov_b32 s27, 2097152
    buffer_load_dwordx4 v238, s[56:59], s27 offen sc1 lds
    buffer_load_dwordx4 v238, s[56:59], s27 offen offset:1024 sc1 lds
    buffer_load_dwordx4 v238, s[56:59], s27 offen offset:2048 sc1 lds
    buffer_load_dwordx4 v238, s[56:59], s27 offen offset:3072 sc1 lds
    s_add_u32 m0, s34, 147456
    s_mov_b32 s27, 2359296
    buffer_load_dwordx4 v238, s[56:59], s27 offen sc1 lds
    buffer_load_dwordx4 v238, s[56:59], s27 offen offset:1024 sc1 lds
    buffer_load_dwordx4 v238, s[56:59], s27 offen offset:2048 sc1 lds
    buffer_load_dwordx4 v238, s[56:59], s27 offen offset:3072 sc1 lds
    s_add_u32 m0, s34, 16384
    s_mov_b32 s27, 2621440
    buffer_load_dwordx4 v238, s[56:59], s27 offen sc1 lds
    buffer_load_dwordx4 v238, s[56:59], s27 offen offset:1024 sc1 lds
    buffer_load_dwordx4 v238, s[56:59], s27 offen offset:2048 sc1 lds
    buffer_load_dwordx4 v238, s[56:59], s27 offen offset:3072 sc1 lds
    s_add_u32 m0, s34, 65536
    s_mov_b32 s27, 2883584
    buffer_load_dwordx4 v238, s[56:59], s27 offen sc1 lds
    buffer_load_dwordx4 v238, s[56:59], s27 offen offset:1024 sc1 lds
    buffer_load_dwordx4 v238, s[56:59], s27 offen offset:2048 sc1 lds
    buffer_load_dwordx4 v238, s[56:59], s27 offen offset:3072 sc1 lds
    s_mov_b32 s27, 3145728
    buffer_load_dwordx4 v[4:7], v238, s[56:59], s27 offen sc1
    buffer_load_dwordx4 v[12:15], v238, s[56:59], s27 offen offset:1024 sc1
    buffer_load_dwordx4 v[20:23], v238, s[56:59], s27 offen offset:2048 sc1
    buffer_load_dwordx4 v[28:31], v238, s[56:59], s27 offen offset:3072 sc1
    s_mov_b32 s27, 3407872
    buffer_load_dwordx4 v[36:39], v238, s[56:59], s27 offen sc1
    buffer_load_dwordx4 v[44:47], v238, s[56:59], s27 offen offset:1024 sc1
    buffer_load_dwordx4 v[52:55], v238, s[56:59], s27 offen offset:2048 sc1
    buffer_load_dwordx4 v[60:63], v238, s[56:59], s27 offen offset:3072 sc1
    s_add_u32 m0, s34, 32768
    s_mov_b32 s27, 3670016
    buffer_load_dwordx4 v238, s[56:59], s27 offen sc1 lds
    buffer_load_dwordx4 v238, s[56:59], s27 offen offset:1024 sc1 lds
    buffer_load_dwordx4 v238, s[56:59], s27 offen offset:2048 sc1 lds
    buffer_load_dwordx4 v238, s[56:59], s27 offen offset:3072 sc1 lds
    s_add_u32 m0, s34, 81920
    s_mov_b32 s27, 3932160
    buffer_load_dwordx4 v238, s[56:59], s27 offen sc1 lds
    buffer_load_dwordx4 v238, s[56:59], s27 offen offset:1024 sc1 lds
    buffer_load_dwordx4 v238, s[56:59], s27 offen offset:2048 sc1 lds
    buffer_load_dwordx4 v238, s[56:59], s27 offen offset:3072 sc1 lds
    s_and_b32 s0, s2, 3
    s_lshl_b32 s0, s0, 1
    s_lshr_b32 s27, s1, 4
    s_add_u32 s0, s0, s27
    s_and_b32 s28, s55, 1
    s_lshl_b32 s28, s28, 2
    s_add_u32 s28, s28, s24
    s_xor_b32 s29, s55, 1
    s_mul_i32 s27, s0, 20
    s_mul_i32 s32, s29, 5
    s_add_u32 s27, s27, s32
    s_lshl_b32 s27, s27, 17
    s_lshl_b32 s32, s28, 14
    s_add_u32 s27, s27, s32
    s_add_u32 s12, s50, s27
    s_addc_u32 s13, s51, 0
    s_mov_b32 s14, 655360
    s_mov_b32 s15, 0x20000
    s_cmp_eq_u32 s29, 3
    s_cselect_b32 s14, 524288, s14
    s_xor_b32 s29, s55, 0
    s_mul_i32 s27, s0, 20
    s_mul_i32 s32, s29, 5
    s_add_u32 s27, s27, s32
    s_lshl_b32 s27, s27, 17
    s_lshl_b32 s32, s28, 14
    s_add_u32 s27, s27, s32
    s_add_u32 s20, s50, s27
    s_addc_u32 s21, s51, 0
    s_mov_b32 s22, 655360
    s_mov_b32 s23, 0x20000
    s_cmp_eq_u32 s29, 3
    s_cselect_b32 s22, 524288, s22
    s_lshr_b32 s27, s55, 1
    s_lshl_b32 s30, s0, 1
    s_add_u32 s30, s30, s27
    s_lshl_b32 s30, s30, 3
    s_add_u32 s30, s30, s28
    s_lshl_b32 s30, s30, 7
    v_and_b32 v255, 7, v237
    v_lshlrev_b32 v255, 2, v255
    s_mov_b32 s31, 0x40000
    v_mov_b32 v254, 1
    s_waitcnt vmcnt(0) lgkmcnt(0)
    buffer_store_dword v254, v253, s[60:63], s53 offen sc0 sc1
    s_branch L_merge
.section .rodata,"a"
.p2align 6
.amdhsa_kernel standalone__mha_block_cached__near_ridge_kernel
  .amdhsa_next_free_vgpr 512
  .amdhsa_next_free_sgpr 102
  .amdhsa_accum_offset 256
  .amdhsa_group_segment_fixed_size 0
  .amdhsa_kernarg_size 64
  .amdhsa_user_sgpr_count 2
  .amdhsa_user_sgpr_kernarg_segment_ptr 1
  .amdhsa_system_sgpr_workgroup_id_x 1
  .amdhsa_float_denorm_mode_32 3
.end_amdhsa_kernel
```
